```python
import torch

def _softmax(x, axis=-1):
    return torch.softmax(x, dim=axis)
def _gelu(x):
    return torch.nn.functional.gelu(x, approximate="tanh")
def _silu(x):
    return torch.nn.functional.silu(x)
def _sigmoid(x):
    return torch.sigmoid(x)
def _layernorm(x, axis=-1, eps=1e-5):
    m = x.mean(dim=axis, keepdim=True)
    v = x.var(dim=axis, keepdim=True, unbiased=False)
    return (x - m) / torch.sqrt(v + eps)
def _scatter_add(tgt, idx, src, axis=0):
    return tgt.clone().index_add_(axis, idx, src)
def _segment_sum(src, seg, n):
    out = torch.zeros((n,) + src.shape[1:], dtype=src.dtype)
    return out.index_add_(0, seg, src)
def _pad(x, pw):
    flat = tuple(v for pair in reversed(pw) for v in pair)
    return torch.nn.functional.pad(x, flat)

kernel_name = 'concat_heads__gqa_block_cached__gqa_block_cached__near_ridge'

def setup_inputs():

    _w = (lambda a: (lambda t: t.to(torch.bfloat16) if t.is_floating_point() else t)(torch.as_tensor(a)))
    def _A_setup():
        B, Sq, D = 16, 96, 640
        Hq, Hkv, Sk, Dh = 32, 32, 512, 192
        assert Hq % Hkv == 0, (Hq, Hkv)
        return {
            "x": _w((lambda *s: torch.randn(*s, dtype=torch.bfloat16) * 0.8)(B, Sq, D)),
            "k_cache": _w((lambda *s: torch.randn(*s, dtype=torch.bfloat16) * 0.8)(B, Hkv, Sk, Dh)),
            "v_cache": _w((lambda *s: torch.randn(*s, dtype=torch.bfloat16) * 0.05)(B, Hkv, Sk, Dh)),
            "wq": _w((lambda *s: torch.randn(*s, dtype=torch.bfloat16) * 0.8)(D, Hq * Dh) * (D ** -0.5)),
            "wo": _w((lambda *s: torch.randn(*s, dtype=torch.bfloat16) * 0.05)(Hq * Dh, D) * ((Hq * Dh) ** -0.5)),
        }
    _A_in = _A_setup()

    def _B_setup():
        B, Sq, D = 16, 96, 640
        Hq, Hkv, Sk, Dh = 32, 32, 512, 192
        assert Hq % Hkv == 0, (Hq, Hkv)
        return {
            "x": _w((lambda *s: torch.randn(*s, dtype=torch.bfloat16) * 0.8)(B, Sq, D)),
            "k_cache": _w((lambda *s: torch.randn(*s, dtype=torch.bfloat16) * 0.8)(B, Hkv, Sk, Dh)),
            "v_cache": _w((lambda *s: torch.randn(*s, dtype=torch.bfloat16) * 0.05)(B, Hkv, Sk, Dh)),
            "wq": _w((lambda *s: torch.randn(*s, dtype=torch.bfloat16) * 0.8)(D, Hq * Dh) * (D ** -0.5)),
            "wo": _w((lambda *s: torch.randn(*s, dtype=torch.bfloat16) * 0.05)(Hq * Dh, D) * ((Hq * Dh) ** -0.5)),
        }
    _B_in = _B_setup()

    return {
        "A_x": _A_in["x"],
        "A_k_cache": _A_in["k_cache"],
        "A_v_cache": _A_in["v_cache"],
        "A_wq": _A_in["wq"],
        "A_wo": _A_in["wo"],
        "B_x": _B_in["x"],
        "B_k_cache": _B_in["k_cache"],
        "B_v_cache": _B_in["v_cache"],
        "B_wq": _B_in["wq"],
        "B_wo": _B_in["wo"],
    }

def reference(A_x, A_k_cache, A_v_cache, A_wq, A_wo, B_x, B_k_cache, B_v_cache, B_wq, B_wo):
    def _A_ref(x, k_cache, v_cache, wq, wo):
        B, Sq, D = x.shape
        Hq, Dh = 32, 192
        Hkv = k_cache.shape[1]
        rep = Hq // Hkv
        q = (lambda x, *d: x.permute(*d))((x @ wq).reshape(B, Sq, Hq, Dh), 0, 2, 1, 3)
        k = (lambda x, n, axis: torch.repeat_interleave(x, n, dim=axis))(k_cache, rep, axis=1)
        v = (lambda x, n, axis: torch.repeat_interleave(x, n, dim=axis))(v_cache, rep, axis=1)
        scores = torch.einsum("bhqd,bhkd->bhqk", q, k) * (Dh ** -0.5)
        p = _softmax(scores, axis=-1)
        o = torch.einsum("bhqk,bhkd->bhqd", p, v)
        return (lambda x, *d: x.permute(*d))(o, 0, 2, 1, 3).reshape(B, Sq, Hq * Dh) @ wo

    def _B_ref(x, k_cache, v_cache, wq, wo):
        B, Sq, D = x.shape
        Hq, Dh = 32, 192
        Hkv = k_cache.shape[1]
        rep = Hq // Hkv
        q = (lambda x, *d: x.permute(*d))((x @ wq).reshape(B, Sq, Hq, Dh), 0, 2, 1, 3)
        k = (lambda x, n, axis: torch.repeat_interleave(x, n, dim=axis))(k_cache, rep, axis=1)
        v = (lambda x, n, axis: torch.repeat_interleave(x, n, dim=axis))(v_cache, rep, axis=1)
        scores = torch.einsum("bhqd,bhkd->bhqk", q, k) * (Dh ** -0.5)
        p = _softmax(scores, axis=-1)
        o = torch.einsum("bhqk,bhkd->bhqd", p, v)
        return (lambda x, *d: x.permute(*d))(o, 0, 2, 1, 3).reshape(B, Sq, Hq * Dh) @ wo

    a = _A_ref(A_x, A_k_cache, A_v_cache, A_wq, A_wo)
    b = _B_ref(B_x, B_k_cache, B_v_cache, B_wq, B_wo)
    return torch.concatenate([a, b], axis=-1)
```

```asm
; @launch grid=(256,1,1) block=(256,1,1) lds=159744
.amdgcn_target "amdgcn-amd-amdhsa--gfx950"
.macro m16 d, a, b, c
 v_mfma_f32_16x16x32_bf16 \d, \a, \b, \c
.endm
.macro m32 d, a, b, c
 v_mfma_f32_32x32x16_bf16 \d, \a, \b, \c
.endm
.macro rtr d, a, o=0
 ds_read_b64_tr_b16 \d, \a offset:\o
.endm
.macro cvt d, a, b
 v_cvt_pk_bf16_f32 \d, \a, \b
.endm
.macro HK0
 buffer_load_dwordx4 v16, s[8:11], s52 offen nt lds
.endm
.macro HK1
 buffer_load_dwordx4 v17, s[8:11], s52 offen offset:1024 nt lds
.endm
.macro HK2
 buffer_load_dwordx4 v18, s[8:11], s52 offen offset:2048 nt lds
.endm
.macro HK3
 buffer_load_dwordx4 v19, s[8:11], s52 offen offset:3072 nt lds
.endm
.macro HK4
 buffer_load_dwordx4 v20, s[8:11], s52 offen nt lds
.endm
.macro HK5
 buffer_load_dwordx4 v21, s[8:11], s52 offen offset:1024 nt lds
.endm
.macro HK6
 buffer_load_dwordx4 v22, s[8:11], s52 offen offset:2048 nt lds
.endm
.macro HK7
 buffer_load_dwordx4 v23, s[8:11], s52 offen offset:3072 nt lds
.endm
.macro HK8
 buffer_load_dwordx4 v24, s[8:11], s52 offen nt lds
.endm
.macro HK9
 buffer_load_dwordx4 v25, s[8:11], s52 offen offset:1024 nt lds
.endm
.macro HK10
 buffer_load_dwordx4 v26, s[8:11], s52 offen offset:2048 nt lds
.endm
.macro HK11
 buffer_load_dwordx4 v27, s[8:11], s52 offen offset:3072 nt lds
.endm
.macro HV0
 buffer_load_dwordx4 v28, s[12:15], s53 offen nt lds
.endm
.macro HV1
 buffer_load_dwordx4 v29, s[12:15], s53 offen offset:1024 nt lds
.endm
.macro HV2
 buffer_load_dwordx4 v30, s[12:15], s53 offen offset:2048 nt lds
.endm
.macro HV3
 buffer_load_dwordx4 v31, s[12:15], s53 offen offset:3072 nt lds
.endm
.macro HV4
 buffer_load_dwordx4 v32, s[12:15], s53 offen nt lds
.endm
.macro HV5
 buffer_load_dwordx4 v33, s[12:15], s53 offen offset:1024 nt lds
.endm
.macro HV6
 buffer_load_dwordx4 v34, s[12:15], s53 offen offset:2048 nt lds
.endm
.macro HV7
 buffer_load_dwordx4 v35, s[12:15], s53 offen offset:3072 nt lds
.endm
.macro HV8
 buffer_load_dwordx4 v36, s[12:15], s53 offen nt lds
.endm
.macro HV9
 buffer_load_dwordx4 v37, s[12:15], s53 offen offset:1024 nt lds
.endm
.macro HV10
 buffer_load_dwordx4 v38, s[12:15], s53 offen offset:2048 nt lds
.endm
.macro HV11
 buffer_load_dwordx4 v39, s[12:15], s53 offen offset:3072 nt lds
.endm
.macro HWQ0
 buffer_load_dwordx4 v40, s[16:19], s54 offen lds
.endm
.macro HWQ1
 buffer_load_dwordx4 v41, s[16:19], s54 offen offset:1024 lds
.endm
.macro HWQ2
 buffer_load_dwordx4 v42, s[16:19], s54 offen offset:2048 lds
.endm
.macro HWQ3
 buffer_load_dwordx4 v43, s[16:19], s54 offen offset:3072 lds
.endm
.macro HWQ4
 buffer_load_dwordx4 v44, s[16:19], s54 offen lds
.endm
.macro HWQ5
 buffer_load_dwordx4 v45, s[16:19], s54 offen offset:1024 lds
.endm
.macro HWQ6
 buffer_load_dwordx4 v46, s[16:19], s54 offen offset:2048 lds
.endm
.macro HWQ7
 buffer_load_dwordx4 v47, s[16:19], s54 offen offset:3072 lds
.endm
.macro HWQ8
 buffer_load_dwordx4 v48, s[16:19], s54 offen lds
.endm
.macro HWQ9
 buffer_load_dwordx4 v49, s[16:19], s54 offen offset:1024 lds
.endm
.macro HWQ10
 buffer_load_dwordx4 v50, s[16:19], s54 offen offset:2048 lds
.endm
.macro HWQ11
 buffer_load_dwordx4 v51, s[16:19], s54 offen offset:3072 lds
.endm
.macro HX0
 buffer_load_dwordx4 v52, s[20:23], s55 offen lds
.endm
.macro HX1
 buffer_load_dwordx4 v53, s[20:23], s55 offen offset:1024 lds
.endm
.macro HX2
 buffer_load_dwordx4 v54, s[20:23], s55 offen offset:2048 lds
.endm
.macro HX3
 buffer_load_dwordx4 v55, s[20:23], s55 offen offset:3072 lds
.endm
.macro HX4
 buffer_load_dwordx4 v56, s[20:23], s55 offen lds
.endm
.macro HX5
 buffer_load_dwordx4 v57, s[20:23], s55 offen offset:1024 lds
.endm
.macro HX6
 buffer_load_dwordx4 v58, s[20:23], s55 offen offset:2048 lds
.endm
.macro HX7
 buffer_load_dwordx4 v59, s[20:23], s55 offen offset:3072 lds
.endm
.macro HX8
 buffer_load_dwordx4 v60, s[20:23], s55 offen lds
.endm
.macro HX9
 buffer_load_dwordx4 v61, s[20:23], s55 offen offset:1024 lds
.endm
.macro HX10
 buffer_load_dwordx4 v62, s[20:23], s55 offen offset:2048 lds
.endm
.macro HX11
 buffer_load_dwordx4 v63, s[20:23], s55 offen offset:3072 lds
.endm
.macro HWO0
 buffer_load_dwordx4 v64, s[24:27], s56 offen lds
.endm
.macro HWO1
 buffer_load_dwordx4 v65, s[24:27], s56 offen offset:1024 lds
.endm
.macro HWO2
 buffer_load_dwordx4 v66, s[24:27], s56 offen offset:2048 lds
.endm
.macro HWO3
 buffer_load_dwordx4 v67, s[24:27], s56 offen offset:3072 lds
.endm
.macro HWO4
 buffer_load_dwordx4 v68, s[24:27], s56 offen lds
.endm
.macro HWO5
 buffer_load_dwordx4 v69, s[24:27], s56 offen offset:1024 lds
.endm
.macro HWO6
 buffer_load_dwordx4 v70, s[24:27], s56 offen offset:2048 lds
.endm
.macro HWO7
 buffer_load_dwordx4 v71, s[24:27], s56 offen offset:3072 lds
.endm
.macro HWO8
 buffer_load_dwordx4 v72, s[24:27], s56 offen lds
.endm
.macro HWO9
 buffer_load_dwordx4 v73, s[24:27], s56 offen offset:1024 lds
.endm
.macro HWO10
 buffer_load_dwordx4 v74, s[24:27], s56 offen offset:2048 lds
.endm
.macro HWO11
 buffer_load_dwordx4 v75, s[24:27], s56 offen offset:3072 lds
.endm
.macro HU0
 buffer_load_dwordx4 v40, s[16:19], s59 offen lds
.endm
.macro HU1
 buffer_load_dwordx4 v41, s[16:19], s59 offen offset:1024 lds
.endm
.macro HU2
 buffer_load_dwordx4 v42, s[16:19], s59 offen offset:2048 lds
.endm
.macro HU3
 buffer_load_dwordx4 v43, s[16:19], s59 offen offset:3072 lds
.endm
.macro HU4
 buffer_load_dwordx4 v44, s[16:19], s59 offen lds
.endm
.macro HU5
 buffer_load_dwordx4 v45, s[16:19], s59 offen offset:1024 lds
.endm
.macro HU6
 buffer_load_dwordx4 v46, s[16:19], s59 offen offset:2048 lds
.endm
.macro HU7
 buffer_load_dwordx4 v47, s[16:19], s59 offen offset:3072 lds
.endm
.macro HU8
 buffer_load_dwordx4 v48, s[16:19], s59 offen lds
.endm
.macro HU9
 buffer_load_dwordx4 v49, s[16:19], s59 offen offset:1024 lds
.endm
.macro HU10
 buffer_load_dwordx4 v50, s[16:19], s59 offen offset:2048 lds
.endm
.macro HU11
 buffer_load_dwordx4 v51, s[16:19], s59 offen offset:3072 lds
.endm
.macro HY0
 buffer_load_dwordx4 v52, s[20:23], s86 offen lds
.endm
.macro HY1
 buffer_load_dwordx4 v53, s[20:23], s86 offen offset:1024 lds
.endm
.macro HY2
 buffer_load_dwordx4 v54, s[20:23], s86 offen offset:2048 lds
.endm
.macro HY3
 buffer_load_dwordx4 v55, s[20:23], s86 offen offset:3072 lds
.endm
.macro HY4
 buffer_load_dwordx4 v56, s[20:23], s86 offen lds
.endm
.macro HY5
 buffer_load_dwordx4 v57, s[20:23], s86 offen offset:1024 lds
.endm
.macro HY6
 buffer_load_dwordx4 v58, s[20:23], s86 offen offset:2048 lds
.endm
.macro HY7
 buffer_load_dwordx4 v59, s[20:23], s86 offen offset:3072 lds
.endm
.macro HY8
 buffer_load_dwordx4 v60, s[20:23], s86 offen lds
.endm
.macro HY9
 buffer_load_dwordx4 v61, s[20:23], s86 offen offset:1024 lds
.endm
.macro HY10
 buffer_load_dwordx4 v62, s[20:23], s86 offen offset:2048 lds
.endm
.macro HY11
 buffer_load_dwordx4 v63, s[20:23], s86 offen offset:3072 lds
.endm
.macro GK0 slot, adv
 s_mov_b32 m0, \slot+0
 s_nop 0
 buffer_load_dwordx4 v16, s[8:11], s52 offen nt lds
 buffer_load_dwordx4 v17, s[8:11], s52 offen offset:1024 nt lds
 buffer_load_dwordx4 v18, s[8:11], s52 offen offset:2048 nt lds
 buffer_load_dwordx4 v19, s[8:11], s52 offen offset:3072 nt lds
.endm
.macro GK1 slot, adv
 s_mov_b32 m0, \slot+4096
 s_nop 0
 buffer_load_dwordx4 v20, s[8:11], s52 offen nt lds
 buffer_load_dwordx4 v21, s[8:11], s52 offen offset:1024 nt lds
 buffer_load_dwordx4 v22, s[8:11], s52 offen offset:2048 nt lds
 buffer_load_dwordx4 v23, s[8:11], s52 offen offset:3072 nt lds
.endm
.macro GK2 slot, adv
 s_mov_b32 m0, \slot+8192
 s_nop 0
 buffer_load_dwordx4 v24, s[8:11], s52 offen nt lds
 buffer_load_dwordx4 v25, s[8:11], s52 offen offset:1024 nt lds
 buffer_load_dwordx4 v26, s[8:11], s52 offen offset:2048 nt lds
 buffer_load_dwordx4 v27, s[8:11], s52 offen offset:3072 nt lds
 s_add_u32 s52, s52, \adv
.endm
.macro TK slot, adv
 GK0 \slot, 0
 GK1 \slot, 0
 GK2 \slot, \adv
.endm
.macro GV0 slot, adv
 s_mov_b32 m0, \slot+0
 s_nop 0
 buffer_load_dwordx4 v28, s[12:15], s53 offen nt lds
 buffer_load_dwordx4 v29, s[12:15], s53 offen offset:1024 nt lds
 buffer_load_dwordx4 v30, s[12:15], s53 offen offset:2048 nt lds
 buffer_load_dwordx4 v31, s[12:15], s53 offen offset:3072 nt lds
.endm
.macro GV1 slot, adv
 s_mov_b32 m0, \slot+4096
 s_nop 0
 buffer_load_dwordx4 v32, s[12:15], s53 offen nt lds
 buffer_load_dwordx4 v33, s[12:15], s53 offen offset:1024 nt lds
 buffer_load_dwordx4 v34, s[12:15], s53 offen offset:2048 nt lds
 buffer_load_dwordx4 v35, s[12:15], s53 offen offset:3072 nt lds
.endm
.macro GV2 slot, adv
 s_mov_b32 m0, \slot+8192
 s_nop 0
 buffer_load_dwordx4 v36, s[12:15], s53 offen nt lds
 buffer_load_dwordx4 v37, s[12:15], s53 offen offset:1024 nt lds
 buffer_load_dwordx4 v38, s[12:15], s53 offen offset:2048 nt lds
 buffer_load_dwordx4 v39, s[12:15], s53 offen offset:3072 nt lds
 s_add_u32 s53, s53, \adv
.endm
.macro TV slot, adv
 GV0 \slot, 0
 GV1 \slot, 0
 GV2 \slot, \adv
.endm
.macro GWQ0 slot, adv
 s_mov_b32 m0, \slot+0
 s_nop 0
 buffer_load_dwordx4 v40, s[16:19], s54 offen lds
 buffer_load_dwordx4 v41, s[16:19], s54 offen offset:1024 lds
 buffer_load_dwordx4 v42, s[16:19], s54 offen offset:2048 lds
 buffer_load_dwordx4 v43, s[16:19], s54 offen offset:3072 lds
.endm
.macro GWQ1 slot, adv
 s_mov_b32 m0, \slot+4096
 s_nop 0
 buffer_load_dwordx4 v44, s[16:19], s54 offen lds
 buffer_load_dwordx4 v45, s[16:19], s54 offen offset:1024 lds
 buffer_load_dwordx4 v46, s[16:19], s54 offen offset:2048 lds
 buffer_load_dwordx4 v47, s[16:19], s54 offen offset:3072 lds
.endm
.macro GWQ2 slot, adv
 s_mov_b32 m0, \slot+8192
 s_nop 0
 buffer_load_dwordx4 v48, s[16:19], s54 offen lds
 buffer_load_dwordx4 v49, s[16:19], s54 offen offset:1024 lds
 buffer_load_dwordx4 v50, s[16:19], s54 offen offset:2048 lds
 buffer_load_dwordx4 v51, s[16:19], s54 offen offset:3072 lds
 s_add_u32 s54, s54, \adv
 s_sub_u32 s46, s54, 7864320
 s_cmp_ge_u32 s54, 7864320
 s_cselect_b32 s54, s46, s54
.endm
.macro TWQ slot, adv
 GWQ0 \slot, 0
 GWQ1 \slot, 0
 GWQ2 \slot, \adv
.endm
.macro GX0 slot, adv
 s_mov_b32 m0, \slot+0
 s_nop 0
 buffer_load_dwordx4 v52, s[20:23], s55 offen lds
 buffer_load_dwordx4 v53, s[20:23], s55 offen offset:1024 lds
 buffer_load_dwordx4 v54, s[20:23], s55 offen offset:2048 lds
 buffer_load_dwordx4 v55, s[20:23], s55 offen offset:3072 lds
.endm
.macro GX1 slot, adv
 s_mov_b32 m0, \slot+4096
 s_nop 0
 buffer_load_dwordx4 v56, s[20:23], s55 offen lds
 buffer_load_dwordx4 v57, s[20:23], s55 offen offset:1024 lds
 buffer_load_dwordx4 v58, s[20:23], s55 offen offset:2048 lds
 buffer_load_dwordx4 v59, s[20:23], s55 offen offset:3072 lds
.endm
.macro GX2 slot, adv
 s_mov_b32 m0, \slot+8192
 s_nop 0
 buffer_load_dwordx4 v60, s[20:23], s55 offen lds
 buffer_load_dwordx4 v61, s[20:23], s55 offen offset:1024 lds
 buffer_load_dwordx4 v62, s[20:23], s55 offen offset:2048 lds
 buffer_load_dwordx4 v63, s[20:23], s55 offen offset:3072 lds
 s_add_u32 s55, s55, \adv
 s_sub_u32 s46, s55, 1280
 s_cmp_ge_u32 s55, s57
 s_cselect_b32 s55, s46, s55
.endm
.macro TX slot, adv
 GX0 \slot, 0
 GX1 \slot, 0
 GX2 \slot, \adv
.endm
.macro GWO0 slot, adv
 s_mov_b32 m0, \slot+0
 s_nop 0
 buffer_load_dwordx4 v64, s[24:27], s56 offen lds
 buffer_load_dwordx4 v65, s[24:27], s56 offen offset:1024 lds
 buffer_load_dwordx4 v66, s[24:27], s56 offen offset:2048 lds
 buffer_load_dwordx4 v67, s[24:27], s56 offen offset:3072 lds
.endm
.macro GWO1 slot, adv
 s_mov_b32 m0, \slot+4096
 s_nop 0
 buffer_load_dwordx4 v68, s[24:27], s56 offen lds
 buffer_load_dwordx4 v69, s[24:27], s56 offen offset:1024 lds
 buffer_load_dwordx4 v70, s[24:27], s56 offen offset:2048 lds
 buffer_load_dwordx4 v71, s[24:27], s56 offen offset:3072 lds
.endm
.macro GWO2 slot, adv
 s_mov_b32 m0, \slot+8192
 s_nop 0
 buffer_load_dwordx4 v72, s[24:27], s56 offen lds
 buffer_load_dwordx4 v73, s[24:27], s56 offen offset:1024 lds
 buffer_load_dwordx4 v74, s[24:27], s56 offen offset:2048 lds
 buffer_load_dwordx4 v75, s[24:27], s56 offen offset:3072 lds
 s_add_u32 s56, s56, \adv
.endm
.macro TWO slot, adv
 GWO0 \slot, 0
 GWO1 \slot, 0
 GWO2 \slot, \adv
.endm
.macro GU0 slot, adv
 s_mov_b32 m0, \slot+0
 s_nop 0
 buffer_load_dwordx4 v40, s[16:19], s59 offen lds
 buffer_load_dwordx4 v41, s[16:19], s59 offen offset:1024 lds
 buffer_load_dwordx4 v42, s[16:19], s59 offen offset:2048 lds
 buffer_load_dwordx4 v43, s[16:19], s59 offen offset:3072 lds
.endm
.macro GU1 slot, adv
 s_mov_b32 m0, \slot+4096
 s_nop 0
 buffer_load_dwordx4 v44, s[16:19], s59 offen lds
 buffer_load_dwordx4 v45, s[16:19], s59 offen offset:1024 lds
 buffer_load_dwordx4 v46, s[16:19], s59 offen offset:2048 lds
 buffer_load_dwordx4 v47, s[16:19], s59 offen offset:3072 lds
.endm
.macro GU2 slot, adv
 s_mov_b32 m0, \slot+8192
 s_nop 0
 buffer_load_dwordx4 v48, s[16:19], s59 offen lds
 buffer_load_dwordx4 v49, s[16:19], s59 offen offset:1024 lds
 buffer_load_dwordx4 v50, s[16:19], s59 offen offset:2048 lds
 buffer_load_dwordx4 v51, s[16:19], s59 offen offset:3072 lds
 s_add_u32 s59, s59, \adv
 s_sub_u32 s46, s59, 7864320
 s_cmp_ge_u32 s59, 7864320
 s_cselect_b32 s59, s46, s59
.endm
.macro TU slot, adv
 GU0 \slot, 0
 GU1 \slot, 0
 GU2 \slot, \adv
.endm
.macro GY0 slot, adv
 s_mov_b32 m0, \slot+0
 s_nop 0
 buffer_load_dwordx4 v52, s[20:23], s86 offen lds
 buffer_load_dwordx4 v53, s[20:23], s86 offen offset:1024 lds
 buffer_load_dwordx4 v54, s[20:23], s86 offen offset:2048 lds
 buffer_load_dwordx4 v55, s[20:23], s86 offen offset:3072 lds
.endm
.macro GY1 slot, adv
 s_mov_b32 m0, \slot+4096
 s_nop 0
 buffer_load_dwordx4 v56, s[20:23], s86 offen lds
 buffer_load_dwordx4 v57, s[20:23], s86 offen offset:1024 lds
 buffer_load_dwordx4 v58, s[20:23], s86 offen offset:2048 lds
 buffer_load_dwordx4 v59, s[20:23], s86 offen offset:3072 lds
.endm
.macro GY2 slot, adv
 s_mov_b32 m0, \slot+8192
 s_nop 0
 buffer_load_dwordx4 v60, s[20:23], s86 offen lds
 buffer_load_dwordx4 v61, s[20:23], s86 offen offset:1024 lds
 buffer_load_dwordx4 v62, s[20:23], s86 offen offset:2048 lds
 buffer_load_dwordx4 v63, s[20:23], s86 offen offset:3072 lds
 s_add_u32 s86, s86, \adv
 s_sub_u32 s46, s86, 1280
 s_cmp_ge_u32 s86, s57
 s_cselect_b32 s86, s46, s86
.endm
.macro TY slot, adv
 GY0 \slot, 0
 GY1 \slot, 0
 GY2 \slot, \adv
.endm
.text
.globl concat_heads__gqa_block_cached__gqa_block_cached__near_ridge_kernel
.p2align 8
.type concat_heads__gqa_block_cached__gqa_block_cached__near_ridge_kernel,@function
concat_heads__gqa_block_cached__gqa_block_cached__near_ridge_kernel:
 s_cmp_ge_u32 s2, 256
 s_cbranch_scc1 EXIT
 s_load_dwordx16 s[64:79], s[0:1], 0
 s_load_dwordx4 s[80:83], s[0:1], 64
 s_load_dwordx2 s[84:85], s[0:1], 96
 s_load_dwordx4 s[60:63], s[0:1], 80
 v_lshrrev_b32 v1, 6, v0
 s_nop 0
 v_readfirstlane_b32 s32, v1
 s_and_b32 s46, s2, 7
 s_lshr_b32 s47, s2, 3
 s_and_b32 s33, s47, 15
 s_lshr_b32 s47, s47, 4
 s_lshr_b32 s35, s46, 2
 s_and_b32 s46, s46, 3
 s_lshl_b32 s34, s46, 1
 s_add_u32 s34, s34, s47
 s_lshl_b32 s40, s35, 4
 s_add_u32 s40, s40, s33
 v_mov_b32 v100, v0
 v_and_b32 v1, 63, v0
 v_lshrrev_b32 v2, 3, v1
 v_add_u32 v2, 0, v2
 v_bfe_u32 v3, v2, 1, 3
 v_and_b32 v4, 7, v1
 v_xor_b32 v3, v3, v4
 v_mul_u32_u24 v2, 1280, v2
 v_lshl_add_u32 v5, v3, 4, v2
 v_lshrrev_b32 v2, 3, v1
 v_add_u32 v2, 8, v2
 v_bfe_u32 v3, v2, 1, 3
 v_and_b32 v4, 7, v1
 v_xor_b32 v3, v3, v4
 v_mul_u32_u24 v2, 1280, v2
 v_lshl_add_u32 v6, v3, 4, v2
 v_add_u32 v52, 0, v5
 v_add_u32 v53, -1024, v6
 v_add_u32 v54, 18432, v5
 v_add_u32 v55, 17408, v6
 v_add_u32 v56, 40960, v5
 v_add_u32 v57, 39936, v6
 v_add_u32 v58, 59392, v5
 v_add_u32 v59, 58368, v6
 v_add_u32 v60, 81920, v5
 v_add_u32 v61, 80896, v6
 v_add_u32 v62, 100352, v5
 v_add_u32 v63, 99328, v6
 s_lshl_b32 s46, s33, 3
 s_add_u32 s46, s46, s34
 s_mul_i32 s52, s46, 786432
 s_mov_b32 s53, s52
 s_mul_i32 s56, s34, 983040
 s_mul_i32 s58, s33, 15360
 s_add_u32 s58, s58, s56
 s_mul_i32 s4, s33, 24576
 s_mul_i32 s46, s34, 1536
 s_add_u32 s4, s4, s46
 s_mul_i32 s47, s33, 10
 s_lshr_b32 s47, s47, 4
 s_and_b32 s46, s34, 1
 s_mul_i32 s46, s46, 5
 s_add_u32 s47, s47, s46
 s_lshr_b32 s46, s34, 8
 s_add_u32 s47, s47, s46
 s_sub_u32 s46, s47, 10
 s_cmp_ge_u32 s47, 10
 s_cselect_b32 s47, s46, s47
 s_mul_i32 s54, s47, 786432
 s_mul_i32 s46, s34, 1536
 s_add_u32 s54, s54, s46
 s_mul_i32 s57, s33, 122880
 s_lshl_b32 s47, s47, 7
 s_add_u32 s55, s57, s47
 s_add_u32 s57, s57, 1280
 s_mul_i32 s5, s34, 1536
 s_add_u32 s59, s5, 768
 s_sub_u32 s86, s57, 128
 v_add_u32 v2, 0, v1
 v_mul_u32_u24 v3, 2731, v2
 v_lshrrev_b32 v82, 16, v3
 v_mul_u32_u24 v3, 24, v82
 v_sub_u32 v88, v2, v3
 v_add_u32 v2, 64, v1
 v_mul_u32_u24 v3, 2731, v2
 v_lshrrev_b32 v83, 16, v3
 v_mul_u32_u24 v3, 24, v83
 v_sub_u32 v89, v2, v3
 v_add_u32 v2, 128, v1
 v_mul_u32_u24 v3, 2731, v2
 v_lshrrev_b32 v84, 16, v3
 v_mul_u32_u24 v3, 24, v84
 v_sub_u32 v90, v2, v3
 v_bfe_u32 v2, v82, 1, 1
 v_lshlrev_b32 v2, 2, v2
 v_xor_b32 v94, v2, v88
 v_mul_u32_u24 v3, 12288, v82
 v_lshl_add_u32 v5, v94, 4, v3
 v_bfe_u32 v2, v83, 1, 1
 v_lshlrev_b32 v2, 2, v2
 v_xor_b32 v95, v2, v89
 v_mul_u32_u24 v3, 12288, v83
 v_lshl_add_u32 v6, v95, 4, v3
 v_bfe_u32 v2, v84, 1, 1
 v_lshlrev_b32 v2, 2, v2
 v_xor_b32 v96, v2, v90
 v_mul_u32_u24 v3, 12288, v84
 v_lshl_add_u32 v7, v96, 4, v3
 v_add_u32 v40, 0, v5
 v_add_u32 v41, -1024, v6
 v_add_u32 v42, -2048, v7
 v_add_u32 v43, 95232, v5
 v_add_u32 v44, 98304, v6
 v_add_u32 v45, 97280, v7
 v_add_u32 v46, 194560, v5
 v_add_u32 v47, 193536, v6
 v_add_u32 v48, 196608, v7
 v_add_u32 v49, 293888, v5
 v_add_u32 v50, 292864, v6
 v_add_u32 v51, 291840, v7
 s_waitcnt lgkmcnt(0)
 s_cmp_eq_u32 s35, 0
 s_cselect_b64 s[20:21], s[64:65], s[74:75]
 s_mov_b32 s22, 1966080
 s_mov_b32 s23, 0x20000
 s_cselect_b64 s[8:9], s[66:67], s[76:77]
 s_mov_b32 s10, 100663296
 s_mov_b32 s11, 0x20000
 s_cselect_b64 s[12:13], s[68:69], s[78:79]
 s_mov_b32 s14, 100663296
 s_mov_b32 s15, 0x20000
 s_cselect_b64 s[16:17], s[70:71], s[80:81]
 s_mov_b32 s18, 7864320
 s_mov_b32 s19, 0x20000
 s_cselect_b64 s[24:25], s[72:73], s[82:83]
 s_mov_b32 s26, 7864320
 s_mov_b32 s27, 0x20000
 s_mov_b64 s[28:29], s[84:85]
 s_mov_b32 s30, 33587200
 s_mov_b32 s31, 0x20000
 s_mov_b64 s[88:89], s[60:61]
 s_mov_b32 s90, 3932160
 s_mov_b32 s91, 0x20000
 s_mov_b64 s[92:93], s[62:63]
 s_mov_b32 s94, 256
 s_mov_b32 s95, 0x20000
 s_cmp_lg_u32 s32, 3
 s_cbranch_scc1 AW
LOADER:
 TX 122880, 128
 TWQ 0, 393216
 TWQ 12288, 393216
 v_add_u32 v2, 192, v1
 v_mul_u32_u24 v3, 2731, v2
 v_lshrrev_b32 v85, 16, v3
 v_mul_u32_u24 v3, 24, v85
 v_sub_u32 v91, v2, v3
 v_add_u32 v2, 256, v1
 v_mul_u32_u24 v3, 2731, v2
 v_lshrrev_b32 v86, 16, v3
 v_mul_u32_u24 v3, 24, v86
 v_sub_u32 v92, v2, v3
 v_add_u32 v2, 320, v1
 v_mul_u32_u24 v3, 2731, v2
 v_lshrrev_b32 v87, 16, v3
 v_mul_u32_u24 v3, 24, v87
 v_sub_u32 v93, v2, v3
 v_bfe_u32 v2, v82, 1, 1
 v_bfe_u32 v3, v82, 2, 1
 v_lshl_add_u32 v2, v2, 1, v3
 v_bfe_u32 v3, v82, 3, 1
 v_lshl_add_u32 v2, v3, 2, v2
 v_xor_b32 v2, v2, v88
 v_mul_u32_u24 v3, 384, v82
 v_lshl_add_u32 v5, v2, 4, v3
 v_bfe_u32 v2, v83, 1, 1
 v_bfe_u32 v3, v83, 2, 1
 v_lshl_add_u32 v2, v2, 1, v3
 v_bfe_u32 v3, v83, 3, 1
 v_lshl_add_u32 v2, v3, 2, v2
 v_xor_b32 v2, v2, v89
 v_mul_u32_u24 v3, 384, v83
 v_lshl_add_u32 v6, v2, 4, v3
 v_bfe_u32 v2, v84, 1, 1
 v_bfe_u32 v3, v84, 2, 1
 v_lshl_add_u32 v2, v2, 1, v3
 v_bfe_u32 v3, v84, 3, 1
 v_lshl_add_u32 v2, v3, 2, v2
 v_xor_b32 v2, v2, v90
 v_mul_u32_u24 v3, 384, v84
 v_lshl_add_u32 v7, v2, 4, v3
 v_bfe_u32 v2, v85, 1, 1
 v_bfe_u32 v3, v85, 2, 1
 v_lshl_add_u32 v2, v2, 1, v3
 v_bfe_u32 v3, v85, 3, 1
 v_lshl_add_u32 v2, v3, 2, v2
 v_xor_b32 v2, v2, v91
 v_mul_u32_u24 v3, 384, v85
 v_lshl_add_u32 v8, v2, 4, v3
 v_bfe_u32 v2, v86, 1, 1
 v_bfe_u32 v3, v86, 2, 1
 v_lshl_add_u32 v2, v2, 1, v3
 v_bfe_u32 v3, v86, 3, 1
 v_lshl_add_u32 v2, v3, 2, v2
 v_xor_b32 v2, v2, v92
 v_mul_u32_u24 v3, 384, v86
 v_lshl_add_u32 v9, v2, 4, v3
 v_bfe_u32 v2, v87, 1, 1
 v_bfe_u32 v3, v87, 2, 1
 v_lshl_add_u32 v2, v2, 1, v3
 v_bfe_u32 v3, v87, 3, 1
 v_lshl_add_u32 v2, v3, 2, v2
 v_xor_b32 v2, v2, v93
 v_mul_u32_u24 v3, 384, v87
 v_lshl_add_u32 v10, v2, 4, v3
 v_add_u32 v16, 0, v5
 v_add_u32 v17, -1024, v6
 v_add_u32 v18, -2048, v7
 v_add_u32 v19, -3072, v8
 v_add_u32 v20, 0, v9
 v_add_u32 v21, -1024, v10
 v_add_u32 v22, 4096, v5
 v_add_u32 v23, 3072, v6
 v_add_u32 v24, 6144, v7
 v_add_u32 v25, 5120, v8
 v_add_u32 v26, 4096, v9
 v_add_u32 v27, 3072, v10
 v_and_b32 v2, 6, v82
 v_xor_b32 v2, v2, v88
 v_mul_u32_u24 v3, 384, v82
 v_lshl_add_u32 v5, v2, 4, v3
 v_and_b32 v2, 6, v83
 v_xor_b32 v2, v2, v89
 v_mul_u32_u24 v3, 384, v83
 v_lshl_add_u32 v6, v2, 4, v3
 v_and_b32 v2, 6, v84
 v_xor_b32 v2, v2, v90
 v_mul_u32_u24 v3, 384, v84
 v_lshl_add_u32 v7, v2, 4, v3
 v_add_u32 v28, 0, v5
 v_add_u32 v29, -1024, v6
 v_add_u32 v30, -2048, v7
 v_add_u32 v31, 0, v5
 v_add_u32 v32, 3072, v6
 v_add_u32 v33, 2048, v7
 v_add_u32 v34, 4096, v5
 v_add_u32 v35, 3072, v6
 v_add_u32 v36, 6144, v7
 v_add_u32 v37, 8192, v5
 v_add_u32 v38, 7168, v6
 v_add_u32 v39, 6144, v7
 v_lshrrev_b32 v2, 3, v1
 v_and_b32 v3, 6, v2
 v_and_b32 v4, 7, v1
 v_xor_b32 v3, v3, v4
 v_mul_u32_u24 v2, 1280, v2
 v_lshl_add_u32 v5, v3, 4, v2
 v_add_u32 v64, 0, v5
 v_add_u32 v65, 9216, v5
 v_add_u32 v66, 18432, v5
 v_add_u32 v67, 27648, v5
 v_add_u32 v68, 40960, v5
 v_add_u32 v69, 50176, v5
 v_add_u32 v70, 59392, v5
 v_add_u32 v71, 68608, v5
 v_add_u32 v72, 81920, v5
 v_add_u32 v73, 91136, v5
 v_add_u32 v74, 100352, v5
 v_add_u32 v75, 109568, v5
 v_min_u32 v2, 23, v1
 v_mul_u32_u24 v3, 5462, v2
 v_lshrrev_b32 v3, 16, v3
 v_mul_u32_u24 v4, 12, v3
 v_sub_u32 v4, v2, v4
 v_mul_u32_u24 v4, 1280, v4
 v_lshl_add_u32 v76, v3, 7, v4
 v_min_u32 v2, 23, v1
 v_mul_u32_u24 v3, 21846, v2
 v_lshrrev_b32 v3, 16, v3
 v_mul_u32_u24 v4, 3, v3
 v_sub_u32 v4, v2, v4
 v_lshrrev_b32 v5, 1, v3
 v_and_b32 v3, 1, v3
 v_lshl_add_u32 v3, v5, 5, v3
 v_mul_u32_u24 v3, 12288, v3
 v_lshl_add_u32 v77, v4, 7, v3
 v_lshrrev_b32 v2, 4, v1
 v_bfe_u32 v3, v1, 1, 3
 v_and_b32 v4, 15, v1
 v_lshlrev_b32 v4, 7, v4
 v_add_u32 v4, 122880, v4
 v_add_u32 v5, 0, v2
 v_xor_b32 v5, v5, v3
 v_lshl_add_u32 v84, v5, 4, v4
 v_subrev_u32 v82, 122880, v84
 v_add_u32 v5, 4, v2
 v_xor_b32 v5, v5, v3
 v_lshl_add_u32 v85, v5, 4, v4
 v_subrev_u32 v83, 122880, v85
 v_bfe_u32 v3, v1, 2, 2
 v_lshl_add_u32 v4, v2, 3, v3
 v_mul_u32_u24 v4, 384, v4
 v_add_u32 v4, 122880, v4
 v_bfe_u32 v5, v1, 1, 1
 v_and_b32 v6, 1, v1
 v_lshl_add_u32 v5, v6, 1, v5
 v_lshlrev_b32 v5, 4, v5
 v_lshrrev_b32 v3, 1, v3
 v_xor_b32 v6, 0, v3
 v_lshlrev_b32 v6, 6, v6
 v_add3_u32 v80, v4, v5, v6
 v_xor_b32 v6, 1, v3
 v_lshlrev_b32 v6, 6, v6
 v_add3_u32 v81, v4, v5, v6
 v_lshlrev_b32 v86, 4, v1
 v_mov_b32 v12, 0x3dd53b95
 v_mov_b32 v13, v12
 v_add_u32 v86, 122880, v86
 s_getpc_b64 s[44:45]
CPL:
 s_sub_u32 s44, s44, CPL-LOADER
 s_subb_u32 s45, s45, 0
 s_lshr_b32 s46, s2, 3
 v_min_u32 v8, 7, v1
 v_lshlrev_b32 v8, 5, v8
 v_add_u32 v8, s46, v8
 v_lshlrev_b32 v8, 7, v8
 v_mov_b32 v9, s45
 v_add_co_u32 v8, vcc, s44, v8
 s_nop 1
 v_addc_co_u32 v9, vcc, 0, v9, vcc
 TX 36864, 128
 TX 24576, 128
 TX 98304, 128
 TX 110592, 128
 s_waitcnt vmcnt(60)
 s_barrier
 TWQ 135168, 393216
 TWQ 147456, 393216
 s_waitcnt vmcnt(60)
 s_barrier
 TWQ 0, 393216
 s_waitcnt vmcnt(24)
 s_barrier
 TWQ 12288, 393216
 TX 122880, 128
 s_waitcnt vmcnt(36)
 s_barrier
 TWQ 135168, 393216
 TK 49152, 12288
 TK 61440, 12288
 s_waitcnt vmcnt(60)
 s_barrier
 TWQ 147456, 393216
 TX 36864, 128
 s_waitcnt vmcnt(60)
 s_barrier
 TWQ 0, 393216
 s_waitcnt vmcnt(60)
 s_barrier
 TWQ 12288, 393216
 TX 24576, 128
 s_waitcnt vmcnt(48)
 s_barrier
 TWQ 135168, 393216
 s_waitcnt vmcnt(36)
 s_barrier
 TWQ 147456, 393216
 TK 73728, 12288
 TV 86016, 12288
 s_waitcnt vmcnt(60)
 s_barrier
 TWQ 0, 393216
 s_waitcnt vmcnt(48)
 s_barrier
 TWQ 12288, 393216
 s_waitcnt vmcnt(48)
 s_barrier
 TWQ 135168, 393216
 s_add_u32 s46, s4, 384
 buffer_load_dword v78, v77, s[16:19], s46 offen
 s_waitcnt vmcnt(25)
 s_barrier
 TWQ 147456, 393216
 TX 122880, 128
 s_waitcnt vmcnt(37)
 s_barrier
 TWQ 0, 393216
 TV 98304, 12288
 TV 110592, 12288
 s_add_u32 s46, s4, 768
 buffer_load_dword v78, v77, s[16:19], s46 offen
 s_waitcnt vmcnt(60)
 s_barrier
 TWQ 12288, 393216
 TX 36864, 128
 s_sub_u32 s55, s57, 1280
 s_waitcnt vmcnt(60)
 s_barrier
 TWQ 135168, 393216
 s_waitcnt vmcnt(60)
 s_barrier
 TWQ 147456, 393600
 s_add_u32 s54, s5, 384
 TX 24576, 128
 s_waitcnt vmcnt(48)
 s_barrier
 TWQ 0, 393216
 s_waitcnt vmcnt(36)
 s_barrier
 TWQ 12288, 393216
 TV 122880, 12288
 s_waitcnt vmcnt(48)
 s_barrier
 TU 135168, 393216
 s_barrier
 TX 36864, 128
 TU 147456, 393216
 s_add_u32 s46, s4, 1573248
 buffer_load_dword v78, v77, s[16:19], s46 offen
 s_waitcnt vmcnt(60)
 s_barrier
 ds_read_b128 v[88:91], v82 offset:24576
 ds_read_b128 v[92:95], v82 offset:26624
 ds_read_b128 v[96:99], v82 offset:28672
 ds_read_b128 v[100:103], v82 offset:30720
 ds_read_b128 v[104:107], v82 offset:32768
 ds_read_b128 v[108:111], v82 offset:34816
 ds_read_b128 v[112:115], v83 offset:24576
 ds_read_b128 v[116:119], v83 offset:26624
 ds_read_b128 v[120:123], v83 offset:28672
 ds_read_b128 v[124:127], v83 offset:30720
 ds_read_b128 v[128:131], v83 offset:32768
 ds_read_b128 v[132:135], v83 offset:34816
 TK 49152, 12288
 s_waitcnt lgkmcnt(0)
 s_waitcnt vmcnt(37)
 s_barrier
 rtr v[136:137], v80, 12288
 rtr v[138:139], v80, 13824
 rtr v[140:141], v80, 12296
 rtr v[142:143], v80, 13832
 rtr v[144:145], v81, 12288
 rtr v[146:147], v81, 13824
 s_mov_b32 m0, 0
 s_nop 0
 HWQ0
 HWQ1
 HWQ2
 HWQ3
 s_mov_b32 m0, 4096
 s_nop 0
 HWQ4
 HWQ5
 HWQ6
 s_waitcnt lgkmcnt(4)
 m16 a[0:3], v[136:139], v[88:91], 0
 HWQ7
 s_mov_b32 m0, 8192
 m16 a[8:11], v[136:139], v[92:95], 0
 HWQ8
 m16 a[96:99], v[136:139], v[96:99], 0
 HWQ9
 m16 a[104:107], v[136:139], v[100:103], 0
 HWQ10
 m16 a[192:195], v[136:139], v[104:107], 0
 HWQ11
 s_add_u32 s54, s54, 393216
 s_sub_u32 s46, s54, 7864320
 s_cmp_ge_u32 s54, 7864320
 s_cselect_b32 s54, s46, s54
 m16 a[200:203], v[136:139], v[108:111], 0
 s_waitcnt lgkmcnt(2)
 m16 a[4:7], v[140:143], v[88:91], 0
 m16 a[12:15], v[140:143], v[92:95], 0
 m16 a[100:103], v[140:143], v[96:99], 0
 m16 a[108:111], v[140:143], v[100:103], 0
 m16 a[196:199], v[140:143], v[104:107], 0
 m16 a[204:207], v[140:143], v[108:111], 0
 s_waitcnt lgkmcnt(0)
 m16 a[16:19], v[144:147], v[88:91], 0
 m16 a[24:27], v[144:147], v[92:95], 0
 m16 a[112:115], v[144:147], v[96:99], 0
 m16 a[120:123], v[144:147], v[100:103], 0
 m16 a[208:211], v[144:147], v[104:107], 0
 m16 a[216:219], v[144:147], v[108:111], 0
 s_barrier
 rtr v[136:137], v81, 12296
 rtr v[138:139], v81, 13832
 rtr v[140:141], v80, 12416
 rtr v[142:143], v80, 13952
 rtr v[144:145], v80, 12424
 rtr v[146:147], v80, 13960
 rtr v[148:149], v81, 12416
 rtr v[150:151], v81, 13952
 rtr v[152:153], v81, 12424
 rtr v[154:155], v81, 13960
 rtr v[156:157], v80, 12544
 rtr v[158:159], v80, 14080
 s_mov_b32 m0, 12288
 s_nop 0
 HWQ0
 HWQ1
 HWQ2
 HWQ3
 s_mov_b32 m0, 16384
 s_nop 0
 HWQ4
 HWQ5
 HWQ6
 s_waitcnt lgkmcnt(4)
 m16 a[20:23], v[136:139], v[88:91], 0
 HWQ7
 s_mov_b32 m0, 20480
 m16 a[28:31], v[136:139], v[92:95], 0
 rtr v[160:161], v80, 12552
 HWQ8
 m16 a[116:119], v[136:139], v[96:99], 0
 rtr v[162:163], v80, 14088
 HWQ9
 m16 a[124:127], v[136:139], v[100:103], 0
 rtr v[164:165], v81, 12544
 HWQ10
 m16 a[212:215], v[136:139], v[104:107], 0
 HWQ11
 s_add_u32 s54, s54, 393216
 s_sub_u32 s46, s54, 7864320
 s_cmp_ge_u32 s54, 7864320
 s_cselect_b32 s54, s46, s54
 s_mov_b32 m0, 24576
 m16 a[220:223], v[136:139], v[108:111], 0
 rtr v[166:167], v81, 14080
 HX0
 m16 a[32:35], v[140:143], v[88:91], 0
 rtr v[136:137], v81, 12552
 HX1
 m16 a[40:43], v[140:143], v[92:95], 0
 rtr v[138:139], v81, 14088
 HX2
 m16 a[128:131], v[140:143], v[96:99], 0
 HX3
 s_mov_b32 m0, 28672
 m16 a[136:139], v[140:143], v[100:103], 0
 HX4
 m16 a[224:227], v[140:143], v[104:107], 0
 HX5
 m16 a[232:235], v[140:143], v[108:111], 0
 HX6
 m16 a[36:39], v[144:147], v[88:91], 0
 HX7
 s_mov_b32 m0, 32768
 m16 a[44:47], v[144:147], v[92:95], 0
 HX8
 m16 a[132:135], v[144:147], v[96:99], 0
 HX9
 m16 a[140:143], v[144:147], v[100:103], 0
 HX10
 m16 a[228:231], v[144:147], v[104:107], 0
 HX11
 s_add_u32 s55, s55, 128
 s_sub_u32 s46, s55, 1280
 s_cmp_ge_u32 s55, s57
 s_cselect_b32 s55, s46, s55
 m16 a[236:239], v[144:147], v[108:111], 0
 m16 a[48:51], v[148:151], v[88:91], 0
 m16 a[56:59], v[148:151], v[92:95], 0
 m16 a[144:147], v[148:151], v[96:99], 0
 m16 a[152:155], v[148:151], v[100:103], 0
 m16 a[240:243], v[148:151], v[104:107], 0
 m16 a[248:251], v[148:151], v[108:111], 0
 s_waitcnt lgkmcnt(4)
 m16 a[52:55], v[152:155], v[88:91], 0
 m16 a[60:63], v[152:155], v[92:95], 0
 m16 a[148:151], v[152:155], v[96:99], 0
 m16 a[156:159], v[152:155], v[100:103], 0
 m16 a[244:247], v[152:155], v[104:107], 0
 m16 a[252:255], v[152:155], v[108:111], 0
 m16 a[64:67], v[156:159], v[88:91], 0
 m16 a[72:75], v[156:159], v[92:95], 0
 m16 a[160:163], v[156:159], v[96:99], 0
 m16 a[168:171], v[156:159], v[100:103], 0
 m16 v[168:171], v[156:159], v[104:107], 0
 m16 v[176:179], v[156:159], v[108:111], 0
 m16 a[68:71], v[160:163], v[88:91], 0
 m16 a[76:79], v[160:163], v[92:95], 0
 m16 a[164:167], v[160:163], v[96:99], 0
 m16 a[172:175], v[160:163], v[100:103], 0
 m16 v[172:175], v[160:163], v[104:107], 0
 m16 v[180:183], v[160:163], v[108:111], 0
 s_waitcnt lgkmcnt(2)
 m16 a[80:83], v[164:167], v[88:91], 0
 m16 a[88:91], v[164:167], v[92:95], 0
 m16 a[176:179], v[164:167], v[96:99], 0
 m16 a[184:187], v[164:167], v[100:103], 0
 m16 v[184:187], v[164:167], v[104:107], 0
 m16 v[192:195], v[164:167], v[108:111], 0
 s_waitcnt lgkmcnt(0)
 m16 a[84:87], v[136:139], v[88:91], 0
 m16 a[92:95], v[136:139], v[92:95], 0
 m16 a[180:183], v[136:139], v[96:99], 0
 m16 a[188:191], v[136:139], v[100:103], 0
 m16 v[188:191], v[136:139], v[104:107], 0
 m16 v[196:199], v[136:139], v[108:111], 0
 s_waitcnt vmcnt(24)
 s_barrier
 TU 135168, 393216
 TK 61440, 12288
 TV 86016, 12288
 s_waitcnt vmcnt(48)
 s_barrier
 rtr v[136:137], v80, 24576
 rtr v[138:139], v80, 26112
 rtr v[140:141], v80, 24584
 rtr v[142:143], v80, 26120
 rtr v[144:145], v81, 24576
 rtr v[146:147], v81, 26112
 ds_read_b128 v[200:203], v82 offset:36864
 ds_read_b128 v[204:207], v82 offset:38912
 ds_read_b128 v[208:211], v82 offset:40960
 ds_read_b128 v[212:215], v82 offset:43008
 ds_read_b128 v[216:219], v82 offset:45056
 ds_read_b128 v[220:223], v82 offset:47104
 s_mov_b32 m0, 0
 s_nop 0
 HWQ0
 HWQ1
 HWQ2
 HWQ3
 s_mov_b32 m0, 4096
 s_nop 0
 HWQ4
 HWQ5
 HWQ6
 s_waitcnt lgkmcnt(4)
 m16 a[0:3], v[136:139], v[112:115], a[0:3]
 HWQ7
 s_mov_b32 m0, 8192
 m16 a[8:11], v[136:139], v[116:119], a[8:11]
 ds_read_b128 v[224:227], v83 offset:36864
 HWQ8
 m16 a[96:99], v[136:139], v[120:123], a[96:99]
 ds_read_b128 v[228:231], v83 offset:38912
 HWQ9
 m16 a[104:107], v[136:139], v[124:127], a[104:107]
 ds_read_b128 v[232:235], v83 offset:40960
 HWQ10
 m16 a[192:195], v[136:139], v[128:131], a[192:195]
 HWQ11
 s_add_u32 s54, s54, 393216
 s_sub_u32 s46, s54, 7864320
 s_cmp_ge_u32 s54, 7864320
 s_cselect_b32 s54, s46, s54
 m16 a[200:203], v[136:139], v[132:135], a[200:203]
 s_add_u32 s46, s4, 1573632
 buffer_load_dword v78, v77, s[16:19], s46 offen
 m16 a[4:7], v[140:143], v[112:115], a[4:7]
 ds_read_b128 v[236:239], v83 offset:43008
 m16 a[12:15], v[140:143], v[116:119], a[12:15]
 ds_read_b128 v[240:243], v83 offset:45056
 m16 a[100:103], v[140:143], v[120:123], a[100:103]
 ds_read_b128 v[244:247], v83 offset:47104
 m16 a[108:111], v[140:143], v[124:127], a[108:111]
 rtr v[148:149], v81, 24584
 m16 a[196:199], v[140:143], v[128:131], a[196:199]
 rtr v[150:151], v81, 26120
 m16 a[204:207], v[140:143], v[132:135], a[204:207]
 rtr v[152:153], v80, 24704
 m16 a[16:19], v[144:147], v[112:115], a[16:19]
 rtr v[154:155], v80, 26240
 m16 a[24:27], v[144:147], v[116:119], a[24:27]
 rtr v[156:157], v80, 24712
 m16 a[112:115], v[144:147], v[120:123], a[112:115]
 rtr v[158:159], v80, 26248
 m16 a[120:123], v[144:147], v[124:127], a[120:123]
 m16 a[208:211], v[144:147], v[128:131], a[208:211]
 rtr v[160:161], v81, 24704
 m16 a[216:219], v[144:147], v[132:135], a[216:219]
 s_waitcnt lgkmcnt(4)
 m16 a[20:23], v[148:151], v[112:115], a[20:23]
 rtr v[162:163], v81, 26240
 m16 a[28:31], v[148:151], v[116:119], a[28:31]
 m16 a[116:119], v[148:151], v[120:123], a[116:119]
 rtr v[164:165], v81, 24712
 m16 a[124:127], v[148:151], v[124:127], a[124:127]
 m16 a[212:215], v[148:151], v[128:131], a[212:215]
 rtr v[166:167], v81, 26248
 m16 a[220:223], v[148:151], v[132:135], a[220:223]
 s_waitcnt lgkmcnt(4)
 m16 a[32:35], v[152:155], v[112:115], a[32:35]
 rtr v[136:137], v80, 24832
 m16 a[40:43], v[152:155], v[116:119], a[40:43]
 m16 a[128:131], v[152:155], v[120:123], a[128:131]
 rtr v[138:139], v80, 26368
 m16 a[136:139], v[152:155], v[124:127], a[136:139]
 m16 a[224:227], v[152:155], v[128:131], a[224:227]
 rtr v[140:141], v80, 24840
 m16 a[232:235], v[152:155], v[132:135], a[232:235]
 m16 a[36:39], v[156:159], v[112:115], a[36:39]
 rtr v[142:143], v80, 26376
 m16 a[44:47], v[156:159], v[116:119], a[44:47]
 m16 a[132:135], v[156:159], v[120:123], a[132:135]
 rtr v[144:145], v81, 24832
 m16 a[140:143], v[156:159], v[124:127], a[140:143]
 m16 a[228:231], v[156:159], v[128:131], a[228:231]
 rtr v[146:147], v81, 26368
 m16 a[236:239], v[156:159], v[132:135], a[236:239]
 s_waitcnt lgkmcnt(4)
 m16 a[48:51], v[160:163], v[112:115], a[48:51]
 rtr v[148:149], v81, 24840
 m16 a[56:59], v[160:163], v[116:119], a[56:59]
 m16 a[144:147], v[160:163], v[120:123], a[144:147]
 rtr v[150:151], v81, 26376
 m16 a[152:155], v[160:163], v[124:127], a[152:155]
 m16 a[240:243], v[160:163], v[128:131], a[240:243]
 m16 a[248:251], v[160:163], v[132:135], a[248:251]
 m16 a[52:55], v[164:167], v[112:115], a[52:55]
 m16 a[60:63], v[164:167], v[116:119], a[60:63]
 m16 a[148:151], v[164:167], v[120:123], a[148:151]
 m16 a[156:159], v[164:167], v[124:127], a[156:159]
 m16 a[244:247], v[164:167], v[128:131], a[244:247]
 m16 a[252:255], v[164:167], v[132:135], a[252:255]
 m16 a[64:67], v[136:139], v[112:115], a[64:67]
 m16 a[72:75], v[136:139], v[116:119], a[72:75]
 m16 a[160:163], v[136:139], v[120:123], a[160:163]
 m16 a[168:171], v[136:139], v[124:127], a[168:171]
 m16 v[168:171], v[136:139], v[128:131], v[168:171]
 m16 v[176:179], v[136:139], v[132:135], v[176:179]
 s_waitcnt lgkmcnt(4)
 m16 a[68:71], v[140:143], v[112:115], a[68:71]
 m16 a[76:79], v[140:143], v[116:119], a[76:79]
 m16 a[164:167], v[140:143], v[120:123], a[164:167]
 m16 a[172:175], v[140:143], v[124:127], a[172:175]
 m16 v[172:175], v[140:143], v[128:131], v[172:175]
 m16 v[180:183], v[140:143], v[132:135], v[180:183]
 s_waitcnt lgkmcnt(2)
 m16 a[80:83], v[144:147], v[112:115], a[80:83]
 m16 a[88:91], v[144:147], v[116:119], a[88:91]
 m16 a[176:179], v[144:147], v[120:123], a[176:179]
 m16 a[184:187], v[144:147], v[124:127], a[184:187]
 m16 v[184:187], v[144:147], v[128:131], v[184:187]
 m16 v[192:195], v[144:147], v[132:135], v[192:195]
 s_waitcnt lgkmcnt(0)
 m16 a[84:87], v[148:151], v[112:115], a[84:87]
 m16 a[92:95], v[148:151], v[116:119], a[92:95]
 m16 a[180:183], v[148:151], v[120:123], a[180:183]
 m16 a[188:191], v[148:151], v[124:127], a[188:191]
 m16 v[188:191], v[148:151], v[128:131], v[188:191]
 m16 v[196:199], v[148:151], v[132:135], v[196:199]
 s_waitcnt vmcnt(1)
 s_barrier
 rtr v[136:137], v80, 12288
 rtr v[138:139], v80, 13824
 rtr v[140:141], v80, 12296
 rtr v[142:143], v80, 13832
 rtr v[144:145], v81, 12288
 rtr v[146:147], v81, 13824
 rtr v[148:149], v81, 12296
 rtr v[150:151], v81, 13832
 rtr v[152:153], v80, 12416
 rtr v[154:155], v80, 13952
 rtr v[156:157], v80, 12424
 rtr v[158:159], v80, 13960
 s_mov_b32 m0, 147456
 s_nop 0
 HU0
 HU1
 HU2
 HU3
 s_mov_b32 m0, 151552
 s_nop 0
 HU4
 HU5
 HU6
 s_waitcnt lgkmcnt(4)
 m16 a[0:3], v[136:139], v[200:203], a[0:3]
 HU7
 s_mov_b32 m0, 155648
 m16 a[8:11], v[136:139], v[204:207], a[8:11]
 rtr v[160:161], v81, 12416
 HU8
 m16 a[96:99], v[136:139], v[208:211], a[96:99]
 rtr v[162:163], v81, 13952
 HU9
 m16 a[104:107], v[136:139], v[212:215], a[104:107]
 rtr v[164:165], v81, 12424
 HU10
 m16 a[192:195], v[136:139], v[216:219], a[192:195]
 HU11
 s_add_u32 s59, s59, 393216
 s_sub_u32 s46, s59, 7864320
 s_cmp_ge_u32 s59, 7864320
 s_cselect_b32 s59, s46, s59
 s_mov_b32 m0, 12288
 m16 a[200:203], v[136:139], v[220:223], a[200:203]
 rtr v[166:167], v81, 13960
 HWQ0
 m16 a[4:7], v[140:143], v[200:203], a[4:7]
 rtr v[136:137], v80, 12544
 HWQ1
 m16 a[12:15], v[140:143], v[204:207], a[12:15]
 rtr v[138:139], v80, 14080
 HWQ2
 m16 a[100:103], v[140:143], v[208:211], a[100:103]
 HWQ3
 s_mov_b32 m0, 16384
 m16 a[108:111], v[140:143], v[212:215], a[108:111]
 HWQ4
 m16 a[196:199], v[140:143], v[216:219], a[196:199]
 HWQ5
 m16 a[204:207], v[140:143], v[220:223], a[204:207]
 rtr v[140:141], v80, 12552
 HWQ6
 m16 a[16:19], v[144:147], v[200:203], a[16:19]
 HWQ7
 s_mov_b32 m0, 20480
 m16 a[24:27], v[144:147], v[204:207], a[24:27]
 rtr v[142:143], v80, 14088
 HWQ8
 m16 a[112:115], v[144:147], v[208:211], a[112:115]
 HWQ9
 m16 a[120:123], v[144:147], v[212:215], a[120:123]
 HWQ10
 m16 a[208:211], v[144:147], v[216:219], a[208:211]
 HWQ11
 s_add_u32 s54, s54, 393216
 s_sub_u32 s46, s54, 7864320
 s_cmp_ge_u32 s54, 7864320
 s_cselect_b32 s54, s46, s54
 s_mov_b32 m0, 36864
 m16 a[216:219], v[144:147], v[220:223], a[216:219]
 HX0
 m16 a[20:23], v[148:151], v[200:203], a[20:23]
 rtr v[144:145], v81, 12544
 HX1
 m16 a[28:31], v[148:151], v[204:207], a[28:31]
 HX2
 m16 a[116:119], v[148:151], v[208:211], a[116:119]
 HX3
 s_mov_b32 m0, 40960
 m16 a[124:127], v[148:151], v[212:215], a[124:127]
 HX4
 m16 a[212:215], v[148:151], v[216:219], a[212:215]
 rtr v[146:147], v81, 14080
 HX5
 m16 a[220:223], v[148:151], v[220:223], a[220:223]
 HX6
 s_waitcnt lgkmcnt(6)
 m16 a[32:35], v[152:155], v[200:203], a[32:35]
 HX7
 s_mov_b32 m0, 45056
 m16 a[40:43], v[152:155], v[204:207], a[40:43]
 HX8
 m16 a[128:131], v[152:155], v[208:211], a[128:131]
 rtr v[148:149], v81, 12552
 HX9
 m16 a[136:139], v[152:155], v[212:215], a[136:139]
 HX10
 m16 a[224:227], v[152:155], v[216:219], a[224:227]
 HX11
 s_add_u32 s55, s55, 128
 s_sub_u32 s46, s55, 1280
 s_cmp_ge_u32 s55, s57
 s_cselect_b32 s55, s46, s55
 s_mov_b32 m0, 73728
 m16 a[232:235], v[152:155], v[220:223], a[232:235]
 HK0
 m16 a[36:39], v[156:159], v[200:203], a[36:39]
 rtr v[150:151], v81, 14088
 HK1
 m16 a[44:47], v[156:159], v[204:207], a[44:47]
 HK2
 m16 a[132:135], v[156:159], v[208:211], a[132:135]
 HK3
 s_mov_b32 m0, 77824
 m16 a[140:143], v[156:159], v[212:215], a[140:143]
 HK4
 m16 a[228:231], v[156:159], v[216:219], a[228:231]
 HK5
 m16 a[236:239], v[156:159], v[220:223], a[236:239]
 HK6
 m16 a[48:51], v[160:163], v[200:203], a[48:51]
 HK7
 s_mov_b32 m0, 81920
 m16 a[56:59], v[160:163], v[204:207], a[56:59]
 HK8
 m16 a[144:147], v[160:163], v[208:211], a[144:147]
 HK9
 m16 a[152:155], v[160:163], v[212:215], a[152:155]
 HK10
 m16 a[240:243], v[160:163], v[216:219], a[240:243]
 HK11
 s_add_u32 s52, s52, 12288
 s_mov_b32 m0, 98304
 m16 a[248:251], v[160:163], v[220:223], a[248:251]
 HV0
 m16 a[52:55], v[164:167], v[200:203], a[52:55]
 HV1
 m16 a[60:63], v[164:167], v[204:207], a[60:63]
 HV2
 m16 a[148:151], v[164:167], v[208:211], a[148:151]
 HV3
 s_mov_b32 m0, 102400
 m16 a[156:159], v[164:167], v[212:215], a[156:159]
 HV4
 m16 a[244:247], v[164:167], v[216:219], a[244:247]
 HV5
 m16 a[252:255], v[164:167], v[220:223], a[252:255]
 HV6
 s_waitcnt lgkmcnt(4)
 m16 a[64:67], v[136:139], v[200:203], a[64:67]
 HV7
 s_mov_b32 m0, 106496
 m16 a[72:75], v[136:139], v[204:207], a[72:75]
 HV8
 m16 a[160:163], v[136:139], v[208:211], a[160:163]
 HV9
 m16 a[168:171], v[136:139], v[212:215], a[168:171]
 HV10
 m16 v[168:171], v[136:139], v[216:219], v[168:171]
 HV11
 s_add_u32 s53, s53, 12288
 m16 v[176:179], v[136:139], v[220:223], v[176:179]
 m16 a[68:71], v[140:143], v[200:203], a[68:71]
 m16 a[76:79], v[140:143], v[204:207], a[76:79]
 m16 a[164:167], v[140:143], v[208:211], a[164:167]
 m16 a[172:175], v[140:143], v[212:215], a[172:175]
 m16 v[172:175], v[140:143], v[216:219], v[172:175]
 m16 v[180:183], v[140:143], v[220:223], v[180:183]
 s_waitcnt lgkmcnt(2)
 m16 a[80:83], v[144:147], v[200:203], a[80:83]
 m16 a[88:91], v[144:147], v[204:207], a[88:91]
 m16 a[176:179], v[144:147], v[208:211], a[176:179]
 m16 a[184:187], v[144:147], v[212:215], a[184:187]
 m16 v[184:187], v[144:147], v[216:219], v[184:187]
 m16 v[192:195], v[144:147], v[220:223], v[192:195]
 s_waitcnt lgkmcnt(0)
 m16 a[84:87], v[148:151], v[200:203], a[84:87]
 m16 a[92:95], v[148:151], v[204:207], a[92:95]
 m16 a[180:183], v[148:151], v[208:211], a[180:183]
 m16 a[188:191], v[148:151], v[212:215], a[188:191]
 m16 v[188:191], v[148:151], v[216:219], v[188:191]
 m16 v[196:199], v[148:151], v[220:223], v[196:199]
 s_waitcnt vmcnt(36)
 s_barrier
 rtr v[136:137], v80, 24576
 rtr v[138:139], v80, 26112
 rtr v[140:141], v80, 24584
 rtr v[142:143], v80, 26120
 rtr v[144:145], v81, 24576
 rtr v[146:147], v81, 26112
 ds_read_b128 v[88:91], v82 offset:24576
 ds_read_b128 v[92:95], v82 offset:26624
 ds_read_b128 v[96:99], v82 offset:28672
 ds_read_b128 v[100:103], v82 offset:30720
 ds_read_b128 v[104:107], v82 offset:32768
 ds_read_b128 v[108:111], v82 offset:34816
 s_mov_b32 m0, 135168
 s_nop 0
 HU0
 HU1
 HU2
 HU3
 s_mov_b32 m0, 139264
 s_nop 0
 HU4
 HU5
 HU6
 s_waitcnt lgkmcnt(4)
 m16 a[0:3], v[136:139], v[224:227], a[0:3]
 HU7
 s_mov_b32 m0, 143360
 m16 a[8:11], v[136:139], v[228:231], a[8:11]
 ds_read_b128 v[112:115], v83 offset:24576
 HU8
 m16 a[96:99], v[136:139], v[232:235], a[96:99]
 ds_read_b128 v[116:119], v83 offset:26624
 HU9
 m16 a[104:107], v[136:139], v[236:239], a[104:107]
 ds_read_b128 v[120:123], v83 offset:28672
 HU10
 m16 a[192:195], v[136:139], v[240:243], a[192:195]
 HU11
 s_add_u32 s59, s59, 393216
 s_sub_u32 s46, s59, 7864320
 s_cmp_ge_u32 s59, 7864320
 s_cselect_b32 s59, s46, s59
 s_mov_b32 m0, 0
 m16 a[200:203], v[136:139], v[244:247], a[200:203]
 ds_read_b128 v[124:127], v83 offset:30720
 HWQ0
 m16 a[4:7], v[140:143], v[224:227], a[4:7]
 ds_read_b128 v[128:131], v83 offset:32768
 HWQ1
 m16 a[12:15], v[140:143], v[228:231], a[12:15]
 ds_read_b128 v[132:135], v83 offset:34816
 HWQ2
 m16 a[100:103], v[140:143], v[232:235], a[100:103]
 HWQ3
 s_mov_b32 m0, 4096
 m16 a[108:111], v[140:143], v[236:239], a[108:111]
 rtr v[148:149], v81, 24584
 HWQ4
 m16 a[196:199], v[140:143], v[240:243], a[196:199]
 rtr v[150:151], v81, 26120
 HWQ5
 m16 a[204:207], v[140:143], v[244:247], a[204:207]
 rtr v[152:153], v80, 24704
 HWQ6
 m16 a[16:19], v[144:147], v[224:227], a[16:19]
 HWQ7
 s_mov_b32 m0, 8192
 m16 a[24:27], v[144:147], v[228:231], a[24:27]
 rtr v[154:155], v80, 26240
 HWQ8
 m16 a[112:115], v[144:147], v[232:235], a[112:115]
 rtr v[156:157], v80, 24712
 HWQ9
 m16 a[120:123], v[144:147], v[236:239], a[120:123]
 HWQ10
 m16 a[208:211], v[144:147], v[240:243], a[208:211]
 HWQ11
 s_add_u32 s54, s54, 393216
 s_sub_u32 s46, s54, 7864320
 s_cmp_ge_u32 s54, 7864320
 s_cselect_b32 s54, s46, s54
 s_mov_b32 m0, 49152
 m16 a[216:219], v[144:147], v[244:247], a[216:219]
 HK0
 s_waitcnt lgkmcnt(3)
 m16 a[20:23], v[148:151], v[224:227], a[20:23]
 rtr v[158:159], v80, 26248
 HK1
 m16 a[28:31], v[148:151], v[228:231], a[28:31]
 HK2
 m16 a[116:119], v[148:151], v[232:235], a[116:119]
 HK3
 s_mov_b32 m0, 53248
 m16 a[124:127], v[148:151], v[236:239], a[124:127]
 HK4
 m16 a[212:215], v[148:151], v[240:243], a[212:215]
 rtr v[160:161], v81, 24704
 HK5
 m16 a[220:223], v[148:151], v[244:247], a[220:223]
 HK6
 s_waitcnt lgkmcnt(3)
 m16 a[32:35], v[152:155], v[224:227], a[32:35]
 HK7
 s_mov_b32 m0, 57344
 m16 a[40:43], v[152:155], v[228:231], a[40:43]
 HK8
 m16 a[128:131], v[152:155], v[232:235], a[128:131]
 rtr v[162:163], v81, 26240
 HK9
 m16 a[136:139], v[152:155], v[236:239], a[136:139]
 HK10
 m16 a[224:227], v[152:155], v[240:243], a[224:227]
 HK11
 s_add_u32 s52, s52, 12288
 s_mov_b32 m0, 110592
 m16 a[232:235], v[152:155], v[244:247], a[232:235]
 HV0
 s_waitcnt lgkmcnt(2)
 m16 a[36:39], v[156:159], v[224:227], a[36:39]
 rtr v[164:165], v81, 24712
 HV1
 m16 a[44:47], v[156:159], v[228:231], a[44:47]
 HV2
 m16 a[132:135], v[156:159], v[232:235], a[132:135]
 HV3
 s_mov_b32 m0, 114688
 m16 a[140:143], v[156:159], v[236:239], a[140:143]
 HV4
 m16 a[228:231], v[156:159], v[240:243], a[228:231]
 rtr v[166:167], v81, 26248
 HV5
 m16 a[236:239], v[156:159], v[244:247], a[236:239]
 HV6
 s_waitcnt lgkmcnt(2)
 m16 a[48:51], v[160:163], v[224:227], a[48:51]
 HV7
 s_mov_b32 m0, 118784
 m16 a[56:59], v[160:163], v[228:231], a[56:59]
 HV8
 m16 a[144:147], v[160:163], v[232:235], a[144:147]
 rtr v[136:137], v80, 24832
 HV9
 m16 a[152:155], v[160:163], v[236:239], a[152:155]
 HV10
 m16 a[240:243], v[160:163], v[240:243], a[240:243]
 HV11
 s_add_u32 s53, s53, 12288
 m16 a[248:251], v[160:163], v[244:247], a[248:251]
 s_add_u32 s46, s4, 3146112
 buffer_load_dword v78, v77, s[16:19], s46 offen
 s_waitcnt lgkmcnt(1)
 m16 a[52:55], v[164:167], v[224:227], a[52:55]
 rtr v[138:139], v80, 26368
 m16 a[60:63], v[164:167], v[228:231], a[60:63]
 m16 a[148:151], v[164:167], v[232:235], a[148:151]
 rtr v[140:141], v80, 24840
 m16 a[156:159], v[164:167], v[236:239], a[156:159]
 m16 a[244:247], v[164:167], v[240:243], a[244:247]
 rtr v[142:143], v80, 26376
 m16 a[252:255], v[164:167], v[244:247], a[252:255]
 s_waitcnt lgkmcnt(2)
 m16 a[64:67], v[136:139], v[224:227], a[64:67]
 rtr v[144:145], v81, 24832
 m16 a[72:75], v[136:139], v[228:231], a[72:75]
 m16 a[160:163], v[136:139], v[232:235], a[160:163]
 rtr v[146:147], v81, 26368
 m16 a[168:171], v[136:139], v[236:239], a[168:171]
 m16 v[168:171], v[136:139], v[240:243], v[168:171]
 rtr v[148:149], v81, 24840
 m16 v[176:179], v[136:139], v[244:247], v[176:179]
 s_waitcnt lgkmcnt(3)
 m16 a[68:71], v[140:143], v[224:227], a[68:71]
 rtr v[150:151], v81, 26376
 m16 a[76:79], v[140:143], v[228:231], a[76:79]
 m16 a[164:167], v[140:143], v[232:235], a[164:167]
 m16 a[172:175], v[140:143], v[236:239], a[172:175]
 m16 v[172:175], v[140:143], v[240:243], v[172:175]
 m16 v[180:183], v[140:143], v[244:247], v[180:183]
 s_waitcnt lgkmcnt(2)
 m16 a[80:83], v[144:147], v[224:227], a[80:83]
 m16 a[88:91], v[144:147], v[228:231], a[88:91]
 m16 a[176:179], v[144:147], v[232:235], a[176:179]
 m16 a[184:187], v[144:147], v[236:239], a[184:187]
 m16 v[184:187], v[144:147], v[240:243], v[184:187]
 m16 v[192:195], v[144:147], v[244:247], v[192:195]
 s_waitcnt lgkmcnt(0)
 m16 a[84:87], v[148:151], v[224:227], a[84:87]
 m16 a[92:95], v[148:151], v[228:231], a[92:95]
 m16 a[180:183], v[148:151], v[232:235], a[180:183]
 m16 a[188:191], v[148:151], v[236:239], a[188:191]
 m16 v[188:191], v[148:151], v[240:243], v[188:191]
 m16 v[196:199], v[148:151], v[244:247], v[196:199]
 s_waitcnt vmcnt(25)
 s_barrier
 rtr v[136:137], v80, 12288
 rtr v[138:139], v80, 13824
 rtr v[140:141], v80, 12296
 rtr v[142:143], v80, 13832
 rtr v[144:145], v81, 12288
 rtr v[146:147], v81, 13824
 rtr v[148:149], v81, 12296
 rtr v[150:151], v81, 13832
 rtr v[152:153], v80, 12416
 rtr v[154:155], v80, 13952
 rtr v[156:157], v80, 12424
 rtr v[158:159], v80, 13960
 s_mov_b32 m0, 147456
 s_nop 0
 HU0
 HU1
 HU2
 HU3
 s_mov_b32 m0, 151552
 s_nop 0
 HU4
 HU5
 HU6
 s_waitcnt lgkmcnt(4)
 m16 a[0:3], v[136:139], v[88:91], a[0:3]
 HU7
 s_mov_b32 m0, 155648
 m16 a[8:11], v[136:139], v[92:95], a[8:11]
 rtr v[160:161], v81, 12416
 HU8
 m16 a[96:99], v[136:139], v[96:99], a[96:99]
 rtr v[162:163], v81, 13952
 HU9
 m16 a[104:107], v[136:139], v[100:103], a[104:107]
 rtr v[164:165], v81, 12424
 HU10
 m16 a[192:195], v[136:139], v[104:107], a[192:195]
 HU11
 s_add_u32 s59, s59, 393216
 s_sub_u32 s46, s59, 7864320
 s_cmp_ge_u32 s59, 7864320
 s_cselect_b32 s59, s46, s59
 s_mov_b32 m0, 12288
 m16 a[200:203], v[136:139], v[108:111], a[200:203]
 rtr v[166:167], v81, 13960
 HWQ0
 m16 a[4:7], v[140:143], v[88:91], a[4:7]
 rtr v[136:137], v80, 12544
 HWQ1
 m16 a[12:15], v[140:143], v[92:95], a[12:15]
 rtr v[138:139], v80, 14080
 HWQ2
 m16 a[100:103], v[140:143], v[96:99], a[100:103]
 HWQ3
 s_mov_b32 m0, 16384
 m16 a[108:111], v[140:143], v[100:103], a[108:111]
 HWQ4
 m16 a[196:199], v[140:143], v[104:107], a[196:199]
 HWQ5
 m16 a[204:207], v[140:143], v[108:111], a[204:207]
 rtr v[140:141], v80, 12552
 HWQ6
 m16 a[16:19], v[144:147], v[88:91], a[16:19]
 HWQ7
 s_mov_b32 m0, 20480
 m16 a[24:27], v[144:147], v[92:95], a[24:27]
 rtr v[142:143], v80, 14088
 HWQ8
 m16 a[112:115], v[144:147], v[96:99], a[112:115]
 HWQ9
 m16 a[120:123], v[144:147], v[100:103], a[120:123]
 HWQ10
 m16 a[208:211], v[144:147], v[104:107], a[208:211]
 HWQ11
 s_add_u32 s54, s54, 393216
 s_sub_u32 s46, s54, 7864320
 s_cmp_ge_u32 s54, 7864320
 s_cselect_b32 s54, s46, s54
 s_mov_b32 m0, 24576
 m16 a[216:219], v[144:147], v[108:111], a[216:219]
 HX0
 m16 a[20:23], v[148:151], v[88:91], a[20:23]
 rtr v[144:145], v81, 12544
 HX1
 m16 a[28:31], v[148:151], v[92:95], a[28:31]
 HX2
 m16 a[116:119], v[148:151], v[96:99], a[116:119]
 HX3
 s_mov_b32 m0, 28672
 m16 a[124:127], v[148:151], v[100:103], a[124:127]
 HX4
 m16 a[212:215], v[148:151], v[104:107], a[212:215]
 rtr v[146:147], v81, 14080
 HX5
 m16 a[220:223], v[148:151], v[108:111], a[220:223]
 HX6
 s_waitcnt lgkmcnt(6)
 m16 a[32:35], v[152:155], v[88:91], a[32:35]
 HX7
 s_mov_b32 m0, 32768
 m16 a[40:43], v[152:155], v[92:95], a[40:43]
 HX8
 m16 a[128:131], v[152:155], v[96:99], a[128:131]
 rtr v[148:149], v81, 12552
 HX9
 m16 a[136:139], v[152:155], v[100:103], a[136:139]
 HX10
 m16 a[224:227], v[152:155], v[104:107], a[224:227]
 HX11
 s_add_u32 s55, s55, 128
 s_sub_u32 s46, s55, 1280
 s_cmp_ge_u32 s55, s57
 s_cselect_b32 s55, s46, s55
 s_mov_b32 m0, 61440
 m16 a[232:235], v[152:155], v[108:111], a[232:235]
 HK0
 m16 a[36:39], v[156:159], v[88:91], a[36:39]
 rtr v[150:151], v81, 14088
 HK1
 m16 a[44:47], v[156:159], v[92:95], a[44:47]
 HK2
 m16 a[132:135], v[156:159], v[96:99], a[132:135]
 HK3
 s_mov_b32 m0, 65536
 m16 a[140:143], v[156:159], v[100:103], a[140:143]
 HK4
 m16 a[228:231], v[156:159], v[104:107], a[228:231]
 HK5
 m16 a[236:239], v[156:159], v[108:111], a[236:239]
 HK6
 m16 a[48:51], v[160:163], v[88:91], a[48:51]
 HK7
 s_mov_b32 m0, 69632
 m16 a[56:59], v[160:163], v[92:95], a[56:59]
 HK8
 m16 a[144:147], v[160:163], v[96:99], a[144:147]
 HK9
 m16 a[152:155], v[160:163], v[100:103], a[152:155]
 HK10
 m16 a[240:243], v[160:163], v[104:107], a[240:243]
 HK11
 s_add_u32 s52, s52, 12288
 s_mov_b32 m0, 122880
 m16 a[248:251], v[160:163], v[108:111], a[248:251]
 HV0
 m16 a[52:55], v[164:167], v[88:91], a[52:55]
 HV1
 m16 a[60:63], v[164:167], v[92:95], a[60:63]
 HV2
 m16 a[148:151], v[164:167], v[96:99], a[148:151]
 HV3
 s_mov_b32 m0, 126976
 m16 a[156:159], v[164:167], v[100:103], a[156:159]
 HV4
 m16 a[244:247], v[164:167], v[104:107], a[244:247]
 HV5
 m16 a[252:255], v[164:167], v[108:111], a[252:255]
 HV6
 s_waitcnt lgkmcnt(4)
 m16 a[64:67], v[136:139], v[88:91], a[64:67]
 HV7
 s_mov_b32 m0, 131072
 m16 a[72:75], v[136:139], v[92:95], a[72:75]
 HV8
 m16 a[160:163], v[136:139], v[96:99], a[160:163]
 HV9
 m16 a[168:171], v[136:139], v[100:103], a[168:171]
 HV10
 m16 v[168:171], v[136:139], v[104:107], v[168:171]
 HV11
 s_add_u32 s53, s53, 12288
 m16 v[176:179], v[136:139], v[108:111], v[176:179]
 m16 a[68:71], v[140:143], v[88:91], a[68:71]
 m16 a[76:79], v[140:143], v[92:95], a[76:79]
 m16 a[164:167], v[140:143], v[96:99], a[164:167]
 m16 a[172:175], v[140:143], v[100:103], a[172:175]
 m16 v[172:175], v[140:143], v[104:107], v[172:175]
 m16 v[180:183], v[140:143], v[108:111], v[180:183]
 s_waitcnt lgkmcnt(2)
 m16 a[80:83], v[144:147], v[88:91], a[80:83]
 m16 a[88:91], v[144:147], v[92:95], a[88:91]
 m16 a[176:179], v[144:147], v[96:99], a[176:179]
 m16 a[184:187], v[144:147], v[100:103], a[184:187]
 m16 v[184:187], v[144:147], v[104:107], v[184:187]
 m16 v[192:195], v[144:147], v[108:111], v[192:195]
 s_waitcnt lgkmcnt(0)
 m16 a[84:87], v[148:151], v[88:91], a[84:87]
 m16 a[92:95], v[148:151], v[92:95], a[92:95]
 m16 a[180:183], v[148:151], v[96:99], a[180:183]
 m16 a[188:191], v[148:151], v[100:103], a[188:191]
 m16 v[188:191], v[148:151], v[104:107], v[188:191]
 m16 v[196:199], v[148:151], v[108:111], v[196:199]
 s_waitcnt vmcnt(36)
 s_barrier
CPS30:
 rtr v[136:137], v80, 24576
 rtr v[138:139], v80, 26112
 rtr v[140:141], v80, 24584
 rtr v[142:143], v80, 26120
 rtr v[144:145], v81, 24576
 rtr v[146:147], v81, 26112
 ds_read_b128 v[200:203], v82 offset:36864
 ds_read_b128 v[204:207], v82 offset:38912
 ds_read_b128 v[208:211], v82 offset:40960
 ds_read_b128 v[212:215], v82 offset:43008
 ds_read_b128 v[216:219], v82 offset:45056
 ds_read_b128 v[220:223], v82 offset:47104
 s_mov_b32 m0, 135168
 s_nop 0
 HU0
 HU1
 HU2
 HU3
 s_mov_b32 m0, 139264
 s_nop 0
 HU4
 HU5
 HU6
 s_waitcnt lgkmcnt(4)
 m16 a[0:3], v[136:139], v[112:115], a[0:3]
 HU7
 s_mov_b32 m0, 143360
 m16 a[8:11], v[136:139], v[116:119], a[8:11]
 ds_read_b128 v[224:227], v83 offset:36864
 HU8
 m16 a[96:99], v[136:139], v[120:123], a[96:99]
 ds_read_b128 v[228:231], v83 offset:38912
 HU9
 m16 a[104:107], v[136:139], v[124:127], a[104:107]
 ds_read_b128 v[232:235], v83 offset:40960
 HU10
 m16 a[192:195], v[136:139], v[128:131], a[192:195]
 HU11
 s_add_u32 s59, s59, 393216
 s_sub_u32 s46, s59, 7864320
 s_cmp_ge_u32 s59, 7864320
 s_cselect_b32 s59, s46, s59
 s_mov_b32 m0, 0
 m16 a[200:203], v[136:139], v[132:135], a[200:203]
 ds_read_b128 v[236:239], v83 offset:43008
 HWQ0
 m16 a[4:7], v[140:143], v[112:115], a[4:7]
 ds_read_b128 v[240:243], v83 offset:45056
 HWQ1
 m16 a[12:15], v[140:143], v[116:119], a[12:15]
 ds_read_b128 v[244:247], v83 offset:47104
 HWQ2
 m16 a[100:103], v[140:143], v[120:123], a[100:103]
 HWQ3
 s_mov_b32 m0, 4096
 m16 a[108:111], v[140:143], v[124:127], a[108:111]
 rtr v[148:149], v81, 24584
 HWQ4
 m16 a[196:199], v[140:143], v[128:131], a[196:199]
 rtr v[150:151], v81, 26120
 HWQ5
 m16 a[204:207], v[140:143], v[132:135], a[204:207]
 rtr v[152:153], v80, 24704
 HWQ6
 m16 a[16:19], v[144:147], v[112:115], a[16:19]
 HWQ7
 s_mov_b32 m0, 8192
 m16 a[24:27], v[144:147], v[116:119], a[24:27]
 rtr v[154:155], v80, 26240
 HWQ8
 m16 a[112:115], v[144:147], v[120:123], a[112:115]
 rtr v[156:157], v80, 24712
 HWQ9
 m16 a[120:123], v[144:147], v[124:127], a[120:123]
 HWQ10
 m16 a[208:211], v[144:147], v[128:131], a[208:211]
 HWQ11
 s_add_u32 s54, s54, 393216
 s_sub_u32 s46, s54, 7864320
 s_cmp_ge_u32 s54, 7864320
 s_cselect_b32 s54, s46, s54
 s_mov_b32 m0, 73728
 m16 a[216:219], v[144:147], v[132:135], a[216:219]
 HK0
 s_waitcnt lgkmcnt(3)
 m16 a[20:23], v[148:151], v[112:115], a[20:23]
 rtr v[158:159], v80, 26248
 HK1
 m16 a[28:31], v[148:151], v[116:119], a[28:31]
 HK2
 m16 a[116:119], v[148:151], v[120:123], a[116:119]
 HK3
 s_mov_b32 m0, 77824
 m16 a[124:127], v[148:151], v[124:127], a[124:127]
 HK4
 m16 a[212:215], v[148:151], v[128:131], a[212:215]
 rtr v[160:161], v81, 24704
 HK5
 m16 a[220:223], v[148:151], v[132:135], a[220:223]
 HK6
 s_waitcnt lgkmcnt(3)
 m16 a[32:35], v[152:155], v[112:115], a[32:35]
 HK7
 s_mov_b32 m0, 81920
 m16 a[40:43], v[152:155], v[116:119], a[40:43]
 HK8
 m16 a[128:131], v[152:155], v[120:123], a[128:131]
 rtr v[162:163], v81, 26240
 HK9
 m16 a[136:139], v[152:155], v[124:127], a[136:139]
 HK10
 m16 a[224:227], v[152:155], v[128:131], a[224:227]
 HK11
 s_add_u32 s52, s52, 12288
 s_mov_b32 m0, 86016
 m16 a[232:235], v[152:155], v[132:135], a[232:235]
 HV0
 s_waitcnt lgkmcnt(2)
 m16 a[36:39], v[156:159], v[112:115], a[36:39]
 rtr v[164:165], v81, 24712
 HV1
 m16 a[44:47], v[156:159], v[116:119], a[44:47]
 HV2
 m16 a[132:135], v[156:159], v[120:123], a[132:135]
 HV3
 s_mov_b32 m0, 90112
 m16 a[140:143], v[156:159], v[124:127], a[140:143]
 HV4
 m16 a[228:231], v[156:159], v[128:131], a[228:231]
 rtr v[166:167], v81, 26248
 HV5
 m16 a[236:239], v[156:159], v[132:135], a[236:239]
 HV6
 s_waitcnt lgkmcnt(2)
 m16 a[48:51], v[160:163], v[112:115], a[48:51]
 HV7
 s_mov_b32 m0, 94208
 m16 a[56:59], v[160:163], v[116:119], a[56:59]
 HV8
 m16 a[144:147], v[160:163], v[120:123], a[144:147]
 rtr v[136:137], v80, 24832
 HV9
 m16 a[152:155], v[160:163], v[124:127], a[152:155]
 HV10
 m16 a[240:243], v[160:163], v[128:131], a[240:243]
 HV11
 s_add_u32 s53, s53, 12288
 m16 a[248:251], v[160:163], v[132:135], a[248:251]
 s_add_u32 s46, s4, 3146496
 buffer_load_dword v78, v77, s[16:19], s46 offen
 s_waitcnt lgkmcnt(1)
 m16 a[52:55], v[164:167], v[112:115], a[52:55]
 v_add_co_u32 v10, vcc, CPS30+4096-LOADER, v8
 s_nop 1
 v_addc_co_u32 v11, vcc, 0, v9, vcc
 global_load_dword v78, v[10:11], off
 m16 a[60:63], v[164:167], v[116:119], a[60:63]
 m16 a[148:151], v[164:167], v[120:123], a[148:151]
 rtr v[138:139], v80, 26368
 m16 a[156:159], v[164:167], v[124:127], a[156:159]
 m16 a[244:247], v[164:167], v[128:131], a[244:247]
 rtr v[140:141], v80, 24840
 m16 a[252:255], v[164:167], v[132:135], a[252:255]
 s_waitcnt lgkmcnt(1)
 m16 a[64:67], v[136:139], v[112:115], a[64:67]
 rtr v[142:143], v80, 26376
 m16 a[72:75], v[136:139], v[116:119], a[72:75]
 m16 a[160:163], v[136:139], v[120:123], a[160:163]
 rtr v[144:145], v81, 24832
 m16 a[168:171], v[136:139], v[124:127], a[168:171]
 m16 v[168:171], v[136:139], v[128:131], v[168:171]
 rtr v[146:147], v81, 26368
 m16 v[176:179], v[136:139], v[132:135], v[176:179]
 s_waitcnt lgkmcnt(2)
 m16 a[68:71], v[140:143], v[112:115], a[68:71]
 rtr v[148:149], v81, 24840
 m16 a[76:79], v[140:143], v[116:119], a[76:79]
 m16 a[164:167], v[140:143], v[120:123], a[164:167]
 rtr v[150:151], v81, 26376
 m16 a[172:175], v[140:143], v[124:127], a[172:175]
 m16 v[172:175], v[140:143], v[128:131], v[172:175]
 m16 v[180:183], v[140:143], v[132:135], v[180:183]
 s_waitcnt lgkmcnt(2)
 m16 a[80:83], v[144:147], v[112:115], a[80:83]
 m16 a[88:91], v[144:147], v[116:119], a[88:91]
 m16 a[176:179], v[144:147], v[120:123], a[176:179]
 m16 a[184:187], v[144:147], v[124:127], a[184:187]
 m16 v[184:187], v[144:147], v[128:131], v[184:187]
 m16 v[192:195], v[144:147], v[132:135], v[192:195]
 s_waitcnt lgkmcnt(0)
 m16 a[84:87], v[148:151], v[112:115], a[84:87]
 m16 a[92:95], v[148:151], v[116:119], a[92:95]
 m16 a[180:183], v[148:151], v[120:123], a[180:183]
 m16 a[188:191], v[148:151], v[124:127], a[188:191]
 m16 v[188:191], v[148:151], v[128:131], v[188:191]
 m16 v[196:199], v[148:151], v[132:135], v[196:199]
 s_waitcnt vmcnt(26)
 s_barrier
 rtr v[136:137], v80, 12288
 rtr v[138:139], v80, 13824
 rtr v[140:141], v80, 12296
 rtr v[142:143], v80, 13832
 rtr v[144:145], v81, 12288
 rtr v[146:147], v81, 13824
 rtr v[148:149], v81, 12296
 rtr v[150:151], v81, 13832
 rtr v[152:153], v80, 12416
 rtr v[154:155], v80, 13952
 rtr v[156:157], v80, 12424
 rtr v[158:159], v80, 13960
 s_mov_b32 m0, 147456
 s_nop 0
 HU0
 HU1
 HU2
 HU3
 s_mov_b32 m0, 151552
 s_nop 0
 HU4
 HU5
 HU6
 s_waitcnt lgkmcnt(4)
 m16 a[0:3], v[136:139], v[200:203], a[0:3]
 HU7
 s_mov_b32 m0, 155648
 m16 a[8:11], v[136:139], v[204:207], a[8:11]
 rtr v[160:161], v81, 12416
 HU8
 m16 a[96:99], v[136:139], v[208:211], a[96:99]
 rtr v[162:163], v81, 13952
 HU9
 m16 a[104:107], v[136:139], v[212:215], a[104:107]
 rtr v[164:165], v81, 12424
 HU10
 m16 a[192:195], v[136:139], v[216:219], a[192:195]
 HU11
 s_add_u32 s59, s59, 393216
 s_sub_u32 s46, s59, 7864320
 s_cmp_ge_u32 s59, 7864320
 s_cselect_b32 s59, s46, s59
 s_mov_b32 m0, 12288
 m16 a[200:203], v[136:139], v[220:223], a[200:203]
 rtr v[166:167], v81, 13960
 HWQ0
 m16 a[4:7], v[140:143], v[200:203], a[4:7]
 rtr v[136:137], v80, 12544
 HWQ1
 m16 a[12:15], v[140:143], v[204:207], a[12:15]
 rtr v[138:139], v80, 14080
 HWQ2
 m16 a[100:103], v[140:143], v[208:211], a[100:103]
 HWQ3
 s_mov_b32 m0, 16384
 m16 a[108:111], v[140:143], v[212:215], a[108:111]
 HWQ4
 m16 a[196:199], v[140:143], v[216:219], a[196:199]
 HWQ5
 m16 a[204:207], v[140:143], v[220:223], a[204:207]
 rtr v[140:141], v80, 12552
 HWQ6
 m16 a[16:19], v[144:147], v[200:203], a[16:19]
 HWQ7
 s_mov_b32 m0, 20480
 m16 a[24:27], v[144:147], v[204:207], a[24:27]
 rtr v[142:143], v80, 14088
 HWQ8
 m16 a[112:115], v[144:147], v[208:211], a[112:115]
 HWQ9
 m16 a[120:123], v[144:147], v[212:215], a[120:123]
 HWQ10
 m16 a[208:211], v[144:147], v[216:219], a[208:211]
 HWQ11
 s_add_u32 s54, s54, 393216
 s_sub_u32 s46, s54, 7864320
 s_cmp_ge_u32 s54, 7864320
 s_cselect_b32 s54, s46, s54
 s_mov_b32 m0, 36864
 m16 a[216:219], v[144:147], v[220:223], a[216:219]
 HX0
 m16 a[20:23], v[148:151], v[200:203], a[20:23]
 rtr v[144:145], v81, 12544
 HX1
 m16 a[28:31], v[148:151], v[204:207], a[28:31]
 HX2
 m16 a[116:119], v[148:151], v[208:211], a[116:119]
 HX3
 s_mov_b32 m0, 40960
 m16 a[124:127], v[148:151], v[212:215], a[124:127]
 HX4
 m16 a[212:215], v[148:151], v[216:219], a[212:215]
 rtr v[146:147], v81, 14080
 HX5
 m16 a[220:223], v[148:151], v[220:223], a[220:223]
 HX6
 s_waitcnt lgkmcnt(6)
 m16 a[32:35], v[152:155], v[200:203], a[32:35]
 HX7
 s_mov_b32 m0, 45056
 m16 a[40:43], v[152:155], v[204:207], a[40:43]
 HX8
 m16 a[128:131], v[152:155], v[208:211], a[128:131]
 rtr v[148:149], v81, 12552
 HX9
 m16 a[136:139], v[152:155], v[212:215], a[136:139]
 HX10
 m16 a[224:227], v[152:155], v[216:219], a[224:227]
 HX11
 s_add_u32 s55, s55, 128
 s_sub_u32 s46, s55, 1280
 s_cmp_ge_u32 s55, s57
 s_cselect_b32 s55, s46, s55
 s_mov_b32 m0, 49152
 m16 a[232:235], v[152:155], v[220:223], a[232:235]
 HK0
 m16 a[36:39], v[156:159], v[200:203], a[36:39]
 rtr v[150:151], v81, 14088
 HK1
 m16 a[44:47], v[156:159], v[204:207], a[44:47]
 HK2
 m16 a[132:135], v[156:159], v[208:211], a[132:135]
 HK3
 s_mov_b32 m0, 53248
 m16 a[140:143], v[156:159], v[212:215], a[140:143]
 HK4
 m16 a[228:231], v[156:159], v[216:219], a[228:231]
 HK5
 m16 a[236:239], v[156:159], v[220:223], a[236:239]
 HK6
 m16 a[48:51], v[160:163], v[200:203], a[48:51]
 HK7
 s_mov_b32 m0, 57344
 m16 a[56:59], v[160:163], v[204:207], a[56:59]
 HK8
 m16 a[144:147], v[160:163], v[208:211], a[144:147]
 HK9
 m16 a[152:155], v[160:163], v[212:215], a[152:155]
 HK10
 m16 a[240:243], v[160:163], v[216:219], a[240:243]
 HK11
 s_add_u32 s52, s52, 12288
 s_mov_b32 m0, 98304
 m16 a[248:251], v[160:163], v[220:223], a[248:251]
 HV0
 m16 a[52:55], v[164:167], v[200:203], a[52:55]
 HV1
 m16 a[60:63], v[164:167], v[204:207], a[60:63]
 HV2
 m16 a[148:151], v[164:167], v[208:211], a[148:151]
 HV3
 s_mov_b32 m0, 102400
 m16 a[156:159], v[164:167], v[212:215], a[156:159]
 HV4
 m16 a[244:247], v[164:167], v[216:219], a[244:247]
 HV5
 m16 a[252:255], v[164:167], v[220:223], a[252:255]
 HV6
 s_waitcnt lgkmcnt(4)
 m16 a[64:67], v[136:139], v[200:203], a[64:67]
 HV7
 s_mov_b32 m0, 106496
 m16 a[72:75], v[136:139], v[204:207], a[72:75]
 HV8
 m16 a[160:163], v[136:139], v[208:211], a[160:163]
 HV9
 m16 a[168:171], v[136:139], v[212:215], a[168:171]
 HV10
 m16 v[168:171], v[136:139], v[216:219], v[168:171]
 HV11
 s_add_u32 s53, s53, 12288
 m16 v[176:179], v[136:139], v[220:223], v[176:179]
 s_add_u32 s46, s4, 4718976
 buffer_load_dword v78, v77, s[16:19], s46 offen
 m16 a[68:71], v[140:143], v[200:203], a[68:71]
 m16 a[76:79], v[140:143], v[204:207], a[76:79]
 m16 a[164:167], v[140:143], v[208:211], a[164:167]
 m16 a[172:175], v[140:143], v[212:215], a[172:175]
 m16 v[172:175], v[140:143], v[216:219], v[172:175]
 m16 v[180:183], v[140:143], v[220:223], v[180:183]
 s_waitcnt lgkmcnt(2)
 m16 a[80:83], v[144:147], v[200:203], a[80:83]
 m16 a[88:91], v[144:147], v[204:207], a[88:91]
 m16 a[176:179], v[144:147], v[208:211], a[176:179]
 m16 a[184:187], v[144:147], v[212:215], a[184:187]
 m16 v[184:187], v[144:147], v[216:219], v[184:187]
 m16 v[192:195], v[144:147], v[220:223], v[192:195]
 s_waitcnt lgkmcnt(0)
 m16 a[84:87], v[148:151], v[200:203], a[84:87]
 m16 a[92:95], v[148:151], v[204:207], a[92:95]
 m16 a[180:183], v[148:151], v[208:211], a[180:183]
 m16 a[188:191], v[148:151], v[212:215], a[188:191]
 m16 v[188:191], v[148:151], v[216:219], v[188:191]
 m16 v[196:199], v[148:151], v[220:223], v[196:199]
 s_waitcnt vmcnt(37)
 s_barrier
 rtr v[136:137], v80, 24576
 rtr v[138:139], v80, 26112
 rtr v[140:141], v80, 24584
 rtr v[142:143], v80, 26120
 rtr v[144:145], v81, 24576
 rtr v[146:147], v81, 26112
 ds_read_b128 v[88:91], v82 offset:24576
 ds_read_b128 v[92:95], v82 offset:26624
 ds_read_b128 v[96:99], v82 offset:28672
 ds_read_b128 v[100:103], v82 offset:30720
 ds_read_b128 v[104:107], v82 offset:32768
 ds_read_b128 v[108:111], v82 offset:34816
 s_mov_b32 m0, 0
 s_nop 0
 HWQ0
 HWQ1
 HWQ2
 HWQ3
 s_mov_b32 m0, 4096
 s_nop 0
 HWQ4
 HWQ5
 HWQ6
 s_waitcnt lgkmcnt(4)
 m16 a[0:3], v[136:139], v[224:227], a[0:3]
 HWQ7
 s_mov_b32 m0, 8192
 m16 a[8:11], v[136:139], v[228:231], a[8:11]
 ds_read_b128 v[112:115], v83 offset:24576
 HWQ8
 m16 a[96:99], v[136:139], v[232:235], a[96:99]
 ds_read_b128 v[116:119], v83 offset:26624
 HWQ9
 m16 a[104:107], v[136:139], v[236:239], a[104:107]
 ds_read_b128 v[120:123], v83 offset:28672
 HWQ10
 m16 a[192:195], v[136:139], v[240:243], a[192:195]
 HWQ11
 s_add_u32 s54, s54, 393216
 s_sub_u32 s46, s54, 7864320
 s_cmp_ge_u32 s54, 7864320
 s_cselect_b32 s54, s46, s54
 s_mov_b32 m0, 135168
 m16 a[200:203], v[136:139], v[244:247], a[200:203]
 ds_read_b128 v[124:127], v83 offset:30720
 HU0
 m16 a[4:7], v[140:143], v[224:227], a[4:7]
 ds_read_b128 v[128:131], v83 offset:32768
 HU1
 m16 a[12:15], v[140:143], v[228:231], a[12:15]
 ds_read_b128 v[132:135], v83 offset:34816
 HU2
 m16 a[100:103], v[140:143], v[232:235], a[100:103]
 HU3
 s_mov_b32 m0, 139264
 m16 a[108:111], v[140:143], v[236:239], a[108:111]
 rtr v[148:149], v81, 24584
 HU4
 m16 a[196:199], v[140:143], v[240:243], a[196:199]
 rtr v[150:151], v81, 26120
 HU5
 m16 a[204:207], v[140:143], v[244:247], a[204:207]
 rtr v[152:153], v80, 24704
 HU6
 m16 a[16:19], v[144:147], v[224:227], a[16:19]
 HU7
 s_mov_b32 m0, 143360
 m16 a[24:27], v[144:147], v[228:231], a[24:27]
 rtr v[154:155], v80, 26240
 HU8
 m16 a[112:115], v[144:147], v[232:235], a[112:115]
 rtr v[156:157], v80, 24712
 HU9
 m16 a[120:123], v[144:147], v[236:239], a[120:123]
 HU10
 m16 a[208:211], v[144:147], v[240:243], a[208:211]
 HU11
 s_add_u32 s59, s59, 393216
 s_sub_u32 s46, s59, 7864320
 s_cmp_ge_u32 s59, 7864320
 s_cselect_b32 s59, s46, s59
 s_mov_b32 m0, 61440
 m16 a[216:219], v[144:147], v[244:247], a[216:219]
 HK0
 s_waitcnt lgkmcnt(3)
 m16 a[20:23], v[148:151], v[224:227], a[20:23]
 rtr v[158:159], v80, 26248
 HK1
 m16 a[28:31], v[148:151], v[228:231], a[28:31]
 HK2
 m16 a[116:119], v[148:151], v[232:235], a[116:119]
 HK3
 s_mov_b32 m0, 65536
 m16 a[124:127], v[148:151], v[236:239], a[124:127]
 HK4
 m16 a[212:215], v[148:151], v[240:243], a[212:215]
 rtr v[160:161], v81, 24704
 HK5
 m16 a[220:223], v[148:151], v[244:247], a[220:223]
 HK6
 s_waitcnt lgkmcnt(3)
 m16 a[32:35], v[152:155], v[224:227], a[32:35]
 HK7
 s_mov_b32 m0, 69632
 m16 a[40:43], v[152:155], v[228:231], a[40:43]
 HK8
 m16 a[128:131], v[152:155], v[232:235], a[128:131]
 rtr v[162:163], v81, 26240
 HK9
 m16 a[136:139], v[152:155], v[236:239], a[136:139]
 HK10
 m16 a[224:227], v[152:155], v[240:243], a[224:227]
 HK11
 s_add_u32 s52, s52, 12288
 s_mov_b32 m0, 110592
 m16 a[232:235], v[152:155], v[244:247], a[232:235]
 HV0
 s_waitcnt lgkmcnt(2)
 m16 a[36:39], v[156:159], v[224:227], a[36:39]
 rtr v[164:165], v81, 24712
 HV1
 m16 a[44:47], v[156:159], v[228:231], a[44:47]
 HV2
 m16 a[132:135], v[156:159], v[232:235], a[132:135]
 HV3
 s_mov_b32 m0, 114688
 m16 a[140:143], v[156:159], v[236:239], a[140:143]
 HV4
 m16 a[228:231], v[156:159], v[240:243], a[228:231]
 rtr v[166:167], v81, 26248
 HV5
 m16 a[236:239], v[156:159], v[244:247], a[236:239]
 HV6
 s_waitcnt lgkmcnt(2)
 m16 a[48:51], v[160:163], v[224:227], a[48:51]
 HV7
 s_mov_b32 m0, 118784
 m16 a[56:59], v[160:163], v[228:231], a[56:59]
 HV8
 m16 a[144:147], v[160:163], v[232:235], a[144:147]
 rtr v[136:137], v80, 24832
 HV9
 m16 a[152:155], v[160:163], v[236:239], a[152:155]
 HV10
 m16 a[240:243], v[160:163], v[240:243], a[240:243]
 HV11
 s_add_u32 s53, s53, 12288
 m16 a[248:251], v[160:163], v[244:247], a[248:251]
 s_waitcnt lgkmcnt(1)
 m16 a[52:55], v[164:167], v[224:227], a[52:55]
 rtr v[138:139], v80, 26368
 m16 a[60:63], v[164:167], v[228:231], a[60:63]
 m16 a[148:151], v[164:167], v[232:235], a[148:151]
 rtr v[140:141], v80, 24840
 m16 a[156:159], v[164:167], v[236:239], a[156:159]
 m16 a[244:247], v[164:167], v[240:243], a[244:247]
 rtr v[142:143], v80, 26376
 m16 a[252:255], v[164:167], v[244:247], a[252:255]
 s_waitcnt lgkmcnt(2)
 m16 a[64:67], v[136:139], v[224:227], a[64:67]
 rtr v[144:145], v81, 24832
 m16 a[72:75], v[136:139], v[228:231], a[72:75]
 m16 a[160:163], v[136:139], v[232:235], a[160:163]
 rtr v[146:147], v81, 26368
 m16 a[168:171], v[136:139], v[236:239], a[168:171]
 m16 v[168:171], v[136:139], v[240:243], v[168:171]
 rtr v[148:149], v81, 24840
 m16 v[176:179], v[136:139], v[244:247], v[176:179]
 s_waitcnt lgkmcnt(3)
 m16 a[68:71], v[140:143], v[224:227], a[68:71]
 rtr v[150:151], v81, 26376
 m16 a[76:79], v[140:143], v[228:231], a[76:79]
 m16 a[164:167], v[140:143], v[232:235], a[164:167]
 m16 a[172:175], v[140:143], v[236:239], a[172:175]
 m16 v[172:175], v[140:143], v[240:243], v[172:175]
 m16 v[180:183], v[140:143], v[244:247], v[180:183]
 s_waitcnt lgkmcnt(2)
 m16 a[80:83], v[144:147], v[224:227], a[80:83]
 m16 a[88:91], v[144:147], v[228:231], a[88:91]
 m16 a[176:179], v[144:147], v[232:235], a[176:179]
 m16 a[184:187], v[144:147], v[236:239], a[184:187]
 m16 v[184:187], v[144:147], v[240:243], v[184:187]
 m16 v[192:195], v[144:147], v[244:247], v[192:195]
 s_waitcnt lgkmcnt(0)
 m16 a[84:87], v[148:151], v[224:227], a[84:87]
 m16 a[92:95], v[148:151], v[228:231], a[92:95]
 m16 a[180:183], v[148:151], v[232:235], a[180:183]
 m16 a[188:191], v[148:151], v[236:239], a[188:191]
 m16 v[188:191], v[148:151], v[240:243], v[188:191]
 m16 v[196:199], v[148:151], v[244:247], v[196:199]
 s_waitcnt vmcnt(36)
 s_barrier
 TWQ 12288, 393216
 TU 147456, 393216
 TX 24576, 128
 TK 73728, 12288
 s_waitcnt vmcnt(36)
 s_barrier
 rtr v[136:137], v80, 12288
 rtr v[138:139], v80, 13824
 rtr v[140:141], v80, 12296
 rtr v[142:143], v80, 13832
 rtr v[144:145], v81, 12288
 rtr v[146:147], v81, 13824
 ds_read_b128 v[200:203], v82 offset:36864
 ds_read_b128 v[204:207], v82 offset:38912
 ds_read_b128 v[208:211], v82 offset:40960
 ds_read_b128 v[212:215], v82 offset:43008
 ds_read_b128 v[216:219], v82 offset:45056
 ds_read_b128 v[220:223], v82 offset:47104
 s_mov_b32 m0, 0
 s_nop 0
 HWQ0
 HWQ1
 HWQ2
 HWQ3
 s_mov_b32 m0, 4096
 s_nop 0
 HWQ4
 HWQ5
 HWQ6
 s_waitcnt lgkmcnt(4)
 m16 a[0:3], v[136:139], v[88:91], a[0:3]
 HWQ7
 s_mov_b32 m0, 8192
 m16 a[8:11], v[136:139], v[92:95], a[8:11]
 ds_read_b128 v[224:227], v83 offset:36864
 HWQ8
 m16 a[96:99], v[136:139], v[96:99], a[96:99]
 ds_read_b128 v[228:231], v83 offset:38912
 HWQ9
 m16 a[104:107], v[136:139], v[100:103], a[104:107]
 ds_read_b128 v[232:235], v83 offset:40960
 HWQ10
 m16 a[192:195], v[136:139], v[104:107], a[192:195]
 HWQ11
 s_add_u32 s54, s54, 393216
 s_sub_u32 s46, s54, 7864320
 s_cmp_ge_u32 s54, 7864320
 s_cselect_b32 s54, s46, s54
 s_mov_b32 m0, 122880
 m16 a[200:203], v[136:139], v[108:111], a[200:203]
 ds_read_b128 v[236:239], v83 offset:43008
 HV0
 m16 a[4:7], v[140:143], v[88:91], a[4:7]
 ds_read_b128 v[240:243], v83 offset:45056
 HV1
 m16 a[12:15], v[140:143], v[92:95], a[12:15]
 ds_read_b128 v[244:247], v83 offset:47104
 HV2
 m16 a[100:103], v[140:143], v[96:99], a[100:103]
 HV3
 s_mov_b32 m0, 126976
 m16 a[108:111], v[140:143], v[100:103], a[108:111]
 rtr v[148:149], v81, 12296
 HV4
 m16 a[196:199], v[140:143], v[104:107], a[196:199]
 rtr v[150:151], v81, 13832
 HV5
 m16 a[204:207], v[140:143], v[108:111], a[204:207]
 rtr v[152:153], v80, 12416
 HV6
 m16 a[16:19], v[144:147], v[88:91], a[16:19]
 HV7
 s_mov_b32 m0, 131072
 m16 a[24:27], v[144:147], v[92:95], a[24:27]
 rtr v[154:155], v80, 13952
 HV8
 m16 a[112:115], v[144:147], v[96:99], a[112:115]
 rtr v[156:157], v80, 12424
 HV9
 m16 a[120:123], v[144:147], v[100:103], a[120:123]
 HV10
 m16 a[208:211], v[144:147], v[104:107], a[208:211]
 HV11
 s_add_u32 s53, s53, 12288
 m16 a[216:219], v[144:147], v[108:111], a[216:219]
 s_waitcnt lgkmcnt(3)
 m16 a[20:23], v[148:151], v[88:91], a[20:23]
 rtr v[158:159], v80, 13960
 m16 a[28:31], v[148:151], v[92:95], a[28:31]
 m16 a[116:119], v[148:151], v[96:99], a[116:119]
 rtr v[160:161], v81, 12416
 m16 a[124:127], v[148:151], v[100:103], a[124:127]
 m16 a[212:215], v[148:151], v[104:107], a[212:215]
 rtr v[162:163], v81, 13952
 m16 a[220:223], v[148:151], v[108:111], a[220:223]
 s_waitcnt lgkmcnt(4)
 m16 a[32:35], v[152:155], v[88:91], a[32:35]
 rtr v[164:165], v81, 12424
 m16 a[40:43], v[152:155], v[92:95], a[40:43]
 m16 a[128:131], v[152:155], v[96:99], a[128:131]
 rtr v[166:167], v81, 13960
 m16 a[136:139], v[152:155], v[100:103], a[136:139]
 m16 a[224:227], v[152:155], v[104:107], a[224:227]
 rtr v[136:137], v80, 12544
 m16 a[232:235], v[152:155], v[108:111], a[232:235]
 s_waitcnt lgkmcnt(4)
 m16 a[36:39], v[156:159], v[88:91], a[36:39]
 rtr v[138:139], v80, 14080
 m16 a[44:47], v[156:159], v[92:95], a[44:47]
 m16 a[132:135], v[156:159], v[96:99], a[132:135]
 rtr v[140:141], v80, 12552
 m16 a[140:143], v[156:159], v[100:103], a[140:143]
 m16 a[228:231], v[156:159], v[104:107], a[228:231]
 rtr v[142:143], v80, 14088
 m16 a[236:239], v[156:159], v[108:111], a[236:239]
 s_waitcnt lgkmcnt(4)
 m16 a[48:51], v[160:163], v[88:91], a[48:51]
 rtr v[144:145], v81, 12544
 m16 a[56:59], v[160:163], v[92:95], a[56:59]
 m16 a[144:147], v[160:163], v[96:99], a[144:147]
 rtr v[146:147], v81, 14080
 m16 a[152:155], v[160:163], v[100:103], a[152:155]
 m16 a[240:243], v[160:163], v[104:107], a[240:243]
 rtr v[148:149], v81, 12552
 m16 a[248:251], v[160:163], v[108:111], a[248:251]
 m16 a[52:55], v[164:167], v[88:91], a[52:55]
 rtr v[150:151], v81, 14088
 m16 a[60:63], v[164:167], v[92:95], a[60:63]
 m16 a[148:151], v[164:167], v[96:99], a[148:151]
 m16 a[156:159], v[164:167], v[100:103], a[156:159]
 m16 a[244:247], v[164:167], v[104:107], a[244:247]
 m16 a[252:255], v[164:167], v[108:111], a[252:255]
 s_waitcnt lgkmcnt(4)
 m16 a[64:67], v[136:139], v[88:91], a[64:67]
 m16 a[72:75], v[136:139], v[92:95], a[72:75]
 m16 a[160:163], v[136:139], v[96:99], a[160:163]
 m16 a[168:171], v[136:139], v[100:103], a[168:171]
 m16 v[168:171], v[136:139], v[104:107], v[168:171]
 m16 v[176:179], v[136:139], v[108:111], v[176:179]
 m16 a[68:71], v[140:143], v[88:91], a[68:71]
 m16 a[76:79], v[140:143], v[92:95], a[76:79]
 m16 a[164:167], v[140:143], v[96:99], a[164:167]
 m16 a[172:175], v[140:143], v[100:103], a[172:175]
 m16 v[172:175], v[140:143], v[104:107], v[172:175]
 m16 v[180:183], v[140:143], v[108:111], v[180:183]
 s_waitcnt lgkmcnt(2)
 m16 a[80:83], v[144:147], v[88:91], a[80:83]
 m16 a[88:91], v[144:147], v[92:95], a[88:91]
 m16 a[176:179], v[144:147], v[96:99], a[176:179]
 m16 a[184:187], v[144:147], v[100:103], a[184:187]
 m16 v[184:187], v[144:147], v[104:107], v[184:187]
 m16 v[192:195], v[144:147], v[108:111], v[192:195]
 s_waitcnt lgkmcnt(0)
 m16 a[84:87], v[148:151], v[88:91], a[84:87]
 m16 a[92:95], v[148:151], v[92:95], a[92:95]
 m16 a[180:183], v[148:151], v[96:99], a[180:183]
 m16 a[188:191], v[148:151], v[100:103], a[188:191]
 m16 v[188:191], v[148:151], v[104:107], v[188:191]
 m16 v[196:199], v[148:151], v[108:111], v[196:199]
 s_waitcnt vmcnt(12)
 s_barrier
 rtr v[136:137], v80, 24576
 rtr v[138:139], v80, 26112
 rtr v[140:141], v80, 24584
 rtr v[142:143], v80, 26120
 rtr v[144:145], v81, 24576
 rtr v[146:147], v81, 26112
 rtr v[148:149], v81, 24584
 rtr v[150:151], v81, 26120
 rtr v[152:153], v80, 24704
 rtr v[154:155], v80, 26240
 rtr v[156:157], v80, 24712
 rtr v[158:159], v80, 26248
 s_mov_b32 m0, 135168
 s_nop 0
 HU0
 HU1
 HU2
 HU3
 s_mov_b32 m0, 139264
 s_nop 0
 HU4
 HU5
 HU6
 s_waitcnt lgkmcnt(4)
 m16 a[0:3], v[136:139], v[112:115], a[0:3]
 HU7
 s_mov_b32 m0, 143360
 m16 a[8:11], v[136:139], v[116:119], a[8:11]
 rtr v[160:161], v81, 24704
 HU8
 m16 a[96:99], v[136:139], v[120:123], a[96:99]
 rtr v[162:163], v81, 26240
 HU9
 m16 a[104:107], v[136:139], v[124:127], a[104:107]
 rtr v[164:165], v81, 24712
 HU10
 m16 a[192:195], v[136:139], v[128:131], a[192:195]
 HU11
 s_add_u32 s59, s59, 393216
 s_sub_u32 s46, s59, 7864320
 s_cmp_ge_u32 s59, 7864320
 s_cselect_b32 s59, s46, s59
 s_mov_b32 m0, 12288
 m16 a[200:203], v[136:139], v[132:135], a[200:203]
 rtr v[166:167], v81, 26248
 HWQ0
 m16 a[4:7], v[140:143], v[112:115], a[4:7]
 rtr v[136:137], v80, 24832
 HWQ1
 m16 a[12:15], v[140:143], v[116:119], a[12:15]
 rtr v[138:139], v80, 26368
 HWQ2
 m16 a[100:103], v[140:143], v[120:123], a[100:103]
 HWQ3
 s_mov_b32 m0, 16384
 m16 a[108:111], v[140:143], v[124:127], a[108:111]
 HWQ4
 m16 a[196:199], v[140:143], v[128:131], a[196:199]
 HWQ5
 m16 a[204:207], v[140:143], v[132:135], a[204:207]
 rtr v[140:141], v80, 24840
 HWQ6
 m16 a[16:19], v[144:147], v[112:115], a[16:19]
 HWQ7
 s_mov_b32 m0, 20480
 m16 a[24:27], v[144:147], v[116:119], a[24:27]
 rtr v[142:143], v80, 26376
 HWQ8
 m16 a[112:115], v[144:147], v[120:123], a[112:115]
 HWQ9
 m16 a[120:123], v[144:147], v[124:127], a[120:123]
 HWQ10
 m16 a[208:211], v[144:147], v[128:131], a[208:211]
 HWQ11
 s_add_u32 s54, s54, 393216
 s_sub_u32 s46, s54, 7864320
 s_cmp_ge_u32 s54, 7864320
 s_cselect_b32 s54, s46, s54
 s_mov_b32 m0, 36864
 m16 a[216:219], v[144:147], v[132:135], a[216:219]
 HX0
 m16 a[20:23], v[148:151], v[112:115], a[20:23]
 rtr v[144:145], v81, 24832
 HX1
 m16 a[28:31], v[148:151], v[116:119], a[28:31]
 HX2
 m16 a[116:119], v[148:151], v[120:123], a[116:119]
 HX3
 s_mov_b32 m0, 40960
 m16 a[124:127], v[148:151], v[124:127], a[124:127]
 HX4
 m16 a[212:215], v[148:151], v[128:131], a[212:215]
 rtr v[146:147], v81, 26368
 HX5
 m16 a[220:223], v[148:151], v[132:135], a[220:223]
 HX6
 s_waitcnt lgkmcnt(6)
 m16 a[32:35], v[152:155], v[112:115], a[32:35]
 HX7
 s_mov_b32 m0, 45056
 m16 a[40:43], v[152:155], v[116:119], a[40:43]
 HX8
 m16 a[128:131], v[152:155], v[120:123], a[128:131]
 rtr v[148:149], v81, 24840
 HX9
 m16 a[136:139], v[152:155], v[124:127], a[136:139]
 HX10
 m16 a[224:227], v[152:155], v[128:131], a[224:227]
 HX11
 s_add_u32 s55, s55, 128
 s_sub_u32 s46, s55, 1280
 s_cmp_ge_u32 s55, s57
 s_cselect_b32 s55, s46, s55
 s_mov_b32 m0, 49152
 m16 a[232:235], v[152:155], v[132:135], a[232:235]
 HK0
 m16 a[36:39], v[156:159], v[112:115], a[36:39]
 rtr v[150:151], v81, 26376
 HK1
 m16 a[44:47], v[156:159], v[116:119], a[44:47]
 HK2
 m16 a[132:135], v[156:159], v[120:123], a[132:135]
 HK3
 s_mov_b32 m0, 53248
 m16 a[140:143], v[156:159], v[124:127], a[140:143]
 HK4
 m16 a[228:231], v[156:159], v[128:131], a[228:231]
 HK5
 m16 a[236:239], v[156:159], v[132:135], a[236:239]
 HK6
 m16 a[48:51], v[160:163], v[112:115], a[48:51]
 HK7
 s_mov_b32 m0, 57344
 m16 a[56:59], v[160:163], v[116:119], a[56:59]
 HK8
 m16 a[144:147], v[160:163], v[120:123], a[144:147]
 HK9
 m16 a[152:155], v[160:163], v[124:127], a[152:155]
 HK10
 m16 a[240:243], v[160:163], v[128:131], a[240:243]
 HK11
 s_add_u32 s52, s52, 12288
 s_mov_b32 m0, 86016
 m16 a[248:251], v[160:163], v[132:135], a[248:251]
 HV0
 m16 a[52:55], v[164:167], v[112:115], a[52:55]
 HV1
 m16 a[60:63], v[164:167], v[116:119], a[60:63]
 HV2
 m16 a[148:151], v[164:167], v[120:123], a[148:151]
 HV3
 s_mov_b32 m0, 90112
 m16 a[156:159], v[164:167], v[124:127], a[156:159]
 HV4
 m16 a[244:247], v[164:167], v[128:131], a[244:247]
 HV5
 m16 a[252:255], v[164:167], v[132:135], a[252:255]
 HV6
 s_waitcnt lgkmcnt(4)
 m16 a[64:67], v[136:139], v[112:115], a[64:67]
 HV7
 s_mov_b32 m0, 94208
 m16 a[72:75], v[136:139], v[116:119], a[72:75]
 HV8
 m16 a[160:163], v[136:139], v[120:123], a[160:163]
 HV9
 m16 a[168:171], v[136:139], v[124:127], a[168:171]
 HV10
 m16 v[168:171], v[136:139], v[128:131], v[168:171]
 HV11
 s_add_u32 s53, s53, 12288
 m16 v[176:179], v[136:139], v[132:135], v[176:179]
 s_add_u32 s46, s4, 4719360
 buffer_load_dword v78, v77, s[16:19], s46 offen
 m16 a[68:71], v[140:143], v[112:115], a[68:71]
 m16 a[76:79], v[140:143], v[116:119], a[76:79]
 m16 a[164:167], v[140:143], v[120:123], a[164:167]
 m16 a[172:175], v[140:143], v[124:127], a[172:175]
 m16 v[172:175], v[140:143], v[128:131], v[172:175]
 m16 v[180:183], v[140:143], v[132:135], v[180:183]
 s_waitcnt lgkmcnt(2)
 m16 a[80:83], v[144:147], v[112:115], a[80:83]
 m16 a[88:91], v[144:147], v[116:119], a[88:91]
 m16 a[176:179], v[144:147], v[120:123], a[176:179]
 m16 a[184:187], v[144:147], v[124:127], a[184:187]
 m16 v[184:187], v[144:147], v[128:131], v[184:187]
 m16 v[192:195], v[144:147], v[132:135], v[192:195]
 s_waitcnt lgkmcnt(0)
 m16 a[84:87], v[148:151], v[112:115], a[84:87]
 m16 a[92:95], v[148:151], v[116:119], a[92:95]
 m16 a[180:183], v[148:151], v[120:123], a[180:183]
 m16 a[188:191], v[148:151], v[124:127], a[188:191]
 m16 v[188:191], v[148:151], v[128:131], v[188:191]
 m16 v[196:199], v[148:151], v[132:135], v[196:199]
 s_waitcnt vmcnt(37)
 s_barrier
 rtr v[136:137], v80, 12288
 rtr v[138:139], v80, 13824
 rtr v[140:141], v80, 12296
 rtr v[142:143], v80, 13832
 rtr v[144:145], v81, 12288
 rtr v[146:147], v81, 13824
 ds_read_b128 v[88:91], v82 offset:24576
 ds_read_b128 v[92:95], v82 offset:26624
 ds_read_b128 v[96:99], v82 offset:28672
 ds_read_b128 v[100:103], v82 offset:30720
 ds_read_b128 v[104:107], v82 offset:32768
 ds_read_b128 v[108:111], v82 offset:34816
 s_mov_b32 m0, 147456
 s_nop 0
 HU0
 HU1
 HU2
 HU3
 s_mov_b32 m0, 151552
 s_nop 0
 HU4
 HU5
 HU6
 s_waitcnt lgkmcnt(4)
 m16 a[0:3], v[136:139], v[200:203], a[0:3]
 HU7
 s_mov_b32 m0, 155648
 m16 a[8:11], v[136:139], v[204:207], a[8:11]
 ds_read_b128 v[112:115], v83 offset:24576
 HU8
 m16 a[96:99], v[136:139], v[208:211], a[96:99]
 ds_read_b128 v[116:119], v83 offset:26624
 HU9
 m16 a[104:107], v[136:139], v[212:215], a[104:107]
 ds_read_b128 v[120:123], v83 offset:28672
 HU10
 m16 a[192:195], v[136:139], v[216:219], a[192:195]
 HU11
 s_add_u32 s59, s59, 393216
 s_sub_u32 s46, s59, 7864320
 s_cmp_ge_u32 s59, 7864320
 s_cselect_b32 s59, s46, s59
 s_mov_b32 m0, 0
 m16 a[200:203], v[136:139], v[220:223], a[200:203]
 ds_read_b128 v[124:127], v83 offset:30720
 HWQ0
 m16 a[4:7], v[140:143], v[200:203], a[4:7]
 ds_read_b128 v[128:131], v83 offset:32768
 HWQ1
 m16 a[12:15], v[140:143], v[204:207], a[12:15]
 ds_read_b128 v[132:135], v83 offset:34816
 HWQ2
 m16 a[100:103], v[140:143], v[208:211], a[100:103]
 HWQ3
 s_mov_b32 m0, 4096
 m16 a[108:111], v[140:143], v[212:215], a[108:111]
 rtr v[148:149], v81, 12296
 HWQ4
 m16 a[196:199], v[140:143], v[216:219], a[196:199]
 rtr v[150:151], v81, 13832
 HWQ5
 m16 a[204:207], v[140:143], v[220:223], a[204:207]
 rtr v[152:153], v80, 12416
 HWQ6
 m16 a[16:19], v[144:147], v[200:203], a[16:19]
 HWQ7
 s_mov_b32 m0, 8192
 m16 a[24:27], v[144:147], v[204:207], a[24:27]
 rtr v[154:155], v80, 13952
 HWQ8
 m16 a[112:115], v[144:147], v[208:211], a[112:115]
 rtr v[156:157], v80, 12424
 HWQ9
 m16 a[120:123], v[144:147], v[212:215], a[120:123]
 HWQ10
 m16 a[208:211], v[144:147], v[216:219], a[208:211]
 HWQ11
 s_add_u32 s54, s54, 393216
 s_sub_u32 s46, s54, 7864320
 s_cmp_ge_u32 s54, 7864320
 s_cselect_b32 s54, s46, s54
 s_mov_b32 m0, 61440
 m16 a[216:219], v[144:147], v[220:223], a[216:219]
 HK0
 s_waitcnt lgkmcnt(3)
 m16 a[20:23], v[148:151], v[200:203], a[20:23]
 rtr v[158:159], v80, 13960
 HK1
 m16 a[28:31], v[148:151], v[204:207], a[28:31]
 HK2
 m16 a[116:119], v[148:151], v[208:211], a[116:119]
 HK3
 s_mov_b32 m0, 65536
 m16 a[124:127], v[148:151], v[212:215], a[124:127]
 HK4
 m16 a[212:215], v[148:151], v[216:219], a[212:215]
 rtr v[160:161], v81, 12416
 HK5
 m16 a[220:223], v[148:151], v[220:223], a[220:223]
 HK6
 s_waitcnt lgkmcnt(3)
 m16 a[32:35], v[152:155], v[200:203], a[32:35]
 HK7
 s_mov_b32 m0, 69632
 m16 a[40:43], v[152:155], v[204:207], a[40:43]
 HK8
 m16 a[128:131], v[152:155], v[208:211], a[128:131]
 rtr v[162:163], v81, 13952
 HK9
 m16 a[136:139], v[152:155], v[212:215], a[136:139]
 HK10
 m16 a[224:227], v[152:155], v[216:219], a[224:227]
 HK11
 s_add_u32 s52, s52, 12288
 s_mov_b32 m0, 98304
 m16 a[232:235], v[152:155], v[220:223], a[232:235]
 HV0
 s_waitcnt lgkmcnt(2)
 m16 a[36:39], v[156:159], v[200:203], a[36:39]
 rtr v[164:165], v81, 12424
 HV1
 m16 a[44:47], v[156:159], v[204:207], a[44:47]
 HV2
 m16 a[132:135], v[156:159], v[208:211], a[132:135]
 HV3
 s_mov_b32 m0, 102400
 m16 a[140:143], v[156:159], v[212:215], a[140:143]
 HV4
 m16 a[228:231], v[156:159], v[216:219], a[228:231]
 rtr v[166:167], v81, 13960
 HV5
 m16 a[236:239], v[156:159], v[220:223], a[236:239]
 HV6
 s_waitcnt lgkmcnt(2)
 m16 a[48:51], v[160:163], v[200:203], a[48:51]
 HV7
 s_mov_b32 m0, 106496
 m16 a[56:59], v[160:163], v[204:207], a[56:59]
 HV8
 m16 a[144:147], v[160:163], v[208:211], a[144:147]
 rtr v[136:137], v80, 12544
 HV9
 m16 a[152:155], v[160:163], v[212:215], a[152:155]
 HV10
 m16 a[240:243], v[160:163], v[216:219], a[240:243]
 HV11
 s_add_u32 s53, s53, 12288
 m16 a[248:251], v[160:163], v[220:223], a[248:251]
 s_add_u32 s46, s4, 6291840
 buffer_load_dword v78, v77, s[16:19], s46 offen
 s_waitcnt lgkmcnt(1)
 m16 a[52:55], v[164:167], v[200:203], a[52:55]
 v_add_co_u32 v10, vcc, LOOP-LOADER, v8
 s_nop 1
 v_addc_co_u32 v11, vcc, 0, v9, vcc
 global_load_dword v78, v[10:11], off
 m16 a[60:63], v[164:167], v[204:207], a[60:63]
 m16 a[148:151], v[164:167], v[208:211], a[148:151]
 rtr v[138:139], v80, 14080
 m16 a[156:159], v[164:167], v[212:215], a[156:159]
 m16 a[244:247], v[164:167], v[216:219], a[244:247]
 rtr v[140:141], v80, 12552
 m16 a[252:255], v[164:167], v[220:223], a[252:255]
 s_waitcnt lgkmcnt(1)
 m16 a[64:67], v[136:139], v[200:203], a[64:67]
 rtr v[142:143], v80, 14088
 m16 a[72:75], v[136:139], v[204:207], a[72:75]
 m16 a[160:163], v[136:139], v[208:211], a[160:163]
 rtr v[144:145], v81, 12544
 m16 a[168:171], v[136:139], v[212:215], a[168:171]
 m16 v[168:171], v[136:139], v[216:219], v[168:171]
 rtr v[146:147], v81, 14080
 m16 v[176:179], v[136:139], v[220:223], v[176:179]
 s_waitcnt lgkmcnt(2)
 m16 a[68:71], v[140:143], v[200:203], a[68:71]
 rtr v[148:149], v81, 12552
 m16 a[76:79], v[140:143], v[204:207], a[76:79]
 m16 a[164:167], v[140:143], v[208:211], a[164:167]
 rtr v[150:151], v81, 14088
 m16 a[172:175], v[140:143], v[212:215], a[172:175]
 m16 v[172:175], v[140:143], v[216:219], v[172:175]
 m16 v[180:183], v[140:143], v[220:223], v[180:183]
 s_waitcnt lgkmcnt(2)
 m16 a[80:83], v[144:147], v[200:203], a[80:83]
 m16 a[88:91], v[144:147], v[204:207], a[88:91]
 m16 a[176:179], v[144:147], v[208:211], a[176:179]
 m16 a[184:187], v[144:147], v[212:215], a[184:187]
 m16 v[184:187], v[144:147], v[216:219], v[184:187]
 m16 v[192:195], v[144:147], v[220:223], v[192:195]
 s_waitcnt lgkmcnt(0)
 m16 a[84:87], v[148:151], v[200:203], a[84:87]
 m16 a[92:95], v[148:151], v[204:207], a[92:95]
 m16 a[180:183], v[148:151], v[208:211], a[180:183]
 m16 a[188:191], v[148:151], v[212:215], a[188:191]
 m16 v[188:191], v[148:151], v[216:219], v[188:191]
 m16 v[196:199], v[148:151], v[220:223], v[196:199]
 s_waitcnt vmcnt(26)
 s_barrier
 rtr v[136:137], v80, 24576
 rtr v[138:139], v80, 26112
 rtr v[140:141], v80, 24584
 rtr v[142:143], v80, 26120
 rtr v[144:145], v81, 24576
 rtr v[146:147], v81, 26112
 rtr v[148:149], v81, 24584
 rtr v[150:151], v81, 26120
 rtr v[152:153], v80, 24704
 rtr v[154:155], v80, 26240
 rtr v[156:157], v80, 24712
 rtr v[158:159], v80, 26248
 s_mov_b32 m0, 135168
 s_nop 0
 HU0
 HU1
 HU2
 HU3
 s_mov_b32 m0, 139264
 s_nop 0
 HU4
 HU5
 HU6
 s_waitcnt lgkmcnt(4)
 m16 a[0:3], v[136:139], v[224:227], a[0:3]
 HU7
 s_mov_b32 m0, 143360
 m16 a[8:11], v[136:139], v[228:231], a[8:11]
 rtr v[160:161], v81, 24704
 HU8
 m16 a[96:99], v[136:139], v[232:235], a[96:99]
 rtr v[162:163], v81, 26240
 HU9
 m16 a[104:107], v[136:139], v[236:239], a[104:107]
 rtr v[164:165], v81, 24712
 HU10
 m16 a[192:195], v[136:139], v[240:243], a[192:195]
 HU11
 s_add_u32 s59, s59, 393216
 s_sub_u32 s46, s59, 7864320
 s_cmp_ge_u32 s59, 7864320
 s_cselect_b32 s59, s46, s59
 s_mov_b32 m0, 12288
 m16 a[200:203], v[136:139], v[244:247], a[200:203]
 rtr v[166:167], v81, 26248
 HWQ0
 m16 a[4:7], v[140:143], v[224:227], a[4:7]
 rtr v[136:137], v80, 24832
 HWQ1
 m16 a[12:15], v[140:143], v[228:231], a[12:15]
 rtr v[138:139], v80, 26368
 HWQ2
 m16 a[100:103], v[140:143], v[232:235], a[100:103]
 HWQ3
 s_mov_b32 m0, 16384
 m16 a[108:111], v[140:143], v[236:239], a[108:111]
 HWQ4
 m16 a[196:199], v[140:143], v[240:243], a[196:199]
 HWQ5
 m16 a[204:207], v[140:143], v[244:247], a[204:207]
 rtr v[140:141], v80, 24840
 HWQ6
 m16 a[16:19], v[144:147], v[224:227], a[16:19]
 HWQ7
 s_mov_b32 m0, 20480
 m16 a[24:27], v[144:147], v[228:231], a[24:27]
 rtr v[142:143], v80, 26376
 HWQ8
 m16 a[112:115], v[144:147], v[232:235], a[112:115]
 HWQ9
 m16 a[120:123], v[144:147], v[236:239], a[120:123]
 HWQ10
 m16 a[208:211], v[144:147], v[240:243], a[208:211]
 HWQ11
 s_add_u32 s54, s54, 393216
 s_sub_u32 s46, s54, 7864320
 s_cmp_ge_u32 s54, 7864320
 s_cselect_b32 s54, s46, s54
 s_mov_b32 m0, 24576
 m16 a[216:219], v[144:147], v[244:247], a[216:219]
 HX0
 m16 a[20:23], v[148:151], v[224:227], a[20:23]
 rtr v[144:145], v81, 24832
 HX1
 m16 a[28:31], v[148:151], v[228:231], a[28:31]
 HX2
 m16 a[116:119], v[148:151], v[232:235], a[116:119]
 HX3
 s_mov_b32 m0, 28672
 m16 a[124:127], v[148:151], v[236:239], a[124:127]
 HX4
 m16 a[212:215], v[148:151], v[240:243], a[212:215]
 rtr v[146:147], v81, 26368
 HX5
 m16 a[220:223], v[148:151], v[244:247], a[220:223]
 HX6
 s_waitcnt lgkmcnt(6)
 m16 a[32:35], v[152:155], v[224:227], a[32:35]
 HX7
 s_mov_b32 m0, 32768
 m16 a[40:43], v[152:155], v[228:231], a[40:43]
 HX8
 m16 a[128:131], v[152:155], v[232:235], a[128:131]
 rtr v[148:149], v81, 24840
 HX9
 m16 a[136:139], v[152:155], v[236:239], a[136:139]
 HX10
 m16 a[224:227], v[152:155], v[240:243], a[224:227]
 HX11
 s_add_u32 s55, s55, 128
 s_sub_u32 s46, s55, 1280
 s_cmp_ge_u32 s55, s57
 s_cselect_b32 s55, s46, s55
 s_mov_b32 m0, 73728
 m16 a[232:235], v[152:155], v[244:247], a[232:235]
 HK0
 m16 a[36:39], v[156:159], v[224:227], a[36:39]
 rtr v[150:151], v81, 26376
 HK1
 m16 a[44:47], v[156:159], v[228:231], a[44:47]
 HK2
 m16 a[132:135], v[156:159], v[232:235], a[132:135]
 HK3
 s_mov_b32 m0, 77824
 m16 a[140:143], v[156:159], v[236:239], a[140:143]
 HK4
 m16 a[228:231], v[156:159], v[240:243], a[228:231]
 HK5
 m16 a[236:239], v[156:159], v[244:247], a[236:239]
 HK6
 m16 a[48:51], v[160:163], v[224:227], a[48:51]
 HK7
 s_mov_b32 m0, 81920
 m16 a[56:59], v[160:163], v[228:231], a[56:59]
 HK8
 m16 a[144:147], v[160:163], v[232:235], a[144:147]
 HK9
 m16 a[152:155], v[160:163], v[236:239], a[152:155]
 HK10
 m16 a[240:243], v[160:163], v[240:243], a[240:243]
 HK11
 s_add_u32 s52, s52, 12288
 s_mov_b32 m0, 110592
 m16 a[248:251], v[160:163], v[244:247], a[248:251]
 HV0
 m16 a[52:55], v[164:167], v[224:227], a[52:55]
 HV1
 m16 a[60:63], v[164:167], v[228:231], a[60:63]
 HV2
 m16 a[148:151], v[164:167], v[232:235], a[148:151]
 HV3
 s_mov_b32 m0, 114688
 m16 a[156:159], v[164:167], v[236:239], a[156:159]
 HV4
 m16 a[244:247], v[164:167], v[240:243], a[244:247]
 HV5
 m16 a[252:255], v[164:167], v[244:247], a[252:255]
 HV6
 s_waitcnt lgkmcnt(4)
 m16 a[64:67], v[136:139], v[224:227], a[64:67]
 HV7
 s_mov_b32 m0, 118784
 m16 a[72:75], v[136:139], v[228:231], a[72:75]
 HV8
 m16 a[160:163], v[136:139], v[232:235], a[160:163]
 HV9
 m16 a[168:171], v[136:139], v[236:239], a[168:171]
 HV10
 m16 v[168:171], v[136:139], v[240:243], v[168:171]
 HV11
 s_add_u32 s53, s53, 12288
 m16 v[176:179], v[136:139], v[244:247], v[176:179]
 m16 a[68:71], v[140:143], v[224:227], a[68:71]
 m16 a[76:79], v[140:143], v[228:231], a[76:79]
 m16 a[164:167], v[140:143], v[232:235], a[164:167]
 m16 a[172:175], v[140:143], v[236:239], a[172:175]
 m16 v[172:175], v[140:143], v[240:243], v[172:175]
 m16 v[180:183], v[140:143], v[244:247], v[180:183]
 s_waitcnt lgkmcnt(2)
 m16 a[80:83], v[144:147], v[224:227], a[80:83]
 m16 a[88:91], v[144:147], v[228:231], a[88:91]
 m16 a[176:179], v[144:147], v[232:235], a[176:179]
 m16 a[184:187], v[144:147], v[236:239], a[184:187]
 m16 v[184:187], v[144:147], v[240:243], v[184:187]
 m16 v[192:195], v[144:147], v[244:247], v[192:195]
 s_waitcnt lgkmcnt(0)
 m16 a[84:87], v[148:151], v[224:227], a[84:87]
 m16 a[92:95], v[148:151], v[228:231], a[92:95]
 m16 a[180:183], v[148:151], v[232:235], a[180:183]
 m16 a[188:191], v[148:151], v[236:239], a[188:191]
 m16 v[188:191], v[148:151], v[240:243], v[188:191]
 m16 v[196:199], v[148:151], v[244:247], v[196:199]
 s_waitcnt vmcnt(36)
 s_barrier
 rtr v[136:137], v80, 12288
 rtr v[138:139], v80, 13824
 rtr v[140:141], v80, 12296
 rtr v[142:143], v80, 13832
 rtr v[144:145], v81, 12288
 rtr v[146:147], v81, 13824
 ds_read_b128 v[200:203], v82 offset:36864
 ds_read_b128 v[204:207], v82 offset:38912
 ds_read_b128 v[208:211], v82 offset:40960
 ds_read_b128 v[212:215], v82 offset:43008
 ds_read_b128 v[216:219], v82 offset:45056
 ds_read_b128 v[220:223], v82 offset:47104
 s_mov_b32 m0, 147456
 s_nop 0
 HU0
 HU1
 HU2
 HU3
 s_mov_b32 m0, 151552
 s_nop 0
 HU4
 HU5
 HU6
 s_waitcnt lgkmcnt(4)
 m16 a[0:3], v[136:139], v[88:91], a[0:3]
 HU7
 s_mov_b32 m0, 155648
 m16 a[8:11], v[136:139], v[92:95], a[8:11]
 ds_read_b128 v[224:227], v83 offset:36864
 HU8
 m16 a[96:99], v[136:139], v[96:99], a[96:99]
 ds_read_b128 v[228:231], v83 offset:38912
 HU9
 m16 a[104:107], v[136:139], v[100:103], a[104:107]
 ds_read_b128 v[232:235], v83 offset:40960
 HU10
 m16 a[192:195], v[136:139], v[104:107], a[192:195]
 HU11
 s_add_u32 s59, s59, 393216
 s_sub_u32 s46, s59, 7864320
 s_cmp_ge_u32 s59, 7864320
 s_cselect_b32 s59, s46, s59
 s_mov_b32 m0, 0
 m16 a[200:203], v[136:139], v[108:111], a[200:203]
 ds_read_b128 v[236:239], v83 offset:43008
 HWQ0
 m16 a[4:7], v[140:143], v[88:91], a[4:7]
 ds_read_b128 v[240:243], v83 offset:45056
 HWQ1
 m16 a[12:15], v[140:143], v[92:95], a[12:15]
 ds_read_b128 v[244:247], v83 offset:47104
 HWQ2
 m16 a[100:103], v[140:143], v[96:99], a[100:103]
 HWQ3
 s_mov_b32 m0, 4096
 m16 a[108:111], v[140:143], v[100:103], a[108:111]
 rtr v[148:149], v81, 12296
 HWQ4
 m16 a[196:199], v[140:143], v[104:107], a[196:199]
 rtr v[150:151], v81, 13832
 HWQ5
 m16 a[204:207], v[140:143], v[108:111], a[204:207]
 rtr v[152:153], v80, 12416
 HWQ6
 m16 a[16:19], v[144:147], v[88:91], a[16:19]
 HWQ7
 s_mov_b32 m0, 8192
 m16 a[24:27], v[144:147], v[92:95], a[24:27]
 rtr v[154:155], v80, 13952
 HWQ8
 m16 a[112:115], v[144:147], v[96:99], a[112:115]
 rtr v[156:157], v80, 12424
 HWQ9
 m16 a[120:123], v[144:147], v[100:103], a[120:123]
 HWQ10
 m16 a[208:211], v[144:147], v[104:107], a[208:211]
 HWQ11
 s_add_u32 s54, s54, 393216
 s_sub_u32 s46, s54, 7864320
 s_cmp_ge_u32 s54, 7864320
 s_cselect_b32 s54, s46, s54
 s_mov_b32 m0, 49152
 m16 a[216:219], v[144:147], v[108:111], a[216:219]
 HK0
 s_waitcnt lgkmcnt(3)
 m16 a[20:23], v[148:151], v[88:91], a[20:23]
 rtr v[158:159], v80, 13960
 HK1
 m16 a[28:31], v[148:151], v[92:95], a[28:31]
 HK2
 m16 a[116:119], v[148:151], v[96:99], a[116:119]
 HK3
 s_mov_b32 m0, 53248
 m16 a[124:127], v[148:151], v[100:103], a[124:127]
 HK4
 m16 a[212:215], v[148:151], v[104:107], a[212:215]
 rtr v[160:161], v81, 12416
 HK5
 m16 a[220:223], v[148:151], v[108:111], a[220:223]
 HK6
 s_waitcnt lgkmcnt(3)
 m16 a[32:35], v[152:155], v[88:91], a[32:35]
 HK7
 s_mov_b32 m0, 57344
 m16 a[40:43], v[152:155], v[92:95], a[40:43]
 HK8
 m16 a[128:131], v[152:155], v[96:99], a[128:131]
 rtr v[162:163], v81, 13952
 HK9
 m16 a[136:139], v[152:155], v[100:103], a[136:139]
 HK10
 m16 a[224:227], v[152:155], v[104:107], a[224:227]
 HK11
 s_add_u32 s52, s52, 24576
 s_mov_b32 m0, 122880
 m16 a[232:235], v[152:155], v[108:111], a[232:235]
 HV0
 s_waitcnt lgkmcnt(2)
 m16 a[36:39], v[156:159], v[88:91], a[36:39]
 rtr v[164:165], v81, 12424
 HV1
 m16 a[44:47], v[156:159], v[92:95], a[44:47]
 HV2
 m16 a[132:135], v[156:159], v[96:99], a[132:135]
 HV3
 s_mov_b32 m0, 126976
 m16 a[140:143], v[156:159], v[100:103], a[140:143]
 HV4
 m16 a[228:231], v[156:159], v[104:107], a[228:231]
 rtr v[166:167], v81, 13960
 HV5
 m16 a[236:239], v[156:159], v[108:111], a[236:239]
 HV6
 s_waitcnt lgkmcnt(2)
 m16 a[48:51], v[160:163], v[88:91], a[48:51]
 HV7
 s_mov_b32 m0, 131072
 m16 a[56:59], v[160:163], v[92:95], a[56:59]
 HV8
 m16 a[144:147], v[160:163], v[96:99], a[144:147]
 rtr v[136:137], v80, 12544
 HV9
 m16 a[152:155], v[160:163], v[100:103], a[152:155]
 HV10
 m16 a[240:243], v[160:163], v[104:107], a[240:243]
 HV11
 s_add_u32 s53, s53, 12288
 m16 a[248:251], v[160:163], v[108:111], a[248:251]
 s_waitcnt lgkmcnt(1)
 m16 a[52:55], v[164:167], v[88:91], a[52:55]
 rtr v[138:139], v80, 14080
 m16 a[60:63], v[164:167], v[92:95], a[60:63]
 m16 a[148:151], v[164:167], v[96:99], a[148:151]
 rtr v[140:141], v80, 12552
 m16 a[156:159], v[164:167], v[100:103], a[156:159]
 m16 a[244:247], v[164:167], v[104:107], a[244:247]
 rtr v[142:143], v80, 14088
 m16 a[252:255], v[164:167], v[108:111], a[252:255]
 s_waitcnt lgkmcnt(2)
 m16 a[64:67], v[136:139], v[88:91], a[64:67]
 rtr v[144:145], v81, 12544
 m16 a[72:75], v[136:139], v[92:95], a[72:75]
 m16 a[160:163], v[136:139], v[96:99], a[160:163]
 rtr v[146:147], v81, 14080
 m16 a[168:171], v[136:139], v[100:103], a[168:171]
 m16 v[168:171], v[136:139], v[104:107], v[168:171]
 rtr v[148:149], v81, 12552
 m16 v[176:179], v[136:139], v[108:111], v[176:179]
 s_waitcnt lgkmcnt(3)
 m16 a[68:71], v[140:143], v[88:91], a[68:71]
 rtr v[150:151], v81, 14088
 m16 a[76:79], v[140:143], v[92:95], a[76:79]
 m16 a[164:167], v[140:143], v[96:99], a[164:167]
 m16 a[172:175], v[140:143], v[100:103], a[172:175]
 m16 v[172:175], v[140:143], v[104:107], v[172:175]
 m16 v[180:183], v[140:143], v[108:111], v[180:183]
 s_waitcnt lgkmcnt(2)
 m16 a[80:83], v[144:147], v[88:91], a[80:83]
 m16 a[88:91], v[144:147], v[92:95], a[88:91]
 m16 a[176:179], v[144:147], v[96:99], a[176:179]
 m16 a[184:187], v[144:147], v[100:103], a[184:187]
 m16 v[184:187], v[144:147], v[104:107], v[184:187]
 m16 v[192:195], v[144:147], v[108:111], v[192:195]
 s_waitcnt lgkmcnt(0)
 m16 a[84:87], v[148:151], v[88:91], a[84:87]
 m16 a[92:95], v[148:151], v[92:95], a[92:95]
 m16 a[180:183], v[148:151], v[96:99], a[180:183]
 m16 a[188:191], v[148:151], v[100:103], a[188:191]
 m16 v[188:191], v[148:151], v[104:107], v[188:191]
 m16 v[196:199], v[148:151], v[108:111], v[196:199]
 s_waitcnt vmcnt(24)
 s_barrier
 rtr v[136:137], v80, 24576
 rtr v[138:139], v80, 26112
 rtr v[140:141], v80, 24584
 rtr v[142:143], v80, 26120
 rtr v[144:145], v81, 24576
 rtr v[146:147], v81, 26112
 rtr v[148:149], v81, 24584
 rtr v[150:151], v81, 26120
 rtr v[152:153], v80, 24704
 rtr v[154:155], v80, 26240
 rtr v[156:157], v80, 24712
 rtr v[158:159], v80, 26248
 s_mov_b32 m0, 135168
 s_nop 0
 HU0
 HU1
 HU2
 HU3
 s_mov_b32 m0, 139264
 s_nop 0
 HU4
 HU5
 HU6
 s_waitcnt lgkmcnt(4)
 m16 a[0:3], v[136:139], v[112:115], a[0:3]
 HU7
 s_mov_b32 m0, 143360
 m16 a[8:11], v[136:139], v[116:119], a[8:11]
 rtr v[160:161], v81, 24704
 HU8
 m16 a[96:99], v[136:139], v[120:123], a[96:99]
 rtr v[162:163], v81, 26240
 HU9
 m16 a[104:107], v[136:139], v[124:127], a[104:107]
 rtr v[164:165], v81, 24712
 HU10
 m16 a[192:195], v[136:139], v[128:131], a[192:195]
 HU11
 s_add_u32 s59, s59, 393216
 s_sub_u32 s46, s59, 7864320
 s_cmp_ge_u32 s59, 7864320
 s_cselect_b32 s59, s46, s59
 s_mov_b32 m0, 12288
 m16 a[200:203], v[136:139], v[132:135], a[200:203]
 rtr v[166:167], v81, 26248
 HWQ0
 m16 a[4:7], v[140:143], v[112:115], a[4:7]
 rtr v[136:137], v80, 24832
 HWQ1
 m16 a[12:15], v[140:143], v[116:119], a[12:15]
 rtr v[138:139], v80, 26368
 HWQ2
 m16 a[100:103], v[140:143], v[120:123], a[100:103]
 HWQ3
 s_mov_b32 m0, 16384
 m16 a[108:111], v[140:143], v[124:127], a[108:111]
 HWQ4
 m16 a[196:199], v[140:143], v[128:131], a[196:199]
 HWQ5
 m16 a[204:207], v[140:143], v[132:135], a[204:207]
 rtr v[140:141], v80, 24840
 HWQ6
 m16 a[16:19], v[144:147], v[112:115], a[16:19]
 HWQ7
 s_mov_b32 m0, 20480
 m16 a[24:27], v[144:147], v[116:119], a[24:27]
 rtr v[142:143], v80, 26376
 HWQ8
 m16 a[112:115], v[144:147], v[120:123], a[112:115]
 HWQ9
 m16 a[120:123], v[144:147], v[124:127], a[120:123]
 HWQ10
 m16 a[208:211], v[144:147], v[128:131], a[208:211]
 HWQ11
 s_add_u32 s54, s54, 393216
 s_sub_u32 s46, s54, 7864320
 s_cmp_ge_u32 s54, 7864320
 s_cselect_b32 s54, s46, s54
 s_mov_b32 m0, 36864
 m16 a[216:219], v[144:147], v[132:135], a[216:219]
 HX0
 m16 a[20:23], v[148:151], v[112:115], a[20:23]
 rtr v[144:145], v81, 24832
 HX1
 m16 a[28:31], v[148:151], v[116:119], a[28:31]
 HX2
 m16 a[116:119], v[148:151], v[120:123], a[116:119]
 HX3
 s_mov_b32 m0, 40960
 m16 a[124:127], v[148:151], v[124:127], a[124:127]
 HX4
 m16 a[212:215], v[148:151], v[128:131], a[212:215]
 rtr v[146:147], v81, 26368
 HX5
 m16 a[220:223], v[148:151], v[132:135], a[220:223]
 HX6
 s_waitcnt lgkmcnt(6)
 m16 a[32:35], v[152:155], v[112:115], a[32:35]
 HX7
 s_mov_b32 m0, 45056
 m16 a[40:43], v[152:155], v[116:119], a[40:43]
 HX8
 m16 a[128:131], v[152:155], v[120:123], a[128:131]
 rtr v[148:149], v81, 24840
 HX9
 m16 a[136:139], v[152:155], v[124:127], a[136:139]
 HX10
 m16 a[224:227], v[152:155], v[128:131], a[224:227]
 HX11
 s_add_u32 s55, s55, 128
 s_sub_u32 s46, s55, 1280
 s_cmp_ge_u32 s55, s57
 s_cselect_b32 s55, s46, s55
 s_mov_b32 m0, 61440
 m16 a[232:235], v[152:155], v[132:135], a[232:235]
 HK0
 m16 a[36:39], v[156:159], v[112:115], a[36:39]
 rtr v[150:151], v81, 26376
 HK1
 m16 a[44:47], v[156:159], v[116:119], a[44:47]
 HK2
 m16 a[132:135], v[156:159], v[120:123], a[132:135]
 HK3
 s_mov_b32 m0, 65536
 m16 a[140:143], v[156:159], v[124:127], a[140:143]
 HK4
 m16 a[228:231], v[156:159], v[128:131], a[228:231]
 HK5
 m16 a[236:239], v[156:159], v[132:135], a[236:239]
 HK6
 m16 a[48:51], v[160:163], v[112:115], a[48:51]
 HK7
 s_mov_b32 m0, 69632
 m16 a[56:59], v[160:163], v[116:119], a[56:59]
 HK8
 m16 a[144:147], v[160:163], v[120:123], a[144:147]
 HK9
 m16 a[152:155], v[160:163], v[124:127], a[152:155]
 HK10
 m16 a[240:243], v[160:163], v[128:131], a[240:243]
 HK11
 s_add_u32 s52, s52, -12288
 m16 a[248:251], v[160:163], v[132:135], a[248:251]
 s_add_u32 s46, s58, 0
 buffer_load_dword v78, v76, s[24:27], s46 offen
 m16 a[52:55], v[164:167], v[112:115], a[52:55]
 s_add_u32 s46, s4, 6292224
 buffer_load_dword v78, v77, s[16:19], s46 offen
 m16 a[60:63], v[164:167], v[116:119], a[60:63]
 m16 a[148:151], v[164:167], v[120:123], a[148:151]
 m16 a[156:159], v[164:167], v[124:127], a[156:159]
 m16 a[244:247], v[164:167], v[128:131], a[244:247]
 m16 a[252:255], v[164:167], v[132:135], a[252:255]
 s_waitcnt lgkmcnt(4)
 m16 a[64:67], v[136:139], v[112:115], a[64:67]
 m16 a[72:75], v[136:139], v[116:119], a[72:75]
 m16 a[160:163], v[136:139], v[120:123], a[160:163]
 m16 a[168:171], v[136:139], v[124:127], a[168:171]
 m16 v[168:171], v[136:139], v[128:131], v[168:171]
 m16 v[176:179], v[136:139], v[132:135], v[176:179]
 m16 a[68:71], v[140:143], v[112:115], a[68:71]
 m16 a[76:79], v[140:143], v[116:119], a[76:79]
 m16 a[164:167], v[140:143], v[120:123], a[164:167]
 m16 a[172:175], v[140:143], v[124:127], a[172:175]
 m16 v[172:175], v[140:143], v[128:131], v[172:175]
 m16 v[180:183], v[140:143], v[132:135], v[180:183]
 s_waitcnt lgkmcnt(2)
 m16 a[80:83], v[144:147], v[112:115], a[80:83]
 m16 a[88:91], v[144:147], v[116:119], a[88:91]
 m16 a[176:179], v[144:147], v[120:123], a[176:179]
 m16 a[184:187], v[144:147], v[124:127], a[184:187]
 m16 v[184:187], v[144:147], v[128:131], v[184:187]
 m16 v[192:195], v[144:147], v[132:135], v[192:195]
 s_waitcnt lgkmcnt(0)
 m16 a[84:87], v[148:151], v[112:115], a[84:87]
 m16 a[92:95], v[148:151], v[116:119], a[92:95]
 m16 a[180:183], v[148:151], v[120:123], a[180:183]
 m16 a[188:191], v[148:151], v[124:127], a[188:191]
 m16 v[188:191], v[148:151], v[128:131], v[188:191]
 m16 v[196:199], v[148:151], v[132:135], v[196:199]
 s_waitcnt vmcnt(60)
 s_barrier
 s_waitcnt vmcnt(26)
 s_barrier
 rtr v[136:137], v80, 12288
 rtr v[138:139], v80, 13824
 rtr v[140:141], v80, 12296
 rtr v[142:143], v80, 13832
 rtr v[144:145], v81, 12288
 rtr v[146:147], v81, 13824
 ds_read_b128 v[88:91], v82 offset:24576
 ds_read_b128 v[92:95], v82 offset:26624
 ds_read_b128 v[96:99], v82 offset:28672
 ds_read_b128 v[100:103], v82 offset:30720
 ds_read_b128 v[104:107], v82 offset:32768
 ds_read_b128 v[108:111], v82 offset:34816
 s_mov_b32 m0, 0
 s_nop 0
 HWQ0
 HWQ1
 HWQ2
 HWQ3
 s_mov_b32 m0, 4096
 s_nop 0
 HWQ4
 HWQ5
 HWQ6
 s_waitcnt lgkmcnt(4)
 m16 a[0:3], v[136:139], v[200:203], a[0:3]
 HWQ7
 s_mov_b32 m0, 8192
 m16 a[8:11], v[136:139], v[204:207], a[8:11]
 ds_read_b128 v[112:115], v83 offset:24576
 HWQ8
 m16 a[96:99], v[136:139], v[208:211], a[96:99]
 ds_read_b128 v[116:119], v83 offset:26624
 HWQ9
 m16 a[104:107], v[136:139], v[212:215], a[104:107]
 ds_read_b128 v[120:123], v83 offset:28672
 HWQ10
 m16 a[192:195], v[136:139], v[216:219], a[192:195]
 HWQ11
 s_add_u32 s54, s54, 393216
 s_sub_u32 s46, s54, 7864320
 s_cmp_ge_u32 s54, 7864320
 s_cselect_b32 s54, s46, s54
 s_mov_b32 m0, 147456
 m16 a[200:203], v[136:139], v[220:223], a[200:203]
 ds_read_b128 v[124:127], v83 offset:30720
 HU0
 m16 a[4:7], v[140:143], v[200:203], a[4:7]
 ds_read_b128 v[128:131], v83 offset:32768
 HU1
 m16 a[12:15], v[140:143], v[204:207], a[12:15]
 ds_read_b128 v[132:135], v83 offset:34816
 HU2
 m16 a[100:103], v[140:143], v[208:211], a[100:103]
 HU3
 s_mov_b32 m0, 151552
 m16 a[108:111], v[140:143], v[212:215], a[108:111]
 rtr v[148:149], v81, 12296
 HU4
 m16 a[196:199], v[140:143], v[216:219], a[196:199]
 rtr v[150:151], v81, 13832
 HU5
 m16 a[204:207], v[140:143], v[220:223], a[204:207]
 rtr v[152:153], v80, 12416
 HU6
 m16 a[16:19], v[144:147], v[200:203], a[16:19]
 HU7
 s_mov_b32 m0, 155648
 m16 a[24:27], v[144:147], v[204:207], a[24:27]
 rtr v[154:155], v80, 13952
 HU8
 m16 a[112:115], v[144:147], v[208:211], a[112:115]
 rtr v[156:157], v80, 12424
 HU9
 m16 a[120:123], v[144:147], v[212:215], a[120:123]
 HU10
 m16 a[208:211], v[144:147], v[216:219], a[208:211]
 HU11
 s_add_u32 s59, s59, 393216
 s_sub_u32 s46, s59, 7864320
 s_cmp_ge_u32 s59, 7864320
 s_cselect_b32 s59, s46, s59
 s_mov_b32 m0, 49152
 m16 a[216:219], v[144:147], v[220:223], a[216:219]
 HK0
 s_waitcnt lgkmcnt(3)
 m16 a[20:23], v[148:151], v[200:203], a[20:23]
 rtr v[158:159], v80, 13960
 HK1
 m16 a[28:31], v[148:151], v[204:207], a[28:31]
 HK2
 m16 a[116:119], v[148:151], v[208:211], a[116:119]
 HK3
 s_mov_b32 m0, 53248
 m16 a[124:127], v[148:151], v[212:215], a[124:127]
 HK4
 m16 a[212:215], v[148:151], v[216:219], a[212:215]
 HK5
 m16 a[220:223], v[148:151], v[220:223], a[220:223]
 HK6
 s_waitcnt lgkmcnt(2)
 m16 a[32:35], v[152:155], v[200:203], a[32:35]
 HK7
 s_mov_b32 m0, 57344
 m16 a[40:43], v[152:155], v[204:207], a[40:43]
 HK8
 m16 a[128:131], v[152:155], v[208:211], a[128:131]
 HK9
 m16 a[136:139], v[152:155], v[212:215], a[136:139]
 HK10
 m16 a[224:227], v[152:155], v[216:219], a[224:227]
 HK11
 s_add_u32 s52, s52, 24576
 s_mov_b32 m0, 73728
 m16 a[232:235], v[152:155], v[220:223], a[232:235]
 HK0
 s_waitcnt lgkmcnt(0)
 m16 a[36:39], v[156:159], v[200:203], a[36:39]
 HK1
 m16 a[44:47], v[156:159], v[204:207], a[44:47]
 HK2
 m16 a[132:135], v[156:159], v[208:211], a[132:135]
 HK3
 s_mov_b32 m0, 77824
 m16 a[140:143], v[156:159], v[212:215], a[140:143]
 HK4
 m16 a[228:231], v[156:159], v[216:219], a[228:231]
 HK5
 m16 a[236:239], v[156:159], v[220:223], a[236:239]
 HK6
 HK7
 s_mov_b32 m0, 81920
 s_nop 0
 HK8
 HK9
 HK10
 HK11
 s_add_u32 s52, s52, 12288
 s_barrier
 rtr v[136:137], v81, 12416
 rtr v[138:139], v81, 13952
 rtr v[140:141], v81, 12424
 rtr v[142:143], v81, 13960
 rtr v[144:145], v80, 12544
 rtr v[146:147], v80, 14080
 s_mov_b32 m0, 12288
 s_nop 0
 HWQ0
 HWQ1
 HWQ2
 HWQ3
 s_mov_b32 m0, 16384
 s_nop 0
 HWQ4
 HWQ5
 HWQ6
 s_waitcnt lgkmcnt(4)
 m16 a[48:51], v[136:139], v[200:203], a[48:51]
 HWQ7
 s_mov_b32 m0, 20480
 m16 a[56:59], v[136:139], v[204:207], a[56:59]
 HWQ8
 m16 a[144:147], v[136:139], v[208:211], a[144:147]
 HWQ9
 m16 a[152:155], v[136:139], v[212:215], a[152:155]
 HWQ10
 m16 a[240:243], v[136:139], v[216:219], a[240:243]
 HWQ11
 s_add_u32 s54, s54, 393600
 s_sub_u32 s46, s54, 7864320
 s_cmp_ge_u32 s54, 7864320
 s_cselect_b32 s54, s46, s54
 m16 a[248:251], v[136:139], v[220:223], a[248:251]
 s_waitcnt lgkmcnt(2)
 m16 a[52:55], v[140:143], v[200:203], a[52:55]
 m16 a[60:63], v[140:143], v[204:207], a[60:63]
 m16 a[148:151], v[140:143], v[208:211], a[148:151]
 m16 a[156:159], v[140:143], v[212:215], a[156:159]
 m16 a[244:247], v[140:143], v[216:219], a[244:247]
 m16 a[252:255], v[140:143], v[220:223], a[252:255]
 s_waitcnt lgkmcnt(0)
 m16 a[64:67], v[144:147], v[200:203], a[64:67]
 m16 a[72:75], v[144:147], v[204:207], a[72:75]
 m16 a[160:163], v[144:147], v[208:211], a[160:163]
 m16 a[168:171], v[144:147], v[212:215], a[168:171]
 m16 v[168:171], v[144:147], v[216:219], v[168:171]
 m16 v[176:179], v[144:147], v[220:223], v[176:179]
 s_waitcnt vmcnt(48)
 s_barrier
 rtr v[136:137], v80, 12552
 rtr v[138:139], v80, 14088
 rtr v[140:141], v81, 12544
 rtr v[142:143], v81, 14080
 rtr v[144:145], v81, 12552
 rtr v[146:147], v81, 14088
 s_mov_b32 m0, 24576
 s_nop 0
 HWO0
 HWO1
 HWO2
 HWO3
 s_mov_b32 m0, 28672
 s_nop 0
 HWO4
 HWO5
 HWO6
 s_waitcnt lgkmcnt(4)
 m16 a[68:71], v[136:139], v[200:203], a[68:71]
 HWO7
 s_mov_b32 m0, 32768
 m16 a[76:79], v[136:139], v[204:207], a[76:79]
 HWO8
 m16 a[164:167], v[136:139], v[208:211], a[164:167]
 HWO9
 m16 a[172:175], v[136:139], v[212:215], a[172:175]
 HWO10
 m16 v[172:175], v[136:139], v[216:219], v[172:175]
 HWO11
 s_add_u32 s56, s56, 122880
 s_mov_b32 m0, 86016
 m16 v[180:183], v[136:139], v[220:223], v[180:183]
 HV0
 s_waitcnt lgkmcnt(2)
 m16 a[80:83], v[140:143], v[200:203], a[80:83]
 HV1
 m16 a[88:91], v[140:143], v[204:207], a[88:91]
 HV2
 m16 a[176:179], v[140:143], v[208:211], a[176:179]
 HV3
 s_mov_b32 m0, 90112
 m16 a[184:187], v[140:143], v[212:215], a[184:187]
 HV4
 m16 v[184:187], v[140:143], v[216:219], v[184:187]
 HV5
 m16 v[192:195], v[140:143], v[220:223], v[192:195]
 HV6
 s_waitcnt lgkmcnt(0)
 m16 a[84:87], v[144:147], v[200:203], a[84:87]
 HV7
 s_mov_b32 m0, 94208
 m16 a[92:95], v[144:147], v[204:207], a[92:95]
 HV8
 m16 a[180:183], v[144:147], v[208:211], a[180:183]
 HV9
 m16 a[188:191], v[144:147], v[212:215], a[188:191]
 HV10
 m16 v[188:191], v[144:147], v[216:219], v[188:191]
 HV11
 s_add_u32 s53, s53, 12288
 s_mov_b32 m0, 98304
 m16 v[196:199], v[144:147], v[220:223], v[196:199]
 HV0
 HV1
 HV2
 HV3
 s_mov_b32 m0, 102400
 s_nop 0
 HV4
 HV5
 HV6
 HV7
 s_mov_b32 m0, 106496
 s_nop 0
 HV8
 HV9
 HV10
 HV11
 s_add_u32 s53, s53, 12288
 s_waitcnt vmcnt(36)
 s_barrier
 rtr v[136:137], v80, 24576
 rtr v[138:139], v80, 26112
 rtr v[140:141], v80, 24584
 rtr v[142:143], v80, 26120
 rtr v[144:145], v81, 24576
 rtr v[146:147], v81, 26112
 s_mov_b32 m0, 0
 s_nop 0
 HWO0
 HWO1
 HWO2
 HWO3
 s_mov_b32 m0, 4096
 s_nop 0
 HWO4
 HWO5
 HWO6
 s_waitcnt lgkmcnt(4)
 m16 a[0:3], v[136:139], v[224:227], a[0:3]
 HWO7
 s_mov_b32 m0, 8192
 m16 a[8:11], v[136:139], v[228:231], a[8:11]
 HWO8
 m16 a[96:99], v[136:139], v[232:235], a[96:99]
 HWO9
 m16 a[104:107], v[136:139], v[236:239], a[104:107]
 HWO10
 m16 a[192:195], v[136:139], v[240:243], a[192:195]
 HWO11
 s_add_u32 s56, s56, -122752
 m16 a[200:203], v[136:139], v[244:247], a[200:203]
 s_add_u32 s46, s58, 256
 buffer_load_dword v78, v76, s[24:27], s46 offen
 s_waitcnt lgkmcnt(2)
 m16 a[4:7], v[140:143], v[224:227], a[4:7]
 m16 a[12:15], v[140:143], v[228:231], a[12:15]
 m16 a[100:103], v[140:143], v[232:235], a[100:103]
 m16 a[108:111], v[140:143], v[236:239], a[108:111]
 m16 a[196:199], v[140:143], v[240:243], a[196:199]
 m16 a[204:207], v[140:143], v[244:247], a[204:207]
 s_waitcnt lgkmcnt(0)
 m16 a[16:19], v[144:147], v[224:227], a[16:19]
 m16 a[24:27], v[144:147], v[228:231], a[24:27]
 m16 a[112:115], v[144:147], v[232:235], a[112:115]
 m16 a[120:123], v[144:147], v[236:239], a[120:123]
 m16 a[208:211], v[144:147], v[240:243], a[208:211]
 m16 a[216:219], v[144:147], v[244:247], a[216:219]
 s_barrier
 rtr v[136:137], v81, 24584
 rtr v[138:139], v81, 26120
 rtr v[140:141], v80, 24704
 rtr v[142:143], v80, 26240
 rtr v[144:145], v80, 24712
 rtr v[146:147], v80, 26248
 rtr v[148:149], v81, 24704
 rtr v[150:151], v81, 26240
 rtr v[152:153], v81, 24712
 rtr v[154:155], v81, 26248
 rtr v[156:157], v80, 24832
 rtr v[158:159], v80, 26368
 s_mov_b32 m0, 135168
 s_nop 0
 HU0
 HU1
 HU2
 HU3
 s_mov_b32 m0, 139264
 s_nop 0
 HU4
 HU5
 HU6
 s_waitcnt lgkmcnt(4)
 m16 a[20:23], v[136:139], v[224:227], a[20:23]
 HU7
 s_mov_b32 m0, 143360
 m16 a[28:31], v[136:139], v[228:231], a[28:31]
 rtr v[160:161], v80, 24840
 HU8
 m16 a[116:119], v[136:139], v[232:235], a[116:119]
 rtr v[162:163], v80, 26376
 HU9
 m16 a[124:127], v[136:139], v[236:239], a[124:127]
 rtr v[164:165], v81, 24832
 HU10
 m16 a[212:215], v[136:139], v[240:243], a[212:215]
 HU11
 s_add_u32 s59, s59, 393216
 s_sub_u32 s46, s59, 7864320
 s_cmp_ge_u32 s59, 7864320
 s_cselect_b32 s59, s46, s59
 m16 a[220:223], v[136:139], v[244:247], a[220:223]
 rtr v[166:167], v81, 26368
 m16 a[32:35], v[140:143], v[224:227], a[32:35]
 rtr v[136:137], v81, 24840
 m16 a[40:43], v[140:143], v[228:231], a[40:43]
 rtr v[138:139], v81, 26376
 m16 a[128:131], v[140:143], v[232:235], a[128:131]
 m16 a[136:139], v[140:143], v[236:239], a[136:139]
 m16 a[224:227], v[140:143], v[240:243], a[224:227]
 m16 a[232:235], v[140:143], v[244:247], a[232:235]
 m16 a[36:39], v[144:147], v[224:227], a[36:39]
 m16 a[44:47], v[144:147], v[228:231], a[44:47]
 m16 a[132:135], v[144:147], v[232:235], a[132:135]
 m16 a[140:143], v[144:147], v[236:239], a[140:143]
 m16 a[228:231], v[144:147], v[240:243], a[228:231]
 m16 a[236:239], v[144:147], v[244:247], a[236:239]
 m16 a[48:51], v[148:151], v[224:227], a[48:51]
 m16 a[56:59], v[148:151], v[228:231], a[56:59]
 m16 a[144:147], v[148:151], v[232:235], a[144:147]
 m16 a[152:155], v[148:151], v[236:239], a[152:155]
 m16 a[240:243], v[148:151], v[240:243], a[240:243]
 m16 a[248:251], v[148:151], v[244:247], a[248:251]
 s_waitcnt lgkmcnt(4)
 m16 a[52:55], v[152:155], v[224:227], a[52:55]
 m16 a[60:63], v[152:155], v[228:231], a[60:63]
 m16 a[148:151], v[152:155], v[232:235], a[148:151]
 m16 a[156:159], v[152:155], v[236:239], a[156:159]
 m16 a[244:247], v[152:155], v[240:243], a[244:247]
 m16 a[252:255], v[152:155], v[244:247], a[252:255]
 m16 a[64:67], v[156:159], v[224:227], a[64:67]
 m16 a[72:75], v[156:159], v[228:231], a[72:75]
 m16 a[160:163], v[156:159], v[232:235], a[160:163]
 m16 a[168:171], v[156:159], v[236:239], a[168:171]
 m16 v[168:171], v[156:159], v[240:243], v[168:171]
 m16 v[176:179], v[156:159], v[244:247], v[176:179]
 m16 a[68:71], v[160:163], v[224:227], a[68:71]
 m16 a[76:79], v[160:163], v[228:231], a[76:79]
 m16 a[164:167], v[160:163], v[232:235], a[164:167]
 m16 a[172:175], v[160:163], v[236:239], a[172:175]
 m16 v[172:175], v[160:163], v[240:243], v[172:175]
 m16 v[180:183], v[160:163], v[244:247], v[180:183]
 s_waitcnt lgkmcnt(2)
 m16 a[80:83], v[164:167], v[224:227], a[80:83]
 m16 a[88:91], v[164:167], v[228:231], a[88:91]
 m16 a[176:179], v[164:167], v[232:235], a[176:179]
 m16 a[184:187], v[164:167], v[236:239], a[184:187]
 m16 v[184:187], v[164:167], v[240:243], v[184:187]
 m16 v[192:195], v[164:167], v[244:247], v[192:195]
 s_waitcnt lgkmcnt(0)
 m16 a[84:87], v[136:139], v[224:227], a[84:87]
 m16 a[92:95], v[136:139], v[228:231], a[92:95]
 m16 a[180:183], v[136:139], v[232:235], a[180:183]
 m16 a[188:191], v[136:139], v[236:239], a[188:191]
 m16 v[188:191], v[136:139], v[240:243], v[188:191]
 m16 v[196:199], v[136:139], v[244:247], v[196:199]
 s_waitcnt vmcnt(13)
 s_barrier
 TU 147456, 393216
 TWO 12288, 122880
 TWO 36864, -122752
 s_waitcnt vmcnt(36)
 s_barrier
 rtr v[136:137], v80, 12288
 rtr v[138:139], v80, 13824
 rtr v[140:141], v80, 12296
 rtr v[142:143], v80, 13832
 rtr v[144:145], v81, 12288
 rtr v[146:147], v81, 13824
 rtr v[148:149], v81, 12296
 rtr v[150:151], v81, 13832
 rtr v[152:153], v80, 12416
 rtr v[154:155], v80, 13952
 rtr v[156:157], v80, 12424
 rtr v[158:159], v80, 13960
 s_mov_b32 m0, 122880
 s_nop 0
 HY0
 HY1
 HY2
 HY3
 s_mov_b32 m0, 126976
 s_nop 0
 HY4
 HY5
 HY6
 s_waitcnt lgkmcnt(4)
 m16 a[0:3], v[136:139], v[88:91], a[0:3]
 HY7
 s_mov_b32 m0, 131072
 m16 a[8:11], v[136:139], v[92:95], a[8:11]
 rtr v[160:161], v81, 12416
 HY8
 m16 a[96:99], v[136:139], v[96:99], a[96:99]
 rtr v[162:163], v81, 13952
 HY9
 m16 a[104:107], v[136:139], v[100:103], a[104:107]
 rtr v[164:165], v81, 12424
 HY10
 m16 a[192:195], v[136:139], v[104:107], a[192:195]
 HY11
 s_add_u32 s86, s86, 128
 s_sub_u32 s46, s86, 1280
 s_cmp_ge_u32 s86, s57
 s_cselect_b32 s86, s46, s86
 s_mov_b32 m0, 49152
 m16 a[200:203], v[136:139], v[108:111], a[200:203]
 rtr v[166:167], v81, 13960
 HK0
 m16 a[4:7], v[140:143], v[88:91], a[4:7]
 rtr v[136:137], v80, 12544
 HK1
 m16 a[12:15], v[140:143], v[92:95], a[12:15]
 rtr v[138:139], v80, 14080
 HK2
 m16 a[100:103], v[140:143], v[96:99], a[100:103]
 HK3
 s_mov_b32 m0, 53248
 m16 a[108:111], v[140:143], v[100:103], a[108:111]
 HK4
 m16 a[196:199], v[140:143], v[104:107], a[196:199]
 HK5
 m16 a[204:207], v[140:143], v[108:111], a[204:207]
 rtr v[140:141], v80, 12552
 HK6
 m16 a[16:19], v[144:147], v[88:91], a[16:19]
 HK7
 s_mov_b32 m0, 57344
 m16 a[24:27], v[144:147], v[92:95], a[24:27]
 rtr v[142:143], v80, 14088
 HK8
 m16 a[112:115], v[144:147], v[96:99], a[112:115]
 HK9
 m16 a[120:123], v[144:147], v[100:103], a[120:123]
 HK10
 m16 a[208:211], v[144:147], v[104:107], a[208:211]
 HK11
 s_add_u32 s52, s52, 12288
 s_mov_b32 m0, 110592
 m16 a[216:219], v[144:147], v[108:111], a[216:219]
 HV0
 m16 a[20:23], v[148:151], v[88:91], a[20:23]
 rtr v[144:145], v81, 12544
 HV1
 m16 a[28:31], v[148:151], v[92:95], a[28:31]
 HV2
 m16 a[116:119], v[148:151], v[96:99], a[116:119]
 HV3
 s_mov_b32 m0, 114688
 m16 a[124:127], v[148:151], v[100:103], a[124:127]
 HV4
 m16 a[212:215], v[148:151], v[104:107], a[212:215]
 rtr v[146:147], v81, 14080
 HV5
 m16 a[220:223], v[148:151], v[108:111], a[220:223]
 HV6
 s_waitcnt lgkmcnt(6)
 m16 a[32:35], v[152:155], v[88:91], a[32:35]
 HV7
 s_mov_b32 m0, 118784
 m16 a[40:43], v[152:155], v[92:95], a[40:43]
 HV8
 m16 a[128:131], v[152:155], v[96:99], a[128:131]
 rtr v[148:149], v81, 12552
 HV9
 m16 a[136:139], v[152:155], v[100:103], a[136:139]
 HV10
 m16 a[224:227], v[152:155], v[104:107], a[224:227]
 HV11
 s_add_u32 s53, s53, 12288
 m16 a[232:235], v[152:155], v[108:111], a[232:235]
 m16 a[36:39], v[156:159], v[88:91], a[36:39]
 rtr v[150:151], v81, 14088
 m16 a[44:47], v[156:159], v[92:95], a[44:47]
 m16 a[132:135], v[156:159], v[96:99], a[132:135]
 m16 a[140:143], v[156:159], v[100:103], a[140:143]
 m16 a[228:231], v[156:159], v[104:107], a[228:231]
 m16 a[236:239], v[156:159], v[108:111], a[236:239]
 m16 a[48:51], v[160:163], v[88:91], a[48:51]
 m16 a[56:59], v[160:163], v[92:95], a[56:59]
 m16 a[144:147], v[160:163], v[96:99], a[144:147]
 m16 a[152:155], v[160:163], v[100:103], a[152:155]
 m16 a[240:243], v[160:163], v[104:107], a[240:243]
 m16 a[248:251], v[160:163], v[108:111], a[248:251]
 m16 a[52:55], v[164:167], v[88:91], a[52:55]
 m16 a[60:63], v[164:167], v[92:95], a[60:63]
 m16 a[148:151], v[164:167], v[96:99], a[148:151]
 m16 a[156:159], v[164:167], v[100:103], a[156:159]
 m16 a[244:247], v[164:167], v[104:107], a[244:247]
 m16 a[252:255], v[164:167], v[108:111], a[252:255]
 s_waitcnt lgkmcnt(4)
 m16 a[64:67], v[136:139], v[88:91], a[64:67]
 m16 a[72:75], v[136:139], v[92:95], a[72:75]
 m16 a[160:163], v[136:139], v[96:99], a[160:163]
 m16 a[168:171], v[136:139], v[100:103], a[168:171]
 m16 v[168:171], v[136:139], v[104:107], v[168:171]
 m16 v[176:179], v[136:139], v[108:111], v[176:179]
 m16 a[68:71], v[140:143], v[88:91], a[68:71]
 m16 a[76:79], v[140:143], v[92:95], a[76:79]
 m16 a[164:167], v[140:143], v[96:99], a[164:167]
 m16 a[172:175], v[140:143], v[100:103], a[172:175]
 m16 v[172:175], v[140:143], v[104:107], v[172:175]
 m16 v[180:183], v[140:143], v[108:111], v[180:183]
 s_waitcnt lgkmcnt(2)
 m16 a[80:83], v[144:147], v[88:91], a[80:83]
 m16 a[88:91], v[144:147], v[92:95], a[88:91]
 m16 a[176:179], v[144:147], v[96:99], a[176:179]
 m16 a[184:187], v[144:147], v[100:103], a[184:187]
 m16 v[184:187], v[144:147], v[104:107], v[184:187]
 m16 v[192:195], v[144:147], v[108:111], v[192:195]
 s_waitcnt lgkmcnt(0)
 m16 a[84:87], v[148:151], v[88:91], a[84:87]
 m16 a[92:95], v[148:151], v[92:95], a[92:95]
 m16 a[180:183], v[148:151], v[96:99], a[180:183]
 m16 a[188:191], v[148:151], v[100:103], a[188:191]
 m16 v[188:191], v[148:151], v[104:107], v[188:191]
 m16 v[196:199], v[148:151], v[108:111], v[196:199]
 s_waitcnt vmcnt(36)
 s_barrier
 rtr v[136:137], v80, 24576
 rtr v[138:139], v80, 26112
 rtr v[140:141], v80, 24584
 rtr v[142:143], v80, 26120
 rtr v[144:145], v81, 24576
 rtr v[146:147], v81, 26112
 rtr v[148:149], v81, 24584
 rtr v[150:151], v81, 26120
 rtr v[152:153], v80, 24704
 rtr v[154:155], v80, 26240
 rtr v[156:157], v80, 24712
 rtr v[158:159], v80, 26248
 s_mov_b32 m0, 135168
 s_nop 0
 HU0
 HU1
 HU2
 HU3
 s_mov_b32 m0, 139264
 s_nop 0
 HU4
 HU5
 HU6
 s_waitcnt lgkmcnt(4)
 m16 a[0:3], v[136:139], v[112:115], a[0:3]
 HU7
 s_mov_b32 m0, 143360
 m16 a[8:11], v[136:139], v[116:119], a[8:11]
 rtr v[160:161], v81, 24704
 HU8
 m16 a[96:99], v[136:139], v[120:123], a[96:99]
 rtr v[162:163], v81, 26240
 HU9
 m16 a[104:107], v[136:139], v[124:127], a[104:107]
 rtr v[164:165], v81, 24712
 HU10
 m16 a[192:195], v[136:139], v[128:131], a[192:195]
 HU11
 s_add_u32 s59, s59, 393216
 s_sub_u32 s46, s59, 7864320
 s_cmp_ge_u32 s59, 7864320
 s_cselect_b32 s59, s46, s59
 s_mov_b32 m0, 24576
 m16 a[200:203], v[136:139], v[132:135], a[200:203]
 rtr v[166:167], v81, 26248
 HWO0
 m16 a[4:7], v[140:143], v[112:115], a[4:7]
 rtr v[136:137], v80, 24832
 HWO1
 m16 a[12:15], v[140:143], v[116:119], a[12:15]
 rtr v[138:139], v80, 26368
 HWO2
 m16 a[100:103], v[140:143], v[120:123], a[100:103]
 HWO3
 s_mov_b32 m0, 28672
 m16 a[108:111], v[140:143], v[124:127], a[108:111]
 HWO4
 m16 a[196:199], v[140:143], v[128:131], a[196:199]
 HWO5
 m16 a[204:207], v[140:143], v[132:135], a[204:207]
 rtr v[140:141], v80, 24840
 HWO6
 m16 a[16:19], v[144:147], v[112:115], a[16:19]
 HWO7
 s_mov_b32 m0, 32768
 m16 a[24:27], v[144:147], v[116:119], a[24:27]
 rtr v[142:143], v80, 26376
 HWO8
 m16 a[112:115], v[144:147], v[120:123], a[112:115]
 HWO9
 m16 a[120:123], v[144:147], v[124:127], a[120:123]
 HWO10
 m16 a[208:211], v[144:147], v[128:131], a[208:211]
 HWO11
 s_add_u32 s56, s56, 122880
 s_mov_b32 m0, 0
 m16 a[216:219], v[144:147], v[132:135], a[216:219]
 HWO0
 m16 a[20:23], v[148:151], v[112:115], a[20:23]
 rtr v[144:145], v81, 24832
 HWO1
 m16 a[28:31], v[148:151], v[116:119], a[28:31]
 HWO2
 m16 a[116:119], v[148:151], v[120:123], a[116:119]
 HWO3
 s_mov_b32 m0, 4096
 m16 a[124:127], v[148:151], v[124:127], a[124:127]
 HWO4
 m16 a[212:215], v[148:151], v[128:131], a[212:215]
 rtr v[146:147], v81, 26368
 HWO5
 m16 a[220:223], v[148:151], v[132:135], a[220:223]
 HWO6
 s_waitcnt lgkmcnt(6)
 m16 a[32:35], v[152:155], v[112:115], a[32:35]
 HWO7
 s_mov_b32 m0, 8192
 m16 a[40:43], v[152:155], v[116:119], a[40:43]
 HWO8
 m16 a[128:131], v[152:155], v[120:123], a[128:131]
 rtr v[148:149], v81, 24840
 HWO9
 m16 a[136:139], v[152:155], v[124:127], a[136:139]
 HWO10
 m16 a[224:227], v[152:155], v[128:131], a[224:227]
 HWO11
 s_add_u32 s56, s56, -122752
 s_mov_b32 m0, 61440
 m16 a[232:235], v[152:155], v[132:135], a[232:235]
 HK0
 m16 a[36:39], v[156:159], v[112:115], a[36:39]
 rtr v[150:151], v81, 26376
 HK1
 m16 a[44:47], v[156:159], v[116:119], a[44:47]
 HK2
 m16 a[132:135], v[156:159], v[120:123], a[132:135]
 HK3
 s_mov_b32 m0, 65536
 m16 a[140:143], v[156:159], v[124:127], a[140:143]
 HK4
 m16 a[228:231], v[156:159], v[128:131], a[228:231]
 HK5
 m16 a[236:239], v[156:159], v[132:135], a[236:239]
 HK6
 m16 a[48:51], v[160:163], v[112:115], a[48:51]
 HK7
 s_mov_b32 m0, 69632
 m16 a[56:59], v[160:163], v[116:119], a[56:59]
 HK8
 m16 a[144:147], v[160:163], v[120:123], a[144:147]
 HK9
 m16 a[152:155], v[160:163], v[124:127], a[152:155]
 HK10
 m16 a[240:243], v[160:163], v[128:131], a[240:243]
 HK11
 s_add_u32 s52, s52, 12288
 s_mov_b32 m0, 86016
 m16 a[248:251], v[160:163], v[132:135], a[248:251]
 HV0
 m16 a[52:55], v[164:167], v[112:115], a[52:55]
 HV1
 m16 a[60:63], v[164:167], v[116:119], a[60:63]
 HV2
 m16 a[148:151], v[164:167], v[120:123], a[148:151]
 HV3
 s_mov_b32 m0, 90112
 m16 a[156:159], v[164:167], v[124:127], a[156:159]
 HV4
 m16 a[244:247], v[164:167], v[128:131], a[244:247]
 HV5
 m16 a[252:255], v[164:167], v[132:135], a[252:255]
 HV6
 s_waitcnt lgkmcnt(4)
 m16 a[64:67], v[136:139], v[112:115], a[64:67]
 HV7
 s_mov_b32 m0, 94208
 m16 a[72:75], v[136:139], v[116:119], a[72:75]
 HV8
 m16 a[160:163], v[136:139], v[120:123], a[160:163]
 HV9
 m16 a[168:171], v[136:139], v[124:127], a[168:171]
 HV10
 m16 v[168:171], v[136:139], v[128:131], v[168:171]
 HV11
 s_add_u32 s53, s53, 12288
 m16 v[176:179], v[136:139], v[132:135], v[176:179]
 m16 a[68:71], v[140:143], v[112:115], a[68:71]
 m16 a[76:79], v[140:143], v[116:119], a[76:79]
 m16 a[164:167], v[140:143], v[120:123], a[164:167]
 m16 a[172:175], v[140:143], v[124:127], a[172:175]
 m16 v[172:175], v[140:143], v[128:131], v[172:175]
 m16 v[180:183], v[140:143], v[132:135], v[180:183]
 s_waitcnt lgkmcnt(2)
 m16 a[80:83], v[144:147], v[112:115], a[80:83]
 m16 a[88:91], v[144:147], v[116:119], a[88:91]
 m16 a[176:179], v[144:147], v[120:123], a[176:179]
 m16 a[184:187], v[144:147], v[124:127], a[184:187]
 m16 v[184:187], v[144:147], v[128:131], v[184:187]
 m16 v[192:195], v[144:147], v[132:135], v[192:195]
 s_waitcnt lgkmcnt(0)
 m16 a[84:87], v[148:151], v[112:115], a[84:87]
 m16 a[92:95], v[148:151], v[116:119], a[92:95]
 m16 a[180:183], v[148:151], v[120:123], a[180:183]
 m16 a[188:191], v[148:151], v[124:127], a[188:191]
 m16 v[188:191], v[148:151], v[128:131], v[188:191]
 m16 v[196:199], v[148:151], v[132:135], v[196:199]
 s_waitcnt vmcnt(48)
 s_barrier
 rtr v[136:137], v80, 12288
 rtr v[138:139], v80, 13824
 ds_read_b128 v[200:203], v84
 ds_read_b128 v[204:207], v84 offset:2048
 ds_read_b128 v[208:211], v84 offset:4096
 ds_read_b128 v[212:215], v84 offset:6144
 ds_read_b128 v[216:219], v84 offset:8192
 ds_read_b128 v[220:223], v84 offset:10240
 rtr v[140:141], v80, 12296
 rtr v[142:143], v80, 13832
 rtr v[144:145], v81, 12288
 rtr v[146:147], v81, 13824
 s_mov_b32 m0, 147456
 s_nop 0
 HU0
 HU1
 HU2
 HU3
 s_mov_b32 m0, 151552
 s_nop 0
 HU4
 HU5
 HU6
 s_waitcnt lgkmcnt(4)
 m16 a[0:3], v[136:139], v[200:203], a[0:3]
 HU7
 s_mov_b32 m0, 155648
 m16 a[8:11], v[136:139], v[204:207], a[8:11]
 ds_read_b128 v[224:227], v85
 HU8
 m16 a[96:99], v[136:139], v[208:211], a[96:99]
 ds_read_b128 v[228:231], v85 offset:2048
 HU9
 m16 a[104:107], v[136:139], v[212:215], a[104:107]
 ds_read_b128 v[232:235], v85 offset:4096
 HU10
 m16 a[192:195], v[136:139], v[216:219], a[192:195]
 HU11
 s_add_u32 s59, s59, 393600
 s_sub_u32 s46, s59, 7864320
 s_cmp_ge_u32 s59, 7864320
 s_cselect_b32 s59, s46, s59
 s_mov_b32 m0, 73728
 m16 a[200:203], v[136:139], v[220:223], a[200:203]
 ds_read_b128 v[236:239], v85 offset:6144
 HK0
 s_waitcnt lgkmcnt(4)
 m16 a[4:7], v[140:143], v[200:203], a[4:7]
 ds_read_b128 v[240:243], v85 offset:8192
 HK1
 m16 a[12:15], v[140:143], v[204:207], a[12:15]
 ds_read_b128 v[244:247], v85 offset:10240
 HK2
 m16 a[100:103], v[140:143], v[208:211], a[100:103]
 HK3
 s_mov_b32 m0, 77824
 m16 a[108:111], v[140:143], v[212:215], a[108:111]
 rtr v[148:149], v81, 12296
 HK4
 m16 a[196:199], v[140:143], v[216:219], a[196:199]
 rtr v[150:151], v81, 13832
 HK5
 m16 a[204:207], v[140:143], v[220:223], a[204:207]
 rtr v[152:153], v80, 12416
 HK6
 m16 a[16:19], v[144:147], v[200:203], a[16:19]
 HK7
 s_mov_b32 m0, 81920
 m16 a[24:27], v[144:147], v[204:207], a[24:27]
 rtr v[154:155], v80, 13952
 HK8
 m16 a[112:115], v[144:147], v[208:211], a[112:115]
 rtr v[156:157], v80, 12424
 HK9
 m16 a[120:123], v[144:147], v[212:215], a[120:123]
 HK10
 m16 a[208:211], v[144:147], v[216:219], a[208:211]
 HK11
 s_add_u32 s52, s52, 12288
 s_mov_b32 m0, 98304
 s_waitcnt lgkmcnt(4)
 m16 a[216:219], v[144:147], v[220:223], a[216:219]
 HV0
 s_waitcnt lgkmcnt(3)
 m16 a[20:23], v[148:151], v[200:203], a[20:23]
 rtr v[158:159], v80, 13960
 HV1
 m16 a[28:31], v[148:151], v[204:207], a[28:31]
 HV2
 m16 a[116:119], v[148:151], v[208:211], a[116:119]
 HV3
 s_mov_b32 m0, 102400
 m16 a[124:127], v[148:151], v[212:215], a[124:127]
 HV4
 m16 a[212:215], v[148:151], v[216:219], a[212:215]
 rtr v[160:161], v81, 12416
 HV5
 m16 a[220:223], v[148:151], v[220:223], a[220:223]
 HV6
 s_waitcnt lgkmcnt(3)
 m16 a[32:35], v[152:155], v[200:203], a[32:35]
 HV7
 s_mov_b32 m0, 106496
 m16 a[40:43], v[152:155], v[204:207], a[40:43]
 HV8
 m16 a[128:131], v[152:155], v[208:211], a[128:131]
 rtr v[162:163], v81, 13952
 HV9
 m16 a[136:139], v[152:155], v[212:215], a[136:139]
 HV10
 m16 a[224:227], v[152:155], v[216:219], a[224:227]
 HV11
 s_add_u32 s53, s53, 12288
 m16 a[232:235], v[152:155], v[220:223], a[232:235]
 s_waitcnt lgkmcnt(2)
 m16 a[36:39], v[156:159], v[200:203], a[36:39]
 rtr v[164:165], v81, 12424
 m16 a[44:47], v[156:159], v[204:207], a[44:47]
 m16 a[132:135], v[156:159], v[208:211], a[132:135]
 rtr v[166:167], v81, 13960
 m16 a[140:143], v[156:159], v[212:215], a[140:143]
 m16 a[228:231], v[156:159], v[216:219], a[228:231]
 rtr v[136:137], v80, 12544
 m16 a[236:239], v[156:159], v[220:223], a[236:239]
 s_waitcnt lgkmcnt(3)
 m16 a[48:51], v[160:163], v[200:203], a[48:51]
 rtr v[138:139], v80, 14080
 m16 a[56:59], v[160:163], v[204:207], a[56:59]
 m16 a[144:147], v[160:163], v[208:211], a[144:147]
 rtr v[140:141], v80, 12552
 m16 a[152:155], v[160:163], v[212:215], a[152:155]
 m16 a[240:243], v[160:163], v[216:219], a[240:243]
 rtr v[142:143], v80, 14088
 m16 a[248:251], v[160:163], v[220:223], a[248:251]
 s_waitcnt lgkmcnt(4)
 m16 a[52:55], v[164:167], v[200:203], a[52:55]
 rtr v[144:145], v81, 12544
 m16 a[60:63], v[164:167], v[204:207], a[60:63]
 m16 a[148:151], v[164:167], v[208:211], a[148:151]
 rtr v[146:147], v81, 14080
 m16 a[156:159], v[164:167], v[212:215], a[156:159]
 m16 a[244:247], v[164:167], v[216:219], a[244:247]
 rtr v[148:149], v81, 12552
 m16 a[252:255], v[164:167], v[220:223], a[252:255]
 s_waitcnt lgkmcnt(4)
 m16 a[64:67], v[136:139], v[200:203], a[64:67]
 rtr v[150:151], v81, 14088
 m16 a[72:75], v[136:139], v[204:207], a[72:75]
 m16 a[160:163], v[136:139], v[208:211], a[160:163]
 m16 a[168:171], v[136:139], v[212:215], a[168:171]
 m16 v[168:171], v[136:139], v[216:219], v[168:171]
 m16 v[176:179], v[136:139], v[220:223], v[176:179]
 s_waitcnt lgkmcnt(4)
 m16 a[68:71], v[140:143], v[200:203], a[68:71]
 m16 a[76:79], v[140:143], v[204:207], a[76:79]
 m16 a[164:167], v[140:143], v[208:211], a[164:167]
 m16 a[172:175], v[140:143], v[212:215], a[172:175]
 m16 v[172:175], v[140:143], v[216:219], v[172:175]
 m16 v[180:183], v[140:143], v[220:223], v[180:183]
 s_waitcnt lgkmcnt(2)
 m16 a[80:83], v[144:147], v[200:203], a[80:83]
 m16 a[88:91], v[144:147], v[204:207], a[88:91]
 m16 a[176:179], v[144:147], v[208:211], a[176:179]
 m16 a[184:187], v[144:147], v[212:215], a[184:187]
 m16 v[184:187], v[144:147], v[216:219], v[184:187]
 m16 v[192:195], v[144:147], v[220:223], v[192:195]
 s_waitcnt lgkmcnt(0)
 m16 a[84:87], v[148:151], v[200:203], a[84:87]
 m16 a[92:95], v[148:151], v[204:207], a[92:95]
 m16 a[180:183], v[148:151], v[208:211], a[180:183]
 m16 a[188:191], v[148:151], v[212:215], a[188:191]
 m16 v[188:191], v[148:151], v[216:219], v[188:191]
 m16 v[196:199], v[148:151], v[220:223], v[196:199]
 s_waitcnt vmcnt(24)
 s_barrier
CPS50:
 rtr v[136:137], v80, 24576
 rtr v[138:139], v80, 26112
 rtr v[140:141], v80, 24584
 rtr v[142:143], v80, 26120
 rtr v[144:145], v81, 24576
 rtr v[146:147], v81, 26112
 rtr v[148:149], v81, 24584
 rtr v[150:151], v81, 26120
 rtr v[152:153], v80, 24704
 rtr v[154:155], v80, 26240
 rtr v[156:157], v80, 24712
 rtr v[158:159], v80, 26248
 s_mov_b32 m0, 12288
 s_nop 0
 HWO0
 HWO1
 HWO2
 HWO3
 s_mov_b32 m0, 16384
 s_nop 0
 HWO4
 HWO5
 HWO6
 s_waitcnt lgkmcnt(4)
 m16 a[0:3], v[136:139], v[224:227], a[0:3]
 HWO7
 s_mov_b32 m0, 20480
 m16 a[8:11], v[136:139], v[228:231], a[8:11]
 rtr v[160:161], v81, 24704
 HWO8
 m16 a[96:99], v[136:139], v[232:235], a[96:99]
 rtr v[162:163], v81, 26240
 HWO9
 m16 a[104:107], v[136:139], v[236:239], a[104:107]
 rtr v[164:165], v81, 24712
 HWO10
 m16 a[192:195], v[136:139], v[240:243], a[192:195]
 HWO11
 s_add_u32 s56, s56, 122880
 s_mov_b32 m0, 36864
 m16 a[200:203], v[136:139], v[244:247], a[200:203]
 rtr v[166:167], v81, 26248
 HWO0
 m16 a[4:7], v[140:143], v[224:227], a[4:7]
 rtr v[136:137], v80, 24832
 HWO1
 m16 a[12:15], v[140:143], v[228:231], a[12:15]
 rtr v[138:139], v80, 26368
 HWO2
 m16 a[100:103], v[140:143], v[232:235], a[100:103]
 HWO3
 s_mov_b32 m0, 40960
 m16 a[108:111], v[140:143], v[236:239], a[108:111]
 HWO4
 m16 a[196:199], v[140:143], v[240:243], a[196:199]
 HWO5
 m16 a[204:207], v[140:143], v[244:247], a[204:207]
 rtr v[140:141], v80, 24840
 HWO6
 m16 a[16:19], v[144:147], v[224:227], a[16:19]
 HWO7
 s_mov_b32 m0, 45056
 m16 a[24:27], v[144:147], v[228:231], a[24:27]
 rtr v[142:143], v80, 26376
 HWO8
 m16 a[112:115], v[144:147], v[232:235], a[112:115]
 HWO9
 m16 a[120:123], v[144:147], v[236:239], a[120:123]
 HWO10
 m16 a[208:211], v[144:147], v[240:243], a[208:211]
 HWO11
 s_add_u32 s56, s56, -122752
 s_mov_b32 m0, 49152
 m16 a[216:219], v[144:147], v[244:247], a[216:219]
 HK0
 m16 a[20:23], v[148:151], v[224:227], a[20:23]
 rtr v[144:145], v81, 24832
 HK1
 m16 a[28:31], v[148:151], v[228:231], a[28:31]
 HK2
 m16 a[116:119], v[148:151], v[232:235], a[116:119]
 HK3
 s_mov_b32 m0, 53248
 m16 a[124:127], v[148:151], v[236:239], a[124:127]
 HK4
 m16 a[212:215], v[148:151], v[240:243], a[212:215]
 rtr v[146:147], v81, 26368
 HK5
 m16 a[220:223], v[148:151], v[244:247], a[220:223]
 HK6
 s_waitcnt lgkmcnt(6)
 m16 a[32:35], v[152:155], v[224:227], a[32:35]
 HK7
 s_mov_b32 m0, 57344
 m16 a[40:43], v[152:155], v[228:231], a[40:43]
 HK8
 m16 a[128:131], v[152:155], v[232:235], a[128:131]
 rtr v[148:149], v81, 24840
 HK9
 m16 a[136:139], v[152:155], v[236:239], a[136:139]
 HK10
 m16 a[224:227], v[152:155], v[240:243], a[224:227]
 HK11
 s_add_u32 s52, s52, 12288
 s_mov_b32 m0, 110592
 m16 a[232:235], v[152:155], v[244:247], a[232:235]
 HV0
 m16 a[36:39], v[156:159], v[224:227], a[36:39]
 rtr v[150:151], v81, 26376
 HV1
 m16 a[44:47], v[156:159], v[228:231], a[44:47]
 HV2
 m16 a[132:135], v[156:159], v[232:235], a[132:135]
 HV3
 s_mov_b32 m0, 114688
 m16 a[140:143], v[156:159], v[236:239], a[140:143]
 HV4
 m16 a[228:231], v[156:159], v[240:243], a[228:231]
 HV5
 m16 a[236:239], v[156:159], v[244:247], a[236:239]
 HV6
 m16 a[48:51], v[160:163], v[224:227], a[48:51]
 HV7
 s_mov_b32 m0, 118784
 m16 a[56:59], v[160:163], v[228:231], a[56:59]
 HV8
 m16 a[144:147], v[160:163], v[232:235], a[144:147]
 HV9
 m16 a[152:155], v[160:163], v[236:239], a[152:155]
 HV10
 m16 a[240:243], v[160:163], v[240:243], a[240:243]
 HV11
 s_add_u32 s53, s53, 12288
 m16 a[248:251], v[160:163], v[244:247], a[248:251]
 s_add_u32 s46, s58, 512
 buffer_load_dword v78, v76, s[24:27], s46 offen
 m16 a[52:55], v[164:167], v[224:227], a[52:55]
 v_add_co_u32 v10, vcc, CPS50+4096-LOADER, v8
 s_nop 1
 v_addc_co_u32 v11, vcc, 0, v9, vcc
 global_load_dword v78, v[10:11], off
 m16 a[60:63], v[164:167], v[228:231], a[60:63]
 m16 a[148:151], v[164:167], v[232:235], a[148:151]
 m16 a[156:159], v[164:167], v[236:239], a[156:159]
 m16 a[244:247], v[164:167], v[240:243], a[244:247]
 m16 a[252:255], v[164:167], v[244:247], a[252:255]
 s_waitcnt lgkmcnt(4)
 m16 a[64:67], v[136:139], v[224:227], a[64:67]
 m16 a[72:75], v[136:139], v[228:231], a[72:75]
 m16 a[160:163], v[136:139], v[232:235], a[160:163]
 m16 a[168:171], v[136:139], v[236:239], a[168:171]
 m16 v[168:171], v[136:139], v[240:243], v[168:171]
 m16 v[176:179], v[136:139], v[244:247], v[176:179]
 m16 a[68:71], v[140:143], v[224:227], a[68:71]
 m16 a[76:79], v[140:143], v[228:231], a[76:79]
 m16 a[164:167], v[140:143], v[232:235], a[164:167]
 m16 a[172:175], v[140:143], v[236:239], a[172:175]
 m16 v[172:175], v[140:143], v[240:243], v[172:175]
 m16 v[180:183], v[140:143], v[244:247], v[180:183]
 s_waitcnt lgkmcnt(2)
 m16 a[80:83], v[144:147], v[224:227], a[80:83]
 m16 a[88:91], v[144:147], v[228:231], a[88:91]
 m16 a[176:179], v[144:147], v[232:235], a[176:179]
 m16 a[184:187], v[144:147], v[236:239], a[184:187]
 m16 v[184:187], v[144:147], v[240:243], v[184:187]
 m16 v[192:195], v[144:147], v[244:247], v[192:195]
 s_waitcnt lgkmcnt(0)
 m16 a[84:87], v[148:151], v[224:227], a[84:87]
 m16 a[92:95], v[148:151], v[228:231], a[92:95]
 m16 a[180:183], v[148:151], v[232:235], a[180:183]
 m16 a[188:191], v[148:151], v[236:239], a[188:191]
 m16 v[188:191], v[148:151], v[240:243], v[188:191]
 m16 v[196:199], v[148:151], v[244:247], v[196:199]
 s_waitcnt vmcnt(50)
 s_barrier
 TK 61440, 12288
 TV 86016, 12288
 s_nop 15
 s_mov_b32 s60, 0
 v_mov_b32 v87, v86
 s_movk_i32 s61, 96
 s_call_b64 s[44:45], CONV
 s_waitcnt vmcnt(26)
 s_barrier
 TWO 24576, 122880
 TWO 0, -122752
 TK 73728, 12288
 TV 98304, 12288
 s_add_u32 s46, s58, 768
 buffer_load_dword v78, v76, s[24:27], s46 offen
 s_add_u32 s46, s4, 1152
 buffer_load_dword v78, v77, s[16:19], s46 offen
 s_movk_i32 s61, 192
 s_call_b64 s[44:45], CONV
 s_waitcnt vmcnt(26)
 s_barrier
 TWO 12288, 122880
 TWO 36864, -122752
 TK 49152, 12288
 TV 110592, 12288
 s_movk_i32 s61, 256
 s_call_b64 s[44:45], CONV
 cvt v88, v168, v169
 cvt v89, v170, v171
 cvt v90, v172, v173
 cvt v91, v174, v175
 ds_write_b128 v87, v[88:91]
 cvt v92, v176, v177
 cvt v93, v178, v179
 cvt v94, v180, v181
 cvt v95, v182, v183
 ds_write_b128 v87, v[92:95] offset:1024
 cvt v96, v184, v185
 cvt v97, v186, v187
 cvt v98, v188, v189
 cvt v99, v190, v191
 ds_write_b128 v87, v[96:99] offset:2048
 cvt v100, v192, v193
 cvt v101, v194, v195
 cvt v102, v196, v197
 cvt v103, v198, v199
 ds_write_b128 v87, v[100:103] offset:3072
 s_waitcnt lgkmcnt(0)
 s_waitcnt vmcnt(60)
 s_barrier
 TK 61440, 12288
 TV 86016, 12288
 s_waitcnt vmcnt(48)
 s_barrier
 TU 135168, 393216
 TY 122880, 128
 s_waitcnt vmcnt(0)
 s_barrier
 rtr v[136:137], v80, 12288
 rtr v[138:139], v80, 13824
 ds_read_b128 v[88:91], v84
 ds_read_b128 v[92:95], v84 offset:2048
 ds_read_b128 v[96:99], v84 offset:4096
 ds_read_b128 v[100:103], v84 offset:6144
 ds_read_b128 v[104:107], v84 offset:8192
 ds_read_b128 v[108:111], v84 offset:10240
 rtr v[140:141], v80, 12296
 rtr v[142:143], v80, 13832
 rtr v[144:145], v81, 12288
 rtr v[146:147], v81, 13824
 s_mov_b32 m0, 147456
 s_nop 0
 HU0
 HU1
 HU2
 HU3
 s_mov_b32 m0, 151552
 s_nop 0
 HU4
 HU5
 HU6
 s_waitcnt lgkmcnt(4)
 m16 a[0:3], v[136:139], v[88:91], 0
 HU7
 s_mov_b32 m0, 155648
 m16 a[8:11], v[136:139], v[92:95], 0
 ds_read_b128 v[112:115], v85
 HU8
 m16 a[96:99], v[136:139], v[96:99], 0
 ds_read_b128 v[116:119], v85 offset:2048
 HU9
 m16 a[104:107], v[136:139], v[100:103], 0
 ds_read_b128 v[120:123], v85 offset:4096
 HU10
 m16 a[192:195], v[136:139], v[104:107], 0
 HU11
 s_add_u32 s59, s59, 393216
 s_sub_u32 s46, s59, 7864320
 s_cmp_ge_u32 s59, 7864320
 s_cselect_b32 s59, s46, s59
 s_mov_b32 m0, 24576
 m16 a[200:203], v[136:139], v[108:111], 0
 ds_read_b128 v[124:127], v85 offset:6144
 HWO0
 s_waitcnt lgkmcnt(4)
 m16 a[4:7], v[140:143], v[88:91], 0
 ds_read_b128 v[128:131], v85 offset:8192
 HWO1
 m16 a[12:15], v[140:143], v[92:95], 0
 ds_read_b128 v[132:135], v85 offset:10240
 HWO2
 m16 a[100:103], v[140:143], v[96:99], 0
 HWO3
 s_mov_b32 m0, 28672
 m16 a[108:111], v[140:143], v[100:103], 0
 rtr v[148:149], v81, 12296
 HWO4
 m16 a[196:199], v[140:143], v[104:107], 0
 rtr v[150:151], v81, 13832
 HWO5
 m16 a[204:207], v[140:143], v[108:111], 0
 rtr v[152:153], v80, 12416
 HWO6
 m16 a[16:19], v[144:147], v[88:91], 0
 HWO7
 s_mov_b32 m0, 32768
 m16 a[24:27], v[144:147], v[92:95], 0
 rtr v[154:155], v80, 13952
 HWO8
 m16 a[112:115], v[144:147], v[96:99], 0
 rtr v[156:157], v80, 12424
 HWO9
 m16 a[120:123], v[144:147], v[100:103], 0
 HWO10
 m16 a[208:211], v[144:147], v[104:107], 0
 HWO11
 s_add_u32 s56, s56, 122880
 s_mov_b32 m0, 0
 s_waitcnt lgkmcnt(4)
 m16 a[216:219], v[144:147], v[108:111], 0
 HWO0
 s_waitcnt lgkmcnt(3)
 m16 a[20:23], v[148:151], v[88:91], 0
 rtr v[158:159], v80, 13960
 HWO1
 m16 a[28:31], v[148:151], v[92:95], 0
 HWO2
 m16 a[116:119], v[148:151], v[96:99], 0
 HWO3
 s_mov_b32 m0, 4096
 m16 a[124:127], v[148:151], v[100:103], 0
 HWO4
 m16 a[212:215], v[148:151], v[104:107], 0
 rtr v[160:161], v81, 12416
 HWO5
 m16 a[220:223], v[148:151], v[108:111], 0
 HWO6
 s_waitcnt lgkmcnt(3)
 m16 a[32:35], v[152:155], v[88:91], 0
 HWO7
 s_mov_b32 m0, 8192
 m16 a[40:43], v[152:155], v[92:95], 0
 HWO8
 m16 a[128:131], v[152:155], v[96:99], 0
 rtr v[162:163], v81, 13952
 HWO9
 m16 a[136:139], v[152:155], v[100:103], 0
 HWO10
 m16 a[224:227], v[152:155], v[104:107], 0
 HWO11
 s_add_u32 s56, s56, -122752
 s_mov_b32 m0, 73728
 m16 a[232:235], v[152:155], v[108:111], 0
 HK0
 s_waitcnt lgkmcnt(2)
 m16 a[36:39], v[156:159], v[88:91], 0
 rtr v[164:165], v81, 12424
 HK1
 m16 a[44:47], v[156:159], v[92:95], 0
 HK2
 m16 a[132:135], v[156:159], v[96:99], 0
 HK3
 s_mov_b32 m0, 77824
 m16 a[140:143], v[156:159], v[100:103], 0
 HK4
 m16 a[228:231], v[156:159], v[104:107], 0
 rtr v[166:167], v81, 13960
 HK5
 m16 a[236:239], v[156:159], v[108:111], 0
 HK6
 s_waitcnt lgkmcnt(2)
 m16 a[48:51], v[160:163], v[88:91], 0
 HK7
 s_mov_b32 m0, 81920
 m16 a[56:59], v[160:163], v[92:95], 0
 HK8
 m16 a[144:147], v[160:163], v[96:99], 0
 rtr v[136:137], v80, 12544
 HK9
 m16 a[152:155], v[160:163], v[100:103], 0
 HK10
 m16 a[240:243], v[160:163], v[104:107], 0
 HK11
 s_add_u32 s52, s52, 12288
 s_mov_b32 m0, 98304
 m16 a[248:251], v[160:163], v[108:111], 0
 HV0
 s_waitcnt lgkmcnt(1)
 m16 a[52:55], v[164:167], v[88:91], 0
 rtr v[138:139], v80, 14080
 HV1
 m16 a[60:63], v[164:167], v[92:95], 0
 HV2
 m16 a[148:151], v[164:167], v[96:99], 0
 HV3
 s_mov_b32 m0, 102400
 m16 a[156:159], v[164:167], v[100:103], 0
 HV4
 m16 a[244:247], v[164:167], v[104:107], 0
 rtr v[140:141], v80, 12552
 HV5
 m16 a[252:255], v[164:167], v[108:111], 0
 HV6
 s_waitcnt lgkmcnt(1)
 m16 a[64:67], v[136:139], v[88:91], 0
 HV7
 s_mov_b32 m0, 106496
 m16 a[72:75], v[136:139], v[92:95], 0
 HV8
 m16 a[160:163], v[136:139], v[96:99], 0
 rtr v[142:143], v80, 14088
 HV9
 m16 a[168:171], v[136:139], v[100:103], 0
 HV10
 m16 v[168:171], v[136:139], v[104:107], 0
 HV11
 s_add_u32 s53, s53, 12288
 m16 v[176:179], v[136:139], v[108:111], 0
 s_waitcnt lgkmcnt(0)
 m16 a[68:71], v[140:143], v[88:91], 0
 rtr v[144:145], v81, 12544
 m16 a[76:79], v[140:143], v[92:95], 0
 m16 a[164:167], v[140:143], v[96:99], 0
 rtr v[146:147], v81, 14080
 m16 a[172:175], v[140:143], v[100:103], 0
 m16 v[172:175], v[140:143], v[104:107], 0
 rtr v[148:149], v81, 12552
 m16 v[180:183], v[140:143], v[108:111], 0
 s_waitcnt lgkmcnt(1)
 m16 a[80:83], v[144:147], v[88:91], 0
 rtr v[150:151], v81, 14088
 m16 a[88:91], v[144:147], v[92:95], 0
 m16 a[176:179], v[144:147], v[96:99], 0
 m16 a[184:187], v[144:147], v[100:103], 0
 m16 v[184:187], v[144:147], v[104:107], 0
 m16 v[192:195], v[144:147], v[108:111], 0
 s_waitcnt lgkmcnt(0)
 m16 a[84:87], v[148:151], v[88:91], 0
 m16 a[92:95], v[148:151], v[92:95], 0
 m16 a[180:183], v[148:151], v[96:99], 0
 m16 a[188:191], v[148:151], v[100:103], 0
 m16 v[188:191], v[148:151], v[104:107], 0
 m16 v[196:199], v[148:151], v[108:111], 0
 s_waitcnt vmcnt(24)
 s_barrier
 rtr v[136:137], v80, 24576
 rtr v[138:139], v80, 26112
 rtr v[140:141], v80, 24584
 rtr v[142:143], v80, 26120
 rtr v[144:145], v81, 24576
 rtr v[146:147], v81, 26112
 rtr v[148:149], v81, 24584
 rtr v[150:151], v81, 26120
 rtr v[152:153], v80, 24704
 rtr v[154:155], v80, 26240
 rtr v[156:157], v80, 24712
 rtr v[158:159], v80, 26248
 s_mov_b32 m0, 135168
 s_nop 0
 HU0
 HU1
 HU2
 HU3
 s_mov_b32 m0, 139264
 s_nop 0
 HU4
 HU5
 HU6
 s_waitcnt lgkmcnt(4)
 m16 a[0:3], v[136:139], v[112:115], a[0:3]
 HU7
 s_mov_b32 m0, 143360
 m16 a[8:11], v[136:139], v[116:119], a[8:11]
 rtr v[160:161], v81, 24704
 HU8
 m16 a[96:99], v[136:139], v[120:123], a[96:99]
 rtr v[162:163], v81, 26240
 HU9
 m16 a[104:107], v[136:139], v[124:127], a[104:107]
 rtr v[164:165], v81, 24712
 HU10
 m16 a[192:195], v[136:139], v[128:131], a[192:195]
 HU11
 s_add_u32 s59, s59, 393216
 s_sub_u32 s46, s59, 7864320
 s_cmp_ge_u32 s59, 7864320
 s_cselect_b32 s59, s46, s59
 s_mov_b32 m0, 122880
 m16 a[200:203], v[136:139], v[132:135], a[200:203]
 rtr v[166:167], v81, 26248
 HY0
 m16 a[4:7], v[140:143], v[112:115], a[4:7]
 rtr v[136:137], v80, 24832
 HY1
 m16 a[12:15], v[140:143], v[116:119], a[12:15]
 rtr v[138:139], v80, 26368
 HY2
 m16 a[100:103], v[140:143], v[120:123], a[100:103]
 HY3
 s_mov_b32 m0, 126976
 m16 a[108:111], v[140:143], v[124:127], a[108:111]
 HY4
 m16 a[196:199], v[140:143], v[128:131], a[196:199]
 HY5
 m16 a[204:207], v[140:143], v[132:135], a[204:207]
 rtr v[140:141], v80, 24840
 HY6
 m16 a[16:19], v[144:147], v[112:115], a[16:19]
 HY7
 s_mov_b32 m0, 131072
 m16 a[24:27], v[144:147], v[116:119], a[24:27]
 rtr v[142:143], v80, 26376
 HY8
 m16 a[112:115], v[144:147], v[120:123], a[112:115]
 HY9
 m16 a[120:123], v[144:147], v[124:127], a[120:123]
 HY10
 m16 a[208:211], v[144:147], v[128:131], a[208:211]
 HY11
 s_add_u32 s86, s86, 128
 s_sub_u32 s46, s86, 1280
 s_cmp_ge_u32 s86, s57
 s_cselect_b32 s86, s46, s86
 s_mov_b32 m0, 12288
 m16 a[216:219], v[144:147], v[132:135], a[216:219]
 HWO0
 m16 a[20:23], v[148:151], v[112:115], a[20:23]
 rtr v[144:145], v81, 24832
 HWO1
 m16 a[28:31], v[148:151], v[116:119], a[28:31]
 HWO2
 m16 a[116:119], v[148:151], v[120:123], a[116:119]
 HWO3
 s_mov_b32 m0, 16384
 m16 a[124:127], v[148:151], v[124:127], a[124:127]
 HWO4
 m16 a[212:215], v[148:151], v[128:131], a[212:215]
 rtr v[146:147], v81, 26368
 HWO5
 m16 a[220:223], v[148:151], v[132:135], a[220:223]
 HWO6
 s_waitcnt lgkmcnt(6)
 m16 a[32:35], v[152:155], v[112:115], a[32:35]
 HWO7
 s_mov_b32 m0, 20480
 m16 a[40:43], v[152:155], v[116:119], a[40:43]
 HWO8
 m16 a[128:131], v[152:155], v[120:123], a[128:131]
 rtr v[148:149], v81, 24840
 HWO9
 m16 a[136:139], v[152:155], v[124:127], a[136:139]
 HWO10
 m16 a[224:227], v[152:155], v[128:131], a[224:227]
 HWO11
 s_add_u32 s56, s56, 122880
 s_mov_b32 m0, 36864
 m16 a[232:235], v[152:155], v[132:135], a[232:235]
 HWO0
 m16 a[36:39], v[156:159], v[112:115], a[36:39]
 rtr v[150:151], v81, 26376
 HWO1
 m16 a[44:47], v[156:159], v[116:119], a[44:47]
 HWO2
 m16 a[132:135], v[156:159], v[120:123], a[132:135]
 HWO3
 s_mov_b32 m0, 40960
 m16 a[140:143], v[156:159], v[124:127], a[140:143]
 HWO4
 m16 a[228:231], v[156:159], v[128:131], a[228:231]
 HWO5
 m16 a[236:239], v[156:159], v[132:135], a[236:239]
 HWO6
 m16 a[48:51], v[160:163], v[112:115], a[48:51]
 HWO7
 s_mov_b32 m0, 45056
 m16 a[56:59], v[160:163], v[116:119], a[56:59]
 HWO8
 m16 a[144:147], v[160:163], v[120:123], a[144:147]
 HWO9
 m16 a[152:155], v[160:163], v[124:127], a[152:155]
 HWO10
 m16 a[240:243], v[160:163], v[128:131], a[240:243]
 HWO11
 s_add_u32 s56, s56, -122752
 s_mov_b32 m0, 49152
 m16 a[248:251], v[160:163], v[132:135], a[248:251]
 HK0
 m16 a[52:55], v[164:167], v[112:115], a[52:55]
 HK1
 m16 a[60:63], v[164:167], v[116:119], a[60:63]
 HK2
 m16 a[148:151], v[164:167], v[120:123], a[148:151]
 HK3
 s_mov_b32 m0, 53248
 m16 a[156:159], v[164:167], v[124:127], a[156:159]
 HK4
 m16 a[244:247], v[164:167], v[128:131], a[244:247]
 HK5
 m16 a[252:255], v[164:167], v[132:135], a[252:255]
 HK6
 s_waitcnt lgkmcnt(4)
 m16 a[64:67], v[136:139], v[112:115], a[64:67]
 HK7
 s_mov_b32 m0, 57344
 m16 a[72:75], v[136:139], v[116:119], a[72:75]
 HK8
 m16 a[160:163], v[136:139], v[120:123], a[160:163]
 HK9
 m16 a[168:171], v[136:139], v[124:127], a[168:171]
 HK10
 m16 v[168:171], v[136:139], v[128:131], v[168:171]
 HK11
 s_add_u32 s52, s52, 12288
 s_mov_b32 m0, 110592
 m16 v[176:179], v[136:139], v[132:135], v[176:179]
 HV0
 m16 a[68:71], v[140:143], v[112:115], a[68:71]
 HV1
 m16 a[76:79], v[140:143], v[116:119], a[76:79]
 HV2
 m16 a[164:167], v[140:143], v[120:123], a[164:167]
 HV3
 s_mov_b32 m0, 114688
 m16 a[172:175], v[140:143], v[124:127], a[172:175]
 HV4
 m16 v[172:175], v[140:143], v[128:131], v[172:175]
 HV5
 m16 v[180:183], v[140:143], v[132:135], v[180:183]
 HV6
 s_waitcnt lgkmcnt(2)
 m16 a[80:83], v[144:147], v[112:115], a[80:83]
 HV7
 s_mov_b32 m0, 118784
 m16 a[88:91], v[144:147], v[116:119], a[88:91]
 HV8
 m16 a[176:179], v[144:147], v[120:123], a[176:179]
 HV9
 m16 a[184:187], v[144:147], v[124:127], a[184:187]
 HV10
 m16 v[184:187], v[144:147], v[128:131], v[184:187]
 HV11
 s_add_u32 s53, s53, 12288
 m16 v[192:195], v[144:147], v[132:135], v[192:195]
 s_add_u32 s46, s58, 1024
 buffer_load_dword v78, v76, s[24:27], s46 offen
 s_waitcnt lgkmcnt(0)
 m16 a[84:87], v[148:151], v[112:115], a[84:87]
 s_add_u32 s46, s4, 1574016
 buffer_load_dword v78, v77, s[16:19], s46 offen
 m16 a[92:95], v[148:151], v[116:119], a[92:95]
 m16 a[180:183], v[148:151], v[120:123], a[180:183]
 m16 a[188:191], v[148:151], v[124:127], a[188:191]
 m16 v[188:191], v[148:151], v[128:131], v[188:191]
 m16 v[196:199], v[148:151], v[132:135], v[196:199]
 s_waitcnt vmcnt(50)
 s_barrier
 rtr v[136:137], v80, 12288
 rtr v[138:139], v80, 13824
 ds_read_b128 v[200:203], v84
 ds_read_b128 v[204:207], v84 offset:2048
 ds_read_b128 v[208:211], v84 offset:4096
 ds_read_b128 v[212:215], v84 offset:6144
 ds_read_b128 v[216:219], v84 offset:8192
 ds_read_b128 v[220:223], v84 offset:10240
 rtr v[140:141], v80, 12296
 rtr v[142:143], v80, 13832
 rtr v[144:145], v81, 12288
 rtr v[146:147], v81, 13824
 s_mov_b32 m0, 147456
 s_nop 0
 HU0
 HU1
 HU2
 HU3
 s_mov_b32 m0, 151552
 s_nop 0
 HU4
 HU5
 HU6
 s_waitcnt lgkmcnt(4)
 m16 a[0:3], v[136:139], v[200:203], a[0:3]
 HU7
 s_mov_b32 m0, 155648
 m16 a[8:11], v[136:139], v[204:207], a[8:11]
 ds_read_b128 v[224:227], v85
 HU8
 m16 a[96:99], v[136:139], v[208:211], a[96:99]
 ds_read_b128 v[228:231], v85 offset:2048
 HU9
 m16 a[104:107], v[136:139], v[212:215], a[104:107]
 ds_read_b128 v[232:235], v85 offset:4096
 HU10
 m16 a[192:195], v[136:139], v[216:219], a[192:195]
 HU11
 s_add_u32 s59, s59, 393216
 s_sub_u32 s46, s59, 7864320
 s_cmp_ge_u32 s59, 7864320
 s_cselect_b32 s59, s46, s59
 s_mov_b32 m0, 61440
 m16 a[200:203], v[136:139], v[220:223], a[200:203]
 ds_read_b128 v[236:239], v85 offset:6144
 HK0
 s_waitcnt lgkmcnt(4)
 m16 a[4:7], v[140:143], v[200:203], a[4:7]
 ds_read_b128 v[240:243], v85 offset:8192
 HK1
 m16 a[12:15], v[140:143], v[204:207], a[12:15]
 ds_read_b128 v[244:247], v85 offset:10240
 HK2
 m16 a[100:103], v[140:143], v[208:211], a[100:103]
 HK3
 s_mov_b32 m0, 65536
 m16 a[108:111], v[140:143], v[212:215], a[108:111]
 rtr v[148:149], v81, 12296
 HK4
 m16 a[196:199], v[140:143], v[216:219], a[196:199]
 rtr v[150:151], v81, 13832
 HK5
 m16 a[204:207], v[140:143], v[220:223], a[204:207]
 rtr v[152:153], v80, 12416
 HK6
 m16 a[16:19], v[144:147], v[200:203], a[16:19]
 HK7
 s_mov_b32 m0, 69632
 m16 a[24:27], v[144:147], v[204:207], a[24:27]
 rtr v[154:155], v80, 13952
 HK8
 m16 a[112:115], v[144:147], v[208:211], a[112:115]
 rtr v[156:157], v80, 12424
 HK9
 m16 a[120:123], v[144:147], v[212:215], a[120:123]
 HK10
 m16 a[208:211], v[144:147], v[216:219], a[208:211]
 HK11
 s_add_u32 s52, s52, 12288
 s_mov_b32 m0, 86016
 s_waitcnt lgkmcnt(4)
 m16 a[216:219], v[144:147], v[220:223], a[216:219]
 HV0
 s_waitcnt lgkmcnt(3)
 m16 a[20:23], v[148:151], v[200:203], a[20:23]
 rtr v[158:159], v80, 13960
 HV1
 m16 a[28:31], v[148:151], v[204:207], a[28:31]
 HV2
 m16 a[116:119], v[148:151], v[208:211], a[116:119]
 HV3
 s_mov_b32 m0, 90112
 m16 a[124:127], v[148:151], v[212:215], a[124:127]
 HV4
 m16 a[212:215], v[148:151], v[216:219], a[212:215]
 rtr v[160:161], v81, 12416
 HV5
 m16 a[220:223], v[148:151], v[220:223], a[220:223]
 HV6
 s_waitcnt lgkmcnt(3)
 m16 a[32:35], v[152:155], v[200:203], a[32:35]
 HV7
 s_mov_b32 m0, 94208
 m16 a[40:43], v[152:155], v[204:207], a[40:43]
 HV8
 m16 a[128:131], v[152:155], v[208:211], a[128:131]
 rtr v[162:163], v81, 13952
 HV9
 m16 a[136:139], v[152:155], v[212:215], a[136:139]
 HV10
 m16 a[224:227], v[152:155], v[216:219], a[224:227]
 HV11
 s_add_u32 s53, s53, 12288
 m16 a[232:235], v[152:155], v[220:223], a[232:235]
 s_waitcnt lgkmcnt(2)
 m16 a[36:39], v[156:159], v[200:203], a[36:39]
 rtr v[164:165], v81, 12424
 m16 a[44:47], v[156:159], v[204:207], a[44:47]
 m16 a[132:135], v[156:159], v[208:211], a[132:135]
 rtr v[166:167], v81, 13960
 m16 a[140:143], v[156:159], v[212:215], a[140:143]
 m16 a[228:231], v[156:159], v[216:219], a[228:231]
 rtr v[136:137], v80, 12544
 m16 a[236:239], v[156:159], v[220:223], a[236:239]
 s_waitcnt lgkmcnt(3)
 m16 a[48:51], v[160:163], v[200:203], a[48:51]
 rtr v[138:139], v80, 14080
 m16 a[56:59], v[160:163], v[204:207], a[56:59]
 m16 a[144:147], v[160:163], v[208:211], a[144:147]
 rtr v[140:141], v80, 12552
 m16 a[152:155], v[160:163], v[212:215], a[152:155]
 m16 a[240:243], v[160:163], v[216:219], a[240:243]
 rtr v[142:143], v80, 14088
 m16 a[248:251], v[160:163], v[220:223], a[248:251]
 s_waitcnt lgkmcnt(4)
 m16 a[52:55], v[164:167], v[200:203], a[52:55]
 rtr v[144:145], v81, 12544
 m16 a[60:63], v[164:167], v[204:207], a[60:63]
 m16 a[148:151], v[164:167], v[208:211], a[148:151]
 rtr v[146:147], v81, 14080
 m16 a[156:159], v[164:167], v[212:215], a[156:159]
 m16 a[244:247], v[164:167], v[216:219], a[244:247]
 rtr v[148:149], v81, 12552
 m16 a[252:255], v[164:167], v[220:223], a[252:255]
 s_waitcnt lgkmcnt(4)
 m16 a[64:67], v[136:139], v[200:203], a[64:67]
 rtr v[150:151], v81, 14088
 m16 a[72:75], v[136:139], v[204:207], a[72:75]
 m16 a[160:163], v[136:139], v[208:211], a[160:163]
 m16 a[168:171], v[136:139], v[212:215], a[168:171]
 m16 v[168:171], v[136:139], v[216:219], v[168:171]
 m16 v[176:179], v[136:139], v[220:223], v[176:179]
 s_waitcnt lgkmcnt(4)
 m16 a[68:71], v[140:143], v[200:203], a[68:71]
 m16 a[76:79], v[140:143], v[204:207], a[76:79]
 m16 a[164:167], v[140:143], v[208:211], a[164:167]
 m16 a[172:175], v[140:143], v[212:215], a[172:175]
 m16 v[172:175], v[140:143], v[216:219], v[172:175]
 m16 v[180:183], v[140:143], v[220:223], v[180:183]
 s_waitcnt lgkmcnt(2)
 m16 a[80:83], v[144:147], v[200:203], a[80:83]
 m16 a[88:91], v[144:147], v[204:207], a[88:91]
 m16 a[176:179], v[144:147], v[208:211], a[176:179]
 m16 a[184:187], v[144:147], v[212:215], a[184:187]
 m16 v[184:187], v[144:147], v[216:219], v[184:187]
 m16 v[192:195], v[144:147], v[220:223], v[192:195]
 s_waitcnt lgkmcnt(0)
 m16 a[84:87], v[148:151], v[200:203], a[84:87]
 m16 a[92:95], v[148:151], v[204:207], a[92:95]
 m16 a[180:183], v[148:151], v[208:211], a[180:183]
 m16 a[188:191], v[148:151], v[212:215], a[188:191]
 m16 v[188:191], v[148:151], v[216:219], v[188:191]
 m16 v[196:199], v[148:151], v[220:223], v[196:199]
 s_waitcnt vmcnt(24)
 s_barrier
 rtr v[136:137], v80, 24576
 rtr v[138:139], v80, 26112
 rtr v[140:141], v80, 24584
 rtr v[142:143], v80, 26120
 rtr v[144:145], v81, 24576
 rtr v[146:147], v81, 26112
 rtr v[148:149], v81, 24584
 rtr v[150:151], v81, 26120
 rtr v[152:153], v80, 24704
 rtr v[154:155], v80, 26240
 rtr v[156:157], v80, 24712
 rtr v[158:159], v80, 26248
 s_mov_b32 m0, 135168
 s_nop 0
 HU0
 HU1
 HU2
 HU3
 s_mov_b32 m0, 139264
 s_nop 0
 HU4
 HU5
 HU6
 s_waitcnt lgkmcnt(4)
 m16 a[0:3], v[136:139], v[224:227], a[0:3]
 HU7
 s_mov_b32 m0, 143360
 m16 a[8:11], v[136:139], v[228:231], a[8:11]
 rtr v[160:161], v81, 24704
 HU8
 m16 a[96:99], v[136:139], v[232:235], a[96:99]
 rtr v[162:163], v81, 26240
 HU9
 m16 a[104:107], v[136:139], v[236:239], a[104:107]
 rtr v[164:165], v81, 24712
 HU10
 m16 a[192:195], v[136:139], v[240:243], a[192:195]
 HU11
 s_add_u32 s59, s59, 393216
 s_sub_u32 s46, s59, 7864320
 s_cmp_ge_u32 s59, 7864320
 s_cselect_b32 s59, s46, s59
 s_mov_b32 m0, 122880
 m16 a[200:203], v[136:139], v[244:247], a[200:203]
 rtr v[166:167], v81, 26248
 HY0
 m16 a[4:7], v[140:143], v[224:227], a[4:7]
 rtr v[136:137], v80, 24832
 HY1
 m16 a[12:15], v[140:143], v[228:231], a[12:15]
 rtr v[138:139], v80, 26368
 HY2
 m16 a[100:103], v[140:143], v[232:235], a[100:103]
 HY3
 s_mov_b32 m0, 126976
 m16 a[108:111], v[140:143], v[236:239], a[108:111]
 HY4
 m16 a[196:199], v[140:143], v[240:243], a[196:199]
 HY5
 m16 a[204:207], v[140:143], v[244:247], a[204:207]
 rtr v[140:141], v80, 24840
 HY6
 m16 a[16:19], v[144:147], v[224:227], a[16:19]
 HY7
 s_mov_b32 m0, 131072
 m16 a[24:27], v[144:147], v[228:231], a[24:27]
 rtr v[142:143], v80, 26376
 HY8
 m16 a[112:115], v[144:147], v[232:235], a[112:115]
 HY9
 m16 a[120:123], v[144:147], v[236:239], a[120:123]
 HY10
 m16 a[208:211], v[144:147], v[240:243], a[208:211]
 HY11
 s_add_u32 s86, s86, 128
 s_sub_u32 s46, s86, 1280
 s_cmp_ge_u32 s86, s57
 s_cselect_b32 s86, s46, s86
 s_mov_b32 m0, 24576
 m16 a[216:219], v[144:147], v[244:247], a[216:219]
 HWO0
 m16 a[20:23], v[148:151], v[224:227], a[20:23]
 rtr v[144:145], v81, 24832
 HWO1
 m16 a[28:31], v[148:151], v[228:231], a[28:31]
 HWO2
 m16 a[116:119], v[148:151], v[232:235], a[116:119]
 HWO3
 s_mov_b32 m0, 28672
 m16 a[124:127], v[148:151], v[236:239], a[124:127]
 HWO4
 m16 a[212:215], v[148:151], v[240:243], a[212:215]
 rtr v[146:147], v81, 26368
 HWO5
 m16 a[220:223], v[148:151], v[244:247], a[220:223]
 HWO6
 s_waitcnt lgkmcnt(6)
 m16 a[32:35], v[152:155], v[224:227], a[32:35]
 HWO7
 s_mov_b32 m0, 32768
 m16 a[40:43], v[152:155], v[228:231], a[40:43]
 HWO8
 m16 a[128:131], v[152:155], v[232:235], a[128:131]
 rtr v[148:149], v81, 24840
 HWO9
 m16 a[136:139], v[152:155], v[236:239], a[136:139]
 HWO10
 m16 a[224:227], v[152:155], v[240:243], a[224:227]
 HWO11
 s_add_u32 s56, s56, 122880
 s_mov_b32 m0, 0
 m16 a[232:235], v[152:155], v[244:247], a[232:235]
 HWO0
 m16 a[36:39], v[156:159], v[224:227], a[36:39]
 rtr v[150:151], v81, 26376
 HWO1
 m16 a[44:47], v[156:159], v[228:231], a[44:47]
 HWO2
 m16 a[132:135], v[156:159], v[232:235], a[132:135]
 HWO3
 s_mov_b32 m0, 4096
 m16 a[140:143], v[156:159], v[236:239], a[140:143]
 HWO4
 m16 a[228:231], v[156:159], v[240:243], a[228:231]
 HWO5
 m16 a[236:239], v[156:159], v[244:247], a[236:239]
 HWO6
 m16 a[48:51], v[160:163], v[224:227], a[48:51]
 HWO7
 s_mov_b32 m0, 8192
 m16 a[56:59], v[160:163], v[228:231], a[56:59]
 HWO8
 m16 a[144:147], v[160:163], v[232:235], a[144:147]
 HWO9
 m16 a[152:155], v[160:163], v[236:239], a[152:155]
 HWO10
 m16 a[240:243], v[160:163], v[240:243], a[240:243]
 HWO11
 s_add_u32 s56, s56, -122752
 s_mov_b32 m0, 73728
 m16 a[248:251], v[160:163], v[244:247], a[248:251]
 HK0
 m16 a[52:55], v[164:167], v[224:227], a[52:55]
 HK1
 m16 a[60:63], v[164:167], v[228:231], a[60:63]
 HK2
 m16 a[148:151], v[164:167], v[232:235], a[148:151]
 HK3
 s_mov_b32 m0, 77824
 m16 a[156:159], v[164:167], v[236:239], a[156:159]
 HK4
 m16 a[244:247], v[164:167], v[240:243], a[244:247]
 HK5
 m16 a[252:255], v[164:167], v[244:247], a[252:255]
 HK6
 s_waitcnt lgkmcnt(4)
 m16 a[64:67], v[136:139], v[224:227], a[64:67]
 HK7
 s_mov_b32 m0, 81920
 m16 a[72:75], v[136:139], v[228:231], a[72:75]
 HK8
 m16 a[160:163], v[136:139], v[232:235], a[160:163]
 HK9
 m16 a[168:171], v[136:139], v[236:239], a[168:171]
 HK10
 m16 v[168:171], v[136:139], v[240:243], v[168:171]
 HK11
 s_add_u32 s52, s52, 12288
 s_mov_b32 m0, 98304
 m16 v[176:179], v[136:139], v[244:247], v[176:179]
 HV0
 m16 a[68:71], v[140:143], v[224:227], a[68:71]
 HV1
 m16 a[76:79], v[140:143], v[228:231], a[76:79]
 HV2
 m16 a[164:167], v[140:143], v[232:235], a[164:167]
 HV3
 s_mov_b32 m0, 102400
 m16 a[172:175], v[140:143], v[236:239], a[172:175]
 HV4
 m16 v[172:175], v[140:143], v[240:243], v[172:175]
 HV5
 m16 v[180:183], v[140:143], v[244:247], v[180:183]
 HV6
 s_waitcnt lgkmcnt(2)
 m16 a[80:83], v[144:147], v[224:227], a[80:83]
 HV7
 s_mov_b32 m0, 106496
 m16 a[88:91], v[144:147], v[228:231], a[88:91]
 HV8
 m16 a[176:179], v[144:147], v[232:235], a[176:179]
 HV9
 m16 a[184:187], v[144:147], v[236:239], a[184:187]
 HV10
 m16 v[184:187], v[144:147], v[240:243], v[184:187]
 HV11
 s_add_u32 s53, s53, 12288
 m16 v[192:195], v[144:147], v[244:247], v[192:195]
 s_waitcnt lgkmcnt(0)
 m16 a[84:87], v[148:151], v[224:227], a[84:87]
 m16 a[92:95], v[148:151], v[228:231], a[92:95]
 m16 a[180:183], v[148:151], v[232:235], a[180:183]
 m16 a[188:191], v[148:151], v[236:239], a[188:191]
 m16 v[188:191], v[148:151], v[240:243], v[188:191]
 m16 v[196:199], v[148:151], v[244:247], v[196:199]
 s_waitcnt vmcnt(48)
 s_barrier
 rtr v[136:137], v80, 12288
 rtr v[138:139], v80, 13824
 ds_read_b128 v[88:91], v84
 ds_read_b128 v[92:95], v84 offset:2048
 ds_read_b128 v[96:99], v84 offset:4096
 ds_read_b128 v[100:103], v84 offset:6144
 ds_read_b128 v[104:107], v84 offset:8192
 ds_read_b128 v[108:111], v84 offset:10240
 rtr v[140:141], v80, 12296
 rtr v[142:143], v80, 13832
 rtr v[144:145], v81, 12288
 rtr v[146:147], v81, 13824
 s_mov_b32 m0, 147456
 s_nop 0
 HU0
 HU1
 HU2
 HU3
 s_mov_b32 m0, 151552
 s_nop 0
 HU4
 HU5
 HU6
 s_waitcnt lgkmcnt(4)
 m16 a[0:3], v[136:139], v[88:91], a[0:3]
 HU7
 s_mov_b32 m0, 155648
 m16 a[8:11], v[136:139], v[92:95], a[8:11]
 ds_read_b128 v[112:115], v85
 HU8
 m16 a[96:99], v[136:139], v[96:99], a[96:99]
 ds_read_b128 v[116:119], v85 offset:2048
 HU9
 m16 a[104:107], v[136:139], v[100:103], a[104:107]
 ds_read_b128 v[120:123], v85 offset:4096
 HU10
 m16 a[192:195], v[136:139], v[104:107], a[192:195]
 HU11
 s_add_u32 s59, s59, 393216
 s_sub_u32 s46, s59, 7864320
 s_cmp_ge_u32 s59, 7864320
 s_cselect_b32 s59, s46, s59
 s_mov_b32 m0, 49152
 m16 a[200:203], v[136:139], v[108:111], a[200:203]
 ds_read_b128 v[124:127], v85 offset:6144
 HK0
 s_waitcnt lgkmcnt(4)
 m16 a[4:7], v[140:143], v[88:91], a[4:7]
 ds_read_b128 v[128:131], v85 offset:8192
 HK1
 m16 a[12:15], v[140:143], v[92:95], a[12:15]
 ds_read_b128 v[132:135], v85 offset:10240
 HK2
 m16 a[100:103], v[140:143], v[96:99], a[100:103]
 HK3
 s_mov_b32 m0, 53248
 m16 a[108:111], v[140:143], v[100:103], a[108:111]
 rtr v[148:149], v81, 12296
 HK4
 m16 a[196:199], v[140:143], v[104:107], a[196:199]
 rtr v[150:151], v81, 13832
 HK5
 m16 a[204:207], v[140:143], v[108:111], a[204:207]
 rtr v[152:153], v80, 12416
 HK6
 m16 a[16:19], v[144:147], v[88:91], a[16:19]
 HK7
 s_mov_b32 m0, 57344
 m16 a[24:27], v[144:147], v[92:95], a[24:27]
 rtr v[154:155], v80, 13952
 HK8
 m16 a[112:115], v[144:147], v[96:99], a[112:115]
 rtr v[156:157], v80, 12424
 HK9
 m16 a[120:123], v[144:147], v[100:103], a[120:123]
 HK10
 m16 a[208:211], v[144:147], v[104:107], a[208:211]
 HK11
 s_add_u32 s52, s52, 24576
 s_mov_b32 m0, 110592
 s_waitcnt lgkmcnt(4)
 m16 a[216:219], v[144:147], v[108:111], a[216:219]
 HV0
 s_waitcnt lgkmcnt(3)
 m16 a[20:23], v[148:151], v[88:91], a[20:23]
 rtr v[158:159], v80, 13960
 HV1
 m16 a[28:31], v[148:151], v[92:95], a[28:31]
 HV2
 m16 a[116:119], v[148:151], v[96:99], a[116:119]
 HV3
 s_mov_b32 m0, 114688
 m16 a[124:127], v[148:151], v[100:103], a[124:127]
 HV4
 m16 a[212:215], v[148:151], v[104:107], a[212:215]
 rtr v[160:161], v81, 12416
 HV5
 m16 a[220:223], v[148:151], v[108:111], a[220:223]
 HV6
 s_waitcnt lgkmcnt(3)
 m16 a[32:35], v[152:155], v[88:91], a[32:35]
 HV7
 s_mov_b32 m0, 118784
 m16 a[40:43], v[152:155], v[92:95], a[40:43]
 HV8
 m16 a[128:131], v[152:155], v[96:99], a[128:131]
 rtr v[162:163], v81, 13952
 HV9
 m16 a[136:139], v[152:155], v[100:103], a[136:139]
 HV10
 m16 a[224:227], v[152:155], v[104:107], a[224:227]
 HV11
 s_add_u32 s53, s53, 12288
 m16 a[232:235], v[152:155], v[108:111], a[232:235]
 s_waitcnt lgkmcnt(2)
 m16 a[36:39], v[156:159], v[88:91], a[36:39]
 rtr v[164:165], v81, 12424
 m16 a[44:47], v[156:159], v[92:95], a[44:47]
 m16 a[132:135], v[156:159], v[96:99], a[132:135]
 rtr v[166:167], v81, 13960
 m16 a[140:143], v[156:159], v[100:103], a[140:143]
 m16 a[228:231], v[156:159], v[104:107], a[228:231]
 rtr v[136:137], v80, 12544
 m16 a[236:239], v[156:159], v[108:111], a[236:239]
 s_waitcnt lgkmcnt(3)
 m16 a[48:51], v[160:163], v[88:91], a[48:51]
 rtr v[138:139], v80, 14080
 m16 a[56:59], v[160:163], v[92:95], a[56:59]
 m16 a[144:147], v[160:163], v[96:99], a[144:147]
 rtr v[140:141], v80, 12552
 m16 a[152:155], v[160:163], v[100:103], a[152:155]
 m16 a[240:243], v[160:163], v[104:107], a[240:243]
 rtr v[142:143], v80, 14088
 m16 a[248:251], v[160:163], v[108:111], a[248:251]
 s_waitcnt lgkmcnt(4)
 m16 a[52:55], v[164:167], v[88:91], a[52:55]
 rtr v[144:145], v81, 12544
 m16 a[60:63], v[164:167], v[92:95], a[60:63]
 m16 a[148:151], v[164:167], v[96:99], a[148:151]
 rtr v[146:147], v81, 14080
 m16 a[156:159], v[164:167], v[100:103], a[156:159]
 m16 a[244:247], v[164:167], v[104:107], a[244:247]
 rtr v[148:149], v81, 12552
 m16 a[252:255], v[164:167], v[108:111], a[252:255]
 s_waitcnt lgkmcnt(4)
 m16 a[64:67], v[136:139], v[88:91], a[64:67]
 rtr v[150:151], v81, 14088
 m16 a[72:75], v[136:139], v[92:95], a[72:75]
 m16 a[160:163], v[136:139], v[96:99], a[160:163]
 m16 a[168:171], v[136:139], v[100:103], a[168:171]
 m16 v[168:171], v[136:139], v[104:107], v[168:171]
 m16 v[176:179], v[136:139], v[108:111], v[176:179]
 s_waitcnt lgkmcnt(4)
 m16 a[68:71], v[140:143], v[88:91], a[68:71]
 m16 a[76:79], v[140:143], v[92:95], a[76:79]
 m16 a[164:167], v[140:143], v[96:99], a[164:167]
 m16 a[172:175], v[140:143], v[100:103], a[172:175]
 m16 v[172:175], v[140:143], v[104:107], v[172:175]
 m16 v[180:183], v[140:143], v[108:111], v[180:183]
 s_waitcnt lgkmcnt(2)
 m16 a[80:83], v[144:147], v[88:91], a[80:83]
 m16 a[88:91], v[144:147], v[92:95], a[88:91]
 m16 a[176:179], v[144:147], v[96:99], a[176:179]
 m16 a[184:187], v[144:147], v[100:103], a[184:187]
 m16 v[184:187], v[144:147], v[104:107], v[184:187]
 m16 v[192:195], v[144:147], v[108:111], v[192:195]
 s_waitcnt lgkmcnt(0)
 m16 a[84:87], v[148:151], v[88:91], a[84:87]
 m16 a[92:95], v[148:151], v[92:95], a[92:95]
 m16 a[180:183], v[148:151], v[96:99], a[180:183]
 m16 a[188:191], v[148:151], v[100:103], a[188:191]
 m16 v[188:191], v[148:151], v[104:107], v[188:191]
 m16 v[196:199], v[148:151], v[108:111], v[196:199]
 s_waitcnt vmcnt(24)
 s_barrier
 rtr v[136:137], v80, 24576
 rtr v[138:139], v80, 26112
 rtr v[140:141], v80, 24584
 rtr v[142:143], v80, 26120
 rtr v[144:145], v81, 24576
 rtr v[146:147], v81, 26112
 rtr v[148:149], v81, 24584
 rtr v[150:151], v81, 26120
 rtr v[152:153], v80, 24704
 rtr v[154:155], v80, 26240
 rtr v[156:157], v80, 24712
 rtr v[158:159], v80, 26248
 s_mov_b32 m0, 135168
 s_nop 0
 HU0
 HU1
 HU2
 HU3
 s_mov_b32 m0, 139264
 s_nop 0
 HU4
 HU5
 HU6
 s_waitcnt lgkmcnt(4)
 m16 a[0:3], v[136:139], v[112:115], a[0:3]
 HU7
 s_mov_b32 m0, 143360
 m16 a[8:11], v[136:139], v[116:119], a[8:11]
 rtr v[160:161], v81, 24704
 HU8
 m16 a[96:99], v[136:139], v[120:123], a[96:99]
 rtr v[162:163], v81, 26240
 HU9
 m16 a[104:107], v[136:139], v[124:127], a[104:107]
 rtr v[164:165], v81, 24712
 HU10
 m16 a[192:195], v[136:139], v[128:131], a[192:195]
 HU11
 s_add_u32 s59, s59, 393216
 s_sub_u32 s46, s59, 7864320
 s_cmp_ge_u32 s59, 7864320
 s_cselect_b32 s59, s46, s59
 s_mov_b32 m0, 122880
 m16 a[200:203], v[136:139], v[132:135], a[200:203]
 rtr v[166:167], v81, 26248
 HY0
 m16 a[4:7], v[140:143], v[112:115], a[4:7]
 rtr v[136:137], v80, 24832
 HY1
 m16 a[12:15], v[140:143], v[116:119], a[12:15]
 rtr v[138:139], v80, 26368
 HY2
 m16 a[100:103], v[140:143], v[120:123], a[100:103]
 HY3
 s_mov_b32 m0, 126976
 m16 a[108:111], v[140:143], v[124:127], a[108:111]
 HY4
 m16 a[196:199], v[140:143], v[128:131], a[196:199]
 HY5
 m16 a[204:207], v[140:143], v[132:135], a[204:207]
 rtr v[140:141], v80, 24840
 HY6
 m16 a[16:19], v[144:147], v[112:115], a[16:19]
 HY7
 s_mov_b32 m0, 131072
 m16 a[24:27], v[144:147], v[116:119], a[24:27]
 rtr v[142:143], v80, 26376
 HY8
 m16 a[112:115], v[144:147], v[120:123], a[112:115]
 HY9
 m16 a[120:123], v[144:147], v[124:127], a[120:123]
 HY10
 m16 a[208:211], v[144:147], v[128:131], a[208:211]
 HY11
 s_add_u32 s86, s86, 128
 s_sub_u32 s46, s86, 1280
 s_cmp_ge_u32 s86, s57
 s_cselect_b32 s86, s46, s86
 s_mov_b32 m0, 12288
 m16 a[216:219], v[144:147], v[132:135], a[216:219]
 HWO0
 m16 a[20:23], v[148:151], v[112:115], a[20:23]
 rtr v[144:145], v81, 24832
 HWO1
 m16 a[28:31], v[148:151], v[116:119], a[28:31]
 HWO2
 m16 a[116:119], v[148:151], v[120:123], a[116:119]
 HWO3
 s_mov_b32 m0, 16384
 m16 a[124:127], v[148:151], v[124:127], a[124:127]
 HWO4
 m16 a[212:215], v[148:151], v[128:131], a[212:215]
 rtr v[146:147], v81, 26368
 HWO5
 m16 a[220:223], v[148:151], v[132:135], a[220:223]
 HWO6
 s_waitcnt lgkmcnt(6)
 m16 a[32:35], v[152:155], v[112:115], a[32:35]
 HWO7
 s_mov_b32 m0, 20480
 m16 a[40:43], v[152:155], v[116:119], a[40:43]
 HWO8
 m16 a[128:131], v[152:155], v[120:123], a[128:131]
 rtr v[148:149], v81, 24840
 HWO9
 m16 a[136:139], v[152:155], v[124:127], a[136:139]
 HWO10
 m16 a[224:227], v[152:155], v[128:131], a[224:227]
 HWO11
 s_add_u32 s56, s56, 122880
 s_mov_b32 m0, 36864
 m16 a[232:235], v[152:155], v[132:135], a[232:235]
 HWO0
 m16 a[36:39], v[156:159], v[112:115], a[36:39]
 rtr v[150:151], v81, 26376
 HWO1
 m16 a[44:47], v[156:159], v[116:119], a[44:47]
 HWO2
 m16 a[132:135], v[156:159], v[120:123], a[132:135]
 HWO3
 s_mov_b32 m0, 40960
 m16 a[140:143], v[156:159], v[124:127], a[140:143]
 HWO4
 m16 a[228:231], v[156:159], v[128:131], a[228:231]
 HWO5
 m16 a[236:239], v[156:159], v[132:135], a[236:239]
 HWO6
 m16 a[48:51], v[160:163], v[112:115], a[48:51]
 HWO7
 s_mov_b32 m0, 45056
 m16 a[56:59], v[160:163], v[116:119], a[56:59]
 HWO8
 m16 a[144:147], v[160:163], v[120:123], a[144:147]
 HWO9
 m16 a[152:155], v[160:163], v[124:127], a[152:155]
 HWO10
 m16 a[240:243], v[160:163], v[128:131], a[240:243]
 HWO11
 s_add_u32 s56, s56, 121728
 s_mov_b32 m0, 86016
 m16 a[248:251], v[160:163], v[132:135], a[248:251]
 HV0
 m16 a[52:55], v[164:167], v[112:115], a[52:55]
 HV1
 m16 a[60:63], v[164:167], v[116:119], a[60:63]
 HV2
 m16 a[148:151], v[164:167], v[120:123], a[148:151]
 HV3
 s_mov_b32 m0, 90112
 m16 a[156:159], v[164:167], v[124:127], a[156:159]
 HV4
 m16 a[244:247], v[164:167], v[128:131], a[244:247]
 HV5
 m16 a[252:255], v[164:167], v[132:135], a[252:255]
 HV6
 s_waitcnt lgkmcnt(4)
 m16 a[64:67], v[136:139], v[112:115], a[64:67]
 HV7
 s_mov_b32 m0, 94208
 m16 a[72:75], v[136:139], v[116:119], a[72:75]
 HV8
 m16 a[160:163], v[136:139], v[120:123], a[160:163]
 HV9
 m16 a[168:171], v[136:139], v[124:127], a[168:171]
 HV10
 m16 v[168:171], v[136:139], v[128:131], v[168:171]
 HV11
 s_add_u32 s53, s53, 12288
 s_mov_b32 m0, 61440
 m16 v[176:179], v[136:139], v[132:135], v[176:179]
 HK0
 m16 a[68:71], v[140:143], v[112:115], a[68:71]
 HK1
 m16 a[76:79], v[140:143], v[116:119], a[76:79]
 HK2
 m16 a[164:167], v[140:143], v[120:123], a[164:167]
 HK3
 s_mov_b32 m0, 65536
 m16 a[172:175], v[140:143], v[124:127], a[172:175]
 HK4
 m16 v[172:175], v[140:143], v[128:131], v[172:175]
 HK5
 m16 v[180:183], v[140:143], v[132:135], v[180:183]
 HK6
 s_waitcnt lgkmcnt(2)
 m16 a[80:83], v[144:147], v[112:115], a[80:83]
 HK7
 s_mov_b32 m0, 69632
 m16 a[88:91], v[144:147], v[116:119], a[88:91]
 HK8
 m16 a[176:179], v[144:147], v[120:123], a[176:179]
 HK9
 m16 a[184:187], v[144:147], v[124:127], a[184:187]
 HK10
 m16 v[184:187], v[144:147], v[128:131], v[184:187]
 HK11
 s_add_u32 s52, s52, -12288
 m16 v[192:195], v[144:147], v[132:135], v[192:195]
 s_add_u32 s46, s58, 245760
 buffer_load_dword v78, v76, s[24:27], s46 offen
 s_waitcnt lgkmcnt(0)
 m16 a[84:87], v[148:151], v[112:115], a[84:87]
 s_add_u32 s46, s4, 3146880
 buffer_load_dword v78, v77, s[16:19], s46 offen
 m16 a[92:95], v[148:151], v[116:119], a[92:95]
 m16 a[180:183], v[148:151], v[120:123], a[180:183]
 m16 a[188:191], v[148:151], v[124:127], a[188:191]
 m16 v[188:191], v[148:151], v[128:131], v[188:191]
 m16 v[196:199], v[148:151], v[132:135], v[196:199]
 s_waitcnt vmcnt(50)
 s_barrier
 rtr v[136:137], v80, 12288
 rtr v[138:139], v80, 13824
 ds_read_b128 v[200:203], v84
 ds_read_b128 v[204:207], v84 offset:2048
 ds_read_b128 v[208:211], v84 offset:4096
 ds_read_b128 v[212:215], v84 offset:6144
 ds_read_b128 v[216:219], v84 offset:8192
 ds_read_b128 v[220:223], v84 offset:10240
 rtr v[140:141], v80, 12296
 rtr v[142:143], v80, 13832
 rtr v[144:145], v81, 12288
 rtr v[146:147], v81, 13824
 s_waitcnt lgkmcnt(4)
 m16 a[0:3], v[136:139], v[200:203], a[0:3]
 ds_read_b128 v[224:227], v85
 m16 a[8:11], v[136:139], v[204:207], a[8:11]
 ds_read_b128 v[228:231], v85 offset:2048
 m16 a[96:99], v[136:139], v[208:211], a[96:99]
 ds_read_b128 v[232:235], v85 offset:4096
 m16 a[104:107], v[136:139], v[212:215], a[104:107]
 ds_read_b128 v[236:239], v85 offset:6144
 m16 a[192:195], v[136:139], v[216:219], a[192:195]
 ds_read_b128 v[240:243], v85 offset:8192
 m16 a[200:203], v[136:139], v[220:223], a[200:203]
 ds_read_b128 v[244:247], v85 offset:10240
 s_waitcnt lgkmcnt(4)
 m16 a[4:7], v[140:143], v[200:203], a[4:7]
 m16 a[12:15], v[140:143], v[204:207], a[12:15]
 m16 a[100:103], v[140:143], v[208:211], a[100:103]
 m16 a[108:111], v[140:143], v[212:215], a[108:111]
 m16 a[196:199], v[140:143], v[216:219], a[196:199]
 m16 a[204:207], v[140:143], v[220:223], a[204:207]
 m16 a[16:19], v[144:147], v[200:203], a[16:19]
 m16 a[24:27], v[144:147], v[204:207], a[24:27]
 m16 a[112:115], v[144:147], v[208:211], a[112:115]
 m16 a[120:123], v[144:147], v[212:215], a[120:123]
 m16 a[208:211], v[144:147], v[216:219], a[208:211]
 s_waitcnt lgkmcnt(0)
 m16 a[216:219], v[144:147], v[220:223], a[216:219]
 s_barrier
 rtr v[136:137], v81, 12296
 rtr v[138:139], v81, 13832
 rtr v[140:141], v80, 12416
 rtr v[142:143], v80, 13952
 rtr v[144:145], v80, 12424
 rtr v[146:147], v80, 13960
 rtr v[148:149], v81, 12416
 rtr v[150:151], v81, 13952
 rtr v[152:153], v81, 12424
 rtr v[154:155], v81, 13960
 rtr v[156:157], v80, 12544
 rtr v[158:159], v80, 14080
 s_mov_b32 m0, 147456
 s_nop 0
 HU0
 HU1
 HU2
 HU3
 s_mov_b32 m0, 151552
 s_nop 0
 HU4
 HU5
 HU6
 s_waitcnt lgkmcnt(4)
 m16 a[20:23], v[136:139], v[200:203], a[20:23]
 HU7
 s_mov_b32 m0, 155648
 m16 a[28:31], v[136:139], v[204:207], a[28:31]
 rtr v[160:161], v80, 12552
 HU8
 m16 a[116:119], v[136:139], v[208:211], a[116:119]
 rtr v[162:163], v80, 14088
 HU9
 m16 a[124:127], v[136:139], v[212:215], a[124:127]
 rtr v[164:165], v81, 12544
 HU10
 m16 a[212:215], v[136:139], v[216:219], a[212:215]
 HU11
 s_add_u32 s59, s59, 393216
 s_sub_u32 s46, s59, 7864320
 s_cmp_ge_u32 s59, 7864320
 s_cselect_b32 s59, s46, s59
 s_mov_b32 m0, 122880
 m16 a[220:223], v[136:139], v[220:223], a[220:223]
 rtr v[166:167], v81, 14080
 HY0
 m16 a[32:35], v[140:143], v[200:203], a[32:35]
 rtr v[136:137], v81, 12552
 HY1
 m16 a[40:43], v[140:143], v[204:207], a[40:43]
 rtr v[138:139], v81, 14088
 HY2
 m16 a[128:131], v[140:143], v[208:211], a[128:131]
 HY3
 s_mov_b32 m0, 126976
 m16 a[136:139], v[140:143], v[212:215], a[136:139]
 HY4
 m16 a[224:227], v[140:143], v[216:219], a[224:227]
 HY5
 m16 a[232:235], v[140:143], v[220:223], a[232:235]
 HY6
 m16 a[36:39], v[144:147], v[200:203], a[36:39]
 HY7
 s_mov_b32 m0, 131072
 m16 a[44:47], v[144:147], v[204:207], a[44:47]
 HY8
 m16 a[132:135], v[144:147], v[208:211], a[132:135]
 HY9
 m16 a[140:143], v[144:147], v[212:215], a[140:143]
 HY10
 m16 a[228:231], v[144:147], v[216:219], a[228:231]
 HY11
 s_add_u32 s86, s86, 128
 s_sub_u32 s46, s86, 1280
 s_cmp_ge_u32 s86, s57
 s_cselect_b32 s86, s46, s86
 s_mov_b32 m0, 49152
 m16 a[236:239], v[144:147], v[220:223], a[236:239]
 HK0
 m16 a[48:51], v[148:151], v[200:203], a[48:51]
 HK1
 m16 a[56:59], v[148:151], v[204:207], a[56:59]
 HK2
 m16 a[144:147], v[148:151], v[208:211], a[144:147]
 HK3
 s_mov_b32 m0, 53248
 m16 a[152:155], v[148:151], v[212:215], a[152:155]
 HK4
 m16 a[240:243], v[148:151], v[216:219], a[240:243]
 HK5
 m16 a[248:251], v[148:151], v[220:223], a[248:251]
 HK6
 s_waitcnt lgkmcnt(4)
 m16 a[52:55], v[152:155], v[200:203], a[52:55]
 HK7
 s_mov_b32 m0, 57344
 m16 a[60:63], v[152:155], v[204:207], a[60:63]
 HK8
 m16 a[148:151], v[152:155], v[208:211], a[148:151]
 HK9
 m16 a[156:159], v[152:155], v[212:215], a[156:159]
 HK10
 m16 a[244:247], v[152:155], v[216:219], a[244:247]
 HK11
 s_add_u32 s52, s52, 24576
 s_mov_b32 m0, 73728
 m16 a[252:255], v[152:155], v[220:223], a[252:255]
 HK0
 m16 a[64:67], v[156:159], v[200:203], a[64:67]
 HK1
 m16 a[72:75], v[156:159], v[204:207], a[72:75]
 HK2
 m16 a[160:163], v[156:159], v[208:211], a[160:163]
 HK3
 s_mov_b32 m0, 77824
 m16 a[168:171], v[156:159], v[212:215], a[168:171]
 HK4
 m16 v[168:171], v[156:159], v[216:219], v[168:171]
 HK5
 m16 v[176:179], v[156:159], v[220:223], v[176:179]
 HK6
 m16 a[68:71], v[160:163], v[200:203], a[68:71]
 HK7
 s_mov_b32 m0, 81920
 m16 a[76:79], v[160:163], v[204:207], a[76:79]
 HK8
 m16 a[164:167], v[160:163], v[208:211], a[164:167]
 HK9
 m16 a[172:175], v[160:163], v[212:215], a[172:175]
 HK10
 m16 v[172:175], v[160:163], v[216:219], v[172:175]
 HK11
 s_add_u32 s52, s52, 12288
 m16 v[180:183], v[160:163], v[220:223], v[180:183]
 s_waitcnt lgkmcnt(2)
 m16 a[80:83], v[164:167], v[200:203], a[80:83]
 m16 a[88:91], v[164:167], v[204:207], a[88:91]
 m16 a[176:179], v[164:167], v[208:211], a[176:179]
 m16 a[184:187], v[164:167], v[212:215], a[184:187]
 m16 v[184:187], v[164:167], v[216:219], v[184:187]
 m16 v[192:195], v[164:167], v[220:223], v[192:195]
 s_waitcnt lgkmcnt(0)
 m16 a[84:87], v[136:139], v[200:203], a[84:87]
 m16 a[92:95], v[136:139], v[204:207], a[92:95]
 m16 a[180:183], v[136:139], v[208:211], a[180:183]
 m16 a[188:191], v[136:139], v[212:215], a[188:191]
 m16 v[188:191], v[136:139], v[216:219], v[188:191]
 m16 v[196:199], v[136:139], v[220:223], v[196:199]
 s_waitcnt vmcnt(36)
 s_barrier
 rtr v[136:137], v80, 24576
 rtr v[138:139], v80, 26112
 rtr v[140:141], v80, 24584
 rtr v[142:143], v80, 26120
 rtr v[144:145], v81, 24576
 rtr v[146:147], v81, 26112
 s_waitcnt lgkmcnt(4)
 m16 a[0:3], v[136:139], v[224:227], a[0:3]
 m16 a[8:11], v[136:139], v[228:231], a[8:11]
 m16 a[96:99], v[136:139], v[232:235], a[96:99]
 m16 a[104:107], v[136:139], v[236:239], a[104:107]
 m16 a[192:195], v[136:139], v[240:243], a[192:195]
 m16 a[200:203], v[136:139], v[244:247], a[200:203]
 s_waitcnt lgkmcnt(2)
 m16 a[4:7], v[140:143], v[224:227], a[4:7]
 m16 a[12:15], v[140:143], v[228:231], a[12:15]
 m16 a[100:103], v[140:143], v[232:235], a[100:103]
 m16 a[108:111], v[140:143], v[236:239], a[108:111]
 m16 a[196:199], v[140:143], v[240:243], a[196:199]
 m16 a[204:207], v[140:143], v[244:247], a[204:207]
 s_waitcnt lgkmcnt(0)
 m16 a[16:19], v[144:147], v[224:227], a[16:19]
 m16 a[24:27], v[144:147], v[228:231], a[24:27]
 m16 a[112:115], v[144:147], v[232:235], a[112:115]
 m16 a[120:123], v[144:147], v[236:239], a[120:123]
 m16 a[208:211], v[144:147], v[240:243], a[208:211]
 m16 a[216:219], v[144:147], v[244:247], a[216:219]
 s_barrier
 rtr v[136:137], v81, 24584
 rtr v[138:139], v81, 26120
 rtr v[140:141], v80, 24704
 rtr v[142:143], v80, 26240
 rtr v[144:145], v80, 24712
 rtr v[146:147], v80, 26248
 s_mov_b32 m0, 24576
 s_nop 0
 HWO0
 HWO1
 HWO2
 HWO3
 s_mov_b32 m0, 28672
 s_nop 0
 HWO4
 HWO5
 HWO6
 s_waitcnt lgkmcnt(4)
 m16 a[20:23], v[136:139], v[224:227], a[20:23]
 HWO7
 s_mov_b32 m0, 32768
 m16 a[28:31], v[136:139], v[228:231], a[28:31]
 HWO8
 m16 a[116:119], v[136:139], v[232:235], a[116:119]
 HWO9
 m16 a[124:127], v[136:139], v[236:239], a[124:127]
 HWO10
 m16 a[212:215], v[136:139], v[240:243], a[212:215]
 HWO11
 s_add_u32 s56, s56, 122880
 s_mov_b32 m0, 0
 m16 a[220:223], v[136:139], v[244:247], a[220:223]
 HWO0
 s_waitcnt lgkmcnt(2)
 m16 a[32:35], v[140:143], v[224:227], a[32:35]
 HWO1
 m16 a[40:43], v[140:143], v[228:231], a[40:43]
 HWO2
 m16 a[128:131], v[140:143], v[232:235], a[128:131]
 HWO3
 s_mov_b32 m0, 4096
 m16 a[136:139], v[140:143], v[236:239], a[136:139]
 HWO4
 m16 a[224:227], v[140:143], v[240:243], a[224:227]
 HWO5
 m16 a[232:235], v[140:143], v[244:247], a[232:235]
 HWO6
 s_waitcnt lgkmcnt(0)
 m16 a[36:39], v[144:147], v[224:227], a[36:39]
 HWO7
 s_mov_b32 m0, 8192
 m16 a[44:47], v[144:147], v[228:231], a[44:47]
 HWO8
 m16 a[132:135], v[144:147], v[232:235], a[132:135]
 HWO9
 m16 a[140:143], v[144:147], v[236:239], a[140:143]
 HWO10
 m16 a[228:231], v[144:147], v[240:243], a[228:231]
 HWO11
 s_add_u32 s56, s56, -122752
 s_mov_b32 m0, 86016
 m16 a[236:239], v[144:147], v[244:247], a[236:239]
 HV0
 HV1
 HV2
 HV3
 s_mov_b32 m0, 90112
 s_nop 0
 HV4
 HV5
 HV6
 HV7
 s_mov_b32 m0, 94208
 s_nop 0
 HV8
 HV9
 HV10
 HV11
 s_add_u32 s53, s53, 12288
 s_mov_b32 m0, 98304
 s_nop 0
 HV0
 HV1
 HV2
 HV3
 s_mov_b32 m0, 102400
 s_nop 0
 HV4
 HV5
 HV6
 HV7
 s_mov_b32 m0, 106496
 s_nop 0
 HV8
 HV9
 HV10
 HV11
 s_add_u32 s53, s53, 12288
 s_barrier
 rtr v[136:137], v81, 24704
 rtr v[138:139], v81, 26240
 rtr v[140:141], v81, 24712
 rtr v[142:143], v81, 26248
 rtr v[144:145], v80, 24832
 rtr v[146:147], v80, 26368
 s_add_u32 s46, s58, 246016
 buffer_load_dword v78, v76, s[24:27], s46 offen
 s_waitcnt lgkmcnt(4)
 m16 a[48:51], v[136:139], v[224:227], a[48:51]
 m16 a[56:59], v[136:139], v[228:231], a[56:59]
 m16 a[144:147], v[136:139], v[232:235], a[144:147]
 m16 a[152:155], v[136:139], v[236:239], a[152:155]
 m16 a[240:243], v[136:139], v[240:243], a[240:243]
 m16 a[248:251], v[136:139], v[244:247], a[248:251]
 s_waitcnt lgkmcnt(2)
 m16 a[52:55], v[140:143], v[224:227], a[52:55]
 m16 a[60:63], v[140:143], v[228:231], a[60:63]
 m16 a[148:151], v[140:143], v[232:235], a[148:151]
 m16 a[156:159], v[140:143], v[236:239], a[156:159]
 m16 a[244:247], v[140:143], v[240:243], a[244:247]
 m16 a[252:255], v[140:143], v[244:247], a[252:255]
 s_waitcnt lgkmcnt(0)
 m16 a[64:67], v[144:147], v[224:227], a[64:67]
 m16 a[72:75], v[144:147], v[228:231], a[72:75]
 m16 a[160:163], v[144:147], v[232:235], a[160:163]
 m16 a[168:171], v[144:147], v[236:239], a[168:171]
 m16 v[168:171], v[144:147], v[240:243], v[168:171]
 m16 v[176:179], v[144:147], v[244:247], v[176:179]
 s_waitcnt vmcnt(60)
 s_barrier
 rtr v[136:137], v80, 24840
 rtr v[138:139], v80, 26376
 rtr v[140:141], v81, 24832
 rtr v[142:143], v81, 26368
 rtr v[144:145], v81, 24840
 rtr v[146:147], v81, 26376
 s_mov_b32 m0, 135168
 s_nop 0
 HU0
 HU1
 HU2
 HU3
 s_mov_b32 m0, 139264
 s_nop 0
 HU4
 HU5
 HU6
 s_waitcnt lgkmcnt(4)
 m16 a[68:71], v[136:139], v[224:227], a[68:71]
 HU7
 s_mov_b32 m0, 143360
 m16 a[76:79], v[136:139], v[228:231], a[76:79]
 HU8
 m16 a[164:167], v[136:139], v[232:235], a[164:167]
 HU9
 m16 a[172:175], v[136:139], v[236:239], a[172:175]
 HU10
 m16 v[172:175], v[136:139], v[240:243], v[172:175]
 HU11
 s_add_u32 s59, s59, 393216
 s_sub_u32 s46, s59, 7864320
 s_cmp_ge_u32 s59, 7864320
 s_cselect_b32 s59, s46, s59
 m16 v[180:183], v[136:139], v[244:247], v[180:183]
 s_waitcnt lgkmcnt(2)
 m16 a[80:83], v[140:143], v[224:227], a[80:83]
 m16 a[88:91], v[140:143], v[228:231], a[88:91]
 m16 a[176:179], v[140:143], v[232:235], a[176:179]
 m16 a[184:187], v[140:143], v[236:239], a[184:187]
 m16 v[184:187], v[140:143], v[240:243], v[184:187]
 m16 v[192:195], v[140:143], v[244:247], v[192:195]
 s_waitcnt lgkmcnt(0)
 m16 a[84:87], v[144:147], v[224:227], a[84:87]
 m16 a[92:95], v[144:147], v[228:231], a[92:95]
 m16 a[180:183], v[144:147], v[232:235], a[180:183]
 m16 a[188:191], v[144:147], v[236:239], a[188:191]
 m16 v[188:191], v[144:147], v[240:243], v[188:191]
 m16 v[196:199], v[144:147], v[244:247], v[196:199]
 s_waitcnt vmcnt(37)
 s_barrier
 TU 147456, 393216
 TWO 12288, 122880
 TWO 36864, -122752
 s_waitcnt vmcnt(36)
 s_barrier
 rtr v[136:137], v80, 12288
 rtr v[138:139], v80, 13824
 ds_read_b128 v[88:91], v84
 ds_read_b128 v[92:95], v84 offset:2048
 ds_read_b128 v[96:99], v84 offset:4096
 ds_read_b128 v[100:103], v84 offset:6144
 ds_read_b128 v[104:107], v84 offset:8192
 ds_read_b128 v[108:111], v84 offset:10240
 rtr v[140:141], v80, 12296
 rtr v[142:143], v80, 13832
 rtr v[144:145], v81, 12288
 rtr v[146:147], v81, 13824
 s_mov_b32 m0, 49152
 s_nop 0
 HK0
 HK1
 HK2
 HK3
 s_mov_b32 m0, 53248
 s_nop 0
 HK4
 HK5
 HK6
 s_waitcnt lgkmcnt(4)
 m16 a[0:3], v[136:139], v[88:91], a[0:3]
 HK7
 s_mov_b32 m0, 57344
 m16 a[8:11], v[136:139], v[92:95], a[8:11]
 ds_read_b128 v[112:115], v85
 HK8
 m16 a[96:99], v[136:139], v[96:99], a[96:99]
 ds_read_b128 v[116:119], v85 offset:2048
 HK9
 m16 a[104:107], v[136:139], v[100:103], a[104:107]
 ds_read_b128 v[120:123], v85 offset:4096
 HK10
 m16 a[192:195], v[136:139], v[104:107], a[192:195]
 HK11
 s_add_u32 s52, s52, 12288
 s_mov_b32 m0, 110592
 m16 a[200:203], v[136:139], v[108:111], a[200:203]
 ds_read_b128 v[124:127], v85 offset:6144
 HV0
 s_waitcnt lgkmcnt(4)
 m16 a[4:7], v[140:143], v[88:91], a[4:7]
 ds_read_b128 v[128:131], v85 offset:8192
 HV1
 m16 a[12:15], v[140:143], v[92:95], a[12:15]
 ds_read_b128 v[132:135], v85 offset:10240
 HV2
 m16 a[100:103], v[140:143], v[96:99], a[100:103]
 HV3
 s_mov_b32 m0, 114688
 m16 a[108:111], v[140:143], v[100:103], a[108:111]
 rtr v[148:149], v81, 12296
 HV4
 m16 a[196:199], v[140:143], v[104:107], a[196:199]
 rtr v[150:151], v81, 13832
 HV5
 m16 a[204:207], v[140:143], v[108:111], a[204:207]
 rtr v[152:153], v80, 12416
 HV6
 m16 a[16:19], v[144:147], v[88:91], a[16:19]
 HV7
 s_mov_b32 m0, 118784
 m16 a[24:27], v[144:147], v[92:95], a[24:27]
 rtr v[154:155], v80, 13952
 HV8
 m16 a[112:115], v[144:147], v[96:99], a[112:115]
 rtr v[156:157], v80, 12424
 HV9
 m16 a[120:123], v[144:147], v[100:103], a[120:123]
 HV10
 m16 a[208:211], v[144:147], v[104:107], a[208:211]
 HV11
 s_add_u32 s53, s53, 12288
 s_waitcnt lgkmcnt(4)
 m16 a[216:219], v[144:147], v[108:111], a[216:219]
 s_waitcnt lgkmcnt(3)
 m16 a[20:23], v[148:151], v[88:91], a[20:23]
 rtr v[158:159], v80, 13960
 m16 a[28:31], v[148:151], v[92:95], a[28:31]
 m16 a[116:119], v[148:151], v[96:99], a[116:119]
 rtr v[160:161], v81, 12416
 m16 a[124:127], v[148:151], v[100:103], a[124:127]
 m16 a[212:215], v[148:151], v[104:107], a[212:215]
 rtr v[162:163], v81, 13952
 m16 a[220:223], v[148:151], v[108:111], a[220:223]
 s_waitcnt lgkmcnt(4)
 m16 a[32:35], v[152:155], v[88:91], a[32:35]
 rtr v[164:165], v81, 12424
 m16 a[40:43], v[152:155], v[92:95], a[40:43]
 m16 a[128:131], v[152:155], v[96:99], a[128:131]
 rtr v[166:167], v81, 13960
 m16 a[136:139], v[152:155], v[100:103], a[136:139]
 m16 a[224:227], v[152:155], v[104:107], a[224:227]
 rtr v[136:137], v80, 12544
 m16 a[232:235], v[152:155], v[108:111], a[232:235]
 s_waitcnt lgkmcnt(4)
 m16 a[36:39], v[156:159], v[88:91], a[36:39]
 rtr v[138:139], v80, 14080
 m16 a[44:47], v[156:159], v[92:95], a[44:47]
 m16 a[132:135], v[156:159], v[96:99], a[132:135]
 rtr v[140:141], v80, 12552
 m16 a[140:143], v[156:159], v[100:103], a[140:143]
 m16 a[228:231], v[156:159], v[104:107], a[228:231]
 rtr v[142:143], v80, 14088
 m16 a[236:239], v[156:159], v[108:111], a[236:239]
 s_waitcnt lgkmcnt(4)
 m16 a[48:51], v[160:163], v[88:91], a[48:51]
 rtr v[144:145], v81, 12544
 m16 a[56:59], v[160:163], v[92:95], a[56:59]
 m16 a[144:147], v[160:163], v[96:99], a[144:147]
 rtr v[146:147], v81, 14080
 m16 a[152:155], v[160:163], v[100:103], a[152:155]
 m16 a[240:243], v[160:163], v[104:107], a[240:243]
 rtr v[148:149], v81, 12552
 m16 a[248:251], v[160:163], v[108:111], a[248:251]
 m16 a[52:55], v[164:167], v[88:91], a[52:55]
 rtr v[150:151], v81, 14088
 m16 a[60:63], v[164:167], v[92:95], a[60:63]
 m16 a[148:151], v[164:167], v[96:99], a[148:151]
 m16 a[156:159], v[164:167], v[100:103], a[156:159]
 m16 a[244:247], v[164:167], v[104:107], a[244:247]
 m16 a[252:255], v[164:167], v[108:111], a[252:255]
 s_waitcnt lgkmcnt(4)
 m16 a[64:67], v[136:139], v[88:91], a[64:67]
 m16 a[72:75], v[136:139], v[92:95], a[72:75]
 m16 a[160:163], v[136:139], v[96:99], a[160:163]
 m16 a[168:171], v[136:139], v[100:103], a[168:171]
 m16 v[168:171], v[136:139], v[104:107], v[168:171]
 m16 v[176:179], v[136:139], v[108:111], v[176:179]
 m16 a[68:71], v[140:143], v[88:91], a[68:71]
 m16 a[76:79], v[140:143], v[92:95], a[76:79]
 m16 a[164:167], v[140:143], v[96:99], a[164:167]
 m16 a[172:175], v[140:143], v[100:103], a[172:175]
 m16 v[172:175], v[140:143], v[104:107], v[172:175]
 m16 v[180:183], v[140:143], v[108:111], v[180:183]
 s_waitcnt lgkmcnt(2)
 m16 a[80:83], v[144:147], v[88:91], a[80:83]
 m16 a[88:91], v[144:147], v[92:95], a[88:91]
 m16 a[176:179], v[144:147], v[96:99], a[176:179]
 m16 a[184:187], v[144:147], v[100:103], a[184:187]
 m16 v[184:187], v[144:147], v[104:107], v[184:187]
 m16 v[192:195], v[144:147], v[108:111], v[192:195]
 s_waitcnt lgkmcnt(0)
 m16 a[84:87], v[148:151], v[88:91], a[84:87]
 m16 a[92:95], v[148:151], v[92:95], a[92:95]
 m16 a[180:183], v[148:151], v[96:99], a[180:183]
 m16 a[188:191], v[148:151], v[100:103], a[188:191]
 m16 v[188:191], v[148:151], v[104:107], v[188:191]
 m16 v[196:199], v[148:151], v[108:111], v[196:199]
 s_waitcnt vmcnt(24)
 s_barrier
 rtr v[136:137], v80, 24576
 rtr v[138:139], v80, 26112
 rtr v[140:141], v80, 24584
 rtr v[142:143], v80, 26120
 rtr v[144:145], v81, 24576
 rtr v[146:147], v81, 26112
 rtr v[148:149], v81, 24584
 rtr v[150:151], v81, 26120
 rtr v[152:153], v80, 24704
 rtr v[154:155], v80, 26240
 rtr v[156:157], v80, 24712
 rtr v[158:159], v80, 26248
 s_mov_b32 m0, 135168
 s_nop 0
 HU0
 HU1
 HU2
 HU3
 s_mov_b32 m0, 139264
 s_nop 0
 HU4
 HU5
 HU6
 s_waitcnt lgkmcnt(4)
 m16 a[0:3], v[136:139], v[112:115], a[0:3]
 HU7
 s_mov_b32 m0, 143360
 m16 a[8:11], v[136:139], v[116:119], a[8:11]
 rtr v[160:161], v81, 24704
 HU8
 m16 a[96:99], v[136:139], v[120:123], a[96:99]
 rtr v[162:163], v81, 26240
 HU9
 m16 a[104:107], v[136:139], v[124:127], a[104:107]
 rtr v[164:165], v81, 24712
 HU10
 m16 a[192:195], v[136:139], v[128:131], a[192:195]
 HU11
 s_add_u32 s59, s59, 393216
 s_sub_u32 s46, s59, 7864320
 s_cmp_ge_u32 s59, 7864320
 s_cselect_b32 s59, s46, s59
 s_mov_b32 m0, 122880
 m16 a[200:203], v[136:139], v[132:135], a[200:203]
 rtr v[166:167], v81, 26248
 HY0
 m16 a[4:7], v[140:143], v[112:115], a[4:7]
 rtr v[136:137], v80, 24832
 HY1
 m16 a[12:15], v[140:143], v[116:119], a[12:15]
 rtr v[138:139], v80, 26368
 HY2
 m16 a[100:103], v[140:143], v[120:123], a[100:103]
 HY3
 s_mov_b32 m0, 126976
 m16 a[108:111], v[140:143], v[124:127], a[108:111]
 HY4
 m16 a[196:199], v[140:143], v[128:131], a[196:199]
 HY5
 m16 a[204:207], v[140:143], v[132:135], a[204:207]
 rtr v[140:141], v80, 24840
 HY6
 m16 a[16:19], v[144:147], v[112:115], a[16:19]
 HY7
 s_mov_b32 m0, 131072
 m16 a[24:27], v[144:147], v[116:119], a[24:27]
 rtr v[142:143], v80, 26376
 HY8
 m16 a[112:115], v[144:147], v[120:123], a[112:115]
 HY9
 m16 a[120:123], v[144:147], v[124:127], a[120:123]
 HY10
 m16 a[208:211], v[144:147], v[128:131], a[208:211]
 HY11
 s_add_u32 s86, s86, 128
 s_sub_u32 s46, s86, 1280
 s_cmp_ge_u32 s86, s57
 s_cselect_b32 s86, s46, s86
 s_mov_b32 m0, 24576
 m16 a[216:219], v[144:147], v[132:135], a[216:219]
 HWO0
 m16 a[20:23], v[148:151], v[112:115], a[20:23]
 rtr v[144:145], v81, 24832
 HWO1
 m16 a[28:31], v[148:151], v[116:119], a[28:31]
 HWO2
 m16 a[116:119], v[148:151], v[120:123], a[116:119]
 HWO3
 s_mov_b32 m0, 28672
 m16 a[124:127], v[148:151], v[124:127], a[124:127]
 HWO4
 m16 a[212:215], v[148:151], v[128:131], a[212:215]
 rtr v[146:147], v81, 26368
 HWO5
 m16 a[220:223], v[148:151], v[132:135], a[220:223]
 HWO6
 s_waitcnt lgkmcnt(6)
 m16 a[32:35], v[152:155], v[112:115], a[32:35]
 HWO7
 s_mov_b32 m0, 32768
 m16 a[40:43], v[152:155], v[116:119], a[40:43]
 HWO8
 m16 a[128:131], v[152:155], v[120:123], a[128:131]
 rtr v[148:149], v81, 24840
 HWO9
 m16 a[136:139], v[152:155], v[124:127], a[136:139]
 HWO10
 m16 a[224:227], v[152:155], v[128:131], a[224:227]
 HWO11
 s_add_u32 s56, s56, 122880
 s_mov_b32 m0, 0
 m16 a[232:235], v[152:155], v[132:135], a[232:235]
 HWO0
 m16 a[36:39], v[156:159], v[112:115], a[36:39]
 rtr v[150:151], v81, 26376
 HWO1
 m16 a[44:47], v[156:159], v[116:119], a[44:47]
 HWO2
 m16 a[132:135], v[156:159], v[120:123], a[132:135]
 HWO3
 s_mov_b32 m0, 4096
 m16 a[140:143], v[156:159], v[124:127], a[140:143]
 HWO4
 m16 a[228:231], v[156:159], v[128:131], a[228:231]
 HWO5
 m16 a[236:239], v[156:159], v[132:135], a[236:239]
 HWO6
 m16 a[48:51], v[160:163], v[112:115], a[48:51]
 HWO7
 s_mov_b32 m0, 8192
 m16 a[56:59], v[160:163], v[116:119], a[56:59]
 HWO8
 m16 a[144:147], v[160:163], v[120:123], a[144:147]
 HWO9
 m16 a[152:155], v[160:163], v[124:127], a[152:155]
 HWO10
 m16 a[240:243], v[160:163], v[128:131], a[240:243]
 HWO11
 s_add_u32 s56, s56, -122752
 s_mov_b32 m0, 61440
 m16 a[248:251], v[160:163], v[132:135], a[248:251]
 HK0
 m16 a[52:55], v[164:167], v[112:115], a[52:55]
 HK1
 m16 a[60:63], v[164:167], v[116:119], a[60:63]
 HK2
 m16 a[148:151], v[164:167], v[120:123], a[148:151]
 HK3
 s_mov_b32 m0, 65536
 m16 a[156:159], v[164:167], v[124:127], a[156:159]
 HK4
 m16 a[244:247], v[164:167], v[128:131], a[244:247]
 HK5
 m16 a[252:255], v[164:167], v[132:135], a[252:255]
 HK6
 s_waitcnt lgkmcnt(4)
 m16 a[64:67], v[136:139], v[112:115], a[64:67]
 HK7
 s_mov_b32 m0, 69632
 m16 a[72:75], v[136:139], v[116:119], a[72:75]
 HK8
 m16 a[160:163], v[136:139], v[120:123], a[160:163]
 HK9
 m16 a[168:171], v[136:139], v[124:127], a[168:171]
 HK10
 m16 v[168:171], v[136:139], v[128:131], v[168:171]
 HK11
 s_add_u32 s52, s52, 12288
 s_mov_b32 m0, 86016
 m16 v[176:179], v[136:139], v[132:135], v[176:179]
 HV0
 m16 a[68:71], v[140:143], v[112:115], a[68:71]
 HV1
 m16 a[76:79], v[140:143], v[116:119], a[76:79]
 HV2
 m16 a[164:167], v[140:143], v[120:123], a[164:167]
 HV3
 s_mov_b32 m0, 90112
 m16 a[172:175], v[140:143], v[124:127], a[172:175]
 HV4
 m16 v[172:175], v[140:143], v[128:131], v[172:175]
 HV5
 m16 v[180:183], v[140:143], v[132:135], v[180:183]
 HV6
 s_waitcnt lgkmcnt(2)
 m16 a[80:83], v[144:147], v[112:115], a[80:83]
 HV7
 s_mov_b32 m0, 94208
 m16 a[88:91], v[144:147], v[116:119], a[88:91]
 HV8
 m16 a[176:179], v[144:147], v[120:123], a[176:179]
 HV9
 m16 a[184:187], v[144:147], v[124:127], a[184:187]
 HV10
 m16 v[184:187], v[144:147], v[128:131], v[184:187]
 HV11
 s_add_u32 s53, s53, 12288
 m16 v[192:195], v[144:147], v[132:135], v[192:195]
 s_add_u32 s46, s4, 4719744
 buffer_load_dword v78, v77, s[16:19], s46 offen
 s_waitcnt lgkmcnt(0)
 m16 a[84:87], v[148:151], v[112:115], a[84:87]
 m16 a[92:95], v[148:151], v[116:119], a[92:95]
 m16 a[180:183], v[148:151], v[120:123], a[180:183]
 m16 a[188:191], v[148:151], v[124:127], a[188:191]
 m16 v[188:191], v[148:151], v[128:131], v[188:191]
 m16 v[196:199], v[148:151], v[132:135], v[196:199]
 s_waitcnt vmcnt(49)
 s_barrier
 rtr v[136:137], v80, 12288
 rtr v[138:139], v80, 13824
 ds_read_b128 v[200:203], v84
 ds_read_b128 v[204:207], v84 offset:2048
 ds_read_b128 v[208:211], v84 offset:4096
 ds_read_b128 v[212:215], v84 offset:6144
 ds_read_b128 v[216:219], v84 offset:8192
 ds_read_b128 v[220:223], v84 offset:10240
 rtr v[140:141], v80, 12296
 rtr v[142:143], v80, 13832
 rtr v[144:145], v81, 12288
 rtr v[146:147], v81, 13824
 s_mov_b32 m0, 147456
 s_nop 0
 HU0
 HU1
 HU2
 HU3
 s_mov_b32 m0, 151552
 s_nop 0
 HU4
 HU5
 HU6
 s_waitcnt lgkmcnt(4)
 m16 a[0:3], v[136:139], v[200:203], a[0:3]
 HU7
 s_mov_b32 m0, 155648
 m16 a[8:11], v[136:139], v[204:207], a[8:11]
 ds_read_b128 v[224:227], v85
 HU8
 m16 a[96:99], v[136:139], v[208:211], a[96:99]
 ds_read_b128 v[228:231], v85 offset:2048
 HU9
 m16 a[104:107], v[136:139], v[212:215], a[104:107]
 ds_read_b128 v[232:235], v85 offset:4096
 HU10
 m16 a[192:195], v[136:139], v[216:219], a[192:195]
 HU11
 s_add_u32 s59, s59, 393216
 s_sub_u32 s46, s59, 7864320
 s_cmp_ge_u32 s59, 7864320
 s_cselect_b32 s59, s46, s59
 s_mov_b32 m0, 73728
 m16 a[200:203], v[136:139], v[220:223], a[200:203]
 ds_read_b128 v[236:239], v85 offset:6144
 HK0
 s_waitcnt lgkmcnt(4)
 m16 a[4:7], v[140:143], v[200:203], a[4:7]
 ds_read_b128 v[240:243], v85 offset:8192
 HK1
 m16 a[12:15], v[140:143], v[204:207], a[12:15]
 ds_read_b128 v[244:247], v85 offset:10240
 HK2
 m16 a[100:103], v[140:143], v[208:211], a[100:103]
 HK3
 s_mov_b32 m0, 77824
 m16 a[108:111], v[140:143], v[212:215], a[108:111]
 rtr v[148:149], v81, 12296
 HK4
 m16 a[196:199], v[140:143], v[216:219], a[196:199]
 rtr v[150:151], v81, 13832
 HK5
 m16 a[204:207], v[140:143], v[220:223], a[204:207]
 rtr v[152:153], v80, 12416
 HK6
 m16 a[16:19], v[144:147], v[200:203], a[16:19]
 HK7
 s_mov_b32 m0, 81920
 m16 a[24:27], v[144:147], v[204:207], a[24:27]
 rtr v[154:155], v80, 13952
 HK8
 m16 a[112:115], v[144:147], v[208:211], a[112:115]
 rtr v[156:157], v80, 12424
 HK9
 m16 a[120:123], v[144:147], v[212:215], a[120:123]
 HK10
 m16 a[208:211], v[144:147], v[216:219], a[208:211]
 HK11
 s_add_u32 s52, s52, 12288
 s_mov_b32 m0, 98304
 s_waitcnt lgkmcnt(4)
 m16 a[216:219], v[144:147], v[220:223], a[216:219]
 HV0
 s_waitcnt lgkmcnt(3)
 m16 a[20:23], v[148:151], v[200:203], a[20:23]
 rtr v[158:159], v80, 13960
 HV1
 m16 a[28:31], v[148:151], v[204:207], a[28:31]
 HV2
 m16 a[116:119], v[148:151], v[208:211], a[116:119]
 HV3
 s_mov_b32 m0, 102400
 m16 a[124:127], v[148:151], v[212:215], a[124:127]
 HV4
 m16 a[212:215], v[148:151], v[216:219], a[212:215]
 rtr v[160:161], v81, 12416
 HV5
 m16 a[220:223], v[148:151], v[220:223], a[220:223]
 HV6
 s_waitcnt lgkmcnt(3)
 m16 a[32:35], v[152:155], v[200:203], a[32:35]
 HV7
 s_mov_b32 m0, 106496
 m16 a[40:43], v[152:155], v[204:207], a[40:43]
 HV8
 m16 a[128:131], v[152:155], v[208:211], a[128:131]
 rtr v[162:163], v81, 13952
 HV9
 m16 a[136:139], v[152:155], v[212:215], a[136:139]
 HV10
 m16 a[224:227], v[152:155], v[216:219], a[224:227]
 HV11
 s_add_u32 s53, s53, 12288
 m16 a[232:235], v[152:155], v[220:223], a[232:235]
 s_waitcnt lgkmcnt(2)
 m16 a[36:39], v[156:159], v[200:203], a[36:39]
 rtr v[164:165], v81, 12424
 m16 a[44:47], v[156:159], v[204:207], a[44:47]
 m16 a[132:135], v[156:159], v[208:211], a[132:135]
 rtr v[166:167], v81, 13960
 m16 a[140:143], v[156:159], v[212:215], a[140:143]
 m16 a[228:231], v[156:159], v[216:219], a[228:231]
 rtr v[136:137], v80, 12544
 m16 a[236:239], v[156:159], v[220:223], a[236:239]
 s_waitcnt lgkmcnt(3)
 m16 a[48:51], v[160:163], v[200:203], a[48:51]
 rtr v[138:139], v80, 14080
 m16 a[56:59], v[160:163], v[204:207], a[56:59]
 m16 a[144:147], v[160:163], v[208:211], a[144:147]
 rtr v[140:141], v80, 12552
 m16 a[152:155], v[160:163], v[212:215], a[152:155]
 m16 a[240:243], v[160:163], v[216:219], a[240:243]
 rtr v[142:143], v80, 14088
 m16 a[248:251], v[160:163], v[220:223], a[248:251]
 s_waitcnt lgkmcnt(4)
 m16 a[52:55], v[164:167], v[200:203], a[52:55]
 rtr v[144:145], v81, 12544
 m16 a[60:63], v[164:167], v[204:207], a[60:63]
 m16 a[148:151], v[164:167], v[208:211], a[148:151]
 rtr v[146:147], v81, 14080
 m16 a[156:159], v[164:167], v[212:215], a[156:159]
 m16 a[244:247], v[164:167], v[216:219], a[244:247]
 rtr v[148:149], v81, 12552
 m16 a[252:255], v[164:167], v[220:223], a[252:255]
 s_waitcnt lgkmcnt(4)
 m16 a[64:67], v[136:139], v[200:203], a[64:67]
 rtr v[150:151], v81, 14088
 m16 a[72:75], v[136:139], v[204:207], a[72:75]
 m16 a[160:163], v[136:139], v[208:211], a[160:163]
 m16 a[168:171], v[136:139], v[212:215], a[168:171]
 m16 v[168:171], v[136:139], v[216:219], v[168:171]
 m16 v[176:179], v[136:139], v[220:223], v[176:179]
 s_waitcnt lgkmcnt(4)
 m16 a[68:71], v[140:143], v[200:203], a[68:71]
 m16 a[76:79], v[140:143], v[204:207], a[76:79]
 m16 a[164:167], v[140:143], v[208:211], a[164:167]
 m16 a[172:175], v[140:143], v[212:215], a[172:175]
 m16 v[172:175], v[140:143], v[216:219], v[172:175]
 m16 v[180:183], v[140:143], v[220:223], v[180:183]
 s_waitcnt lgkmcnt(2)
 m16 a[80:83], v[144:147], v[200:203], a[80:83]
 m16 a[88:91], v[144:147], v[204:207], a[88:91]
 m16 a[176:179], v[144:147], v[208:211], a[176:179]
 m16 a[184:187], v[144:147], v[212:215], a[184:187]
 m16 v[184:187], v[144:147], v[216:219], v[184:187]
 m16 v[192:195], v[144:147], v[220:223], v[192:195]
 s_waitcnt lgkmcnt(0)
 m16 a[84:87], v[148:151], v[200:203], a[84:87]
 m16 a[92:95], v[148:151], v[204:207], a[92:95]
 m16 a[180:183], v[148:151], v[208:211], a[180:183]
 m16 a[188:191], v[148:151], v[212:215], a[188:191]
 m16 v[188:191], v[148:151], v[216:219], v[188:191]
 m16 v[196:199], v[148:151], v[220:223], v[196:199]
 s_waitcnt vmcnt(24)
 s_barrier
CPS72:
 rtr v[136:137], v80, 24576
 rtr v[138:139], v80, 26112
 rtr v[140:141], v80, 24584
 rtr v[142:143], v80, 26120
 rtr v[144:145], v81, 24576
 rtr v[146:147], v81, 26112
 rtr v[148:149], v81, 24584
 rtr v[150:151], v81, 26120
 rtr v[152:153], v80, 24704
 rtr v[154:155], v80, 26240
 rtr v[156:157], v80, 24712
 rtr v[158:159], v80, 26248
 s_mov_b32 m0, 135168
 s_nop 0
 HU0
 HU1
 HU2
 HU3
 s_mov_b32 m0, 139264
 s_nop 0
 HU4
 HU5
 HU6
 s_waitcnt lgkmcnt(4)
 m16 a[0:3], v[136:139], v[224:227], a[0:3]
 HU7
 s_mov_b32 m0, 143360
 m16 a[8:11], v[136:139], v[228:231], a[8:11]
 rtr v[160:161], v81, 24704
 HU8
 m16 a[96:99], v[136:139], v[232:235], a[96:99]
 rtr v[162:163], v81, 26240
 HU9
 m16 a[104:107], v[136:139], v[236:239], a[104:107]
 rtr v[164:165], v81, 24712
 HU10
 m16 a[192:195], v[136:139], v[240:243], a[192:195]
 HU11
 s_add_u32 s59, s59, 393216
 s_sub_u32 s46, s59, 7864320
 s_cmp_ge_u32 s59, 7864320
 s_cselect_b32 s59, s46, s59
 s_mov_b32 m0, 122880
 m16 a[200:203], v[136:139], v[244:247], a[200:203]
 rtr v[166:167], v81, 26248
 HY0
 m16 a[4:7], v[140:143], v[224:227], a[4:7]
 rtr v[136:137], v80, 24832
 HY1
 m16 a[12:15], v[140:143], v[228:231], a[12:15]
 rtr v[138:139], v80, 26368
 HY2
 m16 a[100:103], v[140:143], v[232:235], a[100:103]
 HY3
 s_mov_b32 m0, 126976
 m16 a[108:111], v[140:143], v[236:239], a[108:111]
 HY4
 m16 a[196:199], v[140:143], v[240:243], a[196:199]
 HY5
 m16 a[204:207], v[140:143], v[244:247], a[204:207]
 rtr v[140:141], v80, 24840
 HY6
 m16 a[16:19], v[144:147], v[224:227], a[16:19]
 HY7
 s_mov_b32 m0, 131072
 m16 a[24:27], v[144:147], v[228:231], a[24:27]
 rtr v[142:143], v80, 26376
 HY8
 m16 a[112:115], v[144:147], v[232:235], a[112:115]
 HY9
 m16 a[120:123], v[144:147], v[236:239], a[120:123]
 HY10
 m16 a[208:211], v[144:147], v[240:243], a[208:211]
 HY11
 s_add_u32 s86, s86, 128
 s_sub_u32 s46, s86, 1280
 s_cmp_ge_u32 s86, s57
 s_cselect_b32 s86, s46, s86
 s_mov_b32 m0, 12288
 m16 a[216:219], v[144:147], v[244:247], a[216:219]
 HWO0
 m16 a[20:23], v[148:151], v[224:227], a[20:23]
 rtr v[144:145], v81, 24832
 HWO1
 m16 a[28:31], v[148:151], v[228:231], a[28:31]
 HWO2
 m16 a[116:119], v[148:151], v[232:235], a[116:119]
 HWO3
 s_mov_b32 m0, 16384
 m16 a[124:127], v[148:151], v[236:239], a[124:127]
 HWO4
 m16 a[212:215], v[148:151], v[240:243], a[212:215]
 rtr v[146:147], v81, 26368
 HWO5
 m16 a[220:223], v[148:151], v[244:247], a[220:223]
 HWO6
 s_waitcnt lgkmcnt(6)
 m16 a[32:35], v[152:155], v[224:227], a[32:35]
 HWO7
 s_mov_b32 m0, 20480
 m16 a[40:43], v[152:155], v[228:231], a[40:43]
 HWO8
 m16 a[128:131], v[152:155], v[232:235], a[128:131]
 rtr v[148:149], v81, 24840
 HWO9
 m16 a[136:139], v[152:155], v[236:239], a[136:139]
 HWO10
 m16 a[224:227], v[152:155], v[240:243], a[224:227]
 HWO11
 s_add_u32 s56, s56, 122880
 s_mov_b32 m0, 36864
 m16 a[232:235], v[152:155], v[244:247], a[232:235]
 HWO0
 m16 a[36:39], v[156:159], v[224:227], a[36:39]
 rtr v[150:151], v81, 26376
 HWO1
 m16 a[44:47], v[156:159], v[228:231], a[44:47]
 HWO2
 m16 a[132:135], v[156:159], v[232:235], a[132:135]
 HWO3
 s_mov_b32 m0, 40960
 m16 a[140:143], v[156:159], v[236:239], a[140:143]
 HWO4
 m16 a[228:231], v[156:159], v[240:243], a[228:231]
 HWO5
 m16 a[236:239], v[156:159], v[244:247], a[236:239]
 HWO6
 m16 a[48:51], v[160:163], v[224:227], a[48:51]
 HWO7
 s_mov_b32 m0, 45056
 m16 a[56:59], v[160:163], v[228:231], a[56:59]
 HWO8
 m16 a[144:147], v[160:163], v[232:235], a[144:147]
 HWO9
 m16 a[152:155], v[160:163], v[236:239], a[152:155]
 HWO10
 m16 a[240:243], v[160:163], v[240:243], a[240:243]
 HWO11
 s_add_u32 s56, s56, -122752
 s_mov_b32 m0, 49152
 m16 a[248:251], v[160:163], v[244:247], a[248:251]
 HK0
 m16 a[52:55], v[164:167], v[224:227], a[52:55]
 HK1
 m16 a[60:63], v[164:167], v[228:231], a[60:63]
 HK2
 m16 a[148:151], v[164:167], v[232:235], a[148:151]
 HK3
 s_mov_b32 m0, 53248
 m16 a[156:159], v[164:167], v[236:239], a[156:159]
 HK4
 m16 a[244:247], v[164:167], v[240:243], a[244:247]
 HK5
 m16 a[252:255], v[164:167], v[244:247], a[252:255]
 HK6
 s_waitcnt lgkmcnt(4)
 m16 a[64:67], v[136:139], v[224:227], a[64:67]
 HK7
 s_mov_b32 m0, 57344
 m16 a[72:75], v[136:139], v[228:231], a[72:75]
 HK8
 m16 a[160:163], v[136:139], v[232:235], a[160:163]
 HK9
 m16 a[168:171], v[136:139], v[236:239], a[168:171]
 HK10
 m16 v[168:171], v[136:139], v[240:243], v[168:171]
 HK11
 s_add_u32 s52, s52, 12288
 s_mov_b32 m0, 110592
 m16 v[176:179], v[136:139], v[244:247], v[176:179]
 HV0
 m16 a[68:71], v[140:143], v[224:227], a[68:71]
 HV1
 m16 a[76:79], v[140:143], v[228:231], a[76:79]
 HV2
 m16 a[164:167], v[140:143], v[232:235], a[164:167]
 HV3
 s_mov_b32 m0, 114688
 m16 a[172:175], v[140:143], v[236:239], a[172:175]
 HV4
 m16 v[172:175], v[140:143], v[240:243], v[172:175]
 HV5
 m16 v[180:183], v[140:143], v[244:247], v[180:183]
 HV6
 s_waitcnt lgkmcnt(2)
 m16 a[80:83], v[144:147], v[224:227], a[80:83]
 HV7
 s_mov_b32 m0, 118784
 m16 a[88:91], v[144:147], v[228:231], a[88:91]
 HV8
 m16 a[176:179], v[144:147], v[232:235], a[176:179]
 HV9
 m16 a[184:187], v[144:147], v[236:239], a[184:187]
 HV10
 m16 v[184:187], v[144:147], v[240:243], v[184:187]
 HV11
 s_add_u32 s53, s53, 12288
 m16 v[192:195], v[144:147], v[244:247], v[192:195]
 s_add_u32 s46, s58, 246272
 buffer_load_dword v78, v76, s[24:27], s46 offen
 s_waitcnt lgkmcnt(0)
 m16 a[84:87], v[148:151], v[224:227], a[84:87]
 v_add_co_u32 v10, vcc, CPS72+4096-LOADER, v8
 s_nop 1
 v_addc_co_u32 v11, vcc, 0, v9, vcc
 global_load_dword v78, v[10:11], off
 m16 a[92:95], v[148:151], v[228:231], a[92:95]
 m16 a[180:183], v[148:151], v[232:235], a[180:183]
 m16 a[188:191], v[148:151], v[236:239], a[188:191]
 m16 v[188:191], v[148:151], v[240:243], v[188:191]
 m16 v[196:199], v[148:151], v[244:247], v[196:199]
 s_waitcnt vmcnt(50)
 s_barrier
 rtr v[136:137], v80, 12288
 rtr v[138:139], v80, 13824
 ds_read_b128 v[88:91], v84
 ds_read_b128 v[92:95], v84 offset:2048
 ds_read_b128 v[96:99], v84 offset:4096
 ds_read_b128 v[100:103], v84 offset:6144
 ds_read_b128 v[104:107], v84 offset:8192
 ds_read_b128 v[108:111], v84 offset:10240
 rtr v[140:141], v80, 12296
 rtr v[142:143], v80, 13832
 rtr v[144:145], v81, 12288
 rtr v[146:147], v81, 13824
 s_mov_b32 m0, 147456
 s_nop 0
 HU0
 HU1
 HU2
 HU3
 s_mov_b32 m0, 151552
 s_nop 0
 HU4
 HU5
 HU6
 s_waitcnt lgkmcnt(4)
 m16 a[0:3], v[136:139], v[88:91], a[0:3]
 HU7
 s_mov_b32 m0, 155648
 m16 a[8:11], v[136:139], v[92:95], a[8:11]
 ds_read_b128 v[112:115], v85
 HU8
 m16 a[96:99], v[136:139], v[96:99], a[96:99]
 ds_read_b128 v[116:119], v85 offset:2048
 HU9
 m16 a[104:107], v[136:139], v[100:103], a[104:107]
 ds_read_b128 v[120:123], v85 offset:4096
 HU10
 m16 a[192:195], v[136:139], v[104:107], a[192:195]
 HU11
 s_add_u32 s59, s59, 393216
 s_sub_u32 s46, s59, 7864320
 s_cmp_ge_u32 s59, 7864320
 s_cselect_b32 s59, s46, s59
 s_mov_b32 m0, 61440
 m16 a[200:203], v[136:139], v[108:111], a[200:203]
 ds_read_b128 v[124:127], v85 offset:6144
 HK0
 s_waitcnt lgkmcnt(4)
 m16 a[4:7], v[140:143], v[88:91], a[4:7]
 ds_read_b128 v[128:131], v85 offset:8192
 HK1
 m16 a[12:15], v[140:143], v[92:95], a[12:15]
 ds_read_b128 v[132:135], v85 offset:10240
 HK2
 m16 a[100:103], v[140:143], v[96:99], a[100:103]
 HK3
 s_mov_b32 m0, 65536
 m16 a[108:111], v[140:143], v[100:103], a[108:111]
 rtr v[148:149], v81, 12296
 HK4
 m16 a[196:199], v[140:143], v[104:107], a[196:199]
 rtr v[150:151], v81, 13832
 HK5
 m16 a[204:207], v[140:143], v[108:111], a[204:207]
 rtr v[152:153], v80, 12416
 HK6
 m16 a[16:19], v[144:147], v[88:91], a[16:19]
 HK7
 s_mov_b32 m0, 69632
 m16 a[24:27], v[144:147], v[92:95], a[24:27]
 rtr v[154:155], v80, 13952
 HK8
 m16 a[112:115], v[144:147], v[96:99], a[112:115]
 rtr v[156:157], v80, 12424
 HK9
 m16 a[120:123], v[144:147], v[100:103], a[120:123]
 HK10
 m16 a[208:211], v[144:147], v[104:107], a[208:211]
 HK11
 s_add_u32 s52, s52, 12288
 s_mov_b32 m0, 86016
 s_waitcnt lgkmcnt(4)
 m16 a[216:219], v[144:147], v[108:111], a[216:219]
 HV0
 s_waitcnt lgkmcnt(3)
 m16 a[20:23], v[148:151], v[88:91], a[20:23]
 rtr v[158:159], v80, 13960
 HV1
 m16 a[28:31], v[148:151], v[92:95], a[28:31]
 HV2
 m16 a[116:119], v[148:151], v[96:99], a[116:119]
 HV3
 s_mov_b32 m0, 90112
 m16 a[124:127], v[148:151], v[100:103], a[124:127]
 HV4
 m16 a[212:215], v[148:151], v[104:107], a[212:215]
 rtr v[160:161], v81, 12416
 HV5
 m16 a[220:223], v[148:151], v[108:111], a[220:223]
 HV6
 s_waitcnt lgkmcnt(3)
 m16 a[32:35], v[152:155], v[88:91], a[32:35]
 HV7
 s_mov_b32 m0, 94208
 m16 a[40:43], v[152:155], v[92:95], a[40:43]
 HV8
 m16 a[128:131], v[152:155], v[96:99], a[128:131]
 rtr v[162:163], v81, 13952
 HV9
 m16 a[136:139], v[152:155], v[100:103], a[136:139]
 HV10
 m16 a[224:227], v[152:155], v[104:107], a[224:227]
 HV11
 s_add_u32 s53, s53, 12288
 m16 a[232:235], v[152:155], v[108:111], a[232:235]
 s_waitcnt lgkmcnt(2)
 m16 a[36:39], v[156:159], v[88:91], a[36:39]
 rtr v[164:165], v81, 12424
 m16 a[44:47], v[156:159], v[92:95], a[44:47]
 m16 a[132:135], v[156:159], v[96:99], a[132:135]
 rtr v[166:167], v81, 13960
 m16 a[140:143], v[156:159], v[100:103], a[140:143]
 m16 a[228:231], v[156:159], v[104:107], a[228:231]
 rtr v[136:137], v80, 12544
 m16 a[236:239], v[156:159], v[108:111], a[236:239]
 s_waitcnt lgkmcnt(3)
 m16 a[48:51], v[160:163], v[88:91], a[48:51]
 rtr v[138:139], v80, 14080
 m16 a[56:59], v[160:163], v[92:95], a[56:59]
 m16 a[144:147], v[160:163], v[96:99], a[144:147]
 rtr v[140:141], v80, 12552
 m16 a[152:155], v[160:163], v[100:103], a[152:155]
 m16 a[240:243], v[160:163], v[104:107], a[240:243]
 rtr v[142:143], v80, 14088
 m16 a[248:251], v[160:163], v[108:111], a[248:251]
 s_waitcnt lgkmcnt(4)
 m16 a[52:55], v[164:167], v[88:91], a[52:55]
 rtr v[144:145], v81, 12544
 m16 a[60:63], v[164:167], v[92:95], a[60:63]
 m16 a[148:151], v[164:167], v[96:99], a[148:151]
 rtr v[146:147], v81, 14080
 m16 a[156:159], v[164:167], v[100:103], a[156:159]
 m16 a[244:247], v[164:167], v[104:107], a[244:247]
 rtr v[148:149], v81, 12552
 m16 a[252:255], v[164:167], v[108:111], a[252:255]
 s_waitcnt lgkmcnt(4)
 m16 a[64:67], v[136:139], v[88:91], a[64:67]
 rtr v[150:151], v81, 14088
 m16 a[72:75], v[136:139], v[92:95], a[72:75]
 m16 a[160:163], v[136:139], v[96:99], a[160:163]
 m16 a[168:171], v[136:139], v[100:103], a[168:171]
 m16 v[168:171], v[136:139], v[104:107], v[168:171]
 m16 v[176:179], v[136:139], v[108:111], v[176:179]
 s_waitcnt lgkmcnt(4)
 m16 a[68:71], v[140:143], v[88:91], a[68:71]
 m16 a[76:79], v[140:143], v[92:95], a[76:79]
 m16 a[164:167], v[140:143], v[96:99], a[164:167]
 m16 a[172:175], v[140:143], v[100:103], a[172:175]
 m16 v[172:175], v[140:143], v[104:107], v[172:175]
 m16 v[180:183], v[140:143], v[108:111], v[180:183]
 s_waitcnt lgkmcnt(2)
 m16 a[80:83], v[144:147], v[88:91], a[80:83]
 m16 a[88:91], v[144:147], v[92:95], a[88:91]
 m16 a[176:179], v[144:147], v[96:99], a[176:179]
 m16 a[184:187], v[144:147], v[100:103], a[184:187]
 m16 v[184:187], v[144:147], v[104:107], v[184:187]
 m16 v[192:195], v[144:147], v[108:111], v[192:195]
 s_waitcnt lgkmcnt(0)
 m16 a[84:87], v[148:151], v[88:91], a[84:87]
 m16 a[92:95], v[148:151], v[92:95], a[92:95]
 m16 a[180:183], v[148:151], v[96:99], a[180:183]
 m16 a[188:191], v[148:151], v[100:103], a[188:191]
 m16 v[188:191], v[148:151], v[104:107], v[188:191]
 m16 v[196:199], v[148:151], v[108:111], v[196:199]
 s_waitcnt vmcnt(24)
 s_barrier
 rtr v[136:137], v80, 24576
 rtr v[138:139], v80, 26112
 rtr v[140:141], v80, 24584
 rtr v[142:143], v80, 26120
 rtr v[144:145], v81, 24576
 rtr v[146:147], v81, 26112
 rtr v[148:149], v81, 24584
 rtr v[150:151], v81, 26120
 rtr v[152:153], v80, 24704
 rtr v[154:155], v80, 26240
 rtr v[156:157], v80, 24712
 rtr v[158:159], v80, 26248
 s_mov_b32 m0, 135168
 s_nop 0
 HU0
 HU1
 HU2
 HU3
 s_mov_b32 m0, 139264
 s_nop 0
 HU4
 HU5
 HU6
 s_waitcnt lgkmcnt(4)
 m16 a[0:3], v[136:139], v[112:115], a[0:3]
 HU7
 s_mov_b32 m0, 143360
 m16 a[8:11], v[136:139], v[116:119], a[8:11]
 rtr v[160:161], v81, 24704
 HU8
 m16 a[96:99], v[136:139], v[120:123], a[96:99]
 rtr v[162:163], v81, 26240
 HU9
 m16 a[104:107], v[136:139], v[124:127], a[104:107]
 rtr v[164:165], v81, 24712
 HU10
 m16 a[192:195], v[136:139], v[128:131], a[192:195]
 HU11
 s_add_u32 s59, s59, 393216
 s_sub_u32 s46, s59, 7864320
 s_cmp_ge_u32 s59, 7864320
 s_cselect_b32 s59, s46, s59
 s_mov_b32 m0, 122880
 m16 a[200:203], v[136:139], v[132:135], a[200:203]
 rtr v[166:167], v81, 26248
 HY0
 m16 a[4:7], v[140:143], v[112:115], a[4:7]
 rtr v[136:137], v80, 24832
 HY1
 m16 a[12:15], v[140:143], v[116:119], a[12:15]
 rtr v[138:139], v80, 26368
 HY2
 m16 a[100:103], v[140:143], v[120:123], a[100:103]
 HY3
 s_mov_b32 m0, 126976
 m16 a[108:111], v[140:143], v[124:127], a[108:111]
 HY4
 m16 a[196:199], v[140:143], v[128:131], a[196:199]
 HY5
 m16 a[204:207], v[140:143], v[132:135], a[204:207]
 rtr v[140:141], v80, 24840
 HY6
 m16 a[16:19], v[144:147], v[112:115], a[16:19]
 HY7
 s_mov_b32 m0, 131072
 m16 a[24:27], v[144:147], v[116:119], a[24:27]
 rtr v[142:143], v80, 26376
 HY8
 m16 a[112:115], v[144:147], v[120:123], a[112:115]
 HY9
 m16 a[120:123], v[144:147], v[124:127], a[120:123]
 HY10
 m16 a[208:211], v[144:147], v[128:131], a[208:211]
 HY11
 s_add_u32 s86, s86, 128
 s_sub_u32 s46, s86, 1280
 s_cmp_ge_u32 s86, s57
 s_cselect_b32 s86, s46, s86
 s_mov_b32 m0, 24576
 m16 a[216:219], v[144:147], v[132:135], a[216:219]
 HWO0
 m16 a[20:23], v[148:151], v[112:115], a[20:23]
 rtr v[144:145], v81, 24832
 HWO1
 m16 a[28:31], v[148:151], v[116:119], a[28:31]
 HWO2
 m16 a[116:119], v[148:151], v[120:123], a[116:119]
 HWO3
 s_mov_b32 m0, 28672
 m16 a[124:127], v[148:151], v[124:127], a[124:127]
 HWO4
 m16 a[212:215], v[148:151], v[128:131], a[212:215]
 rtr v[146:147], v81, 26368
 HWO5
 m16 a[220:223], v[148:151], v[132:135], a[220:223]
 HWO6
 s_waitcnt lgkmcnt(6)
 m16 a[32:35], v[152:155], v[112:115], a[32:35]
 HWO7
 s_mov_b32 m0, 32768
 m16 a[40:43], v[152:155], v[116:119], a[40:43]
 HWO8
 m16 a[128:131], v[152:155], v[120:123], a[128:131]
 rtr v[148:149], v81, 24840
 HWO9
 m16 a[136:139], v[152:155], v[124:127], a[136:139]
 HWO10
 m16 a[224:227], v[152:155], v[128:131], a[224:227]
 HWO11
 s_add_u32 s56, s56, 122880
 s_mov_b32 m0, 0
 m16 a[232:235], v[152:155], v[132:135], a[232:235]
 HWO0
 m16 a[36:39], v[156:159], v[112:115], a[36:39]
 rtr v[150:151], v81, 26376
 HWO1
 m16 a[44:47], v[156:159], v[116:119], a[44:47]
 HWO2
 m16 a[132:135], v[156:159], v[120:123], a[132:135]
 HWO3
 s_mov_b32 m0, 4096
 m16 a[140:143], v[156:159], v[124:127], a[140:143]
 HWO4
 m16 a[228:231], v[156:159], v[128:131], a[228:231]
 HWO5
 m16 a[236:239], v[156:159], v[132:135], a[236:239]
 HWO6
 m16 a[48:51], v[160:163], v[112:115], a[48:51]
 HWO7
 s_mov_b32 m0, 8192
 m16 a[56:59], v[160:163], v[116:119], a[56:59]
 HWO8
 m16 a[144:147], v[160:163], v[120:123], a[144:147]
 HWO9
 m16 a[152:155], v[160:163], v[124:127], a[152:155]
 HWO10
 m16 a[240:243], v[160:163], v[128:131], a[240:243]
 HWO11
 s_add_u32 s56, s56, -122752
 s_mov_b32 m0, 73728
 m16 a[248:251], v[160:163], v[132:135], a[248:251]
 HK0
 m16 a[52:55], v[164:167], v[112:115], a[52:55]
 HK1
 m16 a[60:63], v[164:167], v[116:119], a[60:63]
 HK2
 m16 a[148:151], v[164:167], v[120:123], a[148:151]
 HK3
 s_mov_b32 m0, 77824
 m16 a[156:159], v[164:167], v[124:127], a[156:159]
 HK4
 m16 a[244:247], v[164:167], v[128:131], a[244:247]
 HK5
 m16 a[252:255], v[164:167], v[132:135], a[252:255]
 HK6
 s_waitcnt lgkmcnt(4)
 m16 a[64:67], v[136:139], v[112:115], a[64:67]
 HK7
 s_mov_b32 m0, 81920
 m16 a[72:75], v[136:139], v[116:119], a[72:75]
 HK8
 m16 a[160:163], v[136:139], v[120:123], a[160:163]
 HK9
 m16 a[168:171], v[136:139], v[124:127], a[168:171]
 HK10
 m16 v[168:171], v[136:139], v[128:131], v[168:171]
 HK11
 s_add_u32 s52, s52, 12288
 s_mov_b32 m0, 98304
 m16 v[176:179], v[136:139], v[132:135], v[176:179]
 HV0
 m16 a[68:71], v[140:143], v[112:115], a[68:71]
 HV1
 m16 a[76:79], v[140:143], v[116:119], a[76:79]
 HV2
 m16 a[164:167], v[140:143], v[120:123], a[164:167]
 HV3
 s_mov_b32 m0, 102400
 m16 a[172:175], v[140:143], v[124:127], a[172:175]
 HV4
 m16 v[172:175], v[140:143], v[128:131], v[172:175]
 HV5
 m16 v[180:183], v[140:143], v[132:135], v[180:183]
 HV6
 s_waitcnt lgkmcnt(2)
 m16 a[80:83], v[144:147], v[112:115], a[80:83]
 HV7
 s_mov_b32 m0, 106496
 m16 a[88:91], v[144:147], v[116:119], a[88:91]
 HV8
 m16 a[176:179], v[144:147], v[120:123], a[176:179]
 HV9
 m16 a[184:187], v[144:147], v[124:127], a[184:187]
 HV10
 m16 v[184:187], v[144:147], v[128:131], v[184:187]
 HV11
 s_add_u32 s53, s53, 12288
 m16 v[192:195], v[144:147], v[132:135], v[192:195]
 s_add_u32 s46, s58, 246528
 buffer_load_dword v78, v76, s[24:27], s46 offen
 s_waitcnt lgkmcnt(0)
 m16 a[84:87], v[148:151], v[112:115], a[84:87]
 s_add_u32 s46, s4, 6292608
 buffer_load_dword v78, v77, s[16:19], s46 offen
 m16 a[92:95], v[148:151], v[116:119], a[92:95]
 m16 a[180:183], v[148:151], v[120:123], a[180:183]
 m16 a[188:191], v[148:151], v[124:127], a[188:191]
 m16 v[188:191], v[148:151], v[128:131], v[188:191]
 m16 v[196:199], v[148:151], v[132:135], v[196:199]
 s_waitcnt vmcnt(26)
 s_barrier
 rtr v[136:137], v80, 12288
 rtr v[138:139], v80, 13824
 ds_read_b128 v[200:203], v84
 ds_read_b128 v[204:207], v84 offset:2048
 ds_read_b128 v[208:211], v84 offset:4096
 ds_read_b128 v[212:215], v84 offset:6144
 ds_read_b128 v[216:219], v84 offset:8192
 ds_read_b128 v[220:223], v84 offset:10240
 rtr v[140:141], v80, 12296
 rtr v[142:143], v80, 13832
 rtr v[144:145], v81, 12288
 rtr v[146:147], v81, 13824
 s_mov_b32 m0, 147456
 s_nop 0
 HU0
 HU1
 HU2
 HU3
 s_mov_b32 m0, 151552
 s_nop 0
 HU4
 HU5
 HU6
 s_waitcnt lgkmcnt(4)
 m16 a[0:3], v[136:139], v[200:203], a[0:3]
 HU7
 s_mov_b32 m0, 155648
 m16 a[8:11], v[136:139], v[204:207], a[8:11]
 ds_read_b128 v[224:227], v85
 HU8
 m16 a[96:99], v[136:139], v[208:211], a[96:99]
 ds_read_b128 v[228:231], v85 offset:2048
 HU9
 m16 a[104:107], v[136:139], v[212:215], a[104:107]
 ds_read_b128 v[232:235], v85 offset:4096
 HU10
 m16 a[192:195], v[136:139], v[216:219], a[192:195]
 HU11
 s_add_u32 s59, s59, 393216
 s_sub_u32 s46, s59, 7864320
 s_cmp_ge_u32 s59, 7864320
 s_cselect_b32 s59, s46, s59
 s_mov_b32 m0, 12288
 m16 a[200:203], v[136:139], v[220:223], a[200:203]
 ds_read_b128 v[236:239], v85 offset:6144
 HWO0
 s_waitcnt lgkmcnt(4)
 m16 a[4:7], v[140:143], v[200:203], a[4:7]
 ds_read_b128 v[240:243], v85 offset:8192
 HWO1
 m16 a[12:15], v[140:143], v[204:207], a[12:15]
 ds_read_b128 v[244:247], v85 offset:10240
 HWO2
 m16 a[100:103], v[140:143], v[208:211], a[100:103]
 HWO3
 s_mov_b32 m0, 16384
 m16 a[108:111], v[140:143], v[212:215], a[108:111]
 rtr v[148:149], v81, 12296
 HWO4
 m16 a[196:199], v[140:143], v[216:219], a[196:199]
 rtr v[150:151], v81, 13832
 HWO5
 m16 a[204:207], v[140:143], v[220:223], a[204:207]
 rtr v[152:153], v80, 12416
 HWO6
 m16 a[16:19], v[144:147], v[200:203], a[16:19]
 HWO7
 s_mov_b32 m0, 20480
 m16 a[24:27], v[144:147], v[204:207], a[24:27]
 rtr v[154:155], v80, 13952
 HWO8
 m16 a[112:115], v[144:147], v[208:211], a[112:115]
 rtr v[156:157], v80, 12424
 HWO9
 m16 a[120:123], v[144:147], v[212:215], a[120:123]
 HWO10
 m16 a[208:211], v[144:147], v[216:219], a[208:211]
 HWO11
 s_add_u32 s56, s56, 122880
 s_mov_b32 m0, 36864
 s_waitcnt lgkmcnt(4)
 m16 a[216:219], v[144:147], v[220:223], a[216:219]
 HWO0
 s_waitcnt lgkmcnt(3)
 m16 a[20:23], v[148:151], v[200:203], a[20:23]
 rtr v[158:159], v80, 13960
 HWO1
 m16 a[28:31], v[148:151], v[204:207], a[28:31]
 HWO2
 m16 a[116:119], v[148:151], v[208:211], a[116:119]
 HWO3
 s_mov_b32 m0, 40960
 m16 a[124:127], v[148:151], v[212:215], a[124:127]
 HWO4
 m16 a[212:215], v[148:151], v[216:219], a[212:215]
 rtr v[160:161], v81, 12416
 HWO5
 m16 a[220:223], v[148:151], v[220:223], a[220:223]
 HWO6
 s_waitcnt lgkmcnt(3)
 m16 a[32:35], v[152:155], v[200:203], a[32:35]
 HWO7
 s_mov_b32 m0, 45056
 m16 a[40:43], v[152:155], v[204:207], a[40:43]
 HWO8
 m16 a[128:131], v[152:155], v[208:211], a[128:131]
 rtr v[162:163], v81, 13952
 HWO9
 m16 a[136:139], v[152:155], v[212:215], a[136:139]
 HWO10
 m16 a[224:227], v[152:155], v[216:219], a[224:227]
 HWO11
 s_add_u32 s56, s56, -122752
 s_mov_b32 m0, 49152
 m16 a[232:235], v[152:155], v[220:223], a[232:235]
 HK0
 s_waitcnt lgkmcnt(2)
 m16 a[36:39], v[156:159], v[200:203], a[36:39]
 rtr v[164:165], v81, 12424
 HK1
 m16 a[44:47], v[156:159], v[204:207], a[44:47]
 HK2
 m16 a[132:135], v[156:159], v[208:211], a[132:135]
 HK3
 s_mov_b32 m0, 53248
 m16 a[140:143], v[156:159], v[212:215], a[140:143]
 HK4
 m16 a[228:231], v[156:159], v[216:219], a[228:231]
 rtr v[166:167], v81, 13960
 HK5
 m16 a[236:239], v[156:159], v[220:223], a[236:239]
 HK6
 s_waitcnt lgkmcnt(2)
 m16 a[48:51], v[160:163], v[200:203], a[48:51]
 HK7
 s_mov_b32 m0, 57344
 m16 a[56:59], v[160:163], v[204:207], a[56:59]
 HK8
 m16 a[144:147], v[160:163], v[208:211], a[144:147]
 rtr v[136:137], v80, 12544
 HK9
 m16 a[152:155], v[160:163], v[212:215], a[152:155]
 HK10
 m16 a[240:243], v[160:163], v[216:219], a[240:243]
 HK11
 s_add_u32 s52, s52, 12288
 s_mov_b32 m0, 110592
 m16 a[248:251], v[160:163], v[220:223], a[248:251]
 HV0
 s_waitcnt lgkmcnt(1)
 m16 a[52:55], v[164:167], v[200:203], a[52:55]
 rtr v[138:139], v80, 14080
 HV1
 m16 a[60:63], v[164:167], v[204:207], a[60:63]
 HV2
 m16 a[148:151], v[164:167], v[208:211], a[148:151]
 HV3
 s_mov_b32 m0, 114688
 m16 a[156:159], v[164:167], v[212:215], a[156:159]
 HV4
 m16 a[244:247], v[164:167], v[216:219], a[244:247]
 rtr v[140:141], v80, 12552
 HV5
 m16 a[252:255], v[164:167], v[220:223], a[252:255]
 HV6
 s_waitcnt lgkmcnt(1)
 m16 a[64:67], v[136:139], v[200:203], a[64:67]
 HV7
 s_mov_b32 m0, 118784
 m16 a[72:75], v[136:139], v[204:207], a[72:75]
 HV8
 m16 a[160:163], v[136:139], v[208:211], a[160:163]
 rtr v[142:143], v80, 14088
 HV9
 m16 a[168:171], v[136:139], v[212:215], a[168:171]
 HV10
 m16 v[168:171], v[136:139], v[216:219], v[168:171]
 HV11
 s_add_u32 s53, s53, 12288
 m16 v[176:179], v[136:139], v[220:223], v[176:179]
 s_waitcnt lgkmcnt(0)
 m16 a[68:71], v[140:143], v[200:203], a[68:71]
 rtr v[144:145], v81, 12544
 m16 a[76:79], v[140:143], v[204:207], a[76:79]
 m16 a[164:167], v[140:143], v[208:211], a[164:167]
 rtr v[146:147], v81, 14080
 m16 a[172:175], v[140:143], v[212:215], a[172:175]
 m16 v[172:175], v[140:143], v[216:219], v[172:175]
 rtr v[148:149], v81, 12552
 m16 v[180:183], v[140:143], v[220:223], v[180:183]
 s_waitcnt lgkmcnt(1)
 m16 a[80:83], v[144:147], v[200:203], a[80:83]
 rtr v[150:151], v81, 14088
 m16 a[88:91], v[144:147], v[204:207], a[88:91]
 m16 a[176:179], v[144:147], v[208:211], a[176:179]
 m16 a[184:187], v[144:147], v[212:215], a[184:187]
 m16 v[184:187], v[144:147], v[216:219], v[184:187]
 m16 v[192:195], v[144:147], v[220:223], v[192:195]
 s_waitcnt lgkmcnt(0)
 m16 a[84:87], v[148:151], v[200:203], a[84:87]
 m16 a[92:95], v[148:151], v[204:207], a[92:95]
 m16 a[180:183], v[148:151], v[208:211], a[180:183]
 m16 a[188:191], v[148:151], v[212:215], a[188:191]
 m16 v[188:191], v[148:151], v[216:219], v[188:191]
 m16 v[196:199], v[148:151], v[220:223], v[196:199]
 s_waitcnt vmcnt(48)
 s_barrier
 rtr v[136:137], v80, 24576
 rtr v[138:139], v80, 26112
 rtr v[140:141], v80, 24584
 rtr v[142:143], v80, 26120
 rtr v[144:145], v81, 24576
 rtr v[146:147], v81, 26112
 s_mov_b32 m0, 135168
 s_nop 0
 HU0
 HU1
 HU2
 HU3
 s_mov_b32 m0, 139264
 s_nop 0
 HU4
 HU5
 HU6
 s_waitcnt lgkmcnt(4)
 m16 a[0:3], v[136:139], v[224:227], a[0:3]
 HU7
 s_mov_b32 m0, 143360
 m16 a[8:11], v[136:139], v[228:231], a[8:11]
 HU8
 m16 a[96:99], v[136:139], v[232:235], a[96:99]
 HU9
 m16 a[104:107], v[136:139], v[236:239], a[104:107]
 HU10
 m16 a[192:195], v[136:139], v[240:243], a[192:195]
 HU11
 s_add_u32 s59, s59, 393216
 s_sub_u32 s46, s59, 7864320
 s_cmp_ge_u32 s59, 7864320
 s_cselect_b32 s59, s46, s59
 s_mov_b32 m0, 122880
 m16 a[200:203], v[136:139], v[244:247], a[200:203]
 HY0
 s_waitcnt lgkmcnt(2)
 m16 a[4:7], v[140:143], v[224:227], a[4:7]
 HY1
 m16 a[12:15], v[140:143], v[228:231], a[12:15]
 HY2
 m16 a[100:103], v[140:143], v[232:235], a[100:103]
 HY3
 s_mov_b32 m0, 126976
 m16 a[108:111], v[140:143], v[236:239], a[108:111]
 HY4
 m16 a[196:199], v[140:143], v[240:243], a[196:199]
 HY5
 m16 a[204:207], v[140:143], v[244:247], a[204:207]
 HY6
 s_waitcnt lgkmcnt(0)
 m16 a[16:19], v[144:147], v[224:227], a[16:19]
 HY7
 s_mov_b32 m0, 131072
 m16 a[24:27], v[144:147], v[228:231], a[24:27]
 HY8
 m16 a[112:115], v[144:147], v[232:235], a[112:115]
 HY9
 m16 a[120:123], v[144:147], v[236:239], a[120:123]
 HY10
 m16 a[208:211], v[144:147], v[240:243], a[208:211]
 HY11
 s_add_u32 s86, s86, 128
 s_sub_u32 s46, s86, 1280
 s_cmp_ge_u32 s86, s57
 s_cselect_b32 s86, s46, s86
 s_mov_b32 m0, 61440
 m16 a[216:219], v[144:147], v[244:247], a[216:219]
 HK0
 HK1
 HK2
 HK3
 s_mov_b32 m0, 65536
 s_nop 0
 HK4
 HK5
 HK6
 HK7
 s_mov_b32 m0, 69632
 s_nop 0
 HK8
 HK9
 HK10
 HK11
 s_add_u32 s52, s52, 12288
 s_mov_b32 m0, 86016
 s_nop 0
 HV0
 HV1
 HV2
 HV3
 s_mov_b32 m0, 90112
 s_nop 0
 HV4
 HV5
 HV6
 HV7
 s_mov_b32 m0, 94208
 s_nop 0
 HV8
 HV9
 HV10
 HV11
 s_add_u32 s53, s53, 12288
 s_waitcnt vmcnt(60)
 s_barrier
 rtr v[136:137], v81, 24584
 rtr v[138:139], v81, 26120
 rtr v[140:141], v80, 24704
 rtr v[142:143], v80, 26240
 rtr v[144:145], v80, 24712
 rtr v[146:147], v80, 26248
 rtr v[148:149], v81, 24704
 rtr v[150:151], v81, 26240
 rtr v[152:153], v81, 24712
 rtr v[154:155], v81, 26248
 rtr v[156:157], v80, 24832
 rtr v[158:159], v80, 26368
 s_waitcnt lgkmcnt(4)
 m16 a[20:23], v[136:139], v[224:227], a[20:23]
 rtr v[160:161], v80, 24840
 m16 a[28:31], v[136:139], v[228:231], a[28:31]
 rtr v[162:163], v80, 26376
 m16 a[116:119], v[136:139], v[232:235], a[116:119]
 rtr v[164:165], v81, 24832
 m16 a[124:127], v[136:139], v[236:239], a[124:127]
 rtr v[166:167], v81, 26368
 m16 a[212:215], v[136:139], v[240:243], a[212:215]
 m16 a[220:223], v[136:139], v[244:247], a[220:223]
 rtr v[136:137], v81, 24840
 m16 a[32:35], v[140:143], v[224:227], a[32:35]
 rtr v[138:139], v81, 26376
 m16 a[40:43], v[140:143], v[228:231], a[40:43]
 m16 a[128:131], v[140:143], v[232:235], a[128:131]
 m16 a[136:139], v[140:143], v[236:239], a[136:139]
 m16 a[224:227], v[140:143], v[240:243], a[224:227]
 m16 a[232:235], v[140:143], v[244:247], a[232:235]
 m16 a[36:39], v[144:147], v[224:227], a[36:39]
 m16 a[44:47], v[144:147], v[228:231], a[44:47]
 m16 a[132:135], v[144:147], v[232:235], a[132:135]
 m16 a[140:143], v[144:147], v[236:239], a[140:143]
 m16 a[228:231], v[144:147], v[240:243], a[228:231]
 m16 a[236:239], v[144:147], v[244:247], a[236:239]
 m16 a[48:51], v[148:151], v[224:227], a[48:51]
 m16 a[56:59], v[148:151], v[228:231], a[56:59]
 m16 a[144:147], v[148:151], v[232:235], a[144:147]
 m16 a[152:155], v[148:151], v[236:239], a[152:155]
 m16 a[240:243], v[148:151], v[240:243], a[240:243]
 m16 a[248:251], v[148:151], v[244:247], a[248:251]
 s_waitcnt lgkmcnt(4)
 m16 a[52:55], v[152:155], v[224:227], a[52:55]
 m16 a[60:63], v[152:155], v[228:231], a[60:63]
 m16 a[148:151], v[152:155], v[232:235], a[148:151]
 m16 a[156:159], v[152:155], v[236:239], a[156:159]
 m16 a[244:247], v[152:155], v[240:243], a[244:247]
 m16 a[252:255], v[152:155], v[244:247], a[252:255]
 m16 a[64:67], v[156:159], v[224:227], a[64:67]
 m16 a[72:75], v[156:159], v[228:231], a[72:75]
 m16 a[160:163], v[156:159], v[232:235], a[160:163]
 m16 a[168:171], v[156:159], v[236:239], a[168:171]
 m16 v[168:171], v[156:159], v[240:243], v[168:171]
 m16 v[176:179], v[156:159], v[244:247], v[176:179]
 m16 a[68:71], v[160:163], v[224:227], a[68:71]
 m16 a[76:79], v[160:163], v[228:231], a[76:79]
 m16 a[164:167], v[160:163], v[232:235], a[164:167]
 m16 a[172:175], v[160:163], v[236:239], a[172:175]
 m16 v[172:175], v[160:163], v[240:243], v[172:175]
 m16 v[180:183], v[160:163], v[244:247], v[180:183]
 s_waitcnt lgkmcnt(2)
 m16 a[80:83], v[164:167], v[224:227], a[80:83]
 m16 a[88:91], v[164:167], v[228:231], a[88:91]
 m16 a[176:179], v[164:167], v[232:235], a[176:179]
 m16 a[184:187], v[164:167], v[236:239], a[184:187]
 m16 v[184:187], v[164:167], v[240:243], v[184:187]
 m16 v[192:195], v[164:167], v[244:247], v[192:195]
 s_waitcnt lgkmcnt(0)
 m16 a[84:87], v[136:139], v[224:227], a[84:87]
 m16 a[92:95], v[136:139], v[228:231], a[92:95]
 m16 a[180:183], v[136:139], v[232:235], a[180:183]
 m16 a[188:191], v[136:139], v[236:239], a[188:191]
 m16 v[188:191], v[136:139], v[240:243], v[188:191]
 m16 v[196:199], v[136:139], v[244:247], v[196:199]
 s_waitcnt vmcnt(24)
 s_barrier
 rtr v[136:137], v80, 12288
 rtr v[138:139], v80, 13824
 ds_read_b128 v[88:91], v84
 ds_read_b128 v[92:95], v84 offset:2048
 ds_read_b128 v[96:99], v84 offset:4096
 ds_read_b128 v[100:103], v84 offset:6144
 ds_read_b128 v[104:107], v84 offset:8192
 ds_read_b128 v[108:111], v84 offset:10240
 rtr v[140:141], v80, 12296
 rtr v[142:143], v80, 13832
 rtr v[144:145], v81, 12288
 rtr v[146:147], v81, 13824
 s_mov_b32 m0, 147456
 s_nop 0
 HU0
 HU1
 HU2
 HU3
 s_mov_b32 m0, 151552
 s_nop 0
 HU4
 HU5
 HU6
 s_waitcnt lgkmcnt(4)
 m16 a[0:3], v[136:139], v[88:91], a[0:3]
 HU7
 s_mov_b32 m0, 155648
 m16 a[8:11], v[136:139], v[92:95], a[8:11]
 ds_read_b128 v[112:115], v85
 HU8
 m16 a[96:99], v[136:139], v[96:99], a[96:99]
 ds_read_b128 v[116:119], v85 offset:2048
 HU9
 m16 a[104:107], v[136:139], v[100:103], a[104:107]
 ds_read_b128 v[120:123], v85 offset:4096
 HU10
 m16 a[192:195], v[136:139], v[104:107], a[192:195]
 HU11
 s_add_u32 s59, s59, 393216
 s_sub_u32 s46, s59, 7864320
 s_cmp_ge_u32 s59, 7864320
 s_cselect_b32 s59, s46, s59
 s_mov_b32 m0, 24576
 m16 a[200:203], v[136:139], v[108:111], a[200:203]
 ds_read_b128 v[124:127], v85 offset:6144
 HWO0
 s_waitcnt lgkmcnt(4)
 m16 a[4:7], v[140:143], v[88:91], a[4:7]
 ds_read_b128 v[128:131], v85 offset:8192
 HWO1
 m16 a[12:15], v[140:143], v[92:95], a[12:15]
 ds_read_b128 v[132:135], v85 offset:10240
 HWO2
 m16 a[100:103], v[140:143], v[96:99], a[100:103]
 HWO3
 s_mov_b32 m0, 28672
 m16 a[108:111], v[140:143], v[100:103], a[108:111]
 rtr v[148:149], v81, 12296
 HWO4
 m16 a[196:199], v[140:143], v[104:107], a[196:199]
 rtr v[150:151], v81, 13832
 HWO5
 m16 a[204:207], v[140:143], v[108:111], a[204:207]
 rtr v[152:153], v80, 12416
 HWO6
 m16 a[16:19], v[144:147], v[88:91], a[16:19]
 HWO7
 s_mov_b32 m0, 32768
 m16 a[24:27], v[144:147], v[92:95], a[24:27]
 rtr v[154:155], v80, 13952
 HWO8
 m16 a[112:115], v[144:147], v[96:99], a[112:115]
 rtr v[156:157], v80, 12424
 HWO9
 m16 a[120:123], v[144:147], v[100:103], a[120:123]
 HWO10
 m16 a[208:211], v[144:147], v[104:107], a[208:211]
 HWO11
 s_add_u32 s56, s56, 122880
 s_mov_b32 m0, 0
 s_waitcnt lgkmcnt(4)
 m16 a[216:219], v[144:147], v[108:111], a[216:219]
 HWO0
 s_waitcnt lgkmcnt(3)
 m16 a[20:23], v[148:151], v[88:91], a[20:23]
 rtr v[158:159], v80, 13960
 HWO1
 m16 a[28:31], v[148:151], v[92:95], a[28:31]
 HWO2
 m16 a[116:119], v[148:151], v[96:99], a[116:119]
 HWO3
 s_mov_b32 m0, 4096
 m16 a[124:127], v[148:151], v[100:103], a[124:127]
 HWO4
 m16 a[212:215], v[148:151], v[104:107], a[212:215]
 rtr v[160:161], v81, 12416
 HWO5
 m16 a[220:223], v[148:151], v[108:111], a[220:223]
 HWO6
 s_waitcnt lgkmcnt(3)
 m16 a[32:35], v[152:155], v[88:91], a[32:35]
 HWO7
 s_mov_b32 m0, 8192
 m16 a[40:43], v[152:155], v[92:95], a[40:43]
 HWO8
 m16 a[128:131], v[152:155], v[96:99], a[128:131]
 rtr v[162:163], v81, 13952
 HWO9
 m16 a[136:139], v[152:155], v[100:103], a[136:139]
 HWO10
 m16 a[224:227], v[152:155], v[104:107], a[224:227]
 HWO11
 s_add_u32 s56, s56, -122752
 s_mov_b32 m0, 73728
 m16 a[232:235], v[152:155], v[108:111], a[232:235]
 HK0
 s_waitcnt lgkmcnt(2)
 m16 a[36:39], v[156:159], v[88:91], a[36:39]
 rtr v[164:165], v81, 12424
 HK1
 m16 a[44:47], v[156:159], v[92:95], a[44:47]
 HK2
 m16 a[132:135], v[156:159], v[96:99], a[132:135]
 HK3
 s_mov_b32 m0, 77824
 m16 a[140:143], v[156:159], v[100:103], a[140:143]
 HK4
 m16 a[228:231], v[156:159], v[104:107], a[228:231]
 rtr v[166:167], v81, 13960
 HK5
 m16 a[236:239], v[156:159], v[108:111], a[236:239]
 HK6
 s_waitcnt lgkmcnt(2)
 m16 a[48:51], v[160:163], v[88:91], a[48:51]
 HK7
 s_mov_b32 m0, 81920
 m16 a[56:59], v[160:163], v[92:95], a[56:59]
 HK8
 m16 a[144:147], v[160:163], v[96:99], a[144:147]
 rtr v[136:137], v80, 12544
 HK9
 m16 a[152:155], v[160:163], v[100:103], a[152:155]
 HK10
 m16 a[240:243], v[160:163], v[104:107], a[240:243]
 HK11
 s_add_u32 s52, s52, 12288
 s_mov_b32 m0, 98304
 m16 a[248:251], v[160:163], v[108:111], a[248:251]
 HV0
 s_waitcnt lgkmcnt(1)
 m16 a[52:55], v[164:167], v[88:91], a[52:55]
 rtr v[138:139], v80, 14080
 HV1
 m16 a[60:63], v[164:167], v[92:95], a[60:63]
 HV2
 m16 a[148:151], v[164:167], v[96:99], a[148:151]
 HV3
 s_mov_b32 m0, 102400
 m16 a[156:159], v[164:167], v[100:103], a[156:159]
 HV4
 m16 a[244:247], v[164:167], v[104:107], a[244:247]
 rtr v[140:141], v80, 12552
 HV5
 m16 a[252:255], v[164:167], v[108:111], a[252:255]
 HV6
 s_waitcnt lgkmcnt(1)
 m16 a[64:67], v[136:139], v[88:91], a[64:67]
 HV7
 s_mov_b32 m0, 106496
 m16 a[72:75], v[136:139], v[92:95], a[72:75]
 HV8
 m16 a[160:163], v[136:139], v[96:99], a[160:163]
 rtr v[142:143], v80, 14088
 HV9
 m16 a[168:171], v[136:139], v[100:103], a[168:171]
 HV10
 m16 v[168:171], v[136:139], v[104:107], v[168:171]
 HV11
 s_add_u32 s53, s53, 12288
 m16 v[176:179], v[136:139], v[108:111], v[176:179]
 s_waitcnt lgkmcnt(0)
 m16 a[68:71], v[140:143], v[88:91], a[68:71]
 rtr v[144:145], v81, 12544
 m16 a[76:79], v[140:143], v[92:95], a[76:79]
 m16 a[164:167], v[140:143], v[96:99], a[164:167]
 rtr v[146:147], v81, 14080
 m16 a[172:175], v[140:143], v[100:103], a[172:175]
 m16 v[172:175], v[140:143], v[104:107], v[172:175]
 rtr v[148:149], v81, 12552
 m16 v[180:183], v[140:143], v[108:111], v[180:183]
 s_waitcnt lgkmcnt(1)
 m16 a[80:83], v[144:147], v[88:91], a[80:83]
 rtr v[150:151], v81, 14088
 m16 a[88:91], v[144:147], v[92:95], a[88:91]
 m16 a[176:179], v[144:147], v[96:99], a[176:179]
 m16 a[184:187], v[144:147], v[100:103], a[184:187]
 m16 v[184:187], v[144:147], v[104:107], v[184:187]
 m16 v[192:195], v[144:147], v[108:111], v[192:195]
 s_waitcnt lgkmcnt(0)
 m16 a[84:87], v[148:151], v[88:91], a[84:87]
 m16 a[92:95], v[148:151], v[92:95], a[92:95]
 m16 a[180:183], v[148:151], v[96:99], a[180:183]
 m16 a[188:191], v[148:151], v[100:103], a[188:191]
 m16 v[188:191], v[148:151], v[104:107], v[188:191]
 m16 v[196:199], v[148:151], v[108:111], v[196:199]
 s_waitcnt vmcnt(24)
 s_barrier
 rtr v[136:137], v80, 24576
 rtr v[138:139], v80, 26112
 rtr v[140:141], v80, 24584
 rtr v[142:143], v80, 26120
 rtr v[144:145], v81, 24576
 rtr v[146:147], v81, 26112
 rtr v[148:149], v81, 24584
 rtr v[150:151], v81, 26120
 rtr v[152:153], v80, 24704
 rtr v[154:155], v80, 26240
 rtr v[156:157], v80, 24712
 rtr v[158:159], v80, 26248
 s_mov_b32 m0, 135168
 s_nop 0
 HU0
 HU1
 HU2
 HU3
 s_mov_b32 m0, 139264
 s_nop 0
 HU4
 HU5
 HU6
 s_waitcnt lgkmcnt(4)
 m16 a[0:3], v[136:139], v[112:115], a[0:3]
 HU7
 s_mov_b32 m0, 143360
 m16 a[8:11], v[136:139], v[116:119], a[8:11]
 rtr v[160:161], v81, 24704
 HU8
 m16 a[96:99], v[136:139], v[120:123], a[96:99]
 rtr v[162:163], v81, 26240
 HU9
 m16 a[104:107], v[136:139], v[124:127], a[104:107]
 rtr v[164:165], v81, 24712
 HU10
 m16 a[192:195], v[136:139], v[128:131], a[192:195]
 HU11
 s_add_u32 s59, s59, 393216
 s_sub_u32 s46, s59, 7864320
 s_cmp_ge_u32 s59, 7864320
 s_cselect_b32 s59, s46, s59
 s_mov_b32 m0, 122880
 m16 a[200:203], v[136:139], v[132:135], a[200:203]
 rtr v[166:167], v81, 26248
 HY0
 m16 a[4:7], v[140:143], v[112:115], a[4:7]
 rtr v[136:137], v80, 24832
 HY1
 m16 a[12:15], v[140:143], v[116:119], a[12:15]
 rtr v[138:139], v80, 26368
 HY2
 m16 a[100:103], v[140:143], v[120:123], a[100:103]
 HY3
 s_mov_b32 m0, 126976
 m16 a[108:111], v[140:143], v[124:127], a[108:111]
 HY4
 m16 a[196:199], v[140:143], v[128:131], a[196:199]
 HY5
 m16 a[204:207], v[140:143], v[132:135], a[204:207]
 rtr v[140:141], v80, 24840
 HY6
 m16 a[16:19], v[144:147], v[112:115], a[16:19]
 HY7
 s_mov_b32 m0, 131072
 m16 a[24:27], v[144:147], v[116:119], a[24:27]
 rtr v[142:143], v80, 26376
 HY8
 m16 a[112:115], v[144:147], v[120:123], a[112:115]
 HY9
 m16 a[120:123], v[144:147], v[124:127], a[120:123]
 HY10
 m16 a[208:211], v[144:147], v[128:131], a[208:211]
 HY11
 s_add_u32 s86, s86, 128
 s_sub_u32 s46, s86, 1280
 s_cmp_ge_u32 s86, s57
 s_cselect_b32 s86, s46, s86
 s_mov_b32 m0, 12288
 m16 a[216:219], v[144:147], v[132:135], a[216:219]
 HWO0
 m16 a[20:23], v[148:151], v[112:115], a[20:23]
 rtr v[144:145], v81, 24832
 HWO1
 m16 a[28:31], v[148:151], v[116:119], a[28:31]
 HWO2
 m16 a[116:119], v[148:151], v[120:123], a[116:119]
 HWO3
 s_mov_b32 m0, 16384
 m16 a[124:127], v[148:151], v[124:127], a[124:127]
 HWO4
 m16 a[212:215], v[148:151], v[128:131], a[212:215]
 rtr v[146:147], v81, 26368
 HWO5
 m16 a[220:223], v[148:151], v[132:135], a[220:223]
 HWO6
 s_waitcnt lgkmcnt(6)
 m16 a[32:35], v[152:155], v[112:115], a[32:35]
 HWO7
 s_mov_b32 m0, 20480
 m16 a[40:43], v[152:155], v[116:119], a[40:43]
 HWO8
 m16 a[128:131], v[152:155], v[120:123], a[128:131]
 rtr v[148:149], v81, 24840
 HWO9
 m16 a[136:139], v[152:155], v[124:127], a[136:139]
 HWO10
 m16 a[224:227], v[152:155], v[128:131], a[224:227]
 HWO11
 s_add_u32 s56, s56, 122880
 s_mov_b32 m0, 36864
 m16 a[232:235], v[152:155], v[132:135], a[232:235]
 HWO0
 m16 a[36:39], v[156:159], v[112:115], a[36:39]
 rtr v[150:151], v81, 26376
 HWO1
 m16 a[44:47], v[156:159], v[116:119], a[44:47]
 HWO2
 m16 a[132:135], v[156:159], v[120:123], a[132:135]
 HWO3
 s_mov_b32 m0, 40960
 m16 a[140:143], v[156:159], v[124:127], a[140:143]
 HWO4
 m16 a[228:231], v[156:159], v[128:131], a[228:231]
 HWO5
 m16 a[236:239], v[156:159], v[132:135], a[236:239]
 HWO6
 m16 a[48:51], v[160:163], v[112:115], a[48:51]
 HWO7
 s_mov_b32 m0, 45056
 m16 a[56:59], v[160:163], v[116:119], a[56:59]
 HWO8
 m16 a[144:147], v[160:163], v[120:123], a[144:147]
 HWO9
 m16 a[152:155], v[160:163], v[124:127], a[152:155]
 HWO10
 m16 a[240:243], v[160:163], v[128:131], a[240:243]
 HWO11
 s_add_u32 s56, s56, -122752
 s_mov_b32 m0, 49152
 m16 a[248:251], v[160:163], v[132:135], a[248:251]
 HK0
 m16 a[52:55], v[164:167], v[112:115], a[52:55]
 HK1
 m16 a[60:63], v[164:167], v[116:119], a[60:63]
 HK2
 m16 a[148:151], v[164:167], v[120:123], a[148:151]
 HK3
 s_mov_b32 m0, 53248
 m16 a[156:159], v[164:167], v[124:127], a[156:159]
 HK4
 m16 a[244:247], v[164:167], v[128:131], a[244:247]
 HK5
 m16 a[252:255], v[164:167], v[132:135], a[252:255]
 HK6
 s_waitcnt lgkmcnt(4)
 m16 a[64:67], v[136:139], v[112:115], a[64:67]
 HK7
 s_mov_b32 m0, 57344
 m16 a[72:75], v[136:139], v[116:119], a[72:75]
 HK8
 m16 a[160:163], v[136:139], v[120:123], a[160:163]
 HK9
 m16 a[168:171], v[136:139], v[124:127], a[168:171]
 HK10
 m16 v[168:171], v[136:139], v[128:131], v[168:171]
 HK11
 s_add_u32 s52, s52, 12288
 s_mov_b32 m0, 110592
 m16 v[176:179], v[136:139], v[132:135], v[176:179]
 HV0
 m16 a[68:71], v[140:143], v[112:115], a[68:71]
 HV1
 m16 a[76:79], v[140:143], v[116:119], a[76:79]
 HV2
 m16 a[164:167], v[140:143], v[120:123], a[164:167]
 HV3
 s_mov_b32 m0, 114688
 m16 a[172:175], v[140:143], v[124:127], a[172:175]
 HV4
 m16 v[172:175], v[140:143], v[128:131], v[172:175]
 HV5
 m16 v[180:183], v[140:143], v[132:135], v[180:183]
 HV6
 s_waitcnt lgkmcnt(2)
 m16 a[80:83], v[144:147], v[112:115], a[80:83]
 HV7
 s_mov_b32 m0, 118784
 m16 a[88:91], v[144:147], v[116:119], a[88:91]
 HV8
 m16 a[176:179], v[144:147], v[120:123], a[176:179]
 HV9
 m16 a[184:187], v[144:147], v[124:127], a[184:187]
 HV10
 m16 v[184:187], v[144:147], v[128:131], v[184:187]
 HV11
 s_add_u32 s53, s53, 12288
 m16 v[192:195], v[144:147], v[132:135], v[192:195]
 s_add_u32 s46, s58, 246784
 buffer_load_dword v78, v76, s[24:27], s46 offen
 s_waitcnt lgkmcnt(0)
 m16 a[84:87], v[148:151], v[112:115], a[84:87]
 m16 a[92:95], v[148:151], v[116:119], a[92:95]
 m16 a[180:183], v[148:151], v[120:123], a[180:183]
 m16 a[188:191], v[148:151], v[124:127], a[188:191]
 m16 v[188:191], v[148:151], v[128:131], v[188:191]
 m16 v[196:199], v[148:151], v[132:135], v[196:199]
 s_waitcnt vmcnt(49)
 s_barrier
 rtr v[136:137], v80, 12288
 rtr v[138:139], v80, 13824
 ds_read_b128 v[200:203], v84
 ds_read_b128 v[204:207], v84 offset:2048
 ds_read_b128 v[208:211], v84 offset:4096
 ds_read_b128 v[212:215], v84 offset:6144
 ds_read_b128 v[216:219], v84 offset:8192
 ds_read_b128 v[220:223], v84 offset:10240
 rtr v[140:141], v80, 12296
 rtr v[142:143], v80, 13832
 rtr v[144:145], v81, 12288
 rtr v[146:147], v81, 13824
 s_mov_b32 m0, 147456
 s_nop 0
 HU0
 HU1
 HU2
 HU3
 s_mov_b32 m0, 151552
 s_nop 0
 HU4
 HU5
 HU6
 s_waitcnt lgkmcnt(4)
 m16 a[0:3], v[136:139], v[200:203], a[0:3]
 HU7
 s_mov_b32 m0, 155648
 m16 a[8:11], v[136:139], v[204:207], a[8:11]
 ds_read_b128 v[224:227], v85
 HU8
 m16 a[96:99], v[136:139], v[208:211], a[96:99]
 ds_read_b128 v[228:231], v85 offset:2048
 HU9
 m16 a[104:107], v[136:139], v[212:215], a[104:107]
 ds_read_b128 v[232:235], v85 offset:4096
 HU10
 m16 a[192:195], v[136:139], v[216:219], a[192:195]
 HU11
 s_add_u32 s59, s59, 393600
 s_sub_u32 s46, s59, 7864320
 s_cmp_ge_u32 s59, 7864320
 s_cselect_b32 s59, s46, s59
 s_mov_b32 m0, 61440
 m16 a[200:203], v[136:139], v[220:223], a[200:203]
 ds_read_b128 v[236:239], v85 offset:6144
 HK0
 s_waitcnt lgkmcnt(4)
 m16 a[4:7], v[140:143], v[200:203], a[4:7]
 ds_read_b128 v[240:243], v85 offset:8192
 HK1
 m16 a[12:15], v[140:143], v[204:207], a[12:15]
 ds_read_b128 v[244:247], v85 offset:10240
 HK2
 m16 a[100:103], v[140:143], v[208:211], a[100:103]
 HK3
 s_mov_b32 m0, 65536
 m16 a[108:111], v[140:143], v[212:215], a[108:111]
 rtr v[148:149], v81, 12296
 HK4
 m16 a[196:199], v[140:143], v[216:219], a[196:199]
 rtr v[150:151], v81, 13832
 HK5
 m16 a[204:207], v[140:143], v[220:223], a[204:207]
 rtr v[152:153], v80, 12416
 HK6
 m16 a[16:19], v[144:147], v[200:203], a[16:19]
 HK7
 s_mov_b32 m0, 69632
 m16 a[24:27], v[144:147], v[204:207], a[24:27]
 rtr v[154:155], v80, 13952
 HK8
 m16 a[112:115], v[144:147], v[208:211], a[112:115]
 rtr v[156:157], v80, 12424
 HK9
 m16 a[120:123], v[144:147], v[212:215], a[120:123]
 HK10
 m16 a[208:211], v[144:147], v[216:219], a[208:211]
 HK11
 s_add_u32 s52, s52, 12288
 s_mov_b32 m0, 86016
 s_waitcnt lgkmcnt(4)
 m16 a[216:219], v[144:147], v[220:223], a[216:219]
 HV0
 s_waitcnt lgkmcnt(3)
 m16 a[20:23], v[148:151], v[200:203], a[20:23]
 rtr v[158:159], v80, 13960
 HV1
 m16 a[28:31], v[148:151], v[204:207], a[28:31]
 HV2
 m16 a[116:119], v[148:151], v[208:211], a[116:119]
 HV3
 s_mov_b32 m0, 90112
 m16 a[124:127], v[148:151], v[212:215], a[124:127]
 HV4
 m16 a[212:215], v[148:151], v[216:219], a[212:215]
 rtr v[160:161], v81, 12416
 HV5
 m16 a[220:223], v[148:151], v[220:223], a[220:223]
 HV6
 s_waitcnt lgkmcnt(3)
 m16 a[32:35], v[152:155], v[200:203], a[32:35]
 HV7
 s_mov_b32 m0, 94208
 m16 a[40:43], v[152:155], v[204:207], a[40:43]
 HV8
 m16 a[128:131], v[152:155], v[208:211], a[128:131]
 rtr v[162:163], v81, 13952
 HV9
 m16 a[136:139], v[152:155], v[212:215], a[136:139]
 HV10
 m16 a[224:227], v[152:155], v[216:219], a[224:227]
 HV11
 s_add_u32 s53, s53, 12288
 m16 a[232:235], v[152:155], v[220:223], a[232:235]
 s_waitcnt lgkmcnt(2)
 m16 a[36:39], v[156:159], v[200:203], a[36:39]
 rtr v[164:165], v81, 12424
 m16 a[44:47], v[156:159], v[204:207], a[44:47]
 m16 a[132:135], v[156:159], v[208:211], a[132:135]
 rtr v[166:167], v81, 13960
 m16 a[140:143], v[156:159], v[212:215], a[140:143]
 m16 a[228:231], v[156:159], v[216:219], a[228:231]
 rtr v[136:137], v80, 12544
 m16 a[236:239], v[156:159], v[220:223], a[236:239]
 s_waitcnt lgkmcnt(3)
 m16 a[48:51], v[160:163], v[200:203], a[48:51]
 rtr v[138:139], v80, 14080
 m16 a[56:59], v[160:163], v[204:207], a[56:59]
 m16 a[144:147], v[160:163], v[208:211], a[144:147]
 rtr v[140:141], v80, 12552
 m16 a[152:155], v[160:163], v[212:215], a[152:155]
 m16 a[240:243], v[160:163], v[216:219], a[240:243]
 rtr v[142:143], v80, 14088
 m16 a[248:251], v[160:163], v[220:223], a[248:251]
 s_waitcnt lgkmcnt(4)
 m16 a[52:55], v[164:167], v[200:203], a[52:55]
 rtr v[144:145], v81, 12544
 m16 a[60:63], v[164:167], v[204:207], a[60:63]
 m16 a[148:151], v[164:167], v[208:211], a[148:151]
 rtr v[146:147], v81, 14080
 m16 a[156:159], v[164:167], v[212:215], a[156:159]
 m16 a[244:247], v[164:167], v[216:219], a[244:247]
 rtr v[148:149], v81, 12552
 m16 a[252:255], v[164:167], v[220:223], a[252:255]
 s_waitcnt lgkmcnt(4)
 m16 a[64:67], v[136:139], v[200:203], a[64:67]
 rtr v[150:151], v81, 14088
 m16 a[72:75], v[136:139], v[204:207], a[72:75]
 m16 a[160:163], v[136:139], v[208:211], a[160:163]
 m16 a[168:171], v[136:139], v[212:215], a[168:171]
 m16 v[168:171], v[136:139], v[216:219], v[168:171]
 m16 v[176:179], v[136:139], v[220:223], v[176:179]
 s_waitcnt lgkmcnt(4)
 m16 a[68:71], v[140:143], v[200:203], a[68:71]
 m16 a[76:79], v[140:143], v[204:207], a[76:79]
 m16 a[164:167], v[140:143], v[208:211], a[164:167]
 m16 a[172:175], v[140:143], v[212:215], a[172:175]
 m16 v[172:175], v[140:143], v[216:219], v[172:175]
 m16 v[180:183], v[140:143], v[220:223], v[180:183]
 s_waitcnt lgkmcnt(2)
 m16 a[80:83], v[144:147], v[200:203], a[80:83]
 m16 a[88:91], v[144:147], v[204:207], a[88:91]
 m16 a[176:179], v[144:147], v[208:211], a[176:179]
 m16 a[184:187], v[144:147], v[212:215], a[184:187]
 m16 v[184:187], v[144:147], v[216:219], v[184:187]
 m16 v[192:195], v[144:147], v[220:223], v[192:195]
 s_waitcnt lgkmcnt(0)
 m16 a[84:87], v[148:151], v[200:203], a[84:87]
 m16 a[92:95], v[148:151], v[204:207], a[92:95]
 m16 a[180:183], v[148:151], v[208:211], a[180:183]
 m16 a[188:191], v[148:151], v[212:215], a[188:191]
 m16 v[188:191], v[148:151], v[216:219], v[188:191]
 m16 v[196:199], v[148:151], v[220:223], v[196:199]
 s_waitcnt vmcnt(24)
 s_barrier
 rtr v[136:137], v80, 24576
 rtr v[138:139], v80, 26112
 rtr v[140:141], v80, 24584
 rtr v[142:143], v80, 26120
 rtr v[144:145], v81, 24576
 rtr v[146:147], v81, 26112
 rtr v[148:149], v81, 24584
 rtr v[150:151], v81, 26120
 rtr v[152:153], v80, 24704
 rtr v[154:155], v80, 26240
 rtr v[156:157], v80, 24712
 rtr v[158:159], v80, 26248
 s_mov_b32 m0, 24576
 s_nop 0
 HWO0
 HWO1
 HWO2
 HWO3
 s_mov_b32 m0, 28672
 s_nop 0
 HWO4
 HWO5
 HWO6
 s_waitcnt lgkmcnt(4)
 m16 a[0:3], v[136:139], v[224:227], a[0:3]
 HWO7
 s_mov_b32 m0, 32768
 m16 a[8:11], v[136:139], v[228:231], a[8:11]
 rtr v[160:161], v81, 24704
 HWO8
 m16 a[96:99], v[136:139], v[232:235], a[96:99]
 rtr v[162:163], v81, 26240
 HWO9
 m16 a[104:107], v[136:139], v[236:239], a[104:107]
 rtr v[164:165], v81, 24712
 HWO10
 m16 a[192:195], v[136:139], v[240:243], a[192:195]
 HWO11
 s_add_u32 s56, s56, 122880
 s_mov_b32 m0, 0
 m16 a[200:203], v[136:139], v[244:247], a[200:203]
 rtr v[166:167], v81, 26248
 HWO0
 m16 a[4:7], v[140:143], v[224:227], a[4:7]
 rtr v[136:137], v80, 24832
 HWO1
 m16 a[12:15], v[140:143], v[228:231], a[12:15]
 rtr v[138:139], v80, 26368
 HWO2
 m16 a[100:103], v[140:143], v[232:235], a[100:103]
 HWO3
 s_mov_b32 m0, 4096
 m16 a[108:111], v[140:143], v[236:239], a[108:111]
 HWO4
 m16 a[196:199], v[140:143], v[240:243], a[196:199]
 HWO5
 m16 a[204:207], v[140:143], v[244:247], a[204:207]
 rtr v[140:141], v80, 24840
 HWO6
 m16 a[16:19], v[144:147], v[224:227], a[16:19]
 HWO7
 s_mov_b32 m0, 8192
 m16 a[24:27], v[144:147], v[228:231], a[24:27]
 rtr v[142:143], v80, 26376
 HWO8
 m16 a[112:115], v[144:147], v[232:235], a[112:115]
 HWO9
 m16 a[120:123], v[144:147], v[236:239], a[120:123]
 HWO10
 m16 a[208:211], v[144:147], v[240:243], a[208:211]
 HWO11
 s_add_u32 s56, s56, -122752
 s_mov_b32 m0, 73728
 m16 a[216:219], v[144:147], v[244:247], a[216:219]
 HK0
 m16 a[20:23], v[148:151], v[224:227], a[20:23]
 rtr v[144:145], v81, 24832
 HK1
 m16 a[28:31], v[148:151], v[228:231], a[28:31]
 HK2
 m16 a[116:119], v[148:151], v[232:235], a[116:119]
 HK3
 s_mov_b32 m0, 77824
 m16 a[124:127], v[148:151], v[236:239], a[124:127]
 HK4
 m16 a[212:215], v[148:151], v[240:243], a[212:215]
 rtr v[146:147], v81, 26368
 HK5
 m16 a[220:223], v[148:151], v[244:247], a[220:223]
 HK6
 s_waitcnt lgkmcnt(6)
 m16 a[32:35], v[152:155], v[224:227], a[32:35]
 HK7
 s_mov_b32 m0, 81920
 m16 a[40:43], v[152:155], v[228:231], a[40:43]
 HK8
 m16 a[128:131], v[152:155], v[232:235], a[128:131]
 rtr v[148:149], v81, 24840
 HK9
 m16 a[136:139], v[152:155], v[236:239], a[136:139]
 HK10
 m16 a[224:227], v[152:155], v[240:243], a[224:227]
 HK11
 s_add_u32 s52, s52, 12288
 s_mov_b32 m0, 98304
 m16 a[232:235], v[152:155], v[244:247], a[232:235]
 HV0
 m16 a[36:39], v[156:159], v[224:227], a[36:39]
 rtr v[150:151], v81, 26376
 HV1
 m16 a[44:47], v[156:159], v[228:231], a[44:47]
 HV2
 m16 a[132:135], v[156:159], v[232:235], a[132:135]
 HV3
 s_mov_b32 m0, 102400
 m16 a[140:143], v[156:159], v[236:239], a[140:143]
 HV4
 m16 a[228:231], v[156:159], v[240:243], a[228:231]
 HV5
 m16 a[236:239], v[156:159], v[244:247], a[236:239]
 HV6
 m16 a[48:51], v[160:163], v[224:227], a[48:51]
 HV7
 s_mov_b32 m0, 106496
 m16 a[56:59], v[160:163], v[228:231], a[56:59]
 HV8
 m16 a[144:147], v[160:163], v[232:235], a[144:147]
 HV9
 m16 a[152:155], v[160:163], v[236:239], a[152:155]
 HV10
 m16 a[240:243], v[160:163], v[240:243], a[240:243]
 HV11
 s_add_u32 s53, s53, 12288
 m16 a[248:251], v[160:163], v[244:247], a[248:251]
 m16 a[52:55], v[164:167], v[224:227], a[52:55]
 m16 a[60:63], v[164:167], v[228:231], a[60:63]
 m16 a[148:151], v[164:167], v[232:235], a[148:151]
 m16 a[156:159], v[164:167], v[236:239], a[156:159]
 m16 a[244:247], v[164:167], v[240:243], a[244:247]
 m16 a[252:255], v[164:167], v[244:247], a[252:255]
 s_waitcnt lgkmcnt(4)
 m16 a[64:67], v[136:139], v[224:227], a[64:67]
 m16 a[72:75], v[136:139], v[228:231], a[72:75]
 m16 a[160:163], v[136:139], v[232:235], a[160:163]
 m16 a[168:171], v[136:139], v[236:239], a[168:171]
 m16 v[168:171], v[136:139], v[240:243], v[168:171]
 m16 v[176:179], v[136:139], v[244:247], v[176:179]
 m16 a[68:71], v[140:143], v[224:227], a[68:71]
 m16 a[76:79], v[140:143], v[228:231], a[76:79]
 m16 a[164:167], v[140:143], v[232:235], a[164:167]
 m16 a[172:175], v[140:143], v[236:239], a[172:175]
 m16 v[172:175], v[140:143], v[240:243], v[172:175]
 m16 v[180:183], v[140:143], v[244:247], v[180:183]
 s_waitcnt lgkmcnt(2)
 m16 a[80:83], v[144:147], v[224:227], a[80:83]
 m16 a[88:91], v[144:147], v[228:231], a[88:91]
 m16 a[176:179], v[144:147], v[232:235], a[176:179]
 m16 a[184:187], v[144:147], v[236:239], a[184:187]
 m16 v[184:187], v[144:147], v[240:243], v[184:187]
 m16 v[192:195], v[144:147], v[244:247], v[192:195]
 s_waitcnt lgkmcnt(0)
 m16 a[84:87], v[148:151], v[224:227], a[84:87]
 m16 a[92:95], v[148:151], v[228:231], a[92:95]
 m16 a[180:183], v[148:151], v[232:235], a[180:183]
 m16 a[188:191], v[148:151], v[236:239], a[188:191]
 m16 v[188:191], v[148:151], v[240:243], v[188:191]
 m16 v[196:199], v[148:151], v[244:247], v[196:199]
 s_waitcnt vmcnt(48)
 s_barrier
 TK 49152, 24576
 TV 110592, 12288
 s_nop 15
 s_mov_b32 s60, 0
 v_mov_b32 v87, v86
 s_movk_i32 s61, 96
 s_call_b64 s[44:45], CONV
 s_waitcnt vmcnt(24)
 s_barrier
 TWO 12288, 122880
 TWO 36864, 121728
 TV 86016, 12288
 TK 61440, -12288
 s_add_u32 s46, s58, 491520
 buffer_load_dword v78, v76, s[24:27], s46 offen
 s_movk_i32 s61, 192
 s_call_b64 s[44:45], CONV
 s_waitcnt vmcnt(60)
 s_barrier
 s_movk_i32 s61, 224
 s_call_b64 s[44:45], CONV
 s_waitcnt vmcnt(49)
 s_barrier
 TK 49152, 24576
 TK 73728, 12288
 s_movk_i32 s61, 256
 s_call_b64 s[44:45], CONV
 cvt v88, v168, v169
 cvt v89, v170, v171
 cvt v90, v172, v173
 cvt v91, v174, v175
 ds_write_b128 v87, v[88:91]
 cvt v92, v176, v177
 cvt v93, v178, v179
 cvt v94, v180, v181
 cvt v95, v182, v183
 ds_write_b128 v87, v[92:95] offset:1024
 cvt v96, v184, v185
 cvt v97, v186, v187
 cvt v98, v188, v189
 cvt v99, v190, v191
 ds_write_b128 v87, v[96:99] offset:2048
 cvt v100, v192, v193
 cvt v101, v194, v195
 cvt v102, v196, v197
 cvt v103, v198, v199
 ds_write_b128 v87, v[100:103] offset:3072
 s_waitcnt lgkmcnt(0)
 s_waitcnt vmcnt(37)
 s_barrier
 s_barrier
 TWO 24576, 122880
 TWO 0, -122752
 TV 86016, 12288
 TV 98304, 12288
 s_barrier
 s_add_u32 s46, s58, 491776
 buffer_load_dword v78, v76, s[24:27], s46 offen
 s_waitcnt vmcnt(60)
 s_barrier
 s_waitcnt vmcnt(25)
 s_barrier
 TWO 12288, 122880
 TWO 36864, -122752
 s_waitcnt vmcnt(37)
 s_barrier
 TK 49152, 12288
 TV 110592, 12288
 s_waitcnt vmcnt(24)
 s_barrier
 TWO 24576, 122880
 TWO 0, -122752
 TK 61440, 12288
 TV 86016, 12288
 s_waitcnt vmcnt(48)
 s_barrier
 TK 73728, 12288
 TV 98304, 12288
 s_waitcnt vmcnt(24)
 s_barrier
 TWO 12288, 122880
 TWO 36864, -122752
 TK 49152, 12288
 TV 110592, 12288
 s_add_u32 s46, s58, 492032
 buffer_load_dword v78, v76, s[24:27], s46 offen
 s_waitcnt vmcnt(49)
 s_barrier
 TK 61440, 12288
 TV 86016, 12288
 s_waitcnt vmcnt(25)
 s_barrier
 TWO 24576, 122880
 TWO 0, -122752
 TK 73728, 12288
 TV 98304, 12288
 s_add_u32 s46, s58, 492288
 buffer_load_dword v78, v76, s[24:27], s46 offen
 s_waitcnt vmcnt(25)
 s_barrier
 TWO 12288, 122880
 TWO 36864, -122752
 TK 49152, 12288
 TV 110592, 12288
 s_waitcnt vmcnt(60)
 s_barrier
CPS98:
 TK 61440, 12288
 TV 86016, 12288
 v_add_co_u32 v10, vcc, CODEEND-32768-LOADER, v8
 s_nop 1
 v_addc_co_u32 v11, vcc, 0, v9, vcc
 global_load_dword v78, v[10:11], off
 v_add_co_u32 v10, vcc, CPS98+4096-LOADER, v8
 s_nop 1
 v_addc_co_u32 v11, vcc, 0, v9, vcc
 global_load_dword v78, v[10:11], off
 s_waitcnt vmcnt(50)
 s_barrier
 s_waitcnt vmcnt(26)
 s_barrier
 TWO 24576, 122880
 TWO 0, -122752
 TK 73728, 12288
 TV 98304, 12288
 s_waitcnt vmcnt(24)
 s_barrier
 TWO 12288, 122880
 TWO 36864, -122752
 TK 49152, 12288
 TV 110592, 12288
 s_add_u32 s46, s58, 492544
 buffer_load_dword v78, v76, s[24:27], s46 offen
 s_add_u32 s46, s58, 737280
 buffer_load_dword v78, v76, s[24:27], s46 offen
 s_add_u32 s46, s58, 737536
 buffer_load_dword v78, v76, s[24:27], s46 offen
 s_add_u32 s46, s58, 737792
 buffer_load_dword v78, v76, s[24:27], s46 offen
 s_add_u32 s46, s58, 738048
 buffer_load_dword v78, v76, s[24:27], s46 offen
 s_add_u32 s46, s58, 738304
 buffer_load_dword v78, v76, s[24:27], s46 offen
 s_waitcnt vmcnt(54)
 s_barrier
 TK 61440, 12288
 TV 86016, 12288
 s_waitcnt vmcnt(30)
 s_barrier
 TWO 24576, 122880
 TWO 0, -122752
 TK 73728, 12288
 TV 98304, 12288
 s_waitcnt vmcnt(48)
 s_barrier
 TK 49152, 0
 TV 110592, 12288
 s_waitcnt vmcnt(24)
 s_barrier
 TWO 12288, 122880
 TWO 36864, 121728
 TWO 122880, 122880
 TWO 135168, -122752
 TWO 147456, 122880
 TV 86016, 0
 s_waitcnt vmcnt(60)
 s_barrier
 TWO 61440, -122752
 TWO 73728, 122880
 s_waitcnt vmcnt(60)
 s_barrier
 s_mul_i32 s43, s40, 983040
 s_lshl_b32 s46, s34, 10
 s_add_u32 s43, s43, s46
 s_mul_i32 s50, s33, 245760
 s_mul_i32 s46, s35, 1280
 s_add_u32 s50, s50, s46
 s_lshr_b32 s46, s34, 1
 s_lshl_b32 s46, s46, 6
 s_add_u32 s50, s50, s46
 s_and_b32 s46, s34, 1
 s_mul_i32 s46, s46, 40960
 s_add_u32 s50, s50, s46
 s_lshl_b32 s47, s40, 10
 s_add_u32 s47, s47, 33554432
 s_mov_b32 s42, 262144
 v_and_b32 v5, 15, v1
 v_mul_u32_u24 v5, 2560, v5
 v_bfe_u32 v102, v1, 4, 1
 v_lshl_add_u32 v5, v102, 5, v5
 v_lshrrev_b32 v102, 5, v1
 v_lshl_add_u32 v5, v102, 4, v5
 v_and_b32 v101, 7, v1
 v_lshlrev_b32 v101, 7, v101
 v_and_b32 v102, 7, v1
 s_lshl_b32 s46, s40, 3
 buffer_load_ubyte v103, v102, s[92:95], s46 offen sc1
 TWO 98304, -122752
 TWO 49152, 122880
 s_waitcnt vmcnt(49)
 s_barrier
 TWO 110592, -122752
 TWO 24576, 122880
 s_barrier
 TWO 0, -122752
 TWO 86016, 122880
 s_barrier
 s_barrier
 TWO 12288, -122752
 TWO 36864, 122880
 s_barrier
 TWO 122880, -122752
 s_barrier
 TWO 135168, 122880
 s_waitcnt vmcnt(60)
 s_barrier
 TWO 147456, -122752
 s_waitcnt vmcnt(60)
 s_barrier
 TWO 61440, 122880
 s_waitcnt vmcnt(60)
 s_barrier
 TWO 73728, -122752
 s_waitcnt vmcnt(60)
 s_barrier
 TWO 98304, 122880
 s_waitcnt vmcnt(60)
 s_barrier
 TWO 49152, 121728
 s_waitcnt vmcnt(60)
 s_barrier
 s_waitcnt vmcnt(60)
 s_barrier
 s_waitcnt vmcnt(0)
PD:
 s_waitcnt vmcnt(0)
 v_cmp_gt_u32 vcc, 1, v103
 s_cbranch_vccz PDy
 s_sleep 8
 v_and_b32 v102, 7, v1
 s_lshl_b32 s46, s40, 3
 buffer_load_ubyte v103, v102, s[92:95], s46 offen sc1
 s_sub_u32 s42, s42, 1
 s_cbranch_scc0 PD
 s_endpgm
PDy:
 s_barrier
 v_lshlrev_b32 v2, 4, v1
 buffer_load_dwordx4 v[104:107], v101, s[28:31], s47 offen sc1
 s_waitcnt vmcnt(0)
PL0:
 v_min3_u32 v104, v104, v105, v106
 v_cmp_gt_u32 vcc, 1, v104
 s_cbranch_vccz PL0y
 s_sleep 4
 buffer_load_dwordx4 v[104:107], v101, s[28:31], s47 offen sc1
 s_sub_u32 s42, s42, 1
 s_waitcnt vmcnt(0)
 s_cbranch_scc0 PL0
 s_endpgm
PL0y:
 s_add_u32 s46, s43, 0
 buffer_load_dwordx4 v[112:115], v2, s[28:31], s46 offen sc1
 s_add_u32 s46, s46, 122880
 buffer_load_dwordx4 v[116:119], v2, s[28:31], s46 offen sc1
 s_add_u32 s46, s46, 122880
 buffer_load_dwordx4 v[120:123], v2, s[28:31], s46 offen sc1
 s_add_u32 s46, s46, 122880
 buffer_load_dwordx4 v[124:127], v2, s[28:31], s46 offen sc1
 s_add_u32 s46, s46, 122880
 buffer_load_dwordx4 v[128:131], v2, s[28:31], s46 offen sc1
 s_add_u32 s46, s46, 122880
 buffer_load_dwordx4 v[132:135], v2, s[28:31], s46 offen sc1
 s_add_u32 s46, s46, 122880
 buffer_load_dwordx4 v[136:139], v2, s[28:31], s46 offen sc1
 s_add_u32 s46, s46, 122880
 buffer_load_dwordx4 v[140:143], v2, s[28:31], s46 offen sc1
 s_add_u32 s46, s43, 40960
 buffer_load_dwordx4 v[144:147], v2, s[28:31], s46 offen sc1
 s_add_u32 s46, s46, 122880
 buffer_load_dwordx4 v[148:151], v2, s[28:31], s46 offen sc1
 s_add_u32 s46, s46, 122880
 buffer_load_dwordx4 v[152:155], v2, s[28:31], s46 offen sc1
 s_add_u32 s46, s46, 122880
 buffer_load_dwordx4 v[156:159], v2, s[28:31], s46 offen sc1
 s_add_u32 s46, s46, 122880
 buffer_load_dwordx4 v[160:163], v2, s[28:31], s46 offen sc1
 s_add_u32 s46, s46, 122880
 buffer_load_dwordx4 v[164:167], v2, s[28:31], s46 offen sc1
 s_add_u32 s46, s46, 122880
 buffer_load_dwordx4 v[168:171], v2, s[28:31], s46 offen sc1
 s_add_u32 s46, s46, 122880
 buffer_load_dwordx4 v[172:175], v2, s[28:31], s46 offen sc1
 s_add_u32 s46, s43, 81920
 buffer_load_dwordx4 v[176:179], v2, s[28:31], s46 offen sc1
 s_add_u32 s46, s46, 122880
 buffer_load_dwordx4 v[180:183], v2, s[28:31], s46 offen sc1
 s_add_u32 s46, s46, 122880
 buffer_load_dwordx4 v[184:187], v2, s[28:31], s46 offen sc1
 s_add_u32 s46, s46, 122880
 buffer_load_dwordx4 v[188:191], v2, s[28:31], s46 offen sc1
 s_add_u32 s46, s46, 122880
 buffer_load_dwordx4 v[192:195], v2, s[28:31], s46 offen sc1
 s_add_u32 s46, s46, 122880
 buffer_load_dwordx4 v[196:199], v2, s[28:31], s46 offen sc1
 s_add_u32 s46, s46, 122880
 buffer_load_dwordx4 v[200:203], v2, s[28:31], s46 offen sc1
 s_add_u32 s46, s46, 122880
 buffer_load_dwordx4 v[204:207], v2, s[28:31], s46 offen sc1
 buffer_load_dwordx4 v[104:107], v101, s[28:31], s47 offen sc1
 s_movk_i32 s6, 0
 s_add_u32 s46, s50, 0
 s_waitcnt vmcnt(17)
 s_call_b64 s[44:45], RSUM
 s_movk_i32 s6, 32
 s_add_u32 s46, s50, 81920
 s_waitcnt vmcnt(10)
 s_call_b64 s[44:45], RSUM
 s_movk_i32 s6, 64
 s_add_u32 s46, s50, 163840
 s_waitcnt vmcnt(3)
 s_call_b64 s[44:45], RSUM
 s_waitcnt vmcnt(3)
PL1:
 v_min3_u32 v104, v104, v105, v106
 v_cmp_gt_u32 vcc, 2, v104
 s_cbranch_vccz PL1y
 s_sleep 4
 buffer_load_dwordx4 v[104:107], v101, s[28:31], s47 offen sc1
 s_sub_u32 s42, s42, 1
 s_waitcnt vmcnt(0)
 s_cbranch_scc0 PL1
 s_endpgm
PL1y:
 s_add_u32 s46, s43, 8192
 buffer_load_dwordx4 v[112:115], v2, s[28:31], s46 offen sc1
 s_add_u32 s46, s46, 122880
 buffer_load_dwordx4 v[116:119], v2, s[28:31], s46 offen sc1
 s_add_u32 s46, s46, 122880
 buffer_load_dwordx4 v[120:123], v2, s[28:31], s46 offen sc1
 s_add_u32 s46, s46, 122880
 buffer_load_dwordx4 v[124:127], v2, s[28:31], s46 offen sc1
 s_add_u32 s46, s46, 122880
 buffer_load_dwordx4 v[128:131], v2, s[28:31], s46 offen sc1
 s_add_u32 s46, s46, 122880
 buffer_load_dwordx4 v[132:135], v2, s[28:31], s46 offen sc1
 s_add_u32 s46, s46, 122880
 buffer_load_dwordx4 v[136:139], v2, s[28:31], s46 offen sc1
 s_add_u32 s46, s46, 122880
 buffer_load_dwordx4 v[140:143], v2, s[28:31], s46 offen sc1
 s_add_u32 s46, s43, 49152
 buffer_load_dwordx4 v[144:147], v2, s[28:31], s46 offen sc1
 s_add_u32 s46, s46, 122880
 buffer_load_dwordx4 v[148:151], v2, s[28:31], s46 offen sc1
 s_add_u32 s46, s46, 122880
 buffer_load_dwordx4 v[152:155], v2, s[28:31], s46 offen sc1
 s_add_u32 s46, s46, 122880
 buffer_load_dwordx4 v[156:159], v2, s[28:31], s46 offen sc1
 s_add_u32 s46, s46, 122880
 buffer_load_dwordx4 v[160:163], v2, s[28:31], s46 offen sc1
 s_add_u32 s46, s46, 122880
 buffer_load_dwordx4 v[164:167], v2, s[28:31], s46 offen sc1
 s_add_u32 s46, s46, 122880
 buffer_load_dwordx4 v[168:171], v2, s[28:31], s46 offen sc1
 s_add_u32 s46, s46, 122880
 buffer_load_dwordx4 v[172:175], v2, s[28:31], s46 offen sc1
 s_add_u32 s46, s43, 90112
 buffer_load_dwordx4 v[176:179], v2, s[28:31], s46 offen sc1
 s_add_u32 s46, s46, 122880
 buffer_load_dwordx4 v[180:183], v2, s[28:31], s46 offen sc1
 s_add_u32 s46, s46, 122880
 buffer_load_dwordx4 v[184:187], v2, s[28:31], s46 offen sc1
 s_add_u32 s46, s46, 122880
 buffer_load_dwordx4 v[188:191], v2, s[28:31], s46 offen sc1
 s_add_u32 s46, s46, 122880
 buffer_load_dwordx4 v[192:195], v2, s[28:31], s46 offen sc1
 s_add_u32 s46, s46, 122880
 buffer_load_dwordx4 v[196:199], v2, s[28:31], s46 offen sc1
 s_add_u32 s46, s46, 122880
 buffer_load_dwordx4 v[200:203], v2, s[28:31], s46 offen sc1
 s_add_u32 s46, s46, 122880
 buffer_load_dwordx4 v[204:207], v2, s[28:31], s46 offen sc1
 s_movk_i32 s6, 0
 s_add_u32 s46, s50, 256
 s_waitcnt vmcnt(16)
 s_call_b64 s[44:45], RSUM
 s_movk_i32 s6, 32
 s_add_u32 s46, s50, 82176
 s_waitcnt vmcnt(9)
 s_call_b64 s[44:45], RSUM
 s_movk_i32 s6, 64
 s_add_u32 s46, s50, 164096
 s_waitcnt vmcnt(2)
 s_call_b64 s[44:45], RSUM
 s_endpgm
CONV:
 s_set_gpr_idx_on s60, gpr_idx(SRC0)
 v_accvgpr_read_b32 v136, a0
 v_accvgpr_read_b32 v137, a1
 v_accvgpr_read_b32 v138, a2
 v_accvgpr_read_b32 v139, a3
 v_accvgpr_read_b32 v140, a4
 v_accvgpr_read_b32 v141, a5
 v_accvgpr_read_b32 v142, a6
 v_accvgpr_read_b32 v143, a7
 v_accvgpr_read_b32 v144, a8
 v_accvgpr_read_b32 v145, a9
 v_accvgpr_read_b32 v146, a10
 v_accvgpr_read_b32 v147, a11
 v_accvgpr_read_b32 v148, a12
 v_accvgpr_read_b32 v149, a13
 v_accvgpr_read_b32 v150, a14
 v_accvgpr_read_b32 v151, a15
 s_set_gpr_idx_off
 s_add_u32 s60, s60, 16
 cvt v88, v136, v137
 cvt v89, v138, v139
 cvt v90, v140, v141
 cvt v91, v142, v143
 ds_write_b128 v87, v[88:91]
 cvt v92, v144, v145
 cvt v93, v146, v147
 cvt v94, v148, v149
 cvt v95, v150, v151
 ds_write_b128 v87, v[92:95] offset:1024
 v_add_u32 v87, 2048, v87
 s_cmp_lt_u32 s60, s61
 s_cbranch_scc1 CONV
 s_waitcnt lgkmcnt(0)
 s_setpc_b64 s[44:45]
RSUM:
 s_set_gpr_idx_on s6, gpr_idx(SRC1)
 v_lshlrev_b32 v16, 16, v112
 v_and_b32 v17, 0xffff0000, v112
 v_lshlrev_b32 v18, 16, v113
 v_and_b32 v19, 0xffff0000, v113
 v_lshlrev_b32 v20, 16, v114
 v_and_b32 v21, 0xffff0000, v114
 v_lshlrev_b32 v22, 16, v115
 v_and_b32 v23, 0xffff0000, v115
 s_set_gpr_idx_off
 s_set_gpr_idx_on s6, gpr_idx(SRC1)
 v_lshlrev_b32 v24, 16, v116
 v_and_b32 v25, 0xffff0000, v116
 v_lshlrev_b32 v26, 16, v117
 v_and_b32 v27, 0xffff0000, v117
 v_lshlrev_b32 v28, 16, v118
 v_and_b32 v29, 0xffff0000, v118
 v_lshlrev_b32 v30, 16, v119
 v_and_b32 v31, 0xffff0000, v119
 s_set_gpr_idx_off
 v_add_f32 v16, v16, v24
 v_add_f32 v17, v17, v25
 v_add_f32 v18, v18, v26
 v_add_f32 v19, v19, v27
 v_add_f32 v20, v20, v28
 v_add_f32 v21, v21, v29
 v_add_f32 v22, v22, v30
 v_add_f32 v23, v23, v31
 s_set_gpr_idx_on s6, gpr_idx(SRC1)
 v_lshlrev_b32 v24, 16, v120
 v_and_b32 v25, 0xffff0000, v120
 v_lshlrev_b32 v26, 16, v121
 v_and_b32 v27, 0xffff0000, v121
 v_lshlrev_b32 v28, 16, v122
 v_and_b32 v29, 0xffff0000, v122
 v_lshlrev_b32 v30, 16, v123
 v_and_b32 v31, 0xffff0000, v123
 s_set_gpr_idx_off
 v_add_f32 v16, v16, v24
 v_add_f32 v17, v17, v25
 v_add_f32 v18, v18, v26
 v_add_f32 v19, v19, v27
 v_add_f32 v20, v20, v28
 v_add_f32 v21, v21, v29
 v_add_f32 v22, v22, v30
 v_add_f32 v23, v23, v31
 s_set_gpr_idx_on s6, gpr_idx(SRC1)
 v_lshlrev_b32 v24, 16, v124
 v_and_b32 v25, 0xffff0000, v124
 v_lshlrev_b32 v26, 16, v125
 v_and_b32 v27, 0xffff0000, v125
 v_lshlrev_b32 v28, 16, v126
 v_and_b32 v29, 0xffff0000, v126
 v_lshlrev_b32 v30, 16, v127
 v_and_b32 v31, 0xffff0000, v127
 s_set_gpr_idx_off
 v_add_f32 v16, v16, v24
 v_add_f32 v17, v17, v25
 v_add_f32 v18, v18, v26
 v_add_f32 v19, v19, v27
 v_add_f32 v20, v20, v28
 v_add_f32 v21, v21, v29
 v_add_f32 v22, v22, v30
 v_add_f32 v23, v23, v31
 s_set_gpr_idx_on s6, gpr_idx(SRC1)
 v_lshlrev_b32 v24, 16, v128
 v_and_b32 v25, 0xffff0000, v128
 v_lshlrev_b32 v26, 16, v129
 v_and_b32 v27, 0xffff0000, v129
 v_lshlrev_b32 v28, 16, v130
 v_and_b32 v29, 0xffff0000, v130
 v_lshlrev_b32 v30, 16, v131
 v_and_b32 v31, 0xffff0000, v131
 s_set_gpr_idx_off
 v_add_f32 v16, v16, v24
 v_add_f32 v17, v17, v25
 v_add_f32 v18, v18, v26
 v_add_f32 v19, v19, v27
 v_add_f32 v20, v20, v28
 v_add_f32 v21, v21, v29
 v_add_f32 v22, v22, v30
 v_add_f32 v23, v23, v31
 s_set_gpr_idx_on s6, gpr_idx(SRC1)
 v_lshlrev_b32 v24, 16, v132
 v_and_b32 v25, 0xffff0000, v132
 v_lshlrev_b32 v26, 16, v133
 v_and_b32 v27, 0xffff0000, v133
 v_lshlrev_b32 v28, 16, v134
 v_and_b32 v29, 0xffff0000, v134
 v_lshlrev_b32 v30, 16, v135
 v_and_b32 v31, 0xffff0000, v135
 s_set_gpr_idx_off
 v_add_f32 v16, v16, v24
 v_add_f32 v17, v17, v25
 v_add_f32 v18, v18, v26
 v_add_f32 v19, v19, v27
 v_add_f32 v20, v20, v28
 v_add_f32 v21, v21, v29
 v_add_f32 v22, v22, v30
 v_add_f32 v23, v23, v31
 s_set_gpr_idx_on s6, gpr_idx(SRC1)
 v_lshlrev_b32 v24, 16, v136
 v_and_b32 v25, 0xffff0000, v136
 v_lshlrev_b32 v26, 16, v137
 v_and_b32 v27, 0xffff0000, v137
 v_lshlrev_b32 v28, 16, v138
 v_and_b32 v29, 0xffff0000, v138
 v_lshlrev_b32 v30, 16, v139
 v_and_b32 v31, 0xffff0000, v139
 s_set_gpr_idx_off
 v_add_f32 v16, v16, v24
 v_add_f32 v17, v17, v25
 v_add_f32 v18, v18, v26
 v_add_f32 v19, v19, v27
 v_add_f32 v20, v20, v28
 v_add_f32 v21, v21, v29
 v_add_f32 v22, v22, v30
 v_add_f32 v23, v23, v31
 s_set_gpr_idx_on s6, gpr_idx(SRC1)
 v_lshlrev_b32 v24, 16, v140
 v_and_b32 v25, 0xffff0000, v140
 v_lshlrev_b32 v26, 16, v141
 v_and_b32 v27, 0xffff0000, v141
 v_lshlrev_b32 v28, 16, v142
 v_and_b32 v29, 0xffff0000, v142
 v_lshlrev_b32 v30, 16, v143
 v_and_b32 v31, 0xffff0000, v143
 s_set_gpr_idx_off
 v_add_f32 v16, v16, v24
 v_add_f32 v17, v17, v25
 v_add_f32 v18, v18, v26
 v_add_f32 v19, v19, v27
 v_add_f32 v20, v20, v28
 v_add_f32 v21, v21, v29
 v_add_f32 v22, v22, v30
 v_add_f32 v23, v23, v31
 cvt v24, v16, v17
 cvt v25, v18, v19
 cvt v26, v20, v21
 cvt v27, v22, v23
 s_nop 0
 v_permlane16_swap_b32 v24, v26
 v_permlane16_swap_b32 v25, v27
 buffer_store_dwordx4 v[24:27], v5, s[88:91], s46 offen
 s_setpc_b64 s[44:45]
EXIT:
 s_endpgm
AW:
 s_getpc_b64 s[44:45]
CPF:
 s_sub_u32 s44, s44, CPF-LOADER
 s_subb_u32 s45, s45, 0
 s_lshr_b32 s46, s2, 3
 s_mul_i32 s46, s46, 3
 s_add_u32 s46, s46, s32
 v_and_b32 v120, 63, v0
 v_min_u32 v120, 13, v120
 v_mul_u32_u24 v120, 96, v120
 v_add_u32 v120, s46, v120
 v_lshlrev_b32 v120, 7, v120
 v_min_u32 v120, CODEEND-LOADER-4, v120
 v_mov_b32 v121, s45
 v_add_co_u32 v120, vcc, s44, v120
 s_nop 1
 v_addc_co_u32 v121, vcc, 0, v121, vcc
 global_load_dword v206, v[120:121], off
 v_and_b32 v100, 63, v0
 v_lshrrev_b32 v103, 5, v100
 v_bfe_u32 v104, v100, 4, 1
 v_bfe_u32 v101, v100, 2, 2
 v_and_b32 v102, 3, v100
 v_lshrrev_b32 v105, 1, v101
 v_and_b32 v108, 31, v100
 v_bfe_u32 v109, v100, 1, 3
 v_mul_u32_u24 v110, 384, v108
 v_add_u32 v110, 49152, v110
 s_lshl_b32 s46, s32, 12
 v_lshlrev_b32 v111, 7, v108
 v_add_u32 v111, s46, v111
 v_add_u32 v106, 0, v103
 v_xor_b32 v106, v106, v109
 v_lshlrev_b32 v106, 4, v106
 v_add_u32 v202, v111, v106
 v_add_u32 v106, 2, v103
 v_xor_b32 v106, v106, v109
 v_lshlrev_b32 v106, 4, v106
 v_add_u32 v203, v111, v106
 v_add_u32 v106, 4, v103
 v_xor_b32 v106, v106, v109
 v_lshlrev_b32 v106, 4, v106
 v_add_u32 v204, v111, v106
 v_add_u32 v106, 6, v103
 v_xor_b32 v106, v106, v109
 v_lshlrev_b32 v106, 4, v106
 v_add_u32 v205, v111, v106
 v_lshrrev_b32 v112, 1, v102
 v_and_b32 v113, 1, v102
 v_lshl_add_u32 v112, v113, 1, v112
 v_lshlrev_b32 v113, 5, v104
 v_lshl_add_u32 v114, v102, 3, v113
 v_lshl_add_u32 v115, v112, 3, v113
 v_lshl_add_u32 v116, v103, 2, v101
 v_lshl_add_u32 v117, v103, 3, v101
 v_xor_b32 v106, 0, v105
 v_lshlrev_b32 v106, 6, v106
 v_mul_u32_u24 v107, 384, v117
 v_add3_u32 v200, v107, v115, v106
 v_xor_b32 v106, 1, v105
 v_lshlrev_b32 v106, 6, v106
 v_mul_u32_u24 v107, 384, v117
 v_add3_u32 v201, v107, v115, v106
 v_and_b32 v108, 15, v100
 v_mul_u32_u24 v110, 384, v108
 v_add_u32 v110, 49152, v110
 v_bfe_u32 v109, v100, 1, 1
 v_bfe_u32 v111, v100, 2, 1
 v_lshl_add_u32 v109, v109, 1, v111
 v_bfe_u32 v111, v100, 3, 1
 v_lshl_add_u32 v109, v111, 2, v109
 v_lshl_add_u32 v111, v104, 1, v103
 v_add_u32 v106, 0, v111
 v_xor_b32 v106, v106, v109
 v_lshl_add_u32 v240, v106, 4, v110
 v_add_u32 v106, 4, v111
 v_xor_b32 v106, v106, v109
 v_lshl_add_u32 v241, v106, 4, v110
 v_lshrrev_b32 v108, 2, v100
 v_mul_u32_u24 v110, 384, v108
 v_lshl_add_u32 v110, v102, 3, v110
 v_add_u32 v110, 86016, v110
 v_bfe_u32 v109, v100, 3, 2
 v_lshlrev_b32 v111, 7, v108
 v_lshl_add_u32 v111, v102, 3, v111
 v_xor_b32 v106, 0, v109
 v_lshl_add_u32 v242, v106, 5, v110
 v_lshl_add_u32 v172, v106, 5, v111
 v_xor_b32 v106, 1, v109
 v_lshl_add_u32 v243, v106, 5, v110
 v_lshl_add_u32 v173, v106, 5, v111
 v_xor_b32 v106, 2, v109
 v_lshl_add_u32 v244, v106, 5, v110
 v_lshl_add_u32 v174, v106, 5, v111
 v_xor_b32 v106, 3, v109
 v_lshl_add_u32 v245, v106, 5, v110
 v_lshl_add_u32 v175, v106, 5, v111
 s_lshl_b32 s41, s35, 4
 s_add_u32 s41, s41, s33
 s_lshl_b32 s41, s41, 3
 s_add_u32 s41, s41, s34
 s_mul_i32 s41, s41, 3
 s_add_u32 s41, s41, s32
 s_mul_i32 s41, s41, 40960
 s_mov_b32 s36, 0x3dd53b95
 s_mov_b32 s37, 0x45800000
 s_mov_b32 s38, 0
 s_mul_i32 s87, s32, 12288
 s_add_u32 s87, s87, 122880
 s_lshl_b32 s39, s40, 3
 s_add_u32 s39, s39, s34
 s_lshl_b32 s39, s39, 5
 s_add_u32 s39, s39, s32
 s_lshl_b32 s39, s39, 2
 s_add_u32 s39, s39, 33554432
 v_lshlrev_b32 v106, 26, v100
 v_mov_b32 v107, 0
 buffer_store_dword v107, v106, s[28:31], s39 offen sc1
 s_lshl_b32 s51, s40, 3
 s_add_u32 s51, s51, s34
 v_add_u32 v176, 0x1e000, v202
 v_add_u32 v177, 0x1e000, v203
 s_waitcnt lgkmcnt(0)
 s_barrier
 ds_read_b128 v[192:195], v176
 rtr a[224:225], v200
 rtr a[226:227], v200, 1536
 rtr a[228:229], v201
 rtr a[230:231], v201, 1536
 rtr a[232:233], v200, 128
 rtr a[234:235], v200, 1664
 rtr a[236:237], v201, 128
 rtr a[238:239], v201, 1664
 rtr a[240:241], v200, 256
 rtr a[242:243], v200, 1792
 rtr a[244:245], v201, 256
 rtr a[246:247], v201, 1792
 ds_read_b128 v[196:199], v177
 rtr a[248:249], v200, 6144
 s_waitcnt lgkmcnt(12)
 m32 v[0:15], a[224:227], v[192:195], 0
 rtr a[250:251], v200, 7680
 rtr a[252:253], v201, 6144
 rtr a[254:255], v201, 7680
 v_accvgpr_write_b32 a96, 0
 v_accvgpr_write_b32 a97, 0
 s_waitcnt lgkmcnt(13)
 m32 v[16:31], a[228:231], v[192:195], 0
 rtr a[224:225], v200, 6272
 rtr a[226:227], v200, 7808
 rtr a[228:229], v201, 6272
 v_accvgpr_write_b32 a98, 0
 v_accvgpr_write_b32 a99, 0
 s_waitcnt lgkmcnt(6)
 m32 v[32:47], a[232:235], v[192:195], 0
 rtr a[230:231], v201, 7808
 rtr a[232:233], v200, 6400
 rtr a[234:235], v200, 7936
 v_accvgpr_write_b32 a100, 0
 v_accvgpr_write_b32 a101, 0
 v_accvgpr_write_b32 a102, 0
 m32 v[48:63], a[236:239], v[192:195], 0
 rtr a[236:237], v201, 6400
 rtr a[238:239], v201, 7936
 v_accvgpr_write_b32 a103, 0
 v_accvgpr_write_b32 a104, 0
 v_accvgpr_write_b32 a105, 0
 v_accvgpr_write_b32 a106, 0
 m32 v[64:79], a[240:243], v[192:195], 0
 v_accvgpr_write_b32 a107, 0
 v_accvgpr_write_b32 a108, 0
 v_accvgpr_write_b32 a109, 0
 v_accvgpr_write_b32 a110, 0
 v_accvgpr_write_b32 a111, 0
 v_accvgpr_write_b32 a112, 0
 m32 v[80:95], a[244:247], v[192:195], 0
 v_add_u32 v177, 0x1e000, v205
 v_accvgpr_write_b32 a113, 0
 v_accvgpr_write_b32 a114, 0
 v_accvgpr_write_b32 a115, 0
 v_accvgpr_write_b32 a116, 0
 s_waitcnt lgkmcnt(0)
 m32 v[0:15], a[248:251], v[196:199], v[0:15]
 v_add_u32 v176, 0x1e000, v204
 v_accvgpr_write_b32 a117, 0
 v_accvgpr_write_b32 a118, 0
 v_accvgpr_write_b32 a119, 0
 s_barrier
 m32 v[16:31], a[252:255], v[196:199], v[16:31]
 ds_read_b128 v[192:195], v176
 rtr a[240:241], v200, 12288
 rtr a[242:243], v200, 13824
 v_accvgpr_write_b32 a120, 0
 v_accvgpr_write_b32 a121, 0
 v_accvgpr_write_b32 a122, 0
 m32 v[32:47], a[224:227], v[196:199], v[32:47]
 rtr a[244:245], v201, 12288
 rtr a[246:247], v201, 13824
 rtr a[248:249], v200, 12416
 v_accvgpr_write_b32 a123, 0
 v_accvgpr_write_b32 a124, 0
 v_accvgpr_write_b32 a125, 0
 m32 v[48:63], a[228:231], v[196:199], v[48:63]
 rtr a[250:251], v200, 13952
 rtr a[252:253], v201, 12416
 rtr a[254:255], v201, 13952
 v_accvgpr_write_b32 a126, 0
 v_accvgpr_write_b32 a127, 0
 v_accvgpr_write_b32 a128, 0
 m32 v[64:79], a[232:235], v[196:199], v[64:79]
 rtr a[224:225], v200, 12544
 rtr a[226:227], v200, 14080
 rtr a[228:229], v201, 12544
 v_accvgpr_write_b32 a129, 0
 v_accvgpr_write_b32 a130, 0
 v_accvgpr_write_b32 a131, 0
 m32 v[80:95], a[236:239], v[196:199], v[80:95]
 rtr a[230:231], v201, 14080
 ds_read_b128 v[196:199], v177
 rtr a[232:233], v200, 18432
 v_accvgpr_write_b32 a132, 0
 v_accvgpr_write_b32 a133, 0
 s_waitcnt lgkmcnt(6)
 m32 v[0:15], a[240:243], v[192:195], v[0:15]
 rtr a[234:235], v200, 19968
 rtr a[236:237], v201, 18432
 rtr a[238:239], v201, 19968
 v_accvgpr_write_b32 a134, 0
 v_accvgpr_write_b32 a135, 0
 v_accvgpr_write_b32 a136, 0
 m32 v[16:31], a[244:247], v[192:195], v[16:31]
 rtr a[240:241], v200, 18560
 rtr a[242:243], v200, 20096
 rtr a[244:245], v201, 18560
 v_accvgpr_write_b32 a137, 0
 v_accvgpr_write_b32 a138, 0
 v_accvgpr_write_b32 a139, 0
 m32 v[32:47], a[248:251], v[192:195], v[32:47]
 rtr a[246:247], v201, 20096
 rtr a[248:249], v200, 18688
 rtr a[250:251], v200, 20224
 v_accvgpr_write_b32 a140, 0
 v_accvgpr_write_b32 a141, 0
 v_accvgpr_write_b32 a142, 0
 m32 v[48:63], a[252:255], v[192:195], v[48:63]
 rtr a[252:253], v201, 18688
 rtr a[254:255], v201, 20224
 v_accvgpr_write_b32 a143, 0
 v_accvgpr_write_b32 a144, 0
 v_accvgpr_write_b32 a145, 0
 s_waitcnt lgkmcnt(5)
 m32 v[64:79], a[224:227], v[192:195], v[64:79]
 v_accvgpr_write_b32 a146, 0
 v_accvgpr_write_b32 a147, 0
 v_accvgpr_write_b32 a148, 0
 v_accvgpr_write_b32 a149, 0
 v_accvgpr_write_b32 a150, 0
 v_accvgpr_write_b32 a151, 0
 m32 v[80:95], a[228:231], v[192:195], v[80:95]
 v_add_u32 v177, 0x21000, v201
 v_accvgpr_write_b32 a152, 0
 v_accvgpr_write_b32 a153, 0
 v_accvgpr_write_b32 a154, 0
 v_accvgpr_write_b32 a155, 0
 v_accvgpr_write_b32 a156, 0
 m32 v[0:15], a[232:235], v[196:199], v[0:15]
 v_add_u32 v176, 0x21000, v200
 v_accvgpr_write_b32 a157, 0
 v_accvgpr_write_b32 a158, 0
 s_waitcnt lgkmcnt(0)
 s_barrier
 m32 v[16:31], a[236:239], v[196:199], v[16:31]
 ds_read_b128 v[192:195], v202 offset:36864
 rtr a[224:225], v176
 rtr a[226:227], v176, 1536
 v_accvgpr_write_b32 a159, 0
 v_accvgpr_write_b32 a160, 0
 v_accvgpr_write_b32 a161, 0
 m32 v[32:47], a[240:243], v[196:199], v[32:47]
 rtr a[228:229], v177
 rtr a[230:231], v177, 1536
 rtr a[232:233], v176, 128
 v_accvgpr_write_b32 a162, 0
 v_accvgpr_write_b32 a163, 0
 v_accvgpr_write_b32 a164, 0
 m32 v[48:63], a[244:247], v[196:199], v[48:63]
 rtr a[234:235], v176, 1664
 rtr a[236:237], v177, 128
 rtr a[238:239], v177, 1664
 v_accvgpr_write_b32 a165, 0
 v_accvgpr_write_b32 a166, 0
 v_accvgpr_write_b32 a167, 0
 m32 v[64:79], a[248:251], v[196:199], v[64:79]
 rtr a[240:241], v176, 256
 rtr a[242:243], v176, 1792
 rtr a[244:245], v177, 256
 v_accvgpr_write_b32 a168, 0
 v_accvgpr_write_b32 a169, 0
 v_accvgpr_write_b32 a170, 0
 m32 v[80:95], a[252:255], v[196:199], v[80:95]
 rtr a[246:247], v177, 1792
 ds_read_b128 v[196:199], v203 offset:36864
 rtr a[248:249], v176, 6144
 v_accvgpr_write_b32 a171, 0
 v_accvgpr_write_b32 a172, 0
 s_waitcnt lgkmcnt(6)
 m32 v[0:15], a[224:227], v[192:195], v[0:15]
 rtr a[250:251], v176, 7680
 rtr a[252:253], v177, 6144
 rtr a[254:255], v177, 7680
 v_accvgpr_write_b32 a173, 0
 v_accvgpr_write_b32 a174, 0
 v_accvgpr_write_b32 a175, 0
 m32 v[16:31], a[228:231], v[192:195], v[16:31]
 rtr a[224:225], v176, 6272
 rtr a[226:227], v176, 7808
 rtr a[228:229], v177, 6272
 v_accvgpr_write_b32 a176, 0
 v_accvgpr_write_b32 a177, 0
 v_accvgpr_write_b32 a178, 0
 m32 v[32:47], a[232:235], v[192:195], v[32:47]
 rtr a[230:231], v177, 7808
 rtr a[232:233], v176, 6400
 rtr a[234:235], v176, 7936
 v_accvgpr_write_b32 a179, 0
 v_accvgpr_write_b32 a180, 0
 v_accvgpr_write_b32 a181, 0
 m32 v[48:63], a[236:239], v[192:195], v[48:63]
 rtr a[236:237], v177, 6400
 rtr a[238:239], v177, 7936
 v_accvgpr_write_b32 a182, 0
 v_accvgpr_write_b32 a183, 0
 v_accvgpr_write_b32 a184, 0
 s_waitcnt lgkmcnt(5)
 m32 v[64:79], a[240:243], v[192:195], v[64:79]
 v_accvgpr_write_b32 a185, 0
 v_accvgpr_write_b32 a186, 0
 v_accvgpr_write_b32 a187, 0
 v_accvgpr_write_b32 a188, 0
 v_accvgpr_write_b32 a189, 0
 v_accvgpr_write_b32 a190, 0
 m32 v[80:95], a[244:247], v[192:195], v[80:95]
 v_add_u32 v177, 0x24000, v201
 v_accvgpr_write_b32 a191, 0
 v_accvgpr_write_b32 a192, 0
 v_accvgpr_write_b32 a193, 0
 v_accvgpr_write_b32 a194, 0
 v_accvgpr_write_b32 a195, 0
 m32 v[0:15], a[248:251], v[196:199], v[0:15]
 v_add_u32 v176, 0x24000, v200
 v_accvgpr_write_b32 a196, 0
 v_accvgpr_write_b32 a197, 0
 s_waitcnt lgkmcnt(0)
 s_barrier
 m32 v[16:31], a[252:255], v[196:199], v[16:31]
 ds_read_b128 v[192:195], v204 offset:36864
 rtr a[240:241], v176
 rtr a[242:243], v176, 1536
 v_accvgpr_write_b32 a198, 0
 v_accvgpr_write_b32 a199, 0
 v_accvgpr_write_b32 a200, 0
 m32 v[32:47], a[224:227], v[196:199], v[32:47]
 rtr a[244:245], v177
 rtr a[246:247], v177, 1536
 rtr a[248:249], v176, 128
 v_accvgpr_write_b32 a201, 0
 v_accvgpr_write_b32 a202, 0
 v_accvgpr_write_b32 a203, 0
 m32 v[48:63], a[228:231], v[196:199], v[48:63]
 rtr a[250:251], v176, 1664
 rtr a[252:253], v177, 128
 rtr a[254:255], v177, 1664
 v_accvgpr_write_b32 a204, 0
 v_accvgpr_write_b32 a205, 0
 v_accvgpr_write_b32 a206, 0
 m32 v[64:79], a[232:235], v[196:199], v[64:79]
 rtr a[224:225], v176, 256
 rtr a[226:227], v176, 1792
 rtr a[228:229], v177, 256
 v_accvgpr_write_b32 a207, 0
 v_accvgpr_write_b32 a208, 0
 v_accvgpr_write_b32 a209, 0
 m32 v[80:95], a[236:239], v[196:199], v[80:95]
 rtr a[230:231], v177, 1792
 ds_read_b128 v[196:199], v205 offset:36864
 rtr a[232:233], v176, 6144
 v_accvgpr_write_b32 a210, 0
 v_accvgpr_write_b32 a211, 0
 s_waitcnt lgkmcnt(6)
 m32 v[0:15], a[240:243], v[192:195], v[0:15]
 rtr a[234:235], v176, 7680
 rtr a[236:237], v177, 6144
 rtr a[238:239], v177, 7680
 v_accvgpr_write_b32 a212, 0
 v_accvgpr_write_b32 a213, 0
 v_accvgpr_write_b32 a214, 0
 m32 v[16:31], a[244:247], v[192:195], v[16:31]
 rtr a[240:241], v176, 6272
 rtr a[242:243], v176, 7808
 rtr a[244:245], v177, 6272
 v_accvgpr_write_b32 a215, 0
 v_accvgpr_write_b32 a216, 0
 v_accvgpr_write_b32 a217, 0
 m32 v[32:47], a[248:251], v[192:195], v[32:47]
 rtr a[246:247], v177, 7808
 rtr a[248:249], v176, 6400
 rtr a[250:251], v176, 7936
 v_accvgpr_write_b32 a218, 0
 v_accvgpr_write_b32 a219, 0
 v_accvgpr_write_b32 a220, 0
 m32 v[48:63], a[252:255], v[192:195], v[48:63]
 rtr a[252:253], v177, 6400
 rtr a[254:255], v177, 7936
 v_accvgpr_write_b32 a221, 0
 v_accvgpr_write_b32 a222, 0
 v_accvgpr_write_b32 a223, 0
 s_waitcnt lgkmcnt(5)
 m32 v[64:79], a[224:227], v[192:195], v[64:79]
 v_mov_b32 v208, 0
 v_mov_b32 v209, 0
 v_mov_b32 v210, 0
 v_mov_b32 v211, 0
 v_mov_b32 v212, 0
 v_mov_b32 v213, 0
 m32 v[80:95], a[228:231], v[192:195], v[80:95]
 v_mov_b32 v214, 0
 v_mov_b32 v215, 0
 v_mov_b32 v216, 0
 v_mov_b32 v217, 0
 v_mov_b32 v218, 0
 v_mov_b32 v219, 0
 m32 v[0:15], a[232:235], v[196:199], v[0:15]
 v_mov_b32 v220, 0
 v_mov_b32 v221, 0
 v_mov_b32 v222, 0
 s_waitcnt lgkmcnt(0)
 s_barrier
 m32 v[16:31], a[236:239], v[196:199], v[16:31]
 ds_read_b128 v[192:195], v202 offset:24576
 rtr a[224:225], v200
 rtr a[226:227], v200, 1536
 v_mov_b32 v223, 0
 v_mov_b32 v224, 0
 v_mov_b32 v225, 0
 m32 v[32:47], a[240:243], v[196:199], v[32:47]
 rtr a[228:229], v201
 rtr a[230:231], v201, 1536
 rtr a[232:233], v200, 128
 v_mov_b32 v226, 0
 v_mov_b32 v227, 0
 v_mov_b32 v228, 0
 m32 v[48:63], a[244:247], v[196:199], v[48:63]
 rtr a[234:235], v200, 1664
 rtr a[236:237], v201, 128
 rtr a[238:239], v201, 1664
 v_mov_b32 v229, 0
 v_mov_b32 v230, 0
 v_mov_b32 v231, 0
 m32 v[64:79], a[248:251], v[196:199], v[64:79]
 rtr a[240:241], v200, 256
 rtr a[242:243], v200, 1792
 rtr a[244:245], v201, 256
 v_mov_b32 v232, 0
 v_mov_b32 v233, 0
 v_mov_b32 v234, 0
 m32 v[80:95], a[252:255], v[196:199], v[80:95]
 rtr a[246:247], v201, 1792
 ds_read_b128 v[196:199], v203 offset:24576
 rtr a[248:249], v200, 6144
 v_mov_b32 v235, 0
 v_mov_b32 v236, 0
 s_waitcnt lgkmcnt(6)
 m32 v[0:15], a[224:227], v[192:195], v[0:15]
 rtr a[250:251], v200, 7680
 rtr a[252:253], v201, 6144
 rtr a[254:255], v201, 7680
 v_mov_b32 v237, 0
 v_mov_b32 v238, 0
 v_mov_b32 v239, 0
 m32 v[16:31], a[228:231], v[192:195], v[16:31]
 rtr a[224:225], v200, 6272
 rtr a[226:227], v200, 7808
 rtr a[228:229], v201, 6272
 m32 v[32:47], a[232:235], v[192:195], v[32:47]
 rtr a[230:231], v201, 7808
 rtr a[232:233], v200, 6400
 rtr a[234:235], v200, 7936
 m32 v[48:63], a[236:239], v[192:195], v[48:63]
 rtr a[236:237], v201, 6400
 rtr a[238:239], v201, 7936
 s_waitcnt lgkmcnt(5)
 m32 v[64:79], a[240:243], v[192:195], v[64:79]
 m32 v[80:95], a[244:247], v[192:195], v[80:95]
 m32 v[0:15], a[248:251], v[196:199], v[0:15]
 s_waitcnt lgkmcnt(0)
 s_barrier
 m32 v[16:31], a[252:255], v[196:199], v[16:31]
 ds_read_b128 v[192:195], v204 offset:24576
 rtr a[240:241], v200, 12288
 rtr a[242:243], v200, 13824
 m32 v[32:47], a[224:227], v[196:199], v[32:47]
 rtr a[244:245], v201, 12288
 rtr a[246:247], v201, 13824
 rtr a[248:249], v200, 12416
 m32 v[48:63], a[228:231], v[196:199], v[48:63]
 rtr a[250:251], v200, 13952
 rtr a[252:253], v201, 12416
 rtr a[254:255], v201, 13952
 m32 v[64:79], a[232:235], v[196:199], v[64:79]
 rtr a[224:225], v200, 12544
 rtr a[226:227], v200, 14080
 rtr a[228:229], v201, 12544
 m32 v[80:95], a[236:239], v[196:199], v[80:95]
 rtr a[230:231], v201, 14080
 ds_read_b128 v[196:199], v205 offset:24576
 rtr a[232:233], v200, 18432
 s_waitcnt lgkmcnt(6)
 m32 v[0:15], a[240:243], v[192:195], v[0:15]
 rtr a[234:235], v200, 19968
 rtr a[236:237], v201, 18432
 rtr a[238:239], v201, 19968
 m32 v[16:31], a[244:247], v[192:195], v[16:31]
 rtr a[240:241], v200, 18560
 rtr a[242:243], v200, 20096
 rtr a[244:245], v201, 18560
 m32 v[32:47], a[248:251], v[192:195], v[32:47]
 rtr a[246:247], v201, 20096
 rtr a[248:249], v200, 18688
 rtr a[250:251], v200, 20224
 m32 v[48:63], a[252:255], v[192:195], v[48:63]
 rtr a[252:253], v201, 18688
 rtr a[254:255], v201, 20224
 s_waitcnt lgkmcnt(5)
 m32 v[64:79], a[224:227], v[192:195], v[64:79]
 m32 v[80:95], a[228:231], v[192:195], v[80:95]
 v_add_u32 v177, 0x21000, v201
 v_add_u32 v179, 0x18000, v203
 m32 v[0:15], a[232:235], v[196:199], v[0:15]
 v_add_u32 v176, 0x21000, v200
 v_add_u32 v178, 0x18000, v202
 s_waitcnt lgkmcnt(0)
 s_barrier
 m32 v[16:31], a[236:239], v[196:199], v[16:31]
 ds_read_b128 v[192:195], v178
 rtr a[224:225], v176
 rtr a[226:227], v176, 1536
 m32 v[32:47], a[240:243], v[196:199], v[32:47]
 rtr a[228:229], v177
 rtr a[230:231], v177, 1536
 rtr a[232:233], v176, 128
 m32 v[48:63], a[244:247], v[196:199], v[48:63]
 rtr a[234:235], v176, 1664
 rtr a[236:237], v177, 128
 rtr a[238:239], v177, 1664
 m32 v[64:79], a[248:251], v[196:199], v[64:79]
 rtr a[240:241], v176, 256
 rtr a[242:243], v176, 1792
 rtr a[244:245], v177, 256
 m32 v[80:95], a[252:255], v[196:199], v[80:95]
 rtr a[246:247], v177, 1792
 ds_read_b128 v[196:199], v179
 rtr a[248:249], v176, 6144
 s_waitcnt lgkmcnt(6)
 m32 v[0:15], a[224:227], v[192:195], v[0:15]
 rtr a[250:251], v176, 7680
 rtr a[252:253], v177, 6144
 rtr a[254:255], v177, 7680
 m32 v[16:31], a[228:231], v[192:195], v[16:31]
 rtr a[224:225], v176, 6272
 rtr a[226:227], v176, 7808
 rtr a[228:229], v177, 6272
 m32 v[32:47], a[232:235], v[192:195], v[32:47]
 rtr a[230:231], v177, 7808
 rtr a[232:233], v176, 6400
 rtr a[234:235], v176, 7936
 m32 v[48:63], a[236:239], v[192:195], v[48:63]
 rtr a[236:237], v177, 6400
 rtr a[238:239], v177, 7936
 s_waitcnt lgkmcnt(5)
 m32 v[64:79], a[240:243], v[192:195], v[64:79]
 m32 v[80:95], a[244:247], v[192:195], v[80:95]
 v_add_u32 v177, 0x24000, v201
 v_add_u32 v179, 0x18000, v205
 m32 v[0:15], a[248:251], v[196:199], v[0:15]
 v_add_u32 v176, 0x24000, v200
 v_add_u32 v178, 0x18000, v204
 s_waitcnt lgkmcnt(0)
 s_barrier
 m32 v[16:31], a[252:255], v[196:199], v[16:31]
 ds_read_b128 v[192:195], v178
 rtr a[240:241], v176
 rtr a[242:243], v176, 1536
 m32 v[32:47], a[224:227], v[196:199], v[32:47]
 rtr a[244:245], v177
 rtr a[246:247], v177, 1536
 rtr a[248:249], v176, 128
 m32 v[48:63], a[228:231], v[196:199], v[48:63]
 rtr a[250:251], v176, 1664
 rtr a[252:253], v177, 128
 rtr a[254:255], v177, 1664
 m32 v[64:79], a[232:235], v[196:199], v[64:79]
 rtr a[224:225], v176, 256
 rtr a[226:227], v176, 1792
 rtr a[228:229], v177, 256
 m32 v[80:95], a[236:239], v[196:199], v[80:95]
 rtr a[230:231], v177, 1792
 ds_read_b128 v[196:199], v179
 rtr a[232:233], v176, 6144
 s_waitcnt lgkmcnt(6)
 m32 v[0:15], a[240:243], v[192:195], v[0:15]
 rtr a[234:235], v176, 7680
 rtr a[236:237], v177, 6144
 rtr a[238:239], v177, 7680
 m32 v[16:31], a[244:247], v[192:195], v[16:31]
 rtr a[240:241], v176, 6272
 rtr a[242:243], v176, 7808
 rtr a[244:245], v177, 6272
 m32 v[32:47], a[248:251], v[192:195], v[32:47]
 rtr a[246:247], v177, 7808
 rtr a[248:249], v176, 6400
 rtr a[250:251], v176, 7936
 m32 v[48:63], a[252:255], v[192:195], v[48:63]
 rtr a[252:253], v177, 6400
 rtr a[254:255], v177, 7936
 s_waitcnt lgkmcnt(5)
 m32 v[64:79], a[224:227], v[192:195], v[64:79]
 m32 v[80:95], a[228:231], v[192:195], v[80:95]
 v_add_u32 v177, 0x1b000, v203
 m32 v[0:15], a[232:235], v[196:199], v[0:15]
 v_add_u32 v176, 0x1b000, v202
 s_waitcnt lgkmcnt(0)
 s_barrier
 m32 v[16:31], a[236:239], v[196:199], v[16:31]
 ds_read_b128 v[192:195], v176
 rtr a[224:225], v200
 rtr a[226:227], v200, 1536
 m32 v[32:47], a[240:243], v[196:199], v[32:47]
 rtr a[228:229], v201
 rtr a[230:231], v201, 1536
 rtr a[232:233], v200, 128
 m32 v[48:63], a[244:247], v[196:199], v[48:63]
 rtr a[234:235], v200, 1664
 rtr a[236:237], v201, 128
 rtr a[238:239], v201, 1664
 m32 v[64:79], a[248:251], v[196:199], v[64:79]
 rtr a[240:241], v200, 256
 rtr a[242:243], v200, 1792
 rtr a[244:245], v201, 256
 m32 v[80:95], a[252:255], v[196:199], v[80:95]
 rtr a[246:247], v201, 1792
 ds_read_b128 v[196:199], v177
 rtr a[248:249], v200, 6144
 s_waitcnt lgkmcnt(6)
 m32 v[0:15], a[224:227], v[192:195], v[0:15]
 rtr a[250:251], v200, 7680
 rtr a[252:253], v201, 6144
 rtr a[254:255], v201, 7680
 m32 v[16:31], a[228:231], v[192:195], v[16:31]
 rtr a[224:225], v200, 6272
 rtr a[226:227], v200, 7808
 rtr a[228:229], v201, 6272
 m32 v[32:47], a[232:235], v[192:195], v[32:47]
 rtr a[230:231], v201, 7808
 rtr a[232:233], v200, 6400
 rtr a[234:235], v200, 7936
 m32 v[48:63], a[236:239], v[192:195], v[48:63]
 rtr a[236:237], v201, 6400
 rtr a[238:239], v201, 7936
 s_waitcnt lgkmcnt(5)
 m32 v[64:79], a[240:243], v[192:195], v[64:79]
 m32 v[80:95], a[244:247], v[192:195], v[80:95]
 v_add_u32 v177, 0x1b000, v205
 m32 v[0:15], a[248:251], v[196:199], v[0:15]
 v_add_u32 v176, 0x1b000, v204
 s_waitcnt lgkmcnt(0)
 s_barrier
 m32 v[16:31], a[252:255], v[196:199], v[16:31]
 ds_read_b128 v[192:195], v176
 rtr a[240:241], v200, 12288
 rtr a[242:243], v200, 13824
 m32 v[32:47], a[224:227], v[196:199], v[32:47]
 rtr a[244:245], v201, 12288
 rtr a[246:247], v201, 13824
 rtr a[248:249], v200, 12416
 m32 v[48:63], a[228:231], v[196:199], v[48:63]
 rtr a[250:251], v200, 13952
 rtr a[252:253], v201, 12416
 rtr a[254:255], v201, 13952
 m32 v[64:79], a[232:235], v[196:199], v[64:79]
 rtr a[224:225], v200, 12544
 rtr a[226:227], v200, 14080
 rtr a[228:229], v201, 12544
 m32 v[80:95], a[236:239], v[196:199], v[80:95]
 rtr a[230:231], v201, 14080
 ds_read_b128 v[196:199], v177
 rtr a[232:233], v200, 18432
 s_waitcnt lgkmcnt(6)
 m32 v[0:15], a[240:243], v[192:195], v[0:15]
 rtr a[234:235], v200, 19968
 rtr a[236:237], v201, 18432
 rtr a[238:239], v201, 19968
 m32 v[16:31], a[244:247], v[192:195], v[16:31]
 rtr a[240:241], v200, 18560
 rtr a[242:243], v200, 20096
 rtr a[244:245], v201, 18560
 m32 v[32:47], a[248:251], v[192:195], v[32:47]
 rtr a[246:247], v201, 20096
 rtr a[248:249], v200, 18688
 rtr a[250:251], v200, 20224
 m32 v[48:63], a[252:255], v[192:195], v[48:63]
 rtr a[252:253], v201, 18688
 rtr a[254:255], v201, 20224
 s_waitcnt lgkmcnt(5)
 m32 v[64:79], a[224:227], v[192:195], v[64:79]
 m32 v[80:95], a[228:231], v[192:195], v[80:95]
 v_add_u32 v177, 0x21000, v201
 v_add_u32 v179, 0x1e000, v203
 m32 v[0:15], a[232:235], v[196:199], v[0:15]
 v_add_u32 v176, 0x21000, v200
 v_add_u32 v178, 0x1e000, v202
 s_waitcnt lgkmcnt(0)
 s_barrier
 m32 v[16:31], a[236:239], v[196:199], v[16:31]
 ds_read_b128 v[192:195], v178
 rtr a[224:225], v176
 rtr a[226:227], v176, 1536
 m32 v[32:47], a[240:243], v[196:199], v[32:47]
 rtr a[228:229], v177
 rtr a[230:231], v177, 1536
 rtr a[232:233], v176, 128
 m32 v[48:63], a[244:247], v[196:199], v[48:63]
 rtr a[234:235], v176, 1664
 rtr a[236:237], v177, 128
 rtr a[238:239], v177, 1664
 m32 v[64:79], a[248:251], v[196:199], v[64:79]
 rtr a[240:241], v176, 256
 rtr a[242:243], v176, 1792
 rtr a[244:245], v177, 256
 m32 v[80:95], a[252:255], v[196:199], v[80:95]
 rtr a[246:247], v177, 1792
 ds_read_b128 v[196:199], v179
 rtr a[248:249], v176, 6144
 s_waitcnt lgkmcnt(6)
 m32 v[0:15], a[224:227], v[192:195], v[0:15]
 rtr a[250:251], v176, 7680
 rtr a[252:253], v177, 6144
 rtr a[254:255], v177, 7680
 m32 v[16:31], a[228:231], v[192:195], v[16:31]
 rtr a[224:225], v176, 6272
 rtr a[226:227], v176, 7808
 rtr a[228:229], v177, 6272
 m32 v[32:47], a[232:235], v[192:195], v[32:47]
 rtr a[230:231], v177, 7808
 rtr a[232:233], v176, 6400
 rtr a[234:235], v176, 7936
 m32 v[48:63], a[236:239], v[192:195], v[48:63]
 rtr a[236:237], v177, 6400
 rtr a[238:239], v177, 7936
 s_waitcnt lgkmcnt(5)
 m32 v[64:79], a[240:243], v[192:195], v[64:79]
 m32 v[80:95], a[244:247], v[192:195], v[80:95]
 v_add_u32 v177, 0x24000, v201
 v_add_u32 v179, 0x1e000, v205
 m32 v[0:15], a[248:251], v[196:199], v[0:15]
 v_add_u32 v176, 0x24000, v200
 v_add_u32 v178, 0x1e000, v204
 s_waitcnt lgkmcnt(0)
 s_barrier
 m32 v[16:31], a[252:255], v[196:199], v[16:31]
 ds_read_b128 v[192:195], v178
 rtr a[240:241], v176
 rtr a[242:243], v176, 1536
 m32 v[32:47], a[224:227], v[196:199], v[32:47]
 rtr a[244:245], v177
 rtr a[246:247], v177, 1536
 rtr a[248:249], v176, 128
 m32 v[48:63], a[228:231], v[196:199], v[48:63]
 rtr a[250:251], v176, 1664
 rtr a[252:253], v177, 128
 rtr a[254:255], v177, 1664
 m32 v[64:79], a[232:235], v[196:199], v[64:79]
 rtr a[224:225], v176, 256
 rtr a[226:227], v176, 1792
 rtr a[228:229], v177, 256
 m32 v[80:95], a[236:239], v[196:199], v[80:95]
 rtr a[230:231], v177, 1792
 ds_read_b128 v[196:199], v179
 rtr a[232:233], v176, 6144
 s_waitcnt lgkmcnt(6)
 m32 v[0:15], a[240:243], v[192:195], v[0:15]
 rtr a[234:235], v176, 7680
 rtr a[236:237], v177, 6144
 rtr a[238:239], v177, 7680
 m32 v[16:31], a[244:247], v[192:195], v[16:31]
 rtr a[240:241], v176, 6272
 rtr a[242:243], v176, 7808
 rtr a[244:245], v177, 6272
 m32 v[32:47], a[248:251], v[192:195], v[32:47]
 rtr a[246:247], v177, 7808
 rtr a[248:249], v176, 6400
 rtr a[250:251], v176, 7936
 m32 v[48:63], a[252:255], v[192:195], v[48:63]
 rtr a[252:253], v177, 6400
 rtr a[254:255], v177, 7936
 s_waitcnt lgkmcnt(5)
 m32 v[64:79], a[224:227], v[192:195], v[64:79]
 m32 v[80:95], a[228:231], v[192:195], v[80:95]
 m32 v[0:15], a[232:235], v[196:199], v[0:15]
 s_waitcnt vmcnt(0)
 s_waitcnt lgkmcnt(0)
 s_barrier
 m32 v[16:31], a[236:239], v[196:199], v[16:31]
 ds_read_b128 v[192:195], v202 offset:36864
 rtr a[224:225], v200
 rtr a[226:227], v200, 1536
 m32 v[32:47], a[240:243], v[196:199], v[32:47]
 rtr a[228:229], v201
 rtr a[230:231], v201, 1536
 rtr a[232:233], v200, 128
 m32 v[48:63], a[244:247], v[196:199], v[48:63]
 rtr a[234:235], v200, 1664
 rtr a[236:237], v201, 128
 rtr a[238:239], v201, 1664
 m32 v[64:79], a[248:251], v[196:199], v[64:79]
 rtr a[240:241], v200, 256
 rtr a[242:243], v200, 1792
 rtr a[244:245], v201, 256
 m32 v[80:95], a[252:255], v[196:199], v[80:95]
 rtr a[246:247], v201, 1792
 ds_read_b128 v[196:199], v203 offset:36864
 rtr a[248:249], v200, 6144
 s_waitcnt lgkmcnt(6)
 m32 v[0:15], a[224:227], v[192:195], v[0:15]
 rtr a[250:251], v200, 7680
 rtr a[252:253], v201, 6144
 rtr a[254:255], v201, 7680
 m32 v[16:31], a[228:231], v[192:195], v[16:31]
 rtr a[224:225], v200, 6272
 rtr a[226:227], v200, 7808
 rtr a[228:229], v201, 6272
 m32 v[32:47], a[232:235], v[192:195], v[32:47]
 rtr a[230:231], v201, 7808
 rtr a[232:233], v200, 6400
 rtr a[234:235], v200, 7936
 m32 v[48:63], a[236:239], v[192:195], v[48:63]
 rtr a[236:237], v201, 6400
 rtr a[238:239], v201, 7936
 s_waitcnt lgkmcnt(5)
 m32 v[64:79], a[240:243], v[192:195], v[64:79]
 m32 v[80:95], a[244:247], v[192:195], v[80:95]
 m32 v[0:15], a[248:251], v[196:199], v[0:15]
 s_waitcnt lgkmcnt(0)
 s_barrier
 m32 v[16:31], a[252:255], v[196:199], v[16:31]
 ds_read_b128 v[192:195], v204 offset:36864
 rtr a[240:241], v200, 12288
 rtr a[242:243], v200, 13824
 m32 v[32:47], a[224:227], v[196:199], v[32:47]
 rtr a[244:245], v201, 12288
 rtr a[246:247], v201, 13824
 rtr a[248:249], v200, 12416
 m32 v[48:63], a[228:231], v[196:199], v[48:63]
 rtr a[250:251], v200, 13952
 rtr a[252:253], v201, 12416
 rtr a[254:255], v201, 13952
 m32 v[64:79], a[232:235], v[196:199], v[64:79]
 rtr a[224:225], v200, 12544
 rtr a[226:227], v200, 14080
 rtr a[228:229], v201, 12544
 m32 v[80:95], a[236:239], v[196:199], v[80:95]
 rtr a[230:231], v201, 14080
 ds_read_b128 v[196:199], v205 offset:36864
 rtr a[232:233], v200, 18432
 s_waitcnt lgkmcnt(6)
 m32 v[0:15], a[240:243], v[192:195], v[0:15]
 rtr a[234:235], v200, 19968
 rtr a[236:237], v201, 18432
 rtr a[238:239], v201, 19968
 m32 v[16:31], a[244:247], v[192:195], v[16:31]
 rtr a[240:241], v200, 18560
 rtr a[242:243], v200, 20096
 rtr a[244:245], v201, 18560
 m32 v[32:47], a[248:251], v[192:195], v[32:47]
 rtr a[246:247], v201, 20096
 rtr a[248:249], v200, 18688
 rtr a[250:251], v200, 20224
 m32 v[48:63], a[252:255], v[192:195], v[48:63]
 rtr a[252:253], v201, 18688
 rtr a[254:255], v201, 20224
 s_waitcnt lgkmcnt(5)
 m32 v[64:79], a[224:227], v[192:195], v[64:79]
 m32 v[80:95], a[228:231], v[192:195], v[80:95]
 v_add_u32 v177, 0x21000, v201
 m32 v[0:15], a[232:235], v[196:199], v[0:15]
 v_add_u32 v176, 0x21000, v200
 s_waitcnt lgkmcnt(0)
 s_barrier
 m32 v[16:31], a[236:239], v[196:199], v[16:31]
 ds_read_b128 v[192:195], v202 offset:24576
 rtr a[224:225], v176
 rtr a[226:227], v176, 1536
 m32 v[32:47], a[240:243], v[196:199], v[32:47]
 rtr a[228:229], v177
 rtr a[230:231], v177, 1536
 rtr a[232:233], v176, 128
 m32 v[48:63], a[244:247], v[196:199], v[48:63]
 rtr a[234:235], v176, 1664
 rtr a[236:237], v177, 128
 rtr a[238:239], v177, 1664
 m32 v[64:79], a[248:251], v[196:199], v[64:79]
 rtr a[240:241], v176, 256
 rtr a[242:243], v176, 1792
 rtr a[244:245], v177, 256
 m32 v[80:95], a[252:255], v[196:199], v[80:95]
 rtr a[246:247], v177, 1792
 ds_read_b128 v[196:199], v203 offset:24576
 rtr a[248:249], v176, 6144
 s_waitcnt lgkmcnt(6)
 m32 v[0:15], a[224:227], v[192:195], v[0:15]
 rtr a[250:251], v176, 7680
 rtr a[252:253], v177, 6144
 rtr a[254:255], v177, 7680
 m32 v[16:31], a[228:231], v[192:195], v[16:31]
 rtr a[224:225], v176, 6272
 rtr a[226:227], v176, 7808
 rtr a[228:229], v177, 6272
 m32 v[32:47], a[232:235], v[192:195], v[32:47]
 rtr a[230:231], v177, 7808
 rtr a[232:233], v176, 6400
 rtr a[234:235], v176, 7936
 m32 v[48:63], a[236:239], v[192:195], v[48:63]
 rtr a[236:237], v177, 6400
 rtr a[238:239], v177, 7936
 s_waitcnt lgkmcnt(5)
 m32 v[64:79], a[240:243], v[192:195], v[64:79]
 m32 v[80:95], a[244:247], v[192:195], v[80:95]
 v_add_u32 v177, 0x24000, v201
 m32 v[0:15], a[248:251], v[196:199], v[0:15]
 v_add_u32 v176, 0x24000, v200
 s_waitcnt lgkmcnt(0)
 s_barrier
 m32 v[16:31], a[252:255], v[196:199], v[16:31]
 ds_read_b128 v[192:195], v204 offset:24576
 rtr a[240:241], v176
 rtr a[242:243], v176, 1536
 m32 v[32:47], a[224:227], v[196:199], v[32:47]
 rtr a[244:245], v177
 rtr a[246:247], v177, 1536
 rtr a[248:249], v176, 128
 m32 v[48:63], a[228:231], v[196:199], v[48:63]
 rtr a[250:251], v176, 1664
 rtr a[252:253], v177, 128
 rtr a[254:255], v177, 1664
 m32 v[64:79], a[232:235], v[196:199], v[64:79]
 rtr a[224:225], v176, 256
 rtr a[226:227], v176, 1792
 rtr a[228:229], v177, 256
 m32 v[80:95], a[236:239], v[196:199], v[80:95]
 rtr a[230:231], v177, 1792
 ds_read_b128 v[196:199], v205 offset:24576
 rtr a[232:233], v176, 6144
 s_waitcnt lgkmcnt(6)
 m32 v[0:15], a[240:243], v[192:195], v[0:15]
 rtr a[234:235], v176, 7680
 rtr a[236:237], v177, 6144
 rtr a[238:239], v177, 7680
 m32 v[16:31], a[244:247], v[192:195], v[16:31]
 rtr a[240:241], v176, 6272
 rtr a[242:243], v176, 7808
 rtr a[244:245], v177, 6272
 m32 v[32:47], a[248:251], v[192:195], v[32:47]
 rtr a[246:247], v177, 7808
 rtr a[248:249], v176, 6400
 rtr a[250:251], v176, 7936
 m32 v[48:63], a[252:255], v[192:195], v[48:63]
 rtr a[252:253], v177, 6400
 rtr a[254:255], v177, 7936
 s_waitcnt lgkmcnt(5)
 m32 v[64:79], a[224:227], v[192:195], v[64:79]
 m32 v[80:95], a[228:231], v[192:195], v[80:95]
 v_add_u32 v177, 0x1e000, v203
 m32 v[0:15], a[232:235], v[196:199], v[0:15]
 v_add_u32 v176, 0x1e000, v202
 s_waitcnt lgkmcnt(0)
 s_barrier
 m32 v[16:31], a[236:239], v[196:199], v[16:31]
 ds_read_b128 v[192:195], v176
 rtr a[224:225], v200
 rtr a[226:227], v200, 1536
 m32 v[32:47], a[240:243], v[196:199], v[32:47]
 rtr a[228:229], v201
 rtr a[230:231], v201, 1536
 rtr a[232:233], v200, 128
 m32 v[48:63], a[244:247], v[196:199], v[48:63]
 rtr a[234:235], v200, 1664
 rtr a[236:237], v201, 128
 rtr a[238:239], v201, 1664
 m32 v[64:79], a[248:251], v[196:199], v[64:79]
 rtr a[240:241], v200, 256
 rtr a[242:243], v200, 1792
 rtr a[244:245], v201, 256
 m32 v[80:95], a[252:255], v[196:199], v[80:95]
 rtr a[246:247], v201, 1792
 ds_read_b128 v[196:199], v177
 rtr a[248:249], v200, 6144
 s_waitcnt lgkmcnt(6)
 m32 v[0:15], a[224:227], v[192:195], v[0:15]
 rtr a[250:251], v200, 7680
 rtr a[252:253], v201, 6144
 rtr a[254:255], v201, 7680
 m32 v[16:31], a[228:231], v[192:195], v[16:31]
 rtr a[224:225], v200, 6272
 rtr a[226:227], v200, 7808
 rtr a[228:229], v201, 6272
 m32 v[32:47], a[232:235], v[192:195], v[32:47]
 rtr a[230:231], v201, 7808
 rtr a[232:233], v200, 6400
 rtr a[234:235], v200, 7936
 m32 v[48:63], a[236:239], v[192:195], v[48:63]
 rtr a[236:237], v201, 6400
 rtr a[238:239], v201, 7936
 s_waitcnt lgkmcnt(5)
 m32 v[64:79], a[240:243], v[192:195], v[64:79]
 m32 v[80:95], a[244:247], v[192:195], v[80:95]
 v_add_u32 v177, 0x1e000, v205
 m32 v[0:15], a[248:251], v[196:199], v[0:15]
 v_add_u32 v176, 0x1e000, v204
 s_waitcnt lgkmcnt(0)
 s_barrier
 m32 v[16:31], a[252:255], v[196:199], v[16:31]
 ds_read_b128 v[192:195], v176
 rtr a[240:241], v200, 12288
 rtr a[242:243], v200, 13824
 m32 v[32:47], a[224:227], v[196:199], v[32:47]
 rtr a[244:245], v201, 12288
 rtr a[246:247], v201, 13824
 rtr a[248:249], v200, 12416
 m32 v[48:63], a[228:231], v[196:199], v[48:63]
 rtr a[250:251], v200, 13952
 rtr a[252:253], v201, 12416
 rtr a[254:255], v201, 13952
 m32 v[64:79], a[232:235], v[196:199], v[64:79]
 rtr a[224:225], v200, 12544
 rtr a[226:227], v200, 14080
 rtr a[228:229], v201, 12544
 m32 v[80:95], a[236:239], v[196:199], v[80:95]
 rtr a[230:231], v201, 14080
 ds_read_b128 v[196:199], v177
 rtr a[232:233], v200, 18432
 s_waitcnt lgkmcnt(6)
 m32 v[0:15], a[240:243], v[192:195], v[0:15]
 rtr a[234:235], v200, 19968
 rtr a[236:237], v201, 18432
 rtr a[238:239], v201, 19968
 m32 v[16:31], a[244:247], v[192:195], v[16:31]
 rtr a[240:241], v200, 18560
 rtr a[242:243], v200, 20096
 rtr a[244:245], v201, 18560
 m32 v[32:47], a[248:251], v[192:195], v[32:47]
 rtr a[246:247], v201, 20096
 rtr a[248:249], v200, 18688
 rtr a[250:251], v200, 20224
 m32 v[48:63], a[252:255], v[192:195], v[48:63]
 rtr a[252:253], v201, 18688
 rtr a[254:255], v201, 20224
 s_waitcnt lgkmcnt(5)
 m32 v[64:79], a[224:227], v[192:195], v[64:79]
 m32 v[80:95], a[228:231], v[192:195], v[80:95]
 v_add_u32 v177, 0x21000, v201
 m32 v[0:15], a[232:235], v[196:199], v[0:15]
 v_add_u32 v176, 0x21000, v200
 s_waitcnt lgkmcnt(0)
 s_barrier
 m32 v[16:31], a[236:239], v[196:199], v[16:31]
 ds_read_b128 v[192:195], v202 offset:36864
 rtr a[224:225], v176
 rtr a[226:227], v176, 1536
 m32 v[32:47], a[240:243], v[196:199], v[32:47]
 rtr a[228:229], v177
 rtr a[230:231], v177, 1536
 rtr a[232:233], v176, 128
 m32 v[48:63], a[244:247], v[196:199], v[48:63]
 rtr a[234:235], v176, 1664
 rtr a[236:237], v177, 128
 rtr a[238:239], v177, 1664
 m32 v[64:79], a[248:251], v[196:199], v[64:79]
 rtr a[240:241], v176, 256
 rtr a[242:243], v176, 1792
 rtr a[244:245], v177, 256
 m32 v[80:95], a[252:255], v[196:199], v[80:95]
 rtr a[246:247], v177, 1792
 ds_read_b128 v[196:199], v203 offset:36864
 rtr a[248:249], v176, 6144
 s_waitcnt lgkmcnt(6)
 m32 v[0:15], a[224:227], v[192:195], v[0:15]
 rtr a[250:251], v176, 7680
 rtr a[252:253], v177, 6144
 rtr a[254:255], v177, 7680
 m32 v[16:31], a[228:231], v[192:195], v[16:31]
 rtr a[224:225], v176, 6272
 rtr a[226:227], v176, 7808
 rtr a[228:229], v177, 6272
 m32 v[32:47], a[232:235], v[192:195], v[32:47]
 rtr a[230:231], v177, 7808
 rtr a[232:233], v176, 6400
 rtr a[234:235], v176, 7936
 m32 v[48:63], a[236:239], v[192:195], v[48:63]
 rtr a[236:237], v177, 6400
 rtr a[238:239], v177, 7936
 s_waitcnt lgkmcnt(5)
 m32 v[64:79], a[240:243], v[192:195], v[64:79]
 m32 v[80:95], a[244:247], v[192:195], v[80:95]
 v_add_u32 v177, 0x24000, v201
 m32 v[0:15], a[248:251], v[196:199], v[0:15]
 v_add_u32 v176, 0x24000, v200
 s_waitcnt lgkmcnt(0)
 s_barrier
 m32 v[16:31], a[252:255], v[196:199], v[16:31]
 ds_read_b128 v[192:195], v204 offset:36864
 rtr a[240:241], v176
 rtr a[242:243], v176, 1536
 m32 v[32:47], a[224:227], v[196:199], v[32:47]
 ds_read_b128 v[144:147], v205 offset:36864
 rtr a[244:245], v176, 6144
 rtr a[246:247], v176, 7680
 m32 v[48:63], a[228:231], v[196:199], v[48:63]
 rtr a[248:249], v177
 rtr a[250:251], v177, 1536
 rtr a[252:253], v177, 6144
 m32 v[64:79], a[232:235], v[196:199], v[64:79]
 rtr a[254:255], v177, 7680
 rtr a[224:225], v176, 128
 rtr a[226:227], v176, 1664
 m32 v[80:95], a[236:239], v[196:199], v[80:95]
 rtr a[228:229], v176, 6272
 rtr a[230:231], v176, 7808
 rtr a[232:233], v177, 128
 s_waitcnt lgkmcnt(6)
 m32 v[0:15], a[240:243], v[192:195], v[0:15]
 rtr a[234:235], v177, 1664
 rtr a[236:237], v177, 6272
 rtr a[238:239], v177, 7808
 m32 v[0:15], a[244:247], v[144:147], v[0:15]
 rtr a[240:241], v176, 256
 rtr a[242:243], v176, 1792
 rtr a[244:245], v176, 6400
 m32 v[16:31], a[248:251], v[192:195], v[16:31]
 rtr a[246:247], v176, 7936
 rtr a[248:249], v177, 256
 rtr a[250:251], v177, 1792
 s_waitcnt lgkmcnt(6)
 m32 v[16:31], a[252:255], v[144:147], v[16:31]
 rtr a[252:253], v177, 6400
 rtr a[254:255], v177, 7936
 s_nop 0
 cvt v96, v0, v1
 cvt v97, v2, v3
 cvt v98, v4, v5
 cvt v99, v6, v7
 m32 v[32:47], a[224:227], v[192:195], v[32:47]
 cvt v100, v8, v9
 cvt v101, v10, v11
 cvt v102, v12, v13
 cvt v103, v14, v15
 v_permlane16_swap_b32 v96, v100
 v_permlane16_swap_b32 v97, v101
 m32 v[32:47], a[228:231], v[144:147], v[32:47]
 v_permlane16_swap_b32 v98, v102
 v_permlane16_swap_b32 v99, v103
 cvt v104, v16, v17
 cvt v105, v18, v19
 cvt v106, v20, v21
 cvt v107, v22, v23
 m32 v[48:63], a[232:235], v[192:195], v[48:63]
 cvt v108, v24, v25
 cvt v109, v26, v27
 cvt v110, v28, v29
 cvt v111, v30, v31
 v_permlane16_swap_b32 v104, v108
 v_permlane16_swap_b32 v105, v109
 m32 v[48:63], a[236:239], v[144:147], v[48:63]
 v_permlane16_swap_b32 v106, v110
 v_permlane16_swap_b32 v107, v111
 cvt v112, v32, v33
 s_waitcnt lgkmcnt(0)
 s_barrier
 m32 v[64:79], a[240:243], v[192:195], v[64:79]
 ds_read_b128 a[224:227], v240
 ds_read_b128 a[228:231], v240 offset:6144
 cvt v113, v34, v35
 cvt v114, v36, v37
 cvt v115, v38, v39
 cvt v116, v40, v41
 m32 v[64:79], a[244:247], v[144:147], v[64:79]
 ds_read_b128 a[232:235], v241
 ds_read_b128 a[236:239], v241 offset:6144
 cvt v117, v42, v43
 cvt v118, v44, v45
 cvt v119, v46, v47
 v_permlane16_swap_b32 v112, v116
 m32 v[80:95], a[248:251], v[192:195], v[80:95]
 ds_read_b128 a[240:243], v240 offset:128
 ds_read_b128 a[244:247], v240 offset:6272
 v_permlane16_swap_b32 v113, v117
 v_permlane16_swap_b32 v114, v118
 v_permlane16_swap_b32 v115, v119
 cvt v120, v48, v49
 m32 v[80:95], a[252:255], v[144:147], v[80:95]
 ds_read_b128 a[248:251], v241 offset:128
 ds_read_b128 a[252:255], v241 offset:6272
 cvt v121, v50, v51
 cvt v122, v52, v53
 cvt v123, v54, v55
 s_waitcnt lgkmcnt(4)
 m16 v[144:147], a[224:227], v[96:99], 0
 cvt v124, v56, v57
 cvt v125, v58, v59
 m16 v[152:155], a[224:227], v[100:103], 0
 ds_read_b128 a[224:227], v240 offset:256
 cvt v126, v60, v61
 cvt v127, v62, v63
 m16 v[148:151], a[228:231], v[96:99], 0
 v_permlane16_swap_b32 v120, v124
 v_permlane16_swap_b32 v121, v125
 m16 v[156:159], a[228:231], v[100:103], 0
 ds_read_b128 a[228:231], v240 offset:6400
 v_permlane16_swap_b32 v122, v126
 v_permlane16_swap_b32 v123, v127
 m16 v[144:147], a[232:235], v[104:107], v[144:147]
 cvt v128, v64, v65
 cvt v129, v66, v67
 m16 v[152:155], a[232:235], v[108:111], v[152:155]
 ds_read_b128 a[232:235], v241 offset:256
 cvt v130, v68, v69
 cvt v131, v70, v71
 m16 v[148:151], a[236:239], v[104:107], v[148:151]
 cvt v132, v72, v73
 cvt v133, v74, v75
 m16 v[156:159], a[236:239], v[108:111], v[156:159]
 ds_read_b128 a[236:239], v241 offset:6400
 cvt v134, v76, v77
 s_waitcnt lgkmcnt(2)
 m16 v[144:147], a[240:243], v[112:115], v[144:147]
 cvt v135, v78, v79
 v_permlane16_swap_b32 v128, v132
 m16 v[152:155], a[240:243], v[116:119], v[152:155]
 v_permlane16_swap_b32 v129, v133
 v_permlane16_swap_b32 v130, v134
 v_permlane16_swap_b32 v131, v135
 m16 v[148:151], a[244:247], v[112:115], v[148:151]
 cvt v136, v80, v81
 cvt v137, v82, v83
 m16 v[156:159], a[244:247], v[116:119], v[156:159]
 cvt v138, v84, v85
 cvt v139, v86, v87
 cvt v140, v88, v89
 m16 v[144:147], a[248:251], v[120:123], v[144:147]
 cvt v141, v90, v91
 cvt v142, v92, v93
 m16 v[152:155], a[248:251], v[124:127], v[152:155]
 s_waitcnt lgkmcnt(0)
 s_barrier
 m16 v[148:151], a[252:255], v[120:123], v[148:151]
 ds_read_b128 v[192:195], v202 offset:24576
 cvt v143, v94, v95
 m16 v[156:159], a[252:255], v[124:127], v[156:159]
 rtr a[240:241], v200
 rtr a[242:243], v200, 1536
 v_permlane16_swap_b32 v136, v140
 m16 v[144:147], a[224:227], v[128:131], v[144:147]
 rtr a[244:245], v201
 v_permlane16_swap_b32 v137, v141
 m16 v[152:155], a[224:227], v[132:135], v[152:155]
 rtr a[246:247], v201, 1536
 rtr a[248:249], v200, 128
 v_permlane16_swap_b32 v138, v142
 m16 v[148:151], a[228:231], v[128:131], v[148:151]
 rtr a[250:251], v200, 1664
 v_permlane16_swap_b32 v139, v143
 m16 v[156:159], a[228:231], v[132:135], v[156:159]
 rtr a[252:253], v201, 128
 rtr a[254:255], v201, 1664
 m16 v[144:147], a[232:235], v[136:139], v[144:147]
 rtr a[224:225], v200, 256
 m16 v[152:155], a[232:235], v[140:143], v[152:155]
 rtr a[226:227], v200, 1792
 rtr a[228:229], v201, 256
 m16 v[148:151], a[236:239], v[136:139], v[148:151]
 rtr a[230:231], v201, 1792
 m16 v[156:159], a[236:239], v[140:143], v[156:159]
 ds_read_b128 v[196:199], v203 offset:24576
 s_waitcnt lgkmcnt(5)
 m32 a[0:15], a[240:243], v[192:195], 0
 rtr a[232:233], v200, 6144
 rtr a[234:235], v200, 7680
 rtr a[236:237], v201, 6144
 m32 a[16:31], a[244:247], v[192:195], 0
 rtr a[238:239], v201, 7680
 rtr a[240:241], v200, 6272
 rtr a[242:243], v200, 7808
 m32 a[32:47], a[248:251], v[192:195], 0
 rtr a[244:245], v201, 6272
 rtr a[246:247], v201, 7808
 rtr a[248:249], v200, 6400
 v_max3_f32 v250, v144, v145, v146
 v_max3_f32 v250, v250, v147, v148
 v_max3_f32 v250, v250, v149, v150
 m32 a[48:63], a[252:255], v[192:195], 0
 rtr a[250:251], v200, 7936
 rtr a[252:253], v201, 6400
 rtr a[254:255], v201, 7936
 v_max_f32 v250, v250, v151
 v_mov_b32 v251, v250
 s_waitcnt lgkmcnt(6)
 m32 a[64:79], a[224:227], v[192:195], 0
 v_permlane16_swap_b32 v250, v251
 v_max_f32 v250, v250, v251
 v_mov_b32 v251, v250
 s_nop 1
 v_permlane32_swap_b32 v250, v251
 v_max_f32 v250, v250, v251
 v_sub_f32 v160, 0, v250
 m32 a[80:95], a[228:231], v[192:195], 0
 v_sub_f32 v161, 0, v250
 v_sub_f32 v162, 0, v250
 v_sub_f32 v163, 0, v250
 v_sub_f32 v144, v144, v250
 v_sub_f32 v145, v145, v250
 v_sub_f32 v146, v146, v250
 m32 a[0:15], a[232:235], v[196:199], a[0:15]
 v_sub_f32 v147, v147, v250
 v_sub_f32 v148, v148, v250
 v_sub_f32 v149, v149, v250
 s_waitcnt lgkmcnt(0)
 s_barrier
 m32 a[16:31], a[236:239], v[196:199], a[16:31]
 ds_read_b128 v[192:195], v204 offset:24576
 rtr a[224:225], v200, 12288
 rtr a[226:227], v200, 13824
 v_sub_f32 v150, v150, v250
 v_sub_f32 v151, v151, v250
 v_max3_f32 v250, v152, v153, v154
 m32 a[32:47], a[240:243], v[196:199], a[32:47]
 rtr a[228:229], v201, 12288
 rtr a[230:231], v201, 13824
 rtr a[232:233], v200, 12416
 v_max3_f32 v250, v250, v155, v156
 v_max3_f32 v250, v250, v157, v158
 v_max_f32 v250, v250, v159
 m32 a[48:63], a[244:247], v[196:199], a[48:63]
 rtr a[234:235], v200, 13952
 rtr a[236:237], v201, 12416
 rtr a[238:239], v201, 13952
 v_mov_b32 v251, v250
 s_nop 1
 v_permlane16_swap_b32 v250, v251
 v_max_f32 v250, v250, v251
 m32 a[64:79], a[248:251], v[196:199], a[64:79]
 rtr a[240:241], v200, 12544
 rtr a[242:243], v200, 14080
 rtr a[244:245], v201, 12544
 v_mov_b32 v251, v250
 s_nop 1
 v_permlane32_swap_b32 v250, v251
 v_max_f32 v250, v250, v251
 m32 a[80:95], a[252:255], v[196:199], a[80:95]
 rtr a[246:247], v201, 14080
 ds_read_b128 v[196:199], v205 offset:24576
 rtr a[248:249], v200, 18432
 v_sub_f32 v164, 0, v250
 v_sub_f32 v165, 0, v250
 s_waitcnt lgkmcnt(6)
 m32 a[0:15], a[224:227], v[192:195], a[0:15]
 rtr a[250:251], v200, 19968
 rtr a[252:253], v201, 18432
 rtr a[254:255], v201, 19968
 v_sub_f32 v166, 0, v250
 v_sub_f32 v167, 0, v250
 v_sub_f32 v152, v152, v250
 m32 a[16:31], a[228:231], v[192:195], a[16:31]
 rtr a[224:225], v200, 18560
 rtr a[226:227], v200, 20096
 rtr a[228:229], v201, 18560
 v_sub_f32 v153, v153, v250
 v_sub_f32 v154, v154, v250
 v_sub_f32 v155, v155, v250
 m32 a[32:47], a[232:235], v[192:195], a[32:47]
 rtr a[230:231], v201, 20096
 rtr a[232:233], v200, 18688
 rtr a[234:235], v200, 20224
 v_sub_f32 v156, v156, v250
 v_sub_f32 v157, v157, v250
 v_sub_f32 v158, v158, v250
 m32 a[48:63], a[236:239], v[192:195], a[48:63]
 rtr a[236:237], v201, 18688
 rtr a[238:239], v201, 20224
 v_sub_f32 v159, v159, v250
 v_mul_f32 v250, s36, v144
 v_mul_f32 v251, s36, v145
 s_waitcnt lgkmcnt(5)
 m32 a[64:79], a[240:243], v[192:195], a[64:79]
 v_exp_f32 v250, v250
 v_exp_f32 v251, v251
 s_nop 0
 cvt v176, v250, v251
 v_add_f32 v249, v250, v251
 m32 a[80:95], a[244:247], v[192:195], a[80:95]
 v_mul_f32 v250, s36, v146
 v_mul_f32 v251, s36, v147
 v_exp_f32 v250, v250
 v_exp_f32 v251, v251
 m32 a[0:15], a[248:251], v[196:199], a[0:15]
 v_add_f32 v249, v249, v250
 v_add_f32 v249, v249, v251
 cvt v177, v250, v251
 v_mul_f32 v250, s36, v148
 v_mul_f32 v251, s36, v149
 m32 a[16:31], a[252:255], v[196:199], a[16:31]
 v_exp_f32 v250, v250
 s_waitcnt lgkmcnt(0)
 s_barrier
 m32 a[32:47], a[224:227], v[196:199], a[32:47]
 ds_read_b128 a[240:243], v240 offset:12288
 ds_read_b128 a[244:247], v240 offset:18432
 v_exp_f32 v251, v251
 v_add_f32 v249, v249, v250
 v_add_f32 v249, v249, v251
 m32 a[48:63], a[228:231], v[196:199], a[48:63]
 ds_read_b128 a[248:251], v241 offset:12288
 ds_read_b128 a[252:255], v241 offset:18432
 cvt v178, v250, v251
 v_mul_f32 v250, s36, v150
 v_mul_f32 v251, s36, v151
 m32 a[64:79], a[232:235], v[196:199], a[64:79]
 ds_read_b128 a[224:227], v240 offset:12416
 ds_read_b128 a[228:231], v240 offset:18560
 v_exp_f32 v250, v250
 v_exp_f32 v251, v251
 m32 a[80:95], a[236:239], v[196:199], a[80:95]
 ds_read_b128 a[232:235], v241 offset:12416
 ds_read_b128 a[236:239], v241 offset:18560
 v_add_f32 v249, v249, v250
 v_add_f32 v249, v249, v251
 cvt v179, v250, v251
 v_mul_f32 v250, s36, v152
 v_mul_f32 v251, s36, v153
 v_exp_f32 v250, v250
 v_exp_f32 v251, v251
 s_nop 0
 cvt v180, v250, v251
 v_add_f32 v169, v250, v251
 v_mul_f32 v250, s36, v154
 v_mul_f32 v251, s36, v155
 v_exp_f32 v250, v250
 v_exp_f32 v251, v251
 v_add_f32 v169, v169, v250
 v_add_f32 v169, v169, v251
 cvt v181, v250, v251
 v_mul_f32 v250, s36, v156
 v_mul_f32 v251, s36, v157
 v_exp_f32 v250, v250
 v_exp_f32 v251, v251
 v_add_f32 v169, v169, v250
 v_add_f32 v169, v169, v251
 cvt v182, v250, v251
 v_mul_f32 v250, s36, v158
 v_mul_f32 v251, s36, v159
 v_exp_f32 v250, v250
 v_exp_f32 v251, v251
 v_add_f32 v169, v169, v250
 v_add_f32 v169, v169, v251
 cvt v183, v250, v251
 v_mov_b32 v248, v249
 v_mov_b32 v168, v169
 s_waitcnt lgkmcnt(4)
 m16 v[144:147], a[240:243], v[96:99], v[160:163]
 m16 v[152:155], a[240:243], v[100:103], v[164:167]
 ds_read_b128 a[240:243], v240 offset:12544
 m16 v[148:151], a[244:247], v[96:99], v[160:163]
 m16 v[156:159], a[244:247], v[100:103], v[164:167]
 ds_read_b128 a[244:247], v240 offset:18688
 m16 v[144:147], a[248:251], v[104:107], v[144:147]
 m16 v[152:155], a[248:251], v[108:111], v[152:155]
 ds_read_b128 a[248:251], v241 offset:12544
 m16 v[148:151], a[252:255], v[104:107], v[148:151]
 m16 v[156:159], a[252:255], v[108:111], v[156:159]
 ds_read_b128 a[252:255], v241 offset:18688
 s_waitcnt lgkmcnt(2)
 m16 v[144:147], a[224:227], v[112:115], v[144:147]
 m16 v[152:155], a[224:227], v[116:119], v[152:155]
 m16 v[148:151], a[228:231], v[112:115], v[148:151]
 m16 v[156:159], a[228:231], v[116:119], v[156:159]
 m16 v[144:147], a[232:235], v[120:123], v[144:147]
 rtr a[224:225], v242
 m16 v[152:155], a[232:235], v[124:127], v[152:155]
 rtr a[226:227], v242, 6144
 rtr a[228:229], v243
 m16 v[148:151], a[236:239], v[120:123], v[148:151]
 rtr a[230:231], v243, 6144
 m16 v[156:159], a[236:239], v[124:127], v[156:159]
 rtr a[232:233], v244
 rtr a[234:235], v244, 6144
 m16 v[144:147], a[240:243], v[128:131], v[144:147]
 rtr a[236:237], v245
 m16 v[152:155], a[240:243], v[132:135], v[152:155]
 rtr a[238:239], v245, 6144
 rtr a[240:241], v242, 128
 m16 v[148:151], a[244:247], v[128:131], v[148:151]
 rtr a[242:243], v242, 6272
 m16 v[156:159], a[244:247], v[132:135], v[156:159]
 rtr a[244:245], v243, 128
 rtr a[246:247], v243, 6272
 s_waitcnt lgkmcnt(6)
 m16 v[144:147], a[248:251], v[136:139], v[144:147]
 m16 v[152:155], a[248:251], v[140:143], v[152:155]
 rtr a[248:249], v244, 128
 rtr a[250:251], v244, 6272
 m16 v[148:151], a[252:255], v[136:139], v[148:151]
 m16 v[156:159], a[252:255], v[140:143], v[156:159]
 rtr a[252:253], v245, 128
 rtr a[254:255], v245, 6272
 m16 v[0:3], a[224:227], v[176:179], 0
 m16 v[8:11], a[224:227], v[180:183], 0
 rtr a[224:225], v242, 256
 rtr a[226:227], v242, 6400
 m16 v[4:7], a[228:231], v[176:179], 0
 m16 v[12:15], a[228:231], v[180:183], 0
 rtr a[228:229], v243, 256
 rtr a[230:231], v243, 6400
 m16 v[16:19], a[232:235], v[176:179], 0
 m16 v[24:27], a[232:235], v[180:183], 0
 rtr a[232:233], v244, 256
 rtr a[234:235], v244, 6400
 s_waitcnt lgkmcnt(4)
 m16 v[20:23], a[236:239], v[176:179], 0
 v_mul_f32 v250, s36, v144
 v_mul_f32 v251, s36, v145
 m16 v[28:31], a[236:239], v[180:183], 0
 rtr a[236:237], v245, 256
 rtr a[238:239], v245, 6400
 m16 v[32:35], a[240:243], v[176:179], 0
 v_exp_f32 v250, v250
 m16 v[40:43], a[240:243], v[180:183], 0
 v_exp_f32 v251, v251
 s_nop 0
 cvt v184, v250, v251
 m16 v[36:39], a[244:247], v[176:179], 0
 v_add_f32 v249, v250, v251
 v_mul_f32 v250, s36, v146
 m16 v[44:47], a[244:247], v[180:183], 0
 v_mul_f32 v251, s36, v147
 v_exp_f32 v250, v250
 m16 v[48:51], a[248:251], v[176:179], 0
 v_exp_f32 v251, v251
 m16 v[56:59], a[248:251], v[180:183], 0
 s_waitcnt lgkmcnt(0)
 s_barrier
 m16 v[52:55], a[252:255], v[176:179], 0
 ds_read_b128 v[192:195], v202 offset:36864
 v_add_f32 v249, v249, v250
 m16 v[60:63], a[252:255], v[180:183], 0
 rtr a[240:241], v200
 rtr a[242:243], v200, 1536
 v_add_f32 v249, v249, v251
 m16 v[64:67], a[224:227], v[176:179], 0
 rtr a[244:245], v201
 cvt v185, v250, v251
 m16 v[72:75], a[224:227], v[180:183], 0
 rtr a[246:247], v201, 1536
 rtr a[248:249], v200, 128
 v_mul_f32 v250, s36, v148
 m16 v[68:71], a[228:231], v[176:179], 0
 rtr a[250:251], v200, 1664
 v_mul_f32 v251, s36, v149
 m16 v[76:79], a[228:231], v[180:183], 0
 rtr a[252:253], v201, 128
 rtr a[254:255], v201, 1664
 m16 v[80:83], a[232:235], v[176:179], 0
 rtr a[224:225], v200, 256
 m16 v[88:91], a[232:235], v[180:183], 0
 rtr a[226:227], v200, 1792
 rtr a[228:229], v201, 256
 m16 v[84:87], a[236:239], v[176:179], 0
 rtr a[230:231], v201, 1792
 m16 v[92:95], a[236:239], v[180:183], 0
 ds_read_b128 v[196:199], v203 offset:36864
 s_waitcnt lgkmcnt(5)
 m32 a[0:15], a[240:243], v[192:195], a[0:15]
 rtr a[232:233], v200, 6144
 rtr a[234:235], v200, 7680
 rtr a[236:237], v201, 6144
 v_exp_f32 v250, v250
 m32 a[16:31], a[244:247], v[192:195], a[16:31]
 rtr a[238:239], v201, 7680
 rtr a[240:241], v200, 6272
 rtr a[242:243], v200, 7808
 v_exp_f32 v251, v251
 v_add_f32 v249, v249, v250
 m32 a[32:47], a[248:251], v[192:195], a[32:47]
 rtr a[244:245], v201, 6272
 rtr a[246:247], v201, 7808
 rtr a[248:249], v200, 6400
 v_add_f32 v249, v249, v251
 cvt v186, v250, v251
 v_mul_f32 v250, s36, v150
 m32 a[48:63], a[252:255], v[192:195], a[48:63]
 rtr a[250:251], v200, 7936
 rtr a[252:253], v201, 6400
 rtr a[254:255], v201, 7936
 v_mul_f32 v251, s36, v151
 s_waitcnt lgkmcnt(6)
 m32 a[64:79], a[224:227], v[192:195], a[64:79]
 v_exp_f32 v250, v250
 v_exp_f32 v251, v251
 v_add_f32 v249, v249, v250
 v_add_f32 v249, v249, v251
 m32 a[80:95], a[228:231], v[192:195], a[80:95]
 cvt v187, v250, v251
 v_mul_f32 v250, s36, v152
 v_mul_f32 v251, s36, v153
 v_exp_f32 v250, v250
 m32 a[0:15], a[232:235], v[196:199], a[0:15]
 v_exp_f32 v251, v251
 s_nop 0
 cvt v188, v250, v251
 v_add_f32 v169, v250, v251
 v_mul_f32 v250, s36, v154
 v_mul_f32 v251, s36, v155
 m32 a[16:31], a[236:239], v[196:199], a[16:31]
 v_exp_f32 v250, v250
 s_waitcnt lgkmcnt(0)
 s_barrier
 m32 a[32:47], a[240:243], v[196:199], a[32:47]
 ds_read_b128 a[224:227], v240 offset:24576
 ds_read_b128 a[228:231], v240 offset:30720
 v_exp_f32 v251, v251
 v_add_f32 v169, v169, v250
 v_add_f32 v169, v169, v251
 m32 a[48:63], a[244:247], v[196:199], a[48:63]
 ds_read_b128 a[232:235], v241 offset:24576
 ds_read_b128 a[236:239], v241 offset:30720
 cvt v189, v250, v251
 v_mul_f32 v250, s36, v156
 v_mul_f32 v251, s36, v157
 m32 a[64:79], a[248:251], v[196:199], a[64:79]
 ds_read_b128 a[240:243], v240 offset:24704
 ds_read_b128 a[244:247], v240 offset:30848
 v_exp_f32 v250, v250
 v_exp_f32 v251, v251
 v_add_f32 v169, v169, v250
 v_add_f32 v169, v169, v251
 cvt v190, v250, v251
 v_mul_f32 v250, s36, v158
 v_mul_f32 v251, s36, v159
 v_exp_f32 v250, v250
 v_exp_f32 v251, v251
 v_add_f32 v169, v169, v250
 v_add_f32 v169, v169, v251
 cvt v191, v250, v251
 v_add_f32 v250, v249, v169
 v_cmp_nge_f32 s[48:49], s37, v250
 m32 a[80:95], a[252:255], v[196:199], a[80:95]
 ds_read_b128 a[248:251], v241 offset:24704
 ds_read_b128 a[252:255], v241 offset:30848
 s_cmp_lg_u64 s[48:49], 0
 s_cbranch_scc1 RS1_0
RB1_0:
 v_add_f32 v248, v248, v249
 v_add_f32 v168, v168, v169
 s_waitcnt lgkmcnt(4)
 m16 v[144:147], a[224:227], v[96:99], v[160:163]
 m16 v[152:155], a[224:227], v[100:103], v[164:167]
 ds_read_b128 a[224:227], v240 offset:24832
 m16 v[148:151], a[228:231], v[96:99], v[160:163]
 m16 v[156:159], a[228:231], v[100:103], v[164:167]
 ds_read_b128 a[228:231], v240 offset:30976
 m16 v[144:147], a[232:235], v[104:107], v[144:147]
 m16 v[152:155], a[232:235], v[108:111], v[152:155]
 ds_read_b128 a[232:235], v241 offset:24832
 m16 v[148:151], a[236:239], v[104:107], v[148:151]
 m16 v[156:159], a[236:239], v[108:111], v[156:159]
 ds_read_b128 a[236:239], v241 offset:30976
 s_waitcnt lgkmcnt(2)
 m16 v[144:147], a[240:243], v[112:115], v[144:147]
 m16 v[152:155], a[240:243], v[116:119], v[152:155]
 m16 v[148:151], a[244:247], v[112:115], v[148:151]
 m16 v[156:159], a[244:247], v[116:119], v[156:159]
 m16 v[144:147], a[248:251], v[120:123], v[144:147]
 rtr a[240:241], v242, 12288
 m16 v[152:155], a[248:251], v[124:127], v[152:155]
 rtr a[242:243], v242, 18432
 m16 v[148:151], a[252:255], v[120:123], v[148:151]
 rtr a[244:245], v243, 12288
 m16 v[156:159], a[252:255], v[124:127], v[156:159]
 rtr a[246:247], v243, 18432
 m16 v[144:147], a[224:227], v[128:131], v[144:147]
 rtr a[248:249], v244, 12288
 m16 v[152:155], a[224:227], v[132:135], v[152:155]
 rtr a[250:251], v244, 18432
 m16 v[148:151], a[228:231], v[128:131], v[148:151]
 rtr a[252:253], v245, 12288
 m16 v[156:159], a[228:231], v[132:135], v[156:159]
 rtr a[254:255], v245, 18432
 s_waitcnt lgkmcnt(4)
 m16 v[144:147], a[232:235], v[136:139], v[144:147]
 rtr a[224:225], v242, 12416
 m16 v[152:155], a[232:235], v[140:143], v[152:155]
 rtr a[226:227], v242, 18560
 m16 v[148:151], a[236:239], v[136:139], v[148:151]
 rtr a[228:229], v243, 12416
 m16 v[156:159], a[236:239], v[140:143], v[156:159]
 rtr a[230:231], v243, 18560
 m16 v[0:3], a[240:243], v[184:187], v[0:3]
 rtr a[232:233], v244, 12416
 m16 v[8:11], a[240:243], v[188:191], v[8:11]
 rtr a[234:235], v244, 18560
 m16 v[4:7], a[244:247], v[184:187], v[4:7]
 rtr a[236:237], v245, 12416
 m16 v[12:15], a[244:247], v[188:191], v[12:15]
 rtr a[238:239], v245, 18560
 s_waitcnt lgkmcnt(4)
 m16 v[16:19], a[248:251], v[184:187], v[16:19]
 rtr a[240:241], v242, 12544
 m16 v[24:27], a[248:251], v[188:191], v[24:27]
 rtr a[242:243], v242, 18688
 v_mul_f32 v250, s36, v144
 v_mul_f32 v251, s36, v145
 m16 v[20:23], a[252:255], v[184:187], v[20:23]
 rtr a[244:245], v243, 12544
 m16 v[28:31], a[252:255], v[188:191], v[28:31]
 rtr a[246:247], v243, 18688
 v_exp_f32 v250, v250
 m16 v[32:35], a[224:227], v[184:187], v[32:35]
 rtr a[248:249], v244, 12544
 m16 v[40:43], a[224:227], v[188:191], v[40:43]
 rtr a[250:251], v244, 18688
 v_exp_f32 v251, v251
 m16 v[36:39], a[228:231], v[184:187], v[36:39]
 rtr a[252:253], v245, 12544
 cvt v176, v250, v251
 m16 v[44:47], a[228:231], v[188:191], v[44:47]
 rtr a[254:255], v245, 18688
 v_add_f32 v249, v250, v251
 s_waitcnt lgkmcnt(4)
 m16 v[48:51], a[232:235], v[184:187], v[48:51]
 ds_read_b128 v[192:195], v204 offset:36864
 v_mul_f32 v250, s36, v146
 m16 v[56:59], a[232:235], v[188:191], v[56:59]
 rtr a[224:225], v200, 12288
 rtr a[226:227], v200, 13824
 v_mul_f32 v251, s36, v147
 m16 v[52:55], a[236:239], v[184:187], v[52:55]
 rtr a[228:229], v201, 12288
 m16 v[60:63], a[236:239], v[188:191], v[60:63]
 rtr a[230:231], v201, 13824
 rtr a[232:233], v200, 12416
 m16 v[64:67], a[240:243], v[184:187], v[64:67]
 rtr a[234:235], v200, 13952
 m16 v[72:75], a[240:243], v[188:191], v[72:75]
 rtr a[236:237], v201, 12416
 v_exp_f32 v250, v250
 m16 v[68:71], a[244:247], v[184:187], v[68:71]
 rtr a[238:239], v201, 13952
 m16 v[76:79], a[244:247], v[188:191], v[76:79]
 rtr a[240:241], v200, 12544
 s_waitcnt lgkmcnt(4)
 m16 v[80:83], a[248:251], v[184:187], v[80:83]
 rtr a[242:243], v200, 14080
 m16 v[88:91], a[248:251], v[188:191], v[88:91]
 rtr a[244:245], v201, 12544
 v_exp_f32 v251, v251
 m16 v[84:87], a[252:255], v[184:187], v[84:87]
 rtr a[246:247], v201, 14080
 v_add_f32 v249, v249, v250
 m16 v[92:95], a[252:255], v[188:191], v[92:95]
 ds_read_b128 v[196:199], v205 offset:36864
 v_add_f32 v249, v249, v251
 cvt v177, v250, v251
 m32 a[0:15], a[224:227], v[192:195], a[0:15]
 rtr a[248:249], v200, 18432
 rtr a[250:251], v200, 19968
 rtr a[252:253], v201, 18432
 v_mul_f32 v250, s36, v148
 v_mul_f32 v251, s36, v149
 m32 a[16:31], a[228:231], v[192:195], a[16:31]
 rtr a[254:255], v201, 19968
 rtr a[224:225], v200, 18560
 rtr a[226:227], v200, 20096
 v_exp_f32 v250, v250
 s_waitcnt lgkmcnt(6)
 m32 a[32:47], a[232:235], v[192:195], a[32:47]
 rtr a[228:229], v201, 18560
 rtr a[230:231], v201, 20096
 rtr a[232:233], v200, 18688
 v_exp_f32 v251, v251
 v_add_f32 v249, v249, v250
 m32 a[48:63], a[236:239], v[192:195], a[48:63]
 rtr a[234:235], v200, 20224
 rtr a[236:237], v201, 18688
 rtr a[238:239], v201, 20224
 v_add_f32 v249, v249, v251
 cvt v178, v250, v251
 v_mul_f32 v250, s36, v150
 m32 a[64:79], a[240:243], v[192:195], a[64:79]
 v_mul_f32 v251, s36, v151
 v_exp_f32 v250, v250
 v_exp_f32 v251, v251
 v_add_f32 v249, v249, v250
 m32 a[80:95], a[244:247], v[192:195], a[80:95]
 v_add_f32 v249, v249, v251
 cvt v179, v250, v251
 v_mul_f32 v250, s36, v152
 v_mul_f32 v251, s36, v153
 s_waitcnt lgkmcnt(0)
 m32 a[0:15], a[248:251], v[196:199], a[0:15]
 v_exp_f32 v250, v250
 v_exp_f32 v251, v251
 s_nop 0
 cvt v180, v250, v251
 v_add_f32 v169, v250, v251
 m32 a[16:31], a[252:255], v[196:199], a[16:31]
 v_mul_f32 v250, s36, v154
 v_mul_f32 v251, s36, v155
 v_exp_f32 v250, v250
 s_barrier
 m32 a[32:47], a[224:227], v[196:199], a[32:47]
 ds_read_b128 a[240:243], v240
 ds_read_b128 a[244:247], v240 offset:6144
 v_exp_f32 v251, v251
 v_add_f32 v169, v169, v250
 v_add_f32 v169, v169, v251
 m32 a[48:63], a[228:231], v[196:199], a[48:63]
 ds_read_b128 a[248:251], v241
 ds_read_b128 a[252:255], v241 offset:6144
 cvt v181, v250, v251
 v_mul_f32 v250, s36, v156
 v_mul_f32 v251, s36, v157
 m32 a[64:79], a[232:235], v[196:199], a[64:79]
 ds_read_b128 a[224:227], v240 offset:128
 ds_read_b128 a[228:231], v240 offset:6272
 v_exp_f32 v250, v250
 v_exp_f32 v251, v251
 v_add_f32 v169, v169, v250
 v_add_f32 v169, v169, v251
 cvt v182, v250, v251
 v_mul_f32 v250, s36, v158
 v_mul_f32 v251, s36, v159
 v_exp_f32 v250, v250
 v_exp_f32 v251, v251
 v_add_f32 v169, v169, v250
 v_add_f32 v169, v169, v251
 cvt v183, v250, v251
 v_add_f32 v250, v249, v169
 v_cmp_nge_f32 s[48:49], s37, v250
 m32 a[80:95], a[236:239], v[196:199], a[80:95]
 ds_read_b128 a[232:235], v241 offset:128
 ds_read_b128 a[236:239], v241 offset:6272
 s_cmp_lg_u64 s[48:49], 0
 s_cbranch_scc1 RS2_0
RB2_0:
 v_add_f32 v248, v248, v249
 v_add_f32 v168, v168, v169
 s_waitcnt lgkmcnt(4)
 m16 v[144:147], a[240:243], v[96:99], v[160:163]
 m16 v[152:155], a[240:243], v[100:103], v[164:167]
 ds_read_b128 a[240:243], v240 offset:256
 m16 v[148:151], a[244:247], v[96:99], v[160:163]
 m16 v[156:159], a[244:247], v[100:103], v[164:167]
 ds_read_b128 a[244:247], v240 offset:6400
 m16 v[144:147], a[248:251], v[104:107], v[144:147]
 m16 v[152:155], a[248:251], v[108:111], v[152:155]
 ds_read_b128 a[248:251], v241 offset:256
 m16 v[148:151], a[252:255], v[104:107], v[148:151]
 m16 v[156:159], a[252:255], v[108:111], v[156:159]
 ds_read_b128 a[252:255], v241 offset:6400
 s_waitcnt lgkmcnt(2)
 m16 v[144:147], a[224:227], v[112:115], v[144:147]
 m16 v[152:155], a[224:227], v[116:119], v[152:155]
 m16 v[148:151], a[228:231], v[112:115], v[148:151]
 m16 v[156:159], a[228:231], v[116:119], v[156:159]
 m16 v[144:147], a[232:235], v[120:123], v[144:147]
 rtr a[224:225], v242, 24576
 m16 v[152:155], a[232:235], v[124:127], v[152:155]
 rtr a[226:227], v242, 30720
 m16 v[148:151], a[236:239], v[120:123], v[148:151]
 rtr a[228:229], v243, 24576
 m16 v[156:159], a[236:239], v[124:127], v[156:159]
 rtr a[230:231], v243, 30720
 m16 v[144:147], a[240:243], v[128:131], v[144:147]
 rtr a[232:233], v244, 24576
 m16 v[152:155], a[240:243], v[132:135], v[152:155]
 rtr a[234:235], v244, 30720
 m16 v[148:151], a[244:247], v[128:131], v[148:151]
 rtr a[236:237], v245, 24576
 m16 v[156:159], a[244:247], v[132:135], v[156:159]
 rtr a[238:239], v245, 30720
 s_waitcnt lgkmcnt(4)
 m16 v[144:147], a[248:251], v[136:139], v[144:147]
 rtr a[240:241], v242, 24704
 m16 v[152:155], a[248:251], v[140:143], v[152:155]
 rtr a[242:243], v242, 30848
 m16 v[148:151], a[252:255], v[136:139], v[148:151]
 rtr a[244:245], v243, 24704
 m16 v[156:159], a[252:255], v[140:143], v[156:159]
 rtr a[246:247], v243, 30848
 m16 v[0:3], a[224:227], v[176:179], v[0:3]
 rtr a[248:249], v244, 24704
 m16 v[8:11], a[224:227], v[180:183], v[8:11]
 rtr a[250:251], v244, 30848
 m16 v[4:7], a[228:231], v[176:179], v[4:7]
 rtr a[252:253], v245, 24704
 m16 v[12:15], a[228:231], v[180:183], v[12:15]
 rtr a[254:255], v245, 30848
 s_waitcnt lgkmcnt(4)
 m16 v[16:19], a[232:235], v[176:179], v[16:19]
 rtr a[224:225], v242, 24832
 m16 v[24:27], a[232:235], v[180:183], v[24:27]
 rtr a[226:227], v242, 30976
 v_mul_f32 v250, s36, v144
 v_mul_f32 v251, s36, v145
 m16 v[20:23], a[236:239], v[176:179], v[20:23]
 rtr a[228:229], v243, 24832
 m16 v[28:31], a[236:239], v[180:183], v[28:31]
 rtr a[230:231], v243, 30976
 v_exp_f32 v250, v250
 m16 v[32:35], a[240:243], v[176:179], v[32:35]
 rtr a[232:233], v244, 24832
 m16 v[40:43], a[240:243], v[180:183], v[40:43]
 rtr a[234:235], v244, 30976
 v_exp_f32 v251, v251
 m16 v[36:39], a[244:247], v[176:179], v[36:39]
 rtr a[236:237], v245, 24832
 cvt v184, v250, v251
 m16 v[44:47], a[244:247], v[180:183], v[44:47]
 rtr a[238:239], v245, 30976
 v_add_f32 v249, v250, v251
 s_waitcnt lgkmcnt(4)
 m16 v[48:51], a[248:251], v[176:179], v[48:51]
 ds_read_b128 v[192:195], v202 offset:24576
 v_mul_f32 v250, s36, v146
 m16 v[56:59], a[248:251], v[180:183], v[56:59]
 rtr a[240:241], v200
 rtr a[242:243], v200, 1536
 v_mul_f32 v251, s36, v147
 m16 v[52:55], a[252:255], v[176:179], v[52:55]
 rtr a[244:245], v201
 m16 v[60:63], a[252:255], v[180:183], v[60:63]
 rtr a[246:247], v201, 1536
 rtr a[248:249], v200, 128
 m16 v[64:67], a[224:227], v[176:179], v[64:67]
 rtr a[250:251], v200, 1664
 m16 v[72:75], a[224:227], v[180:183], v[72:75]
 rtr a[252:253], v201, 128
 v_exp_f32 v250, v250
 m16 v[68:71], a[228:231], v[176:179], v[68:71]
 rtr a[254:255], v201, 1664
 m16 v[76:79], a[228:231], v[180:183], v[76:79]
 rtr a[224:225], v200, 256
 s_waitcnt lgkmcnt(4)
 m16 v[80:83], a[232:235], v[176:179], v[80:83]
 rtr a[226:227], v200, 1792
 m16 v[88:91], a[232:235], v[180:183], v[88:91]
 rtr a[228:229], v201, 256
 v_exp_f32 v251, v251
 m16 v[84:87], a[236:239], v[176:179], v[84:87]
 rtr a[230:231], v201, 1792
 v_add_f32 v249, v249, v250
 m16 v[92:95], a[236:239], v[180:183], v[92:95]
 ds_read_b128 v[196:199], v203 offset:24576
 v_add_f32 v249, v249, v251
 cvt v185, v250, v251
 m32 a[0:15], a[240:243], v[192:195], a[0:15]
 rtr a[232:233], v200, 6144
 rtr a[234:235], v200, 7680
 rtr a[236:237], v201, 6144
 v_mul_f32 v250, s36, v148
 v_mul_f32 v251, s36, v149
 m32 a[16:31], a[244:247], v[192:195], a[16:31]
 rtr a[238:239], v201, 7680
 rtr a[240:241], v200, 6272
 rtr a[242:243], v200, 7808
 v_exp_f32 v250, v250
 s_waitcnt lgkmcnt(6)
 m32 a[32:47], a[248:251], v[192:195], a[32:47]
 rtr a[244:245], v201, 6272
 rtr a[246:247], v201, 7808
 rtr a[248:249], v200, 6400
 v_exp_f32 v251, v251
 v_add_f32 v249, v249, v250
 m32 a[48:63], a[252:255], v[192:195], a[48:63]
 rtr a[250:251], v200, 7936
 rtr a[252:253], v201, 6400
 rtr a[254:255], v201, 7936
 v_add_f32 v249, v249, v251
 cvt v186, v250, v251
 v_mul_f32 v250, s36, v150
 m32 a[64:79], a[224:227], v[192:195], a[64:79]
 v_mul_f32 v251, s36, v151
 v_exp_f32 v250, v250
 v_exp_f32 v251, v251
 v_add_f32 v249, v249, v250
 m32 a[80:95], a[228:231], v[192:195], a[80:95]
 v_add_f32 v249, v249, v251
 cvt v187, v250, v251
 v_mul_f32 v250, s36, v152
 v_mul_f32 v251, s36, v153
 s_waitcnt lgkmcnt(0)
 m32 a[0:15], a[232:235], v[196:199], a[0:15]
 v_exp_f32 v250, v250
 v_exp_f32 v251, v251
 s_nop 0
 cvt v188, v250, v251
 v_add_f32 v169, v250, v251
 m32 a[16:31], a[236:239], v[196:199], a[16:31]
 v_mul_f32 v250, s36, v154
 v_mul_f32 v251, s36, v155
 v_exp_f32 v250, v250
 s_barrier
 m32 a[32:47], a[240:243], v[196:199], a[32:47]
 ds_read_b128 a[224:227], v240 offset:12288
 ds_read_b128 a[228:231], v240 offset:18432
 v_exp_f32 v251, v251
 v_add_f32 v169, v169, v250
 v_add_f32 v169, v169, v251
 m32 a[48:63], a[244:247], v[196:199], a[48:63]
 ds_read_b128 a[232:235], v241 offset:12288
 ds_read_b128 a[236:239], v241 offset:18432
 cvt v189, v250, v251
 v_mul_f32 v250, s36, v156
 v_mul_f32 v251, s36, v157
 m32 a[64:79], a[248:251], v[196:199], a[64:79]
 ds_read_b128 a[240:243], v240 offset:12416
 ds_read_b128 a[244:247], v240 offset:18560
 v_exp_f32 v250, v250
 v_exp_f32 v251, v251
 v_add_f32 v169, v169, v250
 v_add_f32 v169, v169, v251
 cvt v190, v250, v251
 v_mul_f32 v250, s36, v158
 v_mul_f32 v251, s36, v159
 v_exp_f32 v250, v250
 v_exp_f32 v251, v251
 v_add_f32 v169, v169, v250
 v_add_f32 v169, v169, v251
 cvt v191, v250, v251
 v_add_f32 v250, v249, v169
 v_cmp_nge_f32 s[48:49], s37, v250
 m32 a[80:95], a[252:255], v[196:199], a[80:95]
 ds_read_b128 a[248:251], v241 offset:12416
 ds_read_b128 a[252:255], v241 offset:18560
 s_cmp_lg_u64 s[48:49], 0
 s_cbranch_scc1 RS3_0
RB3_0:
 v_add_f32 v248, v248, v249
 v_add_f32 v168, v168, v169
 s_waitcnt lgkmcnt(4)
 m16 v[144:147], a[224:227], v[96:99], v[160:163]
 m16 v[152:155], a[224:227], v[100:103], v[164:167]
 ds_read_b128 a[224:227], v240 offset:12544
 m16 v[148:151], a[228:231], v[96:99], v[160:163]
 m16 v[156:159], a[228:231], v[100:103], v[164:167]
 ds_read_b128 a[228:231], v240 offset:18688
 m16 v[144:147], a[232:235], v[104:107], v[144:147]
 m16 v[152:155], a[232:235], v[108:111], v[152:155]
 ds_read_b128 a[232:235], v241 offset:12544
 m16 v[148:151], a[236:239], v[104:107], v[148:151]
 m16 v[156:159], a[236:239], v[108:111], v[156:159]
 ds_read_b128 a[236:239], v241 offset:18688
 s_waitcnt lgkmcnt(2)
 m16 v[144:147], a[240:243], v[112:115], v[144:147]
 m16 v[152:155], a[240:243], v[116:119], v[152:155]
 m16 v[148:151], a[244:247], v[112:115], v[148:151]
 m16 v[156:159], a[244:247], v[116:119], v[156:159]
 m16 v[144:147], a[248:251], v[120:123], v[144:147]
 rtr a[240:241], v242, 36864
 m16 v[152:155], a[248:251], v[124:127], v[152:155]
 rtr a[242:243], v242, 43008
 m16 v[148:151], a[252:255], v[120:123], v[148:151]
 rtr a[244:245], v243, 36864
 m16 v[156:159], a[252:255], v[124:127], v[156:159]
 rtr a[246:247], v243, 43008
 m16 v[144:147], a[224:227], v[128:131], v[144:147]
 rtr a[248:249], v244, 36864
 m16 v[152:155], a[224:227], v[132:135], v[152:155]
 rtr a[250:251], v244, 43008
 m16 v[148:151], a[228:231], v[128:131], v[148:151]
 rtr a[252:253], v245, 36864
 m16 v[156:159], a[228:231], v[132:135], v[156:159]
 rtr a[254:255], v245, 43008
 s_waitcnt lgkmcnt(4)
 m16 v[144:147], a[232:235], v[136:139], v[144:147]
 rtr a[224:225], v242, 36992
 m16 v[152:155], a[232:235], v[140:143], v[152:155]
 rtr a[226:227], v242, 43136
 m16 v[148:151], a[236:239], v[136:139], v[148:151]
 rtr a[228:229], v243, 36992
 m16 v[156:159], a[236:239], v[140:143], v[156:159]
 rtr a[230:231], v243, 43136
 m16 v[0:3], a[240:243], v[184:187], v[0:3]
 rtr a[232:233], v244, 36992
 m16 v[8:11], a[240:243], v[188:191], v[8:11]
 rtr a[234:235], v244, 43136
 m16 v[4:7], a[244:247], v[184:187], v[4:7]
 rtr a[236:237], v245, 36992
 m16 v[12:15], a[244:247], v[188:191], v[12:15]
 rtr a[238:239], v245, 43136
 s_waitcnt lgkmcnt(4)
 m16 v[16:19], a[248:251], v[184:187], v[16:19]
 rtr a[240:241], v242, 37120
 m16 v[24:27], a[248:251], v[188:191], v[24:27]
 rtr a[242:243], v242, 43264
 v_mul_f32 v250, s36, v144
 v_mul_f32 v251, s36, v145
 m16 v[20:23], a[252:255], v[184:187], v[20:23]
 rtr a[244:245], v243, 37120
 m16 v[28:31], a[252:255], v[188:191], v[28:31]
 rtr a[246:247], v243, 43264
 v_exp_f32 v250, v250
 m16 v[32:35], a[224:227], v[184:187], v[32:35]
 rtr a[248:249], v244, 37120
 m16 v[40:43], a[224:227], v[188:191], v[40:43]
 rtr a[250:251], v244, 43264
 v_exp_f32 v251, v251
 m16 v[36:39], a[228:231], v[184:187], v[36:39]
 rtr a[252:253], v245, 37120
 cvt v176, v250, v251
 m16 v[44:47], a[228:231], v[188:191], v[44:47]
 rtr a[254:255], v245, 43264
 v_add_f32 v249, v250, v251
 s_waitcnt lgkmcnt(4)
 m16 v[48:51], a[232:235], v[184:187], v[48:51]
 ds_read_b128 v[192:195], v204 offset:24576
 v_mul_f32 v250, s36, v146
 m16 v[56:59], a[232:235], v[188:191], v[56:59]
 rtr a[224:225], v200, 12288
 rtr a[226:227], v200, 13824
 v_mul_f32 v251, s36, v147
 m16 v[52:55], a[236:239], v[184:187], v[52:55]
 rtr a[228:229], v201, 12288
 m16 v[60:63], a[236:239], v[188:191], v[60:63]
 rtr a[230:231], v201, 13824
 rtr a[232:233], v200, 12416
 m16 v[64:67], a[240:243], v[184:187], v[64:67]
 rtr a[234:235], v200, 13952
 m16 v[72:75], a[240:243], v[188:191], v[72:75]
 rtr a[236:237], v201, 12416
 v_exp_f32 v250, v250
 m16 v[68:71], a[244:247], v[184:187], v[68:71]
 rtr a[238:239], v201, 13952
 m16 v[76:79], a[244:247], v[188:191], v[76:79]
 rtr a[240:241], v200, 12544
 s_waitcnt lgkmcnt(4)
 m16 v[80:83], a[248:251], v[184:187], v[80:83]
 rtr a[242:243], v200, 14080
 m16 v[88:91], a[248:251], v[188:191], v[88:91]
 rtr a[244:245], v201, 12544
 v_exp_f32 v251, v251
 m16 v[84:87], a[252:255], v[184:187], v[84:87]
 rtr a[246:247], v201, 14080
 v_add_f32 v249, v249, v250
 m16 v[92:95], a[252:255], v[188:191], v[92:95]
 ds_read_b128 v[196:199], v205 offset:24576
 v_add_f32 v249, v249, v251
 cvt v177, v250, v251
 m32 a[0:15], a[224:227], v[192:195], a[0:15]
 rtr a[248:249], v200, 18432
 rtr a[250:251], v200, 19968
 rtr a[252:253], v201, 18432
 v_mul_f32 v250, s36, v148
 v_mul_f32 v251, s36, v149
 m32 a[16:31], a[228:231], v[192:195], a[16:31]
 rtr a[254:255], v201, 19968
 rtr a[224:225], v200, 18560
 rtr a[226:227], v200, 20096
 v_exp_f32 v250, v250
 s_waitcnt lgkmcnt(6)
 m32 a[32:47], a[232:235], v[192:195], a[32:47]
 rtr a[228:229], v201, 18560
 rtr a[230:231], v201, 20096
 rtr a[232:233], v200, 18688
 v_exp_f32 v251, v251
 v_add_f32 v249, v249, v250
 m32 a[48:63], a[236:239], v[192:195], a[48:63]
 rtr a[234:235], v200, 20224
 rtr a[236:237], v201, 18688
 rtr a[238:239], v201, 20224
 v_add_f32 v249, v249, v251
 cvt v178, v250, v251
 v_mul_f32 v250, s36, v150
 m32 a[64:79], a[240:243], v[192:195], a[64:79]
 v_mul_f32 v251, s36, v151
 v_exp_f32 v250, v250
 v_exp_f32 v251, v251
 v_add_f32 v249, v249, v250
 m32 a[80:95], a[244:247], v[192:195], a[80:95]
 v_add_f32 v249, v249, v251
 cvt v179, v250, v251
 v_mul_f32 v250, s36, v152
 v_mul_f32 v251, s36, v153
 s_waitcnt lgkmcnt(0)
 m32 a[0:15], a[248:251], v[196:199], a[0:15]
 v_exp_f32 v250, v250
 v_exp_f32 v251, v251
 s_nop 0
 cvt v180, v250, v251
 v_add_f32 v169, v250, v251
 m32 a[16:31], a[252:255], v[196:199], a[16:31]
 v_mul_f32 v250, s36, v154
 v_mul_f32 v251, s36, v155
 v_exp_f32 v250, v250
 s_barrier
 m32 a[32:47], a[224:227], v[196:199], a[32:47]
 ds_read_b128 a[240:243], v240 offset:24576
 ds_read_b128 a[244:247], v240 offset:30720
 v_exp_f32 v251, v251
 v_add_f32 v169, v169, v250
 v_add_f32 v169, v169, v251
 m32 a[48:63], a[228:231], v[196:199], a[48:63]
 ds_read_b128 a[248:251], v241 offset:24576
 ds_read_b128 a[252:255], v241 offset:30720
 cvt v181, v250, v251
 v_mul_f32 v250, s36, v156
 v_mul_f32 v251, s36, v157
 m32 a[64:79], a[232:235], v[196:199], a[64:79]
 ds_read_b128 a[224:227], v240 offset:24704
 ds_read_b128 a[228:231], v240 offset:30848
 v_exp_f32 v250, v250
 v_exp_f32 v251, v251
 v_add_f32 v169, v169, v250
 v_add_f32 v169, v169, v251
 cvt v182, v250, v251
 v_mul_f32 v250, s36, v158
 v_mul_f32 v251, s36, v159
 v_exp_f32 v250, v250
 v_exp_f32 v251, v251
 v_add_f32 v169, v169, v250
 v_add_f32 v169, v169, v251
 cvt v183, v250, v251
 v_add_f32 v250, v249, v169
 v_cmp_nge_f32 s[48:49], s37, v250
 m32 a[80:95], a[236:239], v[196:199], a[80:95]
 ds_read_b128 a[232:235], v241 offset:24704
 ds_read_b128 a[236:239], v241 offset:30848
 s_cmp_lg_u64 s[48:49], 0
 s_cbranch_scc1 RS4_0
RB4_0:
 v_add_f32 v248, v248, v249
 v_add_f32 v168, v168, v169
 s_waitcnt lgkmcnt(4)
 m16 v[144:147], a[240:243], v[96:99], v[160:163]
 m16 v[152:155], a[240:243], v[100:103], v[164:167]
 ds_read_b128 a[240:243], v240 offset:24832
 m16 v[148:151], a[244:247], v[96:99], v[160:163]
 m16 v[156:159], a[244:247], v[100:103], v[164:167]
 ds_read_b128 a[244:247], v240 offset:30976
 m16 v[144:147], a[248:251], v[104:107], v[144:147]
 m16 v[152:155], a[248:251], v[108:111], v[152:155]
 ds_read_b128 a[248:251], v241 offset:24832
 m16 v[148:151], a[252:255], v[104:107], v[148:151]
 m16 v[156:159], a[252:255], v[108:111], v[156:159]
 ds_read_b128 a[252:255], v241 offset:30976
 s_waitcnt lgkmcnt(2)
 m16 v[144:147], a[224:227], v[112:115], v[144:147]
 m16 v[152:155], a[224:227], v[116:119], v[152:155]
 m16 v[148:151], a[228:231], v[112:115], v[148:151]
 m16 v[156:159], a[228:231], v[116:119], v[156:159]
 m16 v[144:147], a[232:235], v[120:123], v[144:147]
 rtr a[224:225], v242
 m16 v[152:155], a[232:235], v[124:127], v[152:155]
 rtr a[226:227], v242, 6144
 m16 v[148:151], a[236:239], v[120:123], v[148:151]
 rtr a[228:229], v243
 m16 v[156:159], a[236:239], v[124:127], v[156:159]
 rtr a[230:231], v243, 6144
 m16 v[144:147], a[240:243], v[128:131], v[144:147]
 rtr a[232:233], v244
 m16 v[152:155], a[240:243], v[132:135], v[152:155]
 rtr a[234:235], v244, 6144
 m16 v[148:151], a[244:247], v[128:131], v[148:151]
 rtr a[236:237], v245
 m16 v[156:159], a[244:247], v[132:135], v[156:159]
 rtr a[238:239], v245, 6144
 s_waitcnt lgkmcnt(4)
 m16 v[144:147], a[248:251], v[136:139], v[144:147]
 rtr a[240:241], v242, 128
 m16 v[152:155], a[248:251], v[140:143], v[152:155]
 rtr a[242:243], v242, 6272
 m16 v[148:151], a[252:255], v[136:139], v[148:151]
 rtr a[244:245], v243, 128
 m16 v[156:159], a[252:255], v[140:143], v[156:159]
 rtr a[246:247], v243, 6272
 m16 v[0:3], a[224:227], v[176:179], v[0:3]
 rtr a[248:249], v244, 128
 m16 v[8:11], a[224:227], v[180:183], v[8:11]
 rtr a[250:251], v244, 6272
 m16 v[4:7], a[228:231], v[176:179], v[4:7]
 rtr a[252:253], v245, 128
 m16 v[12:15], a[228:231], v[180:183], v[12:15]
 rtr a[254:255], v245, 6272
 s_waitcnt lgkmcnt(4)
 m16 v[16:19], a[232:235], v[176:179], v[16:19]
 rtr a[224:225], v242, 256
 m16 v[24:27], a[232:235], v[180:183], v[24:27]
 rtr a[226:227], v242, 6400
 v_mul_f32 v250, s36, v144
 v_mul_f32 v251, s36, v145
 m16 v[20:23], a[236:239], v[176:179], v[20:23]
 rtr a[228:229], v243, 256
 m16 v[28:31], a[236:239], v[180:183], v[28:31]
 rtr a[230:231], v243, 6400
 v_exp_f32 v250, v250
 m16 v[32:35], a[240:243], v[176:179], v[32:35]
 rtr a[232:233], v244, 256
 m16 v[40:43], a[240:243], v[180:183], v[40:43]
 rtr a[234:235], v244, 6400
 v_exp_f32 v251, v251
 m16 v[36:39], a[244:247], v[176:179], v[36:39]
 rtr a[236:237], v245, 256
 cvt v184, v250, v251
 m16 v[44:47], a[244:247], v[180:183], v[44:47]
 rtr a[238:239], v245, 6400
 v_add_f32 v249, v250, v251
 s_waitcnt lgkmcnt(4)
 m16 v[48:51], a[248:251], v[176:179], v[48:51]
 ds_read_b128 v[192:195], v202 offset:36864
 v_mul_f32 v250, s36, v146
 m16 v[56:59], a[248:251], v[180:183], v[56:59]
 rtr a[240:241], v200
 rtr a[242:243], v200, 1536
 v_mul_f32 v251, s36, v147
 m16 v[52:55], a[252:255], v[176:179], v[52:55]
 rtr a[244:245], v201
 m16 v[60:63], a[252:255], v[180:183], v[60:63]
 rtr a[246:247], v201, 1536
 rtr a[248:249], v200, 128
 m16 v[64:67], a[224:227], v[176:179], v[64:67]
 rtr a[250:251], v200, 1664
 m16 v[72:75], a[224:227], v[180:183], v[72:75]
 rtr a[252:253], v201, 128
 v_exp_f32 v250, v250
 m16 v[68:71], a[228:231], v[176:179], v[68:71]
 rtr a[254:255], v201, 1664
 m16 v[76:79], a[228:231], v[180:183], v[76:79]
 rtr a[224:225], v200, 256
 s_waitcnt lgkmcnt(4)
 m16 v[80:83], a[232:235], v[176:179], v[80:83]
 rtr a[226:227], v200, 1792
 m16 v[88:91], a[232:235], v[180:183], v[88:91]
 rtr a[228:229], v201, 256
 v_exp_f32 v251, v251
 m16 v[84:87], a[236:239], v[176:179], v[84:87]
 rtr a[230:231], v201, 1792
 v_add_f32 v249, v249, v250
 m16 v[92:95], a[236:239], v[180:183], v[92:95]
 ds_read_b128 v[196:199], v203 offset:36864
 v_add_f32 v249, v249, v251
 cvt v185, v250, v251
 m32 a[0:15], a[240:243], v[192:195], a[0:15]
 rtr a[232:233], v200, 6144
 rtr a[234:235], v200, 7680
 rtr a[236:237], v201, 6144
 v_mul_f32 v250, s36, v148
 v_mul_f32 v251, s36, v149
 m32 a[16:31], a[244:247], v[192:195], a[16:31]
 rtr a[238:239], v201, 7680
 rtr a[240:241], v200, 6272
 rtr a[242:243], v200, 7808
 v_exp_f32 v250, v250
 s_waitcnt lgkmcnt(6)
 m32 a[32:47], a[248:251], v[192:195], a[32:47]
 rtr a[244:245], v201, 6272
 rtr a[246:247], v201, 7808
 rtr a[248:249], v200, 6400
 v_exp_f32 v251, v251
 v_add_f32 v249, v249, v250
 m32 a[48:63], a[252:255], v[192:195], a[48:63]
 rtr a[250:251], v200, 7936
 rtr a[252:253], v201, 6400
 rtr a[254:255], v201, 7936
 v_add_f32 v249, v249, v251
 cvt v186, v250, v251
 v_mul_f32 v250, s36, v150
 m32 a[64:79], a[224:227], v[192:195], a[64:79]
 v_mul_f32 v251, s36, v151
 v_exp_f32 v250, v250
 v_exp_f32 v251, v251
 v_add_f32 v249, v249, v250
 m32 a[80:95], a[228:231], v[192:195], a[80:95]
 v_add_f32 v249, v249, v251
 cvt v187, v250, v251
 v_mul_f32 v250, s36, v152
 v_mul_f32 v251, s36, v153
 s_waitcnt lgkmcnt(0)
 m32 a[0:15], a[232:235], v[196:199], a[0:15]
 v_exp_f32 v250, v250
 v_exp_f32 v251, v251
 s_nop 0
 cvt v188, v250, v251
 v_add_f32 v169, v250, v251
 m32 a[16:31], a[236:239], v[196:199], a[16:31]
 v_mul_f32 v250, s36, v154
 v_mul_f32 v251, s36, v155
 v_exp_f32 v250, v250
 s_barrier
 m32 a[32:47], a[240:243], v[196:199], a[32:47]
 ds_read_b128 a[224:227], v240
 ds_read_b128 a[228:231], v240 offset:6144
 v_exp_f32 v251, v251
 v_add_f32 v169, v169, v250
 v_add_f32 v169, v169, v251
 m32 a[48:63], a[244:247], v[196:199], a[48:63]
 ds_read_b128 a[232:235], v241
 ds_read_b128 a[236:239], v241 offset:6144
 cvt v189, v250, v251
 v_mul_f32 v250, s36, v156
 v_mul_f32 v251, s36, v157
 m32 a[64:79], a[248:251], v[196:199], a[64:79]
 ds_read_b128 a[240:243], v240 offset:128
 ds_read_b128 a[244:247], v240 offset:6272
 v_exp_f32 v250, v250
 v_exp_f32 v251, v251
 v_add_f32 v169, v169, v250
 v_add_f32 v169, v169, v251
 cvt v190, v250, v251
 v_mul_f32 v250, s36, v158
 v_mul_f32 v251, s36, v159
 v_exp_f32 v250, v250
 v_exp_f32 v251, v251
 v_add_f32 v169, v169, v250
 v_add_f32 v169, v169, v251
 cvt v191, v250, v251
 v_add_f32 v250, v249, v169
 v_cmp_nge_f32 s[48:49], s37, v250
 m32 a[80:95], a[252:255], v[196:199], a[80:95]
 ds_read_b128 a[248:251], v241 offset:128
 ds_read_b128 a[252:255], v241 offset:6272
 s_cmp_lg_u64 s[48:49], 0
 s_cbranch_scc1 RS5_0
RB5_0:
 v_add_f32 v248, v248, v249
 v_add_f32 v168, v168, v169
 s_waitcnt lgkmcnt(4)
 m16 v[144:147], a[224:227], v[96:99], v[160:163]
 m16 v[152:155], a[224:227], v[100:103], v[164:167]
 ds_read_b128 a[224:227], v240 offset:256
 m16 v[148:151], a[228:231], v[96:99], v[160:163]
 m16 v[156:159], a[228:231], v[100:103], v[164:167]
 ds_read_b128 a[228:231], v240 offset:6400
 m16 v[144:147], a[232:235], v[104:107], v[144:147]
 m16 v[152:155], a[232:235], v[108:111], v[152:155]
 ds_read_b128 a[232:235], v241 offset:256
 m16 v[148:151], a[236:239], v[104:107], v[148:151]
 m16 v[156:159], a[236:239], v[108:111], v[156:159]
 ds_read_b128 a[236:239], v241 offset:6400
 s_waitcnt lgkmcnt(2)
 m16 v[144:147], a[240:243], v[112:115], v[144:147]
 m16 v[152:155], a[240:243], v[116:119], v[152:155]
 m16 v[148:151], a[244:247], v[112:115], v[148:151]
 m16 v[156:159], a[244:247], v[116:119], v[156:159]
 m16 v[144:147], a[248:251], v[120:123], v[144:147]
 rtr a[240:241], v242, 12288
 m16 v[152:155], a[248:251], v[124:127], v[152:155]
 rtr a[242:243], v242, 18432
 m16 v[148:151], a[252:255], v[120:123], v[148:151]
 rtr a[244:245], v243, 12288
 m16 v[156:159], a[252:255], v[124:127], v[156:159]
 rtr a[246:247], v243, 18432
 m16 v[144:147], a[224:227], v[128:131], v[144:147]
 rtr a[248:249], v244, 12288
 m16 v[152:155], a[224:227], v[132:135], v[152:155]
 rtr a[250:251], v244, 18432
 m16 v[148:151], a[228:231], v[128:131], v[148:151]
 rtr a[252:253], v245, 12288
 m16 v[156:159], a[228:231], v[132:135], v[156:159]
 rtr a[254:255], v245, 18432
 s_waitcnt lgkmcnt(4)
 m16 v[144:147], a[232:235], v[136:139], v[144:147]
 rtr a[224:225], v242, 12416
 m16 v[152:155], a[232:235], v[140:143], v[152:155]
 rtr a[226:227], v242, 18560
 m16 v[148:151], a[236:239], v[136:139], v[148:151]
 rtr a[228:229], v243, 12416
 m16 v[156:159], a[236:239], v[140:143], v[156:159]
 rtr a[230:231], v243, 18560
 m16 v[0:3], a[240:243], v[184:187], v[0:3]
 rtr a[232:233], v244, 12416
 m16 v[8:11], a[240:243], v[188:191], v[8:11]
 rtr a[234:235], v244, 18560
 m16 v[4:7], a[244:247], v[184:187], v[4:7]
 rtr a[236:237], v245, 12416
 m16 v[12:15], a[244:247], v[188:191], v[12:15]
 rtr a[238:239], v245, 18560
 s_waitcnt lgkmcnt(4)
 m16 v[16:19], a[248:251], v[184:187], v[16:19]
 rtr a[240:241], v242, 12544
 m16 v[24:27], a[248:251], v[188:191], v[24:27]
 rtr a[242:243], v242, 18688
 v_mul_f32 v250, s36, v144
 v_mul_f32 v251, s36, v145
 m16 v[20:23], a[252:255], v[184:187], v[20:23]
 rtr a[244:245], v243, 12544
 m16 v[28:31], a[252:255], v[188:191], v[28:31]
 rtr a[246:247], v243, 18688
 v_exp_f32 v250, v250
 m16 v[32:35], a[224:227], v[184:187], v[32:35]
 rtr a[248:249], v244, 12544
 m16 v[40:43], a[224:227], v[188:191], v[40:43]
 rtr a[250:251], v244, 18688
 v_exp_f32 v251, v251
 m16 v[36:39], a[228:231], v[184:187], v[36:39]
 rtr a[252:253], v245, 12544
 cvt v176, v250, v251
 m16 v[44:47], a[228:231], v[188:191], v[44:47]
 rtr a[254:255], v245, 18688
 v_add_f32 v249, v250, v251
 s_waitcnt lgkmcnt(4)
 m16 v[48:51], a[232:235], v[184:187], v[48:51]
 ds_read_b128 v[192:195], v204 offset:36864
 v_mul_f32 v250, s36, v146
 m16 v[56:59], a[232:235], v[188:191], v[56:59]
 rtr a[224:225], v200, 12288
 rtr a[226:227], v200, 13824
 v_mul_f32 v251, s36, v147
 m16 v[52:55], a[236:239], v[184:187], v[52:55]
 rtr a[228:229], v201, 12288
 m16 v[60:63], a[236:239], v[188:191], v[60:63]
 rtr a[230:231], v201, 13824
 rtr a[232:233], v200, 12416
 m16 v[64:67], a[240:243], v[184:187], v[64:67]
 rtr a[234:235], v200, 13952
 m16 v[72:75], a[240:243], v[188:191], v[72:75]
 rtr a[236:237], v201, 12416
 v_exp_f32 v250, v250
 m16 v[68:71], a[244:247], v[184:187], v[68:71]
 rtr a[238:239], v201, 13952
 m16 v[76:79], a[244:247], v[188:191], v[76:79]
 rtr a[240:241], v200, 12544
 s_waitcnt lgkmcnt(4)
 m16 v[80:83], a[248:251], v[184:187], v[80:83]
 rtr a[242:243], v200, 14080
 m16 v[88:91], a[248:251], v[188:191], v[88:91]
 rtr a[244:245], v201, 12544
 v_exp_f32 v251, v251
 m16 v[84:87], a[252:255], v[184:187], v[84:87]
 rtr a[246:247], v201, 14080
 v_add_f32 v249, v249, v250
 m16 v[92:95], a[252:255], v[188:191], v[92:95]
 ds_read_b128 v[196:199], v205 offset:36864
 v_add_f32 v249, v249, v251
 cvt v177, v250, v251
 m32 a[0:15], a[224:227], v[192:195], a[0:15]
 rtr a[248:249], v200, 18432
 rtr a[250:251], v200, 19968
 rtr a[252:253], v201, 18432
 v_mul_f32 v250, s36, v148
 v_mul_f32 v251, s36, v149
 m32 a[16:31], a[228:231], v[192:195], a[16:31]
 rtr a[254:255], v201, 19968
 rtr a[224:225], v200, 18560
 rtr a[226:227], v200, 20096
 v_exp_f32 v250, v250
 s_waitcnt lgkmcnt(6)
 m32 a[32:47], a[232:235], v[192:195], a[32:47]
 rtr a[228:229], v201, 18560
 rtr a[230:231], v201, 20096
 rtr a[232:233], v200, 18688
 v_exp_f32 v251, v251
 v_add_f32 v249, v249, v250
 m32 a[48:63], a[236:239], v[192:195], a[48:63]
 rtr a[234:235], v200, 20224
 rtr a[236:237], v201, 18688
 rtr a[238:239], v201, 20224
 v_add_f32 v249, v249, v251
 cvt v178, v250, v251
 v_mul_f32 v250, s36, v150
 m32 a[64:79], a[240:243], v[192:195], a[64:79]
 v_mul_f32 v251, s36, v151
 v_exp_f32 v250, v250
 v_exp_f32 v251, v251
 v_add_f32 v249, v249, v250
 m32 a[80:95], a[244:247], v[192:195], a[80:95]
 v_add_f32 v249, v249, v251
 cvt v179, v250, v251
 v_mul_f32 v250, s36, v152
 v_mul_f32 v251, s36, v153
 s_waitcnt lgkmcnt(0)
 m32 a[0:15], a[248:251], v[196:199], a[0:15]
 v_exp_f32 v250, v250
 v_exp_f32 v251, v251
 s_nop 0
 cvt v180, v250, v251
 v_add_f32 v169, v250, v251
 m32 a[16:31], a[252:255], v[196:199], a[16:31]
 v_mul_f32 v250, s36, v154
 v_mul_f32 v251, s36, v155
 v_exp_f32 v250, v250
 s_barrier
 m32 a[32:47], a[224:227], v[196:199], a[32:47]
 ds_read_b128 a[240:243], v240 offset:12288
 ds_read_b128 a[244:247], v240 offset:18432
 v_exp_f32 v251, v251
 v_add_f32 v169, v169, v250
 v_add_f32 v169, v169, v251
 m32 a[48:63], a[228:231], v[196:199], a[48:63]
 ds_read_b128 a[248:251], v241 offset:12288
 ds_read_b128 a[252:255], v241 offset:18432
 cvt v181, v250, v251
 v_mul_f32 v250, s36, v156
 v_mul_f32 v251, s36, v157
 m32 a[64:79], a[232:235], v[196:199], a[64:79]
 ds_read_b128 a[224:227], v240 offset:12416
 ds_read_b128 a[228:231], v240 offset:18560
 v_exp_f32 v250, v250
 v_exp_f32 v251, v251
 v_add_f32 v169, v169, v250
 v_add_f32 v169, v169, v251
 cvt v182, v250, v251
 v_mul_f32 v250, s36, v158
 v_mul_f32 v251, s36, v159
 v_exp_f32 v250, v250
 v_exp_f32 v251, v251
 v_add_f32 v169, v169, v250
 v_add_f32 v169, v169, v251
 cvt v183, v250, v251
 v_add_f32 v250, v249, v169
 v_cmp_nge_f32 s[48:49], s37, v250
 m32 a[80:95], a[236:239], v[196:199], a[80:95]
 ds_read_b128 a[232:235], v241 offset:12416
 ds_read_b128 a[236:239], v241 offset:18560
 s_cmp_lg_u64 s[48:49], 0
 s_cbranch_scc1 RS6_0
RB6_0:
 v_add_f32 v248, v248, v249
 v_add_f32 v168, v168, v169
 s_waitcnt lgkmcnt(4)
 m16 v[144:147], a[240:243], v[96:99], v[160:163]
 m16 v[152:155], a[240:243], v[100:103], v[164:167]
 ds_read_b128 a[240:243], v240 offset:12544
 m16 v[148:151], a[244:247], v[96:99], v[160:163]
 m16 v[156:159], a[244:247], v[100:103], v[164:167]
 ds_read_b128 a[244:247], v240 offset:18688
 m16 v[144:147], a[248:251], v[104:107], v[144:147]
 m16 v[152:155], a[248:251], v[108:111], v[152:155]
 ds_read_b128 a[248:251], v241 offset:12544
 m16 v[148:151], a[252:255], v[104:107], v[148:151]
 m16 v[156:159], a[252:255], v[108:111], v[156:159]
 ds_read_b128 a[252:255], v241 offset:18688
 s_waitcnt lgkmcnt(2)
 m16 v[144:147], a[224:227], v[112:115], v[144:147]
 m16 v[152:155], a[224:227], v[116:119], v[152:155]
 m16 v[148:151], a[228:231], v[112:115], v[148:151]
 m16 v[156:159], a[228:231], v[116:119], v[156:159]
 m16 v[144:147], a[232:235], v[120:123], v[144:147]
 rtr a[224:225], v242, 24576
 m16 v[152:155], a[232:235], v[124:127], v[152:155]
 rtr a[226:227], v242, 30720
 m16 v[148:151], a[236:239], v[120:123], v[148:151]
 rtr a[228:229], v243, 24576
 m16 v[156:159], a[236:239], v[124:127], v[156:159]
 rtr a[230:231], v243, 30720
 m16 v[144:147], a[240:243], v[128:131], v[144:147]
 rtr a[232:233], v244, 24576
 m16 v[152:155], a[240:243], v[132:135], v[152:155]
 rtr a[234:235], v244, 30720
 m16 v[148:151], a[244:247], v[128:131], v[148:151]
 rtr a[236:237], v245, 24576
 m16 v[156:159], a[244:247], v[132:135], v[156:159]
 rtr a[238:239], v245, 30720
 s_waitcnt lgkmcnt(4)
 m16 v[144:147], a[248:251], v[136:139], v[144:147]
 rtr a[240:241], v242, 24704
 m16 v[152:155], a[248:251], v[140:143], v[152:155]
 rtr a[242:243], v242, 30848
 m16 v[148:151], a[252:255], v[136:139], v[148:151]
 rtr a[244:245], v243, 24704
 m16 v[156:159], a[252:255], v[140:143], v[156:159]
 rtr a[246:247], v243, 30848
 m16 v[0:3], a[224:227], v[176:179], v[0:3]
 rtr a[248:249], v244, 24704
 m16 v[8:11], a[224:227], v[180:183], v[8:11]
 rtr a[250:251], v244, 30848
 m16 v[4:7], a[228:231], v[176:179], v[4:7]
 rtr a[252:253], v245, 24704
 m16 v[12:15], a[228:231], v[180:183], v[12:15]
 rtr a[254:255], v245, 30848
 s_waitcnt lgkmcnt(4)
 m16 v[16:19], a[232:235], v[176:179], v[16:19]
 rtr a[224:225], v242, 24832
 m16 v[24:27], a[232:235], v[180:183], v[24:27]
 rtr a[226:227], v242, 30976
 v_mul_f32 v250, s36, v144
 v_mul_f32 v251, s36, v145
 m16 v[20:23], a[236:239], v[176:179], v[20:23]
 rtr a[228:229], v243, 24832
 m16 v[28:31], a[236:239], v[180:183], v[28:31]
 rtr a[230:231], v243, 30976
 v_exp_f32 v250, v250
 m16 v[32:35], a[240:243], v[176:179], v[32:35]
 rtr a[232:233], v244, 24832
 m16 v[40:43], a[240:243], v[180:183], v[40:43]
 rtr a[234:235], v244, 30976
 v_exp_f32 v251, v251
 m16 v[36:39], a[244:247], v[176:179], v[36:39]
 rtr a[236:237], v245, 24832
 cvt v184, v250, v251
 m16 v[44:47], a[244:247], v[180:183], v[44:47]
 rtr a[238:239], v245, 30976
 v_add_f32 v249, v250, v251
 s_waitcnt lgkmcnt(4)
 m16 v[48:51], a[248:251], v[176:179], v[48:51]
 ds_read_b128 v[192:195], v202 offset:24576
 v_mul_f32 v250, s36, v146
 m16 v[56:59], a[248:251], v[180:183], v[56:59]
 rtr a[240:241], v200
 rtr a[242:243], v200, 1536
 v_mul_f32 v251, s36, v147
 m16 v[52:55], a[252:255], v[176:179], v[52:55]
 rtr a[244:245], v201
 m16 v[60:63], a[252:255], v[180:183], v[60:63]
 rtr a[246:247], v201, 1536
 rtr a[248:249], v200, 128
 m16 v[64:67], a[224:227], v[176:179], v[64:67]
 rtr a[250:251], v200, 1664
 m16 v[72:75], a[224:227], v[180:183], v[72:75]
 rtr a[252:253], v201, 128
 v_exp_f32 v250, v250
 m16 v[68:71], a[228:231], v[176:179], v[68:71]
 rtr a[254:255], v201, 1664
 m16 v[76:79], a[228:231], v[180:183], v[76:79]
 rtr a[224:225], v200, 256
 s_waitcnt lgkmcnt(4)
 m16 v[80:83], a[232:235], v[176:179], v[80:83]
 rtr a[226:227], v200, 1792
 m16 v[88:91], a[232:235], v[180:183], v[88:91]
 rtr a[228:229], v201, 256
 v_exp_f32 v251, v251
 m16 v[84:87], a[236:239], v[176:179], v[84:87]
 rtr a[230:231], v201, 1792
 v_add_f32 v249, v249, v250
 m16 v[92:95], a[236:239], v[180:183], v[92:95]
 ds_read_b128 v[196:199], v203 offset:24576
 v_add_f32 v249, v249, v251
 cvt v185, v250, v251
 m32 a[0:15], a[240:243], v[192:195], a[0:15]
 rtr a[232:233], v200, 6144
 rtr a[234:235], v200, 7680
 rtr a[236:237], v201, 6144
 v_mul_f32 v250, s36, v148
 v_mul_f32 v251, s36, v149
 m32 a[16:31], a[244:247], v[192:195], a[16:31]
 rtr a[238:239], v201, 7680
 rtr a[240:241], v200, 6272
 rtr a[242:243], v200, 7808
 v_exp_f32 v250, v250
 s_waitcnt lgkmcnt(6)
 m32 a[32:47], a[248:251], v[192:195], a[32:47]
 rtr a[244:245], v201, 6272
 rtr a[246:247], v201, 7808
 rtr a[248:249], v200, 6400
 v_exp_f32 v251, v251
 v_add_f32 v249, v249, v250
 m32 a[48:63], a[252:255], v[192:195], a[48:63]
 rtr a[250:251], v200, 7936
 rtr a[252:253], v201, 6400
 rtr a[254:255], v201, 7936
 v_add_f32 v249, v249, v251
 cvt v186, v250, v251
 v_mul_f32 v250, s36, v150
 m32 a[64:79], a[224:227], v[192:195], a[64:79]
 v_mul_f32 v251, s36, v151
 v_exp_f32 v250, v250
 v_exp_f32 v251, v251
 v_add_f32 v249, v249, v250
 m32 a[80:95], a[228:231], v[192:195], a[80:95]
 v_add_f32 v249, v249, v251
 cvt v187, v250, v251
 v_mul_f32 v250, s36, v152
 v_mul_f32 v251, s36, v153
 s_waitcnt lgkmcnt(0)
 m32 a[0:15], a[232:235], v[196:199], a[0:15]
 v_exp_f32 v250, v250
 v_exp_f32 v251, v251
 s_nop 0
 cvt v188, v250, v251
 v_add_f32 v169, v250, v251
 m32 a[16:31], a[236:239], v[196:199], a[16:31]
 v_mul_f32 v250, s36, v154
 v_mul_f32 v251, s36, v155
 v_exp_f32 v250, v250
 s_barrier
 m32 a[32:47], a[240:243], v[196:199], a[32:47]
 ds_read_b128 a[224:227], v240 offset:24576
 ds_read_b128 a[228:231], v240 offset:30720
 v_exp_f32 v251, v251
 v_add_f32 v169, v169, v250
 v_add_f32 v169, v169, v251
 m32 a[48:63], a[244:247], v[196:199], a[48:63]
 ds_read_b128 a[232:235], v241 offset:24576
 ds_read_b128 a[236:239], v241 offset:30720
 cvt v189, v250, v251
 v_mul_f32 v250, s36, v156
 v_mul_f32 v251, s36, v157
 m32 a[64:79], a[248:251], v[196:199], a[64:79]
 ds_read_b128 a[240:243], v240 offset:24704
 ds_read_b128 a[244:247], v240 offset:30848
 v_exp_f32 v250, v250
 v_exp_f32 v251, v251
 v_add_f32 v169, v169, v250
 v_add_f32 v169, v169, v251
 cvt v190, v250, v251
 v_mul_f32 v250, s36, v158
 v_mul_f32 v251, s36, v159
 v_exp_f32 v250, v250
 v_exp_f32 v251, v251
 v_add_f32 v169, v169, v250
 v_add_f32 v169, v169, v251
 cvt v191, v250, v251
 v_add_f32 v250, v249, v169
 v_cmp_nge_f32 s[48:49], s37, v250
 m32 a[80:95], a[252:255], v[196:199], a[80:95]
 ds_read_b128 a[248:251], v241 offset:24704
 ds_read_b128 a[252:255], v241 offset:30848
 s_cmp_lg_u64 s[48:49], 0
 s_cbranch_scc1 RS7_0
RB7_0:
 v_add_f32 v248, v248, v249
 v_add_f32 v168, v168, v169
 s_waitcnt lgkmcnt(4)
 m16 v[144:147], a[224:227], v[96:99], v[160:163]
 m16 v[152:155], a[224:227], v[100:103], v[164:167]
 ds_read_b128 a[224:227], v240 offset:24832
 m16 v[148:151], a[228:231], v[96:99], v[160:163]
 m16 v[156:159], a[228:231], v[100:103], v[164:167]
 ds_read_b128 a[228:231], v240 offset:30976
 m16 v[144:147], a[232:235], v[104:107], v[144:147]
 m16 v[152:155], a[232:235], v[108:111], v[152:155]
 ds_read_b128 a[232:235], v241 offset:24832
 m16 v[148:151], a[236:239], v[104:107], v[148:151]
 m16 v[156:159], a[236:239], v[108:111], v[156:159]
 ds_read_b128 a[236:239], v241 offset:30976
 s_waitcnt lgkmcnt(2)
 m16 v[144:147], a[240:243], v[112:115], v[144:147]
 m16 v[152:155], a[240:243], v[116:119], v[152:155]
 m16 v[148:151], a[244:247], v[112:115], v[148:151]
 m16 v[156:159], a[244:247], v[116:119], v[156:159]
 m16 v[144:147], a[248:251], v[120:123], v[144:147]
 rtr a[240:241], v242, 36864
 m16 v[152:155], a[248:251], v[124:127], v[152:155]
 rtr a[242:243], v242, 43008
 m16 v[148:151], a[252:255], v[120:123], v[148:151]
 rtr a[244:245], v243, 36864
 m16 v[156:159], a[252:255], v[124:127], v[156:159]
 rtr a[246:247], v243, 43008
 m16 v[144:147], a[224:227], v[128:131], v[144:147]
 rtr a[248:249], v244, 36864
 m16 v[152:155], a[224:227], v[132:135], v[152:155]
 rtr a[250:251], v244, 43008
 m16 v[148:151], a[228:231], v[128:131], v[148:151]
 rtr a[252:253], v245, 36864
 m16 v[156:159], a[228:231], v[132:135], v[156:159]
 rtr a[254:255], v245, 43008
 s_waitcnt lgkmcnt(4)
 m16 v[144:147], a[232:235], v[136:139], v[144:147]
 rtr a[224:225], v242, 36992
 m16 v[152:155], a[232:235], v[140:143], v[152:155]
 rtr a[226:227], v242, 43136
 m16 v[148:151], a[236:239], v[136:139], v[148:151]
 rtr a[228:229], v243, 36992
 m16 v[156:159], a[236:239], v[140:143], v[156:159]
 rtr a[230:231], v243, 43136
 m16 v[0:3], a[240:243], v[184:187], v[0:3]
 rtr a[232:233], v244, 36992
 m16 v[8:11], a[240:243], v[188:191], v[8:11]
 rtr a[234:235], v244, 43136
 m16 v[4:7], a[244:247], v[184:187], v[4:7]
 rtr a[236:237], v245, 36992
 m16 v[12:15], a[244:247], v[188:191], v[12:15]
 rtr a[238:239], v245, 43136
 s_waitcnt lgkmcnt(4)
 m16 v[16:19], a[248:251], v[184:187], v[16:19]
 rtr a[240:241], v242, 37120
 m16 v[24:27], a[248:251], v[188:191], v[24:27]
 rtr a[242:243], v242, 43264
 v_mul_f32 v250, s36, v144
 v_mul_f32 v251, s36, v145
 m16 v[20:23], a[252:255], v[184:187], v[20:23]
 rtr a[244:245], v243, 37120
 m16 v[28:31], a[252:255], v[188:191], v[28:31]
 rtr a[246:247], v243, 43264
 v_exp_f32 v250, v250
 m16 v[32:35], a[224:227], v[184:187], v[32:35]
 rtr a[248:249], v244, 37120
 m16 v[40:43], a[224:227], v[188:191], v[40:43]
 rtr a[250:251], v244, 43264
 v_exp_f32 v251, v251
 m16 v[36:39], a[228:231], v[184:187], v[36:39]
 rtr a[252:253], v245, 37120
 cvt v176, v250, v251
 m16 v[44:47], a[228:231], v[188:191], v[44:47]
 rtr a[254:255], v245, 43264
 v_add_f32 v249, v250, v251
 s_waitcnt lgkmcnt(4)
 m16 v[48:51], a[232:235], v[184:187], v[48:51]
 ds_read_b128 v[192:195], v204 offset:24576
 v_mul_f32 v250, s36, v146
 m16 v[56:59], a[232:235], v[188:191], v[56:59]
 rtr a[224:225], v200, 12288
 rtr a[226:227], v200, 13824
 v_mul_f32 v251, s36, v147
 m16 v[52:55], a[236:239], v[184:187], v[52:55]
 rtr a[228:229], v201, 12288
 m16 v[60:63], a[236:239], v[188:191], v[60:63]
 rtr a[230:231], v201, 13824
 rtr a[232:233], v200, 12416
 m16 v[64:67], a[240:243], v[184:187], v[64:67]
 rtr a[234:235], v200, 13952
 m16 v[72:75], a[240:243], v[188:191], v[72:75]
 rtr a[236:237], v201, 12416
 v_exp_f32 v250, v250
 m16 v[68:71], a[244:247], v[184:187], v[68:71]
 rtr a[238:239], v201, 13952
 m16 v[76:79], a[244:247], v[188:191], v[76:79]
 rtr a[240:241], v200, 12544
 s_waitcnt lgkmcnt(4)
 m16 v[80:83], a[248:251], v[184:187], v[80:83]
 rtr a[242:243], v200, 14080
 m16 v[88:91], a[248:251], v[188:191], v[88:91]
 rtr a[244:245], v201, 12544
 v_exp_f32 v251, v251
 m16 v[84:87], a[252:255], v[184:187], v[84:87]
 rtr a[246:247], v201, 14080
 v_add_f32 v249, v249, v250
 m16 v[92:95], a[252:255], v[188:191], v[92:95]
 ds_read_b128 v[196:199], v205 offset:24576
 v_add_f32 v249, v249, v251
 cvt v177, v250, v251
 m32 a[0:15], a[224:227], v[192:195], a[0:15]
 rtr a[248:249], v200, 18432
 rtr a[250:251], v200, 19968
 rtr a[252:253], v201, 18432
 v_mul_f32 v250, s36, v148
 v_mul_f32 v251, s36, v149
 m32 a[16:31], a[228:231], v[192:195], a[16:31]
 rtr a[254:255], v201, 19968
 rtr a[224:225], v200, 18560
 rtr a[226:227], v200, 20096
 v_exp_f32 v250, v250
 s_waitcnt lgkmcnt(6)
 m32 a[32:47], a[232:235], v[192:195], a[32:47]
 rtr a[228:229], v201, 18560
 rtr a[230:231], v201, 20096
 rtr a[232:233], v200, 18688
 v_exp_f32 v251, v251
 v_add_f32 v249, v249, v250
 m32 a[48:63], a[236:239], v[192:195], a[48:63]
 rtr a[234:235], v200, 20224
 rtr a[236:237], v201, 18688
 rtr a[238:239], v201, 20224
 v_add_f32 v249, v249, v251
 cvt v178, v250, v251
 v_mul_f32 v250, s36, v150
 m32 a[64:79], a[240:243], v[192:195], a[64:79]
 v_mul_f32 v251, s36, v151
 v_exp_f32 v250, v250
 v_exp_f32 v251, v251
 v_add_f32 v249, v249, v250
 m32 a[80:95], a[244:247], v[192:195], a[80:95]
 v_add_f32 v249, v249, v251
 cvt v179, v250, v251
 v_mul_f32 v250, s36, v152
 v_mul_f32 v251, s36, v153
 s_waitcnt lgkmcnt(0)
 m32 a[0:15], a[248:251], v[196:199], a[0:15]
 v_exp_f32 v250, v250
 v_exp_f32 v251, v251
 s_barrier
 m32 a[16:31], a[252:255], v[196:199], a[16:31]
 ds_read_b128 v[192:195], v202 offset:36864
 rtr a[240:241], v200
 rtr a[242:243], v200, 1536
 cvt v180, v250, v251
 v_add_f32 v169, v250, v251
 v_mul_f32 v250, s36, v154
 m32 a[32:47], a[224:227], v[196:199], a[32:47]
 rtr a[244:245], v201
 rtr a[246:247], v201, 1536
 rtr a[248:249], v200, 128
 v_mul_f32 v251, s36, v155
 v_exp_f32 v250, v250
 m32 a[48:63], a[228:231], v[196:199], a[48:63]
 rtr a[250:251], v200, 1664
 rtr a[252:253], v201, 128
 rtr a[254:255], v201, 1664
 v_exp_f32 v251, v251
 v_add_f32 v169, v169, v250
 m32 a[64:79], a[232:235], v[196:199], a[64:79]
 rtr a[224:225], v200, 256
 rtr a[226:227], v200, 1792
 rtr a[228:229], v201, 256
 v_add_f32 v169, v169, v251
 cvt v181, v250, v251
 v_mul_f32 v250, s36, v156
 m32 a[80:95], a[236:239], v[196:199], a[80:95]
 rtr a[230:231], v201, 1792
 ds_read_b128 v[196:199], v203 offset:36864
 rtr a[232:233], v200, 6144
 v_mul_f32 v251, s36, v157
 s_waitcnt lgkmcnt(6)
 m32 a[0:15], a[240:243], v[192:195], a[0:15]
 rtr a[234:235], v200, 7680
 rtr a[236:237], v201, 6144
 rtr a[238:239], v201, 7680
 v_exp_f32 v250, v250
 m32 a[16:31], a[244:247], v[192:195], a[16:31]
 rtr a[240:241], v200, 6272
 rtr a[242:243], v200, 7808
 rtr a[244:245], v201, 6272
 v_exp_f32 v251, v251
 v_add_f32 v169, v169, v250
 m32 a[32:47], a[248:251], v[192:195], a[32:47]
 rtr a[246:247], v201, 7808
 rtr a[248:249], v200, 6400
 rtr a[250:251], v200, 7936
 v_add_f32 v169, v169, v251
 cvt v182, v250, v251
 v_mul_f32 v250, s36, v158
 m32 a[48:63], a[252:255], v[192:195], a[48:63]
 rtr a[252:253], v201, 6400
 rtr a[254:255], v201, 7936
 v_mul_f32 v251, s36, v159
 v_exp_f32 v250, v250
 s_waitcnt lgkmcnt(5)
 m32 a[64:79], a[224:227], v[192:195], a[64:79]
 v_exp_f32 v251, v251
 v_add_f32 v169, v169, v250
 v_add_f32 v169, v169, v251
 cvt v183, v250, v251
 v_add_f32 v250, v249, v169
 m32 a[80:95], a[228:231], v[192:195], a[80:95]
 v_cmp_nge_f32 s[48:49], s37, v250
 m32 a[0:15], a[232:235], v[196:199], a[0:15]
 m32 a[16:31], a[236:239], v[196:199], a[16:31]
 s_waitcnt lgkmcnt(0)
 s_barrier
 m32 a[32:47], a[240:243], v[196:199], a[32:47]
 ds_read_b128 a[224:227], v240
 ds_read_b128 a[228:231], v240 offset:6144
 m32 a[48:63], a[244:247], v[196:199], a[48:63]
 ds_read_b128 a[232:235], v241
 ds_read_b128 a[236:239], v241 offset:6144
 m32 a[64:79], a[248:251], v[196:199], a[64:79]
 ds_read_b128 a[240:243], v240 offset:128
 ds_read_b128 a[244:247], v240 offset:6272
 m32 a[80:95], a[252:255], v[196:199], a[80:95]
 ds_read_b128 a[248:251], v241 offset:128
 ds_read_b128 a[252:255], v241 offset:6272
 s_cmp_lg_u64 s[48:49], 0
 s_cbranch_scc1 RS8_0
RB8_0:
 v_add_f32 v248, v248, v249
 v_add_f32 v168, v168, v169
 s_waitcnt lgkmcnt(4)
 m16 v[144:147], a[224:227], v[96:99], v[160:163]
 m16 v[152:155], a[224:227], v[100:103], v[164:167]
 ds_read_b128 a[224:227], v240 offset:256
 m16 v[148:151], a[228:231], v[96:99], v[160:163]
 m16 v[156:159], a[228:231], v[100:103], v[164:167]
 ds_read_b128 a[228:231], v240 offset:6400
 m16 v[144:147], a[232:235], v[104:107], v[144:147]
 m16 v[152:155], a[232:235], v[108:111], v[152:155]
 ds_read_b128 a[232:235], v241 offset:256
 m16 v[148:151], a[236:239], v[104:107], v[148:151]
 m16 v[156:159], a[236:239], v[108:111], v[156:159]
 ds_read_b128 a[236:239], v241 offset:6400
 s_waitcnt lgkmcnt(2)
 m16 v[144:147], a[240:243], v[112:115], v[144:147]
 m16 v[152:155], a[240:243], v[116:119], v[152:155]
 m16 v[148:151], a[244:247], v[112:115], v[148:151]
 m16 v[156:159], a[244:247], v[116:119], v[156:159]
 m16 v[144:147], a[248:251], v[120:123], v[144:147]
 rtr a[240:241], v242
 m16 v[152:155], a[248:251], v[124:127], v[152:155]
 rtr a[242:243], v242, 6144
 m16 v[148:151], a[252:255], v[120:123], v[148:151]
 rtr a[244:245], v243
 m16 v[156:159], a[252:255], v[124:127], v[156:159]
 rtr a[246:247], v243, 6144
 m16 v[144:147], a[224:227], v[128:131], v[144:147]
 rtr a[248:249], v244
 m16 v[152:155], a[224:227], v[132:135], v[152:155]
 rtr a[250:251], v244, 6144
 m16 v[148:151], a[228:231], v[128:131], v[148:151]
 rtr a[252:253], v245
 m16 v[156:159], a[228:231], v[132:135], v[156:159]
 rtr a[254:255], v245, 6144
 s_waitcnt lgkmcnt(4)
 m16 v[144:147], a[232:235], v[136:139], v[144:147]
 rtr a[224:225], v242, 128
 m16 v[152:155], a[232:235], v[140:143], v[152:155]
 rtr a[226:227], v242, 6272
 m16 v[148:151], a[236:239], v[136:139], v[148:151]
 rtr a[228:229], v243, 128
 m16 v[156:159], a[236:239], v[140:143], v[156:159]
 rtr a[230:231], v243, 6272
 m16 v[0:3], a[240:243], v[176:179], v[0:3]
 rtr a[232:233], v244, 128
 m16 v[8:11], a[240:243], v[180:183], v[8:11]
 rtr a[234:235], v244, 6272
 m16 v[4:7], a[244:247], v[176:179], v[4:7]
 rtr a[236:237], v245, 128
 m16 v[12:15], a[244:247], v[180:183], v[12:15]
 rtr a[238:239], v245, 6272
 s_waitcnt lgkmcnt(4)
 m16 v[16:19], a[248:251], v[176:179], v[16:19]
 rtr a[240:241], v242, 256
 m16 v[24:27], a[248:251], v[180:183], v[24:27]
 rtr a[242:243], v242, 6400
 v_mul_f32 v250, s36, v144
 v_mul_f32 v251, s36, v145
 m16 v[20:23], a[252:255], v[176:179], v[20:23]
 rtr a[244:245], v243, 256
 m16 v[28:31], a[252:255], v[180:183], v[28:31]
 rtr a[246:247], v243, 6400
 v_exp_f32 v250, v250
 m16 v[32:35], a[224:227], v[176:179], v[32:35]
 rtr a[248:249], v244, 256
 m16 v[40:43], a[224:227], v[180:183], v[40:43]
 rtr a[250:251], v244, 6400
 v_exp_f32 v251, v251
 m16 v[36:39], a[228:231], v[176:179], v[36:39]
 rtr a[252:253], v245, 256
 cvt v184, v250, v251
 m16 v[44:47], a[228:231], v[180:183], v[44:47]
 rtr a[254:255], v245, 6400
 v_add_f32 v249, v250, v251
 s_waitcnt lgkmcnt(4)
 m16 v[48:51], a[232:235], v[176:179], v[48:51]
 ds_read_b128 v[192:195], v204 offset:36864
 v_mul_f32 v250, s36, v146
 m16 v[56:59], a[232:235], v[180:183], v[56:59]
 rtr a[224:225], v200, 12288
 rtr a[226:227], v200, 13824
 v_mul_f32 v251, s36, v147
 m16 v[52:55], a[236:239], v[176:179], v[52:55]
 rtr a[228:229], v201, 12288
 m16 v[60:63], a[236:239], v[180:183], v[60:63]
 rtr a[230:231], v201, 13824
 rtr a[232:233], v200, 12416
 m16 v[64:67], a[240:243], v[176:179], v[64:67]
 rtr a[234:235], v200, 13952
 m16 v[72:75], a[240:243], v[180:183], v[72:75]
 rtr a[236:237], v201, 12416
 v_exp_f32 v250, v250
 m16 v[68:71], a[244:247], v[176:179], v[68:71]
 rtr a[238:239], v201, 13952
 m16 v[76:79], a[244:247], v[180:183], v[76:79]
 rtr a[240:241], v200, 12544
 s_waitcnt lgkmcnt(4)
 m16 v[80:83], a[248:251], v[176:179], v[80:83]
 rtr a[242:243], v200, 14080
 m16 v[88:91], a[248:251], v[180:183], v[88:91]
 rtr a[244:245], v201, 12544
 v_exp_f32 v251, v251
 m16 v[84:87], a[252:255], v[176:179], v[84:87]
 rtr a[246:247], v201, 14080
 v_add_f32 v249, v249, v250
 m16 v[92:95], a[252:255], v[180:183], v[92:95]
 ds_read_b128 v[196:199], v205 offset:36864
 v_add_f32 v249, v249, v251
 cvt v185, v250, v251
 m32 a[0:15], a[224:227], v[192:195], a[0:15]
 rtr a[248:249], v200, 18432
 rtr a[250:251], v200, 19968
 rtr a[252:253], v201, 18432
 v_mul_f32 v250, s36, v148
 v_mul_f32 v251, s36, v149
 m32 a[16:31], a[228:231], v[192:195], a[16:31]
 rtr a[254:255], v201, 19968
 rtr a[224:225], v200, 18560
 rtr a[226:227], v200, 20096
 v_exp_f32 v250, v250
 s_waitcnt lgkmcnt(6)
 m32 a[32:47], a[232:235], v[192:195], a[32:47]
 rtr a[228:229], v201, 18560
 rtr a[230:231], v201, 20096
 rtr a[232:233], v200, 18688
 v_exp_f32 v251, v251
 v_add_f32 v249, v249, v250
 m32 a[48:63], a[236:239], v[192:195], a[48:63]
 rtr a[234:235], v200, 20224
 rtr a[236:237], v201, 18688
 rtr a[238:239], v201, 20224
 v_add_f32 v249, v249, v251
 cvt v186, v250, v251
 v_mul_f32 v250, s36, v150
 m32 a[64:79], a[240:243], v[192:195], a[64:79]
 v_mul_f32 v251, s36, v151
 v_exp_f32 v250, v250
 v_exp_f32 v251, v251
 v_add_f32 v249, v249, v250
 m32 a[80:95], a[244:247], v[192:195], a[80:95]
 v_add_f32 v249, v249, v251
 cvt v187, v250, v251
 v_mul_f32 v250, s36, v152
 v_mul_f32 v251, s36, v153
 s_waitcnt lgkmcnt(0)
 m32 a[0:15], a[248:251], v[196:199], a[0:15]
 v_exp_f32 v250, v250
 v_exp_f32 v251, v251
 s_nop 0
 cvt v188, v250, v251
 v_add_f32 v169, v250, v251
 m32 a[16:31], a[252:255], v[196:199], a[16:31]
 v_mul_f32 v250, s36, v154
 v_mul_f32 v251, s36, v155
 v_exp_f32 v250, v250
 s_barrier
 m32 a[32:47], a[224:227], v[196:199], a[32:47]
 ds_read_b128 a[240:243], v240 offset:12288
 ds_read_b128 a[244:247], v240 offset:18432
 v_exp_f32 v251, v251
 v_add_f32 v169, v169, v250
 v_add_f32 v169, v169, v251
 m32 a[48:63], a[228:231], v[196:199], a[48:63]
 ds_read_b128 a[248:251], v241 offset:12288
 ds_read_b128 a[252:255], v241 offset:18432
 cvt v189, v250, v251
 v_mul_f32 v250, s36, v156
 v_mul_f32 v251, s36, v157
 m32 a[64:79], a[232:235], v[196:199], a[64:79]
 ds_read_b128 a[224:227], v240 offset:12416
 ds_read_b128 a[228:231], v240 offset:18560
 v_exp_f32 v250, v250
 v_exp_f32 v251, v251
 v_add_f32 v169, v169, v250
 v_add_f32 v169, v169, v251
 cvt v190, v250, v251
 v_mul_f32 v250, s36, v158
 v_mul_f32 v251, s36, v159
 v_exp_f32 v250, v250
 v_exp_f32 v251, v251
 v_add_f32 v169, v169, v250
 v_add_f32 v169, v169, v251
 cvt v191, v250, v251
 v_add_f32 v250, v249, v169
 v_cmp_nge_f32 s[48:49], s37, v250
 m32 a[80:95], a[236:239], v[196:199], a[80:95]
 ds_read_b128 a[232:235], v241 offset:12416
 ds_read_b128 a[236:239], v241 offset:18560
 s_cmp_lg_u64 s[48:49], 0
 s_cbranch_scc1 RS9_0
RB9_0:
 v_add_f32 v248, v248, v249
 v_add_f32 v168, v168, v169
 s_waitcnt lgkmcnt(4)
 m16 v[144:147], a[240:243], v[96:99], v[160:163]
 m16 v[152:155], a[240:243], v[100:103], v[164:167]
 ds_read_b128 a[240:243], v240 offset:12544
 m16 v[148:151], a[244:247], v[96:99], v[160:163]
 m16 v[156:159], a[244:247], v[100:103], v[164:167]
 ds_read_b128 a[244:247], v240 offset:18688
 m16 v[144:147], a[248:251], v[104:107], v[144:147]
 m16 v[152:155], a[248:251], v[108:111], v[152:155]
 ds_read_b128 a[248:251], v241 offset:12544
 m16 v[148:151], a[252:255], v[104:107], v[148:151]
 m16 v[156:159], a[252:255], v[108:111], v[156:159]
 ds_read_b128 a[252:255], v241 offset:18688
 s_waitcnt lgkmcnt(2)
 m16 v[144:147], a[224:227], v[112:115], v[144:147]
 m16 v[152:155], a[224:227], v[116:119], v[152:155]
 m16 v[148:151], a[228:231], v[112:115], v[148:151]
 m16 v[156:159], a[228:231], v[116:119], v[156:159]
 m16 v[144:147], a[232:235], v[120:123], v[144:147]
 rtr a[224:225], v242, 12288
 m16 v[152:155], a[232:235], v[124:127], v[152:155]
 rtr a[226:227], v242, 18432
 m16 v[148:151], a[236:239], v[120:123], v[148:151]
 rtr a[228:229], v243, 12288
 m16 v[156:159], a[236:239], v[124:127], v[156:159]
 rtr a[230:231], v243, 18432
 m16 v[144:147], a[240:243], v[128:131], v[144:147]
 rtr a[232:233], v244, 12288
 m16 v[152:155], a[240:243], v[132:135], v[152:155]
 rtr a[234:235], v244, 18432
 m16 v[148:151], a[244:247], v[128:131], v[148:151]
 rtr a[236:237], v245, 12288
 m16 v[156:159], a[244:247], v[132:135], v[156:159]
 rtr a[238:239], v245, 18432
 s_waitcnt lgkmcnt(4)
 m16 v[144:147], a[248:251], v[136:139], v[144:147]
 rtr a[240:241], v242, 12416
 m16 v[152:155], a[248:251], v[140:143], v[152:155]
 rtr a[242:243], v242, 18560
 m16 v[148:151], a[252:255], v[136:139], v[148:151]
 rtr a[244:245], v243, 12416
 m16 v[156:159], a[252:255], v[140:143], v[156:159]
 rtr a[246:247], v243, 18560
 m16 v[0:3], a[224:227], v[184:187], v[0:3]
 rtr a[248:249], v244, 12416
 m16 v[8:11], a[224:227], v[188:191], v[8:11]
 rtr a[250:251], v244, 18560
 m16 v[4:7], a[228:231], v[184:187], v[4:7]
 rtr a[252:253], v245, 12416
 m16 v[12:15], a[228:231], v[188:191], v[12:15]
 rtr a[254:255], v245, 18560
 s_waitcnt lgkmcnt(4)
 m16 v[16:19], a[232:235], v[184:187], v[16:19]
 rtr a[224:225], v242, 12544
 m16 v[24:27], a[232:235], v[188:191], v[24:27]
 rtr a[226:227], v242, 18688
 v_mul_f32 v250, s36, v144
 v_mul_f32 v251, s36, v145
 m16 v[20:23], a[236:239], v[184:187], v[20:23]
 rtr a[228:229], v243, 12544
 m16 v[28:31], a[236:239], v[188:191], v[28:31]
 rtr a[230:231], v243, 18688
 v_exp_f32 v250, v250
 m16 v[32:35], a[240:243], v[184:187], v[32:35]
 rtr a[232:233], v244, 12544
 m16 v[40:43], a[240:243], v[188:191], v[40:43]
 rtr a[234:235], v244, 18688
 v_exp_f32 v251, v251
 m16 v[36:39], a[244:247], v[184:187], v[36:39]
 rtr a[236:237], v245, 12544
 cvt v176, v250, v251
 m16 v[44:47], a[244:247], v[188:191], v[44:47]
 rtr a[238:239], v245, 18688
 v_add_f32 v249, v250, v251
 s_waitcnt lgkmcnt(4)
 m16 v[48:51], a[248:251], v[184:187], v[48:51]
 ds_read_b128 v[192:195], v202 offset:24576
 v_mul_f32 v250, s36, v146
 m16 v[56:59], a[248:251], v[188:191], v[56:59]
 rtr a[240:241], v200
 rtr a[242:243], v200, 1536
 v_mul_f32 v251, s36, v147
 m16 v[52:55], a[252:255], v[184:187], v[52:55]
 rtr a[244:245], v201
 m16 v[60:63], a[252:255], v[188:191], v[60:63]
 rtr a[246:247], v201, 1536
 rtr a[248:249], v200, 128
 m16 v[64:67], a[224:227], v[184:187], v[64:67]
 rtr a[250:251], v200, 1664
 m16 v[72:75], a[224:227], v[188:191], v[72:75]
 rtr a[252:253], v201, 128
 v_exp_f32 v250, v250
 m16 v[68:71], a[228:231], v[184:187], v[68:71]
 rtr a[254:255], v201, 1664
 m16 v[76:79], a[228:231], v[188:191], v[76:79]
 rtr a[224:225], v200, 256
 s_waitcnt lgkmcnt(4)
 m16 v[80:83], a[232:235], v[184:187], v[80:83]
 rtr a[226:227], v200, 1792
 m16 v[88:91], a[232:235], v[188:191], v[88:91]
 rtr a[228:229], v201, 256
 v_exp_f32 v251, v251
 m16 v[84:87], a[236:239], v[184:187], v[84:87]
 rtr a[230:231], v201, 1792
 v_add_f32 v249, v249, v250
 m16 v[92:95], a[236:239], v[188:191], v[92:95]
 ds_read_b128 v[196:199], v203 offset:24576
 v_add_f32 v249, v249, v251
 cvt v177, v250, v251
 m32 a[0:15], a[240:243], v[192:195], a[0:15]
 rtr a[232:233], v200, 6144
 rtr a[234:235], v200, 7680
 rtr a[236:237], v201, 6144
 v_mul_f32 v250, s36, v148
 v_mul_f32 v251, s36, v149
 m32 a[16:31], a[244:247], v[192:195], a[16:31]
 rtr a[238:239], v201, 7680
 rtr a[240:241], v200, 6272
 rtr a[242:243], v200, 7808
 v_exp_f32 v250, v250
 s_waitcnt lgkmcnt(6)
 m32 a[32:47], a[248:251], v[192:195], a[32:47]
 rtr a[244:245], v201, 6272
 rtr a[246:247], v201, 7808
 rtr a[248:249], v200, 6400
 v_exp_f32 v251, v251
 v_add_f32 v249, v249, v250
 m32 a[48:63], a[252:255], v[192:195], a[48:63]
 rtr a[250:251], v200, 7936
 rtr a[252:253], v201, 6400
 rtr a[254:255], v201, 7936
 v_add_f32 v249, v249, v251
 cvt v178, v250, v251
 v_mul_f32 v250, s36, v150
 m32 a[64:79], a[224:227], v[192:195], a[64:79]
 v_mul_f32 v251, s36, v151
 v_exp_f32 v250, v250
 v_exp_f32 v251, v251
 v_add_f32 v249, v249, v250
 m32 a[80:95], a[228:231], v[192:195], a[80:95]
 v_add_f32 v249, v249, v251
 cvt v179, v250, v251
 v_mul_f32 v250, s36, v152
 v_mul_f32 v251, s36, v153
 s_waitcnt lgkmcnt(0)
 m32 a[0:15], a[232:235], v[196:199], a[0:15]
 v_exp_f32 v250, v250
 v_exp_f32 v251, v251
 s_nop 0
 cvt v180, v250, v251
 v_add_f32 v169, v250, v251
 m32 a[16:31], a[236:239], v[196:199], a[16:31]
 v_mul_f32 v250, s36, v154
 v_mul_f32 v251, s36, v155
 v_exp_f32 v250, v250
 s_barrier
 m32 a[32:47], a[240:243], v[196:199], a[32:47]
 ds_read_b128 a[224:227], v240 offset:24576
 ds_read_b128 a[228:231], v240 offset:30720
 v_exp_f32 v251, v251
 v_add_f32 v169, v169, v250
 v_add_f32 v169, v169, v251
 m32 a[48:63], a[244:247], v[196:199], a[48:63]
 ds_read_b128 a[232:235], v241 offset:24576
 ds_read_b128 a[236:239], v241 offset:30720
 cvt v181, v250, v251
 v_mul_f32 v250, s36, v156
 v_mul_f32 v251, s36, v157
 m32 a[64:79], a[248:251], v[196:199], a[64:79]
 ds_read_b128 a[240:243], v240 offset:24704
 ds_read_b128 a[244:247], v240 offset:30848
 v_exp_f32 v250, v250
 v_exp_f32 v251, v251
 v_add_f32 v169, v169, v250
 v_add_f32 v169, v169, v251
 cvt v182, v250, v251
 v_mul_f32 v250, s36, v158
 v_mul_f32 v251, s36, v159
 v_exp_f32 v250, v250
 v_exp_f32 v251, v251
 v_add_f32 v169, v169, v250
 v_add_f32 v169, v169, v251
 cvt v183, v250, v251
 v_add_f32 v250, v249, v169
 v_cmp_nge_f32 s[48:49], s37, v250
 m32 a[80:95], a[252:255], v[196:199], a[80:95]
 ds_read_b128 a[248:251], v241 offset:24704
 ds_read_b128 a[252:255], v241 offset:30848
 s_cmp_lg_u64 s[48:49], 0
 s_cbranch_scc1 RS10_0
RB10_0:
 v_add_f32 v248, v248, v249
 v_add_f32 v168, v168, v169
 s_waitcnt lgkmcnt(4)
 m16 v[144:147], a[224:227], v[96:99], v[160:163]
 m16 v[152:155], a[224:227], v[100:103], v[164:167]
 ds_read_b128 a[224:227], v240 offset:24832
 m16 v[148:151], a[228:231], v[96:99], v[160:163]
 m16 v[156:159], a[228:231], v[100:103], v[164:167]
 ds_read_b128 a[228:231], v240 offset:30976
 m16 v[144:147], a[232:235], v[104:107], v[144:147]
 m16 v[152:155], a[232:235], v[108:111], v[152:155]
 ds_read_b128 a[232:235], v241 offset:24832
 m16 v[148:151], a[236:239], v[104:107], v[148:151]
 m16 v[156:159], a[236:239], v[108:111], v[156:159]
 ds_read_b128 a[236:239], v241 offset:30976
 s_waitcnt lgkmcnt(2)
 m16 v[144:147], a[240:243], v[112:115], v[144:147]
 m16 v[152:155], a[240:243], v[116:119], v[152:155]
 m16 v[148:151], a[244:247], v[112:115], v[148:151]
 m16 v[156:159], a[244:247], v[116:119], v[156:159]
 m16 v[144:147], a[248:251], v[120:123], v[144:147]
 rtr a[240:241], v242, 24576
 m16 v[152:155], a[248:251], v[124:127], v[152:155]
 rtr a[242:243], v242, 30720
 m16 v[148:151], a[252:255], v[120:123], v[148:151]
 rtr a[244:245], v243, 24576
 m16 v[156:159], a[252:255], v[124:127], v[156:159]
 rtr a[246:247], v243, 30720
 m16 v[144:147], a[224:227], v[128:131], v[144:147]
 rtr a[248:249], v244, 24576
 m16 v[152:155], a[224:227], v[132:135], v[152:155]
 rtr a[250:251], v244, 30720
 m16 v[148:151], a[228:231], v[128:131], v[148:151]
 rtr a[252:253], v245, 24576
 m16 v[156:159], a[228:231], v[132:135], v[156:159]
 rtr a[254:255], v245, 30720
 s_waitcnt lgkmcnt(4)
 m16 v[144:147], a[232:235], v[136:139], v[144:147]
 rtr a[224:225], v242, 24704
 m16 v[152:155], a[232:235], v[140:143], v[152:155]
 rtr a[226:227], v242, 30848
 m16 v[148:151], a[236:239], v[136:139], v[148:151]
 rtr a[228:229], v243, 24704
 m16 v[156:159], a[236:239], v[140:143], v[156:159]
 rtr a[230:231], v243, 30848
 m16 v[0:3], a[240:243], v[176:179], v[0:3]
 rtr a[232:233], v244, 24704
 m16 v[8:11], a[240:243], v[180:183], v[8:11]
 rtr a[234:235], v244, 30848
 m16 v[4:7], a[244:247], v[176:179], v[4:7]
 rtr a[236:237], v245, 24704
 m16 v[12:15], a[244:247], v[180:183], v[12:15]
 rtr a[238:239], v245, 30848
 s_waitcnt lgkmcnt(4)
 m16 v[16:19], a[248:251], v[176:179], v[16:19]
 rtr a[240:241], v242, 24832
 m16 v[24:27], a[248:251], v[180:183], v[24:27]
 rtr a[242:243], v242, 30976
 v_mul_f32 v250, s36, v144
 v_mul_f32 v251, s36, v145
 m16 v[20:23], a[252:255], v[176:179], v[20:23]
 rtr a[244:245], v243, 24832
 m16 v[28:31], a[252:255], v[180:183], v[28:31]
 rtr a[246:247], v243, 30976
 v_exp_f32 v250, v250
 m16 v[32:35], a[224:227], v[176:179], v[32:35]
 rtr a[248:249], v244, 24832
 m16 v[40:43], a[224:227], v[180:183], v[40:43]
 rtr a[250:251], v244, 30976
 v_exp_f32 v251, v251
 m16 v[36:39], a[228:231], v[176:179], v[36:39]
 rtr a[252:253], v245, 24832
 cvt v184, v250, v251
 m16 v[44:47], a[228:231], v[180:183], v[44:47]
 rtr a[254:255], v245, 30976
 v_add_f32 v249, v250, v251
 s_waitcnt lgkmcnt(4)
 m16 v[48:51], a[232:235], v[176:179], v[48:51]
 ds_read_b128 v[192:195], v204 offset:24576
 v_mul_f32 v250, s36, v146
 m16 v[56:59], a[232:235], v[180:183], v[56:59]
 rtr a[224:225], v200, 12288
 rtr a[226:227], v200, 13824
 v_mul_f32 v251, s36, v147
 m16 v[52:55], a[236:239], v[176:179], v[52:55]
 rtr a[228:229], v201, 12288
 m16 v[60:63], a[236:239], v[180:183], v[60:63]
 rtr a[230:231], v201, 13824
 rtr a[232:233], v200, 12416
 m16 v[64:67], a[240:243], v[176:179], v[64:67]
 rtr a[234:235], v200, 13952
 m16 v[72:75], a[240:243], v[180:183], v[72:75]
 rtr a[236:237], v201, 12416
 v_exp_f32 v250, v250
 m16 v[68:71], a[244:247], v[176:179], v[68:71]
 rtr a[238:239], v201, 13952
 m16 v[76:79], a[244:247], v[180:183], v[76:79]
 rtr a[240:241], v200, 12544
 s_waitcnt lgkmcnt(4)
 m16 v[80:83], a[248:251], v[176:179], v[80:83]
 rtr a[242:243], v200, 14080
 m16 v[88:91], a[248:251], v[180:183], v[88:91]
 rtr a[244:245], v201, 12544
 v_exp_f32 v251, v251
 m16 v[84:87], a[252:255], v[176:179], v[84:87]
 rtr a[246:247], v201, 14080
 v_add_f32 v249, v249, v250
 m16 v[92:95], a[252:255], v[180:183], v[92:95]
 ds_read_b128 v[196:199], v205 offset:24576
 v_add_f32 v249, v249, v251
 cvt v185, v250, v251
 m32 a[0:15], a[224:227], v[192:195], a[0:15]
 rtr a[248:249], v200, 18432
 rtr a[250:251], v200, 19968
 rtr a[252:253], v201, 18432
 v_mul_f32 v250, s36, v148
 v_mul_f32 v251, s36, v149
 m32 a[16:31], a[228:231], v[192:195], a[16:31]
 rtr a[254:255], v201, 19968
 rtr a[224:225], v200, 18560
 rtr a[226:227], v200, 20096
 v_exp_f32 v250, v250
 s_waitcnt lgkmcnt(6)
 m32 a[32:47], a[232:235], v[192:195], a[32:47]
 rtr a[228:229], v201, 18560
 rtr a[230:231], v201, 20096
 rtr a[232:233], v200, 18688
 v_exp_f32 v251, v251
 v_add_f32 v249, v249, v250
 m32 a[48:63], a[236:239], v[192:195], a[48:63]
 rtr a[234:235], v200, 20224
 rtr a[236:237], v201, 18688
 rtr a[238:239], v201, 20224
 v_add_f32 v249, v249, v251
 cvt v186, v250, v251
 v_mul_f32 v250, s36, v150
 m32 a[64:79], a[240:243], v[192:195], a[64:79]
 v_mul_f32 v251, s36, v151
 v_exp_f32 v250, v250
 v_exp_f32 v251, v251
 v_add_f32 v249, v249, v250
 m32 a[80:95], a[244:247], v[192:195], a[80:95]
 v_add_f32 v249, v249, v251
 cvt v187, v250, v251
 v_mul_f32 v250, s36, v152
 v_mul_f32 v251, s36, v153
 s_waitcnt lgkmcnt(0)
 m32 a[0:15], a[248:251], v[196:199], a[0:15]
 v_exp_f32 v250, v250
 v_exp_f32 v251, v251
 s_nop 0
 cvt v188, v250, v251
 v_add_f32 v169, v250, v251
 m32 a[16:31], a[252:255], v[196:199], a[16:31]
 v_mul_f32 v250, s36, v154
 v_mul_f32 v251, s36, v155
 v_exp_f32 v250, v250
 s_barrier
 m32 a[32:47], a[224:227], v[196:199], a[32:47]
 ds_read_b128 a[240:243], v240
 ds_read_b128 a[244:247], v240 offset:6144
 v_exp_f32 v251, v251
 v_add_f32 v169, v169, v250
 v_add_f32 v169, v169, v251
 m32 a[48:63], a[228:231], v[196:199], a[48:63]
 ds_read_b128 a[248:251], v241
 ds_read_b128 a[252:255], v241 offset:6144
 cvt v189, v250, v251
 v_mul_f32 v250, s36, v156
 v_mul_f32 v251, s36, v157
 m32 a[64:79], a[232:235], v[196:199], a[64:79]
 ds_read_b128 a[224:227], v240 offset:128
 ds_read_b128 a[228:231], v240 offset:6272
 v_exp_f32 v250, v250
 v_exp_f32 v251, v251
 v_add_f32 v169, v169, v250
 v_add_f32 v169, v169, v251
 cvt v190, v250, v251
 v_mul_f32 v250, s36, v158
 v_mul_f32 v251, s36, v159
 v_exp_f32 v250, v250
 v_exp_f32 v251, v251
 v_add_f32 v169, v169, v250
 v_add_f32 v169, v169, v251
 cvt v191, v250, v251
 v_add_f32 v250, v249, v169
 v_cmp_nge_f32 s[48:49], s37, v250
 m32 a[80:95], a[236:239], v[196:199], a[80:95]
 ds_read_b128 a[232:235], v241 offset:128
 ds_read_b128 a[236:239], v241 offset:6272
 s_cmp_lg_u64 s[48:49], 0
 s_cbranch_scc1 RS11_0
RB11_0:
 v_add_f32 v248, v248, v249
 v_add_f32 v168, v168, v169
 s_waitcnt lgkmcnt(4)
 m16 v[144:147], a[240:243], v[96:99], v[160:163]
 m16 v[152:155], a[240:243], v[100:103], v[164:167]
 ds_read_b128 a[240:243], v240 offset:256
 m16 v[148:151], a[244:247], v[96:99], v[160:163]
 m16 v[156:159], a[244:247], v[100:103], v[164:167]
 ds_read_b128 a[244:247], v240 offset:6400
 m16 v[144:147], a[248:251], v[104:107], v[144:147]
 m16 v[152:155], a[248:251], v[108:111], v[152:155]
 ds_read_b128 a[248:251], v241 offset:256
 m16 v[148:151], a[252:255], v[104:107], v[148:151]
 m16 v[156:159], a[252:255], v[108:111], v[156:159]
 ds_read_b128 a[252:255], v241 offset:6400
 s_waitcnt lgkmcnt(2)
 m16 v[144:147], a[224:227], v[112:115], v[144:147]
 m16 v[152:155], a[224:227], v[116:119], v[152:155]
 m16 v[148:151], a[228:231], v[112:115], v[148:151]
 m16 v[156:159], a[228:231], v[116:119], v[156:159]
 m16 v[144:147], a[232:235], v[120:123], v[144:147]
 rtr a[224:225], v242, 36864
 m16 v[152:155], a[232:235], v[124:127], v[152:155]
 rtr a[226:227], v242, 43008
 m16 v[148:151], a[236:239], v[120:123], v[148:151]
 rtr a[228:229], v243, 36864
 m16 v[156:159], a[236:239], v[124:127], v[156:159]
 rtr a[230:231], v243, 43008
 m16 v[144:147], a[240:243], v[128:131], v[144:147]
 rtr a[232:233], v244, 36864
 m16 v[152:155], a[240:243], v[132:135], v[152:155]
 rtr a[234:235], v244, 43008
 m16 v[148:151], a[244:247], v[128:131], v[148:151]
 rtr a[236:237], v245, 36864
 m16 v[156:159], a[244:247], v[132:135], v[156:159]
 rtr a[238:239], v245, 43008
 s_waitcnt lgkmcnt(4)
 m16 v[144:147], a[248:251], v[136:139], v[144:147]
 rtr a[240:241], v242, 36992
 m16 v[152:155], a[248:251], v[140:143], v[152:155]
 rtr a[242:243], v242, 43136
 m16 v[148:151], a[252:255], v[136:139], v[148:151]
 rtr a[244:245], v243, 36992
 m16 v[156:159], a[252:255], v[140:143], v[156:159]
 rtr a[246:247], v243, 43136
 m16 v[0:3], a[224:227], v[184:187], v[0:3]
 rtr a[248:249], v244, 36992
 m16 v[8:11], a[224:227], v[188:191], v[8:11]
 rtr a[250:251], v244, 43136
 m16 v[4:7], a[228:231], v[184:187], v[4:7]
 rtr a[252:253], v245, 36992
 m16 v[12:15], a[228:231], v[188:191], v[12:15]
 rtr a[254:255], v245, 43136
 s_waitcnt lgkmcnt(4)
 m16 v[16:19], a[232:235], v[184:187], v[16:19]
 rtr a[224:225], v242, 37120
 m16 v[24:27], a[232:235], v[188:191], v[24:27]
 rtr a[226:227], v242, 43264
 v_mul_f32 v250, s36, v144
 v_mul_f32 v251, s36, v145
 m16 v[20:23], a[236:239], v[184:187], v[20:23]
 rtr a[228:229], v243, 37120
 m16 v[28:31], a[236:239], v[188:191], v[28:31]
 rtr a[230:231], v243, 43264
 v_exp_f32 v250, v250
 m16 v[32:35], a[240:243], v[184:187], v[32:35]
 rtr a[232:233], v244, 37120
 m16 v[40:43], a[240:243], v[188:191], v[40:43]
 rtr a[234:235], v244, 43264
 v_exp_f32 v251, v251
 m16 v[36:39], a[244:247], v[184:187], v[36:39]
 rtr a[236:237], v245, 37120
 cvt v176, v250, v251
 m16 v[44:47], a[244:247], v[188:191], v[44:47]
 rtr a[238:239], v245, 43264
 v_add_f32 v249, v250, v251
 s_waitcnt lgkmcnt(4)
 m16 v[48:51], a[248:251], v[184:187], v[48:51]
 ds_read_b128 v[192:195], v202 offset:36864
 v_mul_f32 v250, s36, v146
 m16 v[56:59], a[248:251], v[188:191], v[56:59]
 rtr a[240:241], v200
 rtr a[242:243], v200, 1536
 v_mul_f32 v251, s36, v147
 m16 v[52:55], a[252:255], v[184:187], v[52:55]
 rtr a[244:245], v201
 m16 v[60:63], a[252:255], v[188:191], v[60:63]
 rtr a[246:247], v201, 1536
 rtr a[248:249], v200, 128
 m16 v[64:67], a[224:227], v[184:187], v[64:67]
 rtr a[250:251], v200, 1664
 m16 v[72:75], a[224:227], v[188:191], v[72:75]
 rtr a[252:253], v201, 128
 v_exp_f32 v250, v250
 m16 v[68:71], a[228:231], v[184:187], v[68:71]
 rtr a[254:255], v201, 1664
 m16 v[76:79], a[228:231], v[188:191], v[76:79]
 rtr a[224:225], v200, 256
 s_waitcnt lgkmcnt(4)
 m16 v[80:83], a[232:235], v[184:187], v[80:83]
 rtr a[226:227], v200, 1792
 m16 v[88:91], a[232:235], v[188:191], v[88:91]
 rtr a[228:229], v201, 256
 v_exp_f32 v251, v251
 m16 v[84:87], a[236:239], v[184:187], v[84:87]
 rtr a[230:231], v201, 1792
 v_add_f32 v249, v249, v250
 m16 v[92:95], a[236:239], v[188:191], v[92:95]
 ds_read_b128 v[196:199], v203 offset:36864
 v_add_f32 v249, v249, v251
 cvt v177, v250, v251
 m32 a[0:15], a[240:243], v[192:195], a[0:15]
 rtr a[232:233], v200, 6144
 rtr a[234:235], v200, 7680
 rtr a[236:237], v201, 6144
 v_mul_f32 v250, s36, v148
 v_mul_f32 v251, s36, v149
 m32 a[16:31], a[244:247], v[192:195], a[16:31]
 rtr a[238:239], v201, 7680
 rtr a[240:241], v200, 6272
 rtr a[242:243], v200, 7808
 v_exp_f32 v250, v250
 s_waitcnt lgkmcnt(6)
 m32 a[32:47], a[248:251], v[192:195], a[32:47]
 rtr a[244:245], v201, 6272
 rtr a[246:247], v201, 7808
 rtr a[248:249], v200, 6400
 v_exp_f32 v251, v251
 v_add_f32 v249, v249, v250
 m32 a[48:63], a[252:255], v[192:195], a[48:63]
 rtr a[250:251], v200, 7936
 rtr a[252:253], v201, 6400
 rtr a[254:255], v201, 7936
 v_add_f32 v249, v249, v251
 cvt v178, v250, v251
 v_mul_f32 v250, s36, v150
 m32 a[64:79], a[224:227], v[192:195], a[64:79]
 v_mul_f32 v251, s36, v151
 v_exp_f32 v250, v250
 v_exp_f32 v251, v251
 v_add_f32 v249, v249, v250
 m32 a[80:95], a[228:231], v[192:195], a[80:95]
 v_add_f32 v249, v249, v251
 cvt v179, v250, v251
 v_mul_f32 v250, s36, v152
 v_mul_f32 v251, s36, v153
 s_waitcnt lgkmcnt(0)
 m32 a[0:15], a[232:235], v[196:199], a[0:15]
 v_exp_f32 v250, v250
 v_exp_f32 v251, v251
 s_nop 0
 cvt v180, v250, v251
 v_add_f32 v169, v250, v251
 m32 a[16:31], a[236:239], v[196:199], a[16:31]
 v_mul_f32 v250, s36, v154
 v_mul_f32 v251, s36, v155
 v_exp_f32 v250, v250
 s_barrier
 m32 a[32:47], a[240:243], v[196:199], a[32:47]
 ds_read_b128 a[224:227], v240 offset:12288
 ds_read_b128 a[228:231], v240 offset:18432
 v_exp_f32 v251, v251
 v_add_f32 v169, v169, v250
 v_add_f32 v169, v169, v251
 m32 a[48:63], a[244:247], v[196:199], a[48:63]
 ds_read_b128 a[232:235], v241 offset:12288
 ds_read_b128 a[236:239], v241 offset:18432
 cvt v181, v250, v251
 v_mul_f32 v250, s36, v156
 v_mul_f32 v251, s36, v157
 m32 a[64:79], a[248:251], v[196:199], a[64:79]
 ds_read_b128 a[240:243], v240 offset:12416
 ds_read_b128 a[244:247], v240 offset:18560
 v_exp_f32 v250, v250
 v_exp_f32 v251, v251
 v_add_f32 v169, v169, v250
 v_add_f32 v169, v169, v251
 cvt v182, v250, v251
 v_mul_f32 v250, s36, v158
 v_mul_f32 v251, s36, v159
 v_exp_f32 v250, v250
 v_exp_f32 v251, v251
 v_add_f32 v169, v169, v250
 v_add_f32 v169, v169, v251
 cvt v183, v250, v251
 v_add_f32 v250, v249, v169
 v_cmp_nge_f32 s[48:49], s37, v250
 m32 a[80:95], a[252:255], v[196:199], a[80:95]
 ds_read_b128 a[248:251], v241 offset:12416
 ds_read_b128 a[252:255], v241 offset:18560
 s_cmp_lg_u64 s[48:49], 0
 s_cbranch_scc1 RS12_0
RB12_0:
 v_add_f32 v248, v248, v249
 v_add_f32 v168, v168, v169
 s_waitcnt lgkmcnt(4)
 m16 v[144:147], a[224:227], v[96:99], v[160:163]
 m16 v[152:155], a[224:227], v[100:103], v[164:167]
 ds_read_b128 a[224:227], v240 offset:12544
 m16 v[148:151], a[228:231], v[96:99], v[160:163]
 m16 v[156:159], a[228:231], v[100:103], v[164:167]
 ds_read_b128 a[228:231], v240 offset:18688
 m16 v[144:147], a[232:235], v[104:107], v[144:147]
 m16 v[152:155], a[232:235], v[108:111], v[152:155]
 ds_read_b128 a[232:235], v241 offset:12544
 m16 v[148:151], a[236:239], v[104:107], v[148:151]
 m16 v[156:159], a[236:239], v[108:111], v[156:159]
 ds_read_b128 a[236:239], v241 offset:18688
 s_waitcnt lgkmcnt(2)
 m16 v[144:147], a[240:243], v[112:115], v[144:147]
 m16 v[152:155], a[240:243], v[116:119], v[152:155]
 m16 v[148:151], a[244:247], v[112:115], v[148:151]
 m16 v[156:159], a[244:247], v[116:119], v[156:159]
 m16 v[144:147], a[248:251], v[120:123], v[144:147]
 rtr a[240:241], v242
 m16 v[152:155], a[248:251], v[124:127], v[152:155]
 rtr a[242:243], v242, 6144
 m16 v[148:151], a[252:255], v[120:123], v[148:151]
 rtr a[244:245], v243
 m16 v[156:159], a[252:255], v[124:127], v[156:159]
 rtr a[246:247], v243, 6144
 m16 v[144:147], a[224:227], v[128:131], v[144:147]
 rtr a[248:249], v244
 m16 v[152:155], a[224:227], v[132:135], v[152:155]
 rtr a[250:251], v244, 6144
 m16 v[148:151], a[228:231], v[128:131], v[148:151]
 rtr a[252:253], v245
 m16 v[156:159], a[228:231], v[132:135], v[156:159]
 rtr a[254:255], v245, 6144
 s_waitcnt lgkmcnt(4)
 m16 v[144:147], a[232:235], v[136:139], v[144:147]
 rtr a[224:225], v242, 128
 m16 v[152:155], a[232:235], v[140:143], v[152:155]
 rtr a[226:227], v242, 6272
 m16 v[148:151], a[236:239], v[136:139], v[148:151]
 rtr a[228:229], v243, 128
 m16 v[156:159], a[236:239], v[140:143], v[156:159]
 rtr a[230:231], v243, 6272
 m16 v[0:3], a[240:243], v[176:179], v[0:3]
 rtr a[232:233], v244, 128
 m16 v[8:11], a[240:243], v[180:183], v[8:11]
 rtr a[234:235], v244, 6272
 m16 v[4:7], a[244:247], v[176:179], v[4:7]
 rtr a[236:237], v245, 128
 m16 v[12:15], a[244:247], v[180:183], v[12:15]
 rtr a[238:239], v245, 6272
 s_waitcnt lgkmcnt(4)
 m16 v[16:19], a[248:251], v[176:179], v[16:19]
 rtr a[240:241], v242, 256
 m16 v[24:27], a[248:251], v[180:183], v[24:27]
 rtr a[242:243], v242, 6400
 v_mul_f32 v250, s36, v144
 v_mul_f32 v251, s36, v145
 m16 v[20:23], a[252:255], v[176:179], v[20:23]
 rtr a[244:245], v243, 256
 m16 v[28:31], a[252:255], v[180:183], v[28:31]
 rtr a[246:247], v243, 6400
 v_exp_f32 v250, v250
 m16 v[32:35], a[224:227], v[176:179], v[32:35]
 rtr a[248:249], v244, 256
 m16 v[40:43], a[224:227], v[180:183], v[40:43]
 rtr a[250:251], v244, 6400
 v_exp_f32 v251, v251
 m16 v[36:39], a[228:231], v[176:179], v[36:39]
 rtr a[252:253], v245, 256
 cvt v184, v250, v251
 m16 v[44:47], a[228:231], v[180:183], v[44:47]
 rtr a[254:255], v245, 6400
 v_add_f32 v249, v250, v251
 s_waitcnt lgkmcnt(4)
 m16 v[48:51], a[232:235], v[176:179], v[48:51]
 ds_read_b128 v[192:195], v204 offset:36864
 v_mul_f32 v250, s36, v146
 m16 v[56:59], a[232:235], v[180:183], v[56:59]
 rtr a[224:225], v200, 12288
 rtr a[226:227], v200, 13824
 v_mul_f32 v251, s36, v147
 m16 v[52:55], a[236:239], v[176:179], v[52:55]
 rtr a[228:229], v201, 12288
 m16 v[60:63], a[236:239], v[180:183], v[60:63]
 rtr a[230:231], v201, 13824
 rtr a[232:233], v200, 12416
 m16 v[64:67], a[240:243], v[176:179], v[64:67]
 rtr a[234:235], v200, 13952
 m16 v[72:75], a[240:243], v[180:183], v[72:75]
 rtr a[236:237], v201, 12416
 v_exp_f32 v250, v250
 m16 v[68:71], a[244:247], v[176:179], v[68:71]
 rtr a[238:239], v201, 13952
 m16 v[76:79], a[244:247], v[180:183], v[76:79]
 rtr a[240:241], v200, 12544
 s_waitcnt lgkmcnt(4)
 m16 v[80:83], a[248:251], v[176:179], v[80:83]
 rtr a[242:243], v200, 14080
 m16 v[88:91], a[248:251], v[180:183], v[88:91]
 rtr a[244:245], v201, 12544
 v_exp_f32 v251, v251
 m16 v[84:87], a[252:255], v[176:179], v[84:87]
 rtr a[246:247], v201, 14080
 v_add_f32 v249, v249, v250
 m16 v[92:95], a[252:255], v[180:183], v[92:95]
 ds_read_b128 v[196:199], v205 offset:36864
 v_add_f32 v249, v249, v251
 cvt v185, v250, v251
 m32 a[0:15], a[224:227], v[192:195], a[0:15]
 rtr a[248:249], v200, 18432
 rtr a[250:251], v200, 19968
 rtr a[252:253], v201, 18432
 v_mul_f32 v250, s36, v148
 v_mul_f32 v251, s36, v149
 m32 a[16:31], a[228:231], v[192:195], a[16:31]
 rtr a[254:255], v201, 19968
 rtr a[224:225], v200, 18560
 rtr a[226:227], v200, 20096
 v_exp_f32 v250, v250
 s_waitcnt lgkmcnt(6)
 m32 a[32:47], a[232:235], v[192:195], a[32:47]
 rtr a[228:229], v201, 18560
 rtr a[230:231], v201, 20096
 rtr a[232:233], v200, 18688
 v_exp_f32 v251, v251
 v_add_f32 v249, v249, v250
 m32 a[48:63], a[236:239], v[192:195], a[48:63]
 rtr a[234:235], v200, 20224
 rtr a[236:237], v201, 18688
 rtr a[238:239], v201, 20224
 v_add_f32 v249, v249, v251
 cvt v186, v250, v251
 v_mul_f32 v250, s36, v150
 m32 a[64:79], a[240:243], v[192:195], a[64:79]
 v_mul_f32 v251, s36, v151
 v_exp_f32 v250, v250
 v_exp_f32 v251, v251
 v_add_f32 v249, v249, v250
 m32 a[80:95], a[244:247], v[192:195], a[80:95]
 v_add_f32 v249, v249, v251
 cvt v187, v250, v251
 v_mul_f32 v250, s36, v152
 v_mul_f32 v251, s36, v153
 s_waitcnt lgkmcnt(0)
 m32 a[0:15], a[248:251], v[196:199], a[0:15]
 v_exp_f32 v250, v250
 v_exp_f32 v251, v251
 s_nop 0
 cvt v188, v250, v251
 v_add_f32 v169, v250, v251
 m32 a[16:31], a[252:255], v[196:199], a[16:31]
 v_mul_f32 v250, s36, v154
 v_mul_f32 v251, s36, v155
 v_exp_f32 v250, v250
 s_barrier
 m32 a[32:47], a[224:227], v[196:199], a[32:47]
 ds_read_b128 a[240:243], v240 offset:24576
 ds_read_b128 a[244:247], v240 offset:30720
 v_exp_f32 v251, v251
 v_add_f32 v169, v169, v250
 v_add_f32 v169, v169, v251
 m32 a[48:63], a[228:231], v[196:199], a[48:63]
 ds_read_b128 a[248:251], v241 offset:24576
 ds_read_b128 a[252:255], v241 offset:30720
 cvt v189, v250, v251
 v_mul_f32 v250, s36, v156
 v_mul_f32 v251, s36, v157
 m32 a[64:79], a[232:235], v[196:199], a[64:79]
 ds_read_b128 a[224:227], v240 offset:24704
 ds_read_b128 a[228:231], v240 offset:30848
 v_exp_f32 v250, v250
 v_exp_f32 v251, v251
 v_add_f32 v169, v169, v250
 v_add_f32 v169, v169, v251
 cvt v190, v250, v251
 v_mul_f32 v250, s36, v158
 v_mul_f32 v251, s36, v159
 v_exp_f32 v250, v250
 v_exp_f32 v251, v251
 v_add_f32 v169, v169, v250
 v_add_f32 v169, v169, v251
 cvt v191, v250, v251
 v_add_f32 v250, v249, v169
 v_cmp_nge_f32 s[48:49], s37, v250
 m32 a[80:95], a[236:239], v[196:199], a[80:95]
 ds_read_b128 a[232:235], v241 offset:24704
 ds_read_b128 a[236:239], v241 offset:30848
 s_cmp_lg_u64 s[48:49], 0
 s_cbranch_scc1 RS13_0
RB13_0:
 v_add_f32 v248, v248, v249
 v_add_f32 v168, v168, v169
 s_waitcnt lgkmcnt(4)
 m16 v[144:147], a[240:243], v[96:99], v[160:163]
 m16 v[152:155], a[240:243], v[100:103], v[164:167]
 ds_read_b128 a[240:243], v240 offset:24832
 m16 v[148:151], a[244:247], v[96:99], v[160:163]
 m16 v[156:159], a[244:247], v[100:103], v[164:167]
 ds_read_b128 a[244:247], v240 offset:30976
 m16 v[144:147], a[248:251], v[104:107], v[144:147]
 m16 v[152:155], a[248:251], v[108:111], v[152:155]
 ds_read_b128 a[248:251], v241 offset:24832
 m16 v[148:151], a[252:255], v[104:107], v[148:151]
 m16 v[156:159], a[252:255], v[108:111], v[156:159]
 ds_read_b128 a[252:255], v241 offset:30976
 s_waitcnt lgkmcnt(2)
 m16 v[144:147], a[224:227], v[112:115], v[144:147]
 m16 v[152:155], a[224:227], v[116:119], v[152:155]
 m16 v[148:151], a[228:231], v[112:115], v[148:151]
 m16 v[156:159], a[228:231], v[116:119], v[156:159]
 m16 v[144:147], a[232:235], v[120:123], v[144:147]
 rtr a[224:225], v242, 12288
 m16 v[152:155], a[232:235], v[124:127], v[152:155]
 rtr a[226:227], v242, 18432
 m16 v[148:151], a[236:239], v[120:123], v[148:151]
 rtr a[228:229], v243, 12288
 m16 v[156:159], a[236:239], v[124:127], v[156:159]
 rtr a[230:231], v243, 18432
 m16 v[144:147], a[240:243], v[128:131], v[144:147]
 rtr a[232:233], v244, 12288
 m16 v[152:155], a[240:243], v[132:135], v[152:155]
 rtr a[234:235], v244, 18432
 m16 v[148:151], a[244:247], v[128:131], v[148:151]
 rtr a[236:237], v245, 12288
 m16 v[156:159], a[244:247], v[132:135], v[156:159]
 rtr a[238:239], v245, 18432
 s_waitcnt lgkmcnt(4)
 m16 v[144:147], a[248:251], v[136:139], v[144:147]
 rtr a[240:241], v242, 12416
 m16 v[152:155], a[248:251], v[140:143], v[152:155]
 rtr a[242:243], v242, 18560
 m16 v[148:151], a[252:255], v[136:139], v[148:151]
 rtr a[244:245], v243, 12416
 m16 v[156:159], a[252:255], v[140:143], v[156:159]
 rtr a[246:247], v243, 18560
 m16 v[0:3], a[224:227], v[184:187], v[0:3]
 rtr a[248:249], v244, 12416
 m16 v[8:11], a[224:227], v[188:191], v[8:11]
 rtr a[250:251], v244, 18560
 m16 v[4:7], a[228:231], v[184:187], v[4:7]
 rtr a[252:253], v245, 12416
 m16 v[12:15], a[228:231], v[188:191], v[12:15]
 rtr a[254:255], v245, 18560
 s_waitcnt lgkmcnt(4)
 m16 v[16:19], a[232:235], v[184:187], v[16:19]
 rtr a[224:225], v242, 12544
 m16 v[24:27], a[232:235], v[188:191], v[24:27]
 rtr a[226:227], v242, 18688
 v_mul_f32 v250, s36, v144
 v_mul_f32 v251, s36, v145
 m16 v[20:23], a[236:239], v[184:187], v[20:23]
 rtr a[228:229], v243, 12544
 m16 v[28:31], a[236:239], v[188:191], v[28:31]
 rtr a[230:231], v243, 18688
 v_exp_f32 v250, v250
 m16 v[32:35], a[240:243], v[184:187], v[32:35]
 rtr a[232:233], v244, 12544
 m16 v[40:43], a[240:243], v[188:191], v[40:43]
 rtr a[234:235], v244, 18688
 v_exp_f32 v251, v251
 m16 v[36:39], a[244:247], v[184:187], v[36:39]
 rtr a[236:237], v245, 12544
 cvt v176, v250, v251
 m16 v[44:47], a[244:247], v[188:191], v[44:47]
 rtr a[238:239], v245, 18688
 v_add_f32 v249, v250, v251
 s_waitcnt lgkmcnt(4)
 m16 v[48:51], a[248:251], v[184:187], v[48:51]
 ds_read_b128 v[192:195], v202 offset:24576
 v_mul_f32 v250, s36, v146
 m16 v[56:59], a[248:251], v[188:191], v[56:59]
 rtr a[240:241], v200
 rtr a[242:243], v200, 1536
 v_mul_f32 v251, s36, v147
 m16 v[52:55], a[252:255], v[184:187], v[52:55]
 rtr a[244:245], v201
 m16 v[60:63], a[252:255], v[188:191], v[60:63]
 rtr a[246:247], v201, 1536
 rtr a[248:249], v200, 128
 m16 v[64:67], a[224:227], v[184:187], v[64:67]
 rtr a[250:251], v200, 1664
 m16 v[72:75], a[224:227], v[188:191], v[72:75]
 rtr a[252:253], v201, 128
 v_exp_f32 v250, v250
 m16 v[68:71], a[228:231], v[184:187], v[68:71]
 rtr a[254:255], v201, 1664
 m16 v[76:79], a[228:231], v[188:191], v[76:79]
 rtr a[224:225], v200, 256
 s_waitcnt lgkmcnt(4)
 m16 v[80:83], a[232:235], v[184:187], v[80:83]
 rtr a[226:227], v200, 1792
 m16 v[88:91], a[232:235], v[188:191], v[88:91]
 rtr a[228:229], v201, 256
 v_exp_f32 v251, v251
 m16 v[84:87], a[236:239], v[184:187], v[84:87]
 rtr a[230:231], v201, 1792
 v_add_f32 v249, v249, v250
 m16 v[92:95], a[236:239], v[188:191], v[92:95]
 ds_read_b128 v[196:199], v203 offset:24576
 v_add_f32 v249, v249, v251
 cvt v177, v250, v251
 m32 a[0:15], a[240:243], v[192:195], a[0:15]
 rtr a[232:233], v200, 6144
 rtr a[234:235], v200, 7680
 rtr a[236:237], v201, 6144
 v_mul_f32 v250, s36, v148
 v_mul_f32 v251, s36, v149
 m32 a[16:31], a[244:247], v[192:195], a[16:31]
 rtr a[238:239], v201, 7680
 rtr a[240:241], v200, 6272
 rtr a[242:243], v200, 7808
 v_exp_f32 v250, v250
 s_waitcnt lgkmcnt(6)
 m32 a[32:47], a[248:251], v[192:195], a[32:47]
 rtr a[244:245], v201, 6272
 rtr a[246:247], v201, 7808
 rtr a[248:249], v200, 6400
 v_exp_f32 v251, v251
 v_add_f32 v249, v249, v250
 m32 a[48:63], a[252:255], v[192:195], a[48:63]
 rtr a[250:251], v200, 7936
 rtr a[252:253], v201, 6400
 rtr a[254:255], v201, 7936
 v_add_f32 v249, v249, v251
 cvt v178, v250, v251
 v_mul_f32 v250, s36, v150
 m32 a[64:79], a[224:227], v[192:195], a[64:79]
 v_mul_f32 v251, s36, v151
 v_exp_f32 v250, v250
 v_exp_f32 v251, v251
 v_add_f32 v249, v249, v250
 m32 a[80:95], a[228:231], v[192:195], a[80:95]
 v_add_f32 v249, v249, v251
 cvt v179, v250, v251
 v_mul_f32 v250, s36, v152
 v_mul_f32 v251, s36, v153
 s_waitcnt lgkmcnt(0)
 m32 a[0:15], a[232:235], v[196:199], a[0:15]
 v_exp_f32 v250, v250
 v_exp_f32 v251, v251
 s_nop 0
 cvt v180, v250, v251
 v_add_f32 v169, v250, v251
 m32 a[16:31], a[236:239], v[196:199], a[16:31]
 v_mul_f32 v250, s36, v154
 v_mul_f32 v251, s36, v155
 v_exp_f32 v250, v250
 s_barrier
 m32 a[32:47], a[240:243], v[196:199], a[32:47]
 ds_read_b128 a[224:227], v240
 ds_read_b128 a[228:231], v240 offset:6144
 v_exp_f32 v251, v251
 v_add_f32 v169, v169, v250
 v_add_f32 v169, v169, v251
 m32 a[48:63], a[244:247], v[196:199], a[48:63]
 ds_read_b128 a[232:235], v241
 ds_read_b128 a[236:239], v241 offset:6144
 cvt v181, v250, v251
 v_mul_f32 v250, s36, v156
 v_mul_f32 v251, s36, v157
 m32 a[64:79], a[248:251], v[196:199], a[64:79]
 ds_read_b128 a[240:243], v240 offset:128
 ds_read_b128 a[244:247], v240 offset:6272
 v_exp_f32 v250, v250
 v_exp_f32 v251, v251
 v_add_f32 v169, v169, v250
 v_add_f32 v169, v169, v251
 cvt v182, v250, v251
 v_mul_f32 v250, s36, v158
 v_mul_f32 v251, s36, v159
 v_exp_f32 v250, v250
 v_exp_f32 v251, v251
 v_add_f32 v169, v169, v250
 v_add_f32 v169, v169, v251
 cvt v183, v250, v251
 v_add_f32 v250, v249, v169
 v_cmp_nge_f32 s[48:49], s37, v250
 m32 a[80:95], a[252:255], v[196:199], a[80:95]
 ds_read_b128 a[248:251], v241 offset:128
 ds_read_b128 a[252:255], v241 offset:6272
 s_cmp_lg_u64 s[48:49], 0
 s_cbranch_scc1 RS14_0
RB14_0:
 v_add_f32 v248, v248, v249
 v_add_f32 v168, v168, v169
 s_waitcnt lgkmcnt(4)
 m16 v[144:147], a[224:227], v[96:99], v[160:163]
 m16 v[152:155], a[224:227], v[100:103], v[164:167]
 ds_read_b128 a[224:227], v240 offset:256
 m16 v[148:151], a[228:231], v[96:99], v[160:163]
 m16 v[156:159], a[228:231], v[100:103], v[164:167]
 ds_read_b128 a[228:231], v240 offset:6400
 m16 v[144:147], a[232:235], v[104:107], v[144:147]
 m16 v[152:155], a[232:235], v[108:111], v[152:155]
 ds_read_b128 a[232:235], v241 offset:256
 m16 v[148:151], a[236:239], v[104:107], v[148:151]
 m16 v[156:159], a[236:239], v[108:111], v[156:159]
 ds_read_b128 a[236:239], v241 offset:6400
 s_waitcnt lgkmcnt(2)
 m16 v[144:147], a[240:243], v[112:115], v[144:147]
 m16 v[152:155], a[240:243], v[116:119], v[152:155]
 m16 v[148:151], a[244:247], v[112:115], v[148:151]
 m16 v[156:159], a[244:247], v[116:119], v[156:159]
 m16 v[144:147], a[248:251], v[120:123], v[144:147]
 m16 v[152:155], a[248:251], v[124:127], v[152:155]
 m16 v[148:151], a[252:255], v[120:123], v[148:151]
 m16 v[156:159], a[252:255], v[124:127], v[156:159]
 s_waitcnt lgkmcnt(0)
 s_barrier
 m16 v[144:147], a[224:227], v[128:131], v[144:147]
 rtr a[240:241], v242, 24576
 m16 v[152:155], a[224:227], v[132:135], v[152:155]
 rtr a[242:243], v242, 30720
 rtr a[244:245], v243, 24576
 m16 v[148:151], a[228:231], v[128:131], v[148:151]
 rtr a[246:247], v243, 30720
 m16 v[156:159], a[228:231], v[132:135], v[156:159]
 rtr a[248:249], v244, 24576
 rtr a[250:251], v244, 30720
 m16 v[144:147], a[232:235], v[136:139], v[144:147]
 rtr a[252:253], v245, 24576
 m16 v[152:155], a[232:235], v[140:143], v[152:155]
 rtr a[254:255], v245, 30720
 m16 v[148:151], a[236:239], v[136:139], v[148:151]
 rtr a[224:225], v242, 24704
 m16 v[156:159], a[236:239], v[140:143], v[156:159]
 rtr a[226:227], v242, 30848
 s_waitcnt lgkmcnt(4)
 m16 v[0:3], a[240:243], v[176:179], v[0:3]
 rtr a[228:229], v243, 24704
 m16 v[8:11], a[240:243], v[180:183], v[8:11]
 rtr a[230:231], v243, 30848
 m16 v[4:7], a[244:247], v[176:179], v[4:7]
 rtr a[232:233], v244, 24704
 m16 v[12:15], a[244:247], v[180:183], v[12:15]
 rtr a[234:235], v244, 30848
 m16 v[16:19], a[248:251], v[176:179], v[16:19]
 rtr a[236:237], v245, 24704
 m16 v[24:27], a[248:251], v[180:183], v[24:27]
 rtr a[238:239], v245, 30848
 v_mul_f32 v250, s36, v144
 s_waitcnt lgkmcnt(4)
 m16 v[20:23], a[252:255], v[176:179], v[20:23]
 rtr a[240:241], v242, 24832
 v_mul_f32 v251, s36, v145
 m16 v[28:31], a[252:255], v[180:183], v[28:31]
 rtr a[242:243], v242, 30976
 v_exp_f32 v250, v250
 m16 v[32:35], a[224:227], v[176:179], v[32:35]
 rtr a[244:245], v243, 24832
 m16 v[40:43], a[224:227], v[180:183], v[40:43]
 rtr a[246:247], v243, 30976
 v_exp_f32 v251, v251
 m16 v[36:39], a[228:231], v[176:179], v[36:39]
 rtr a[248:249], v244, 24832
 cvt v184, v250, v251
 m16 v[44:47], a[228:231], v[180:183], v[44:47]
 rtr a[250:251], v244, 30976
 v_add_f32 v249, v250, v251
 s_waitcnt lgkmcnt(4)
 m16 v[48:51], a[232:235], v[176:179], v[48:51]
 rtr a[252:253], v245, 24832
 v_mul_f32 v250, s36, v146
 m16 v[56:59], a[232:235], v[180:183], v[56:59]
 rtr a[254:255], v245, 30976
 ds_read_b128 v[192:195], v204 offset:24576
 v_mul_f32 v251, s36, v147
 m16 v[52:55], a[236:239], v[176:179], v[52:55]
 rtr a[224:225], v200, 12288
 m16 v[60:63], a[236:239], v[180:183], v[60:63]
 rtr a[226:227], v200, 13824
 rtr a[228:229], v201, 12288
 m16 v[64:67], a[240:243], v[176:179], v[64:67]
 rtr a[230:231], v201, 13824
 m16 v[72:75], a[240:243], v[180:183], v[72:75]
 rtr a[232:233], v200, 12416
 rtr a[234:235], v200, 13952
 s_waitcnt lgkmcnt(6)
 m16 v[68:71], a[244:247], v[176:179], v[68:71]
 rtr a[236:237], v201, 12416
 m16 v[76:79], a[244:247], v[180:183], v[76:79]
 rtr a[238:239], v201, 13952
 rtr a[240:241], v200, 12544
 m16 v[80:83], a[248:251], v[176:179], v[80:83]
 rtr a[242:243], v200, 14080
 m16 v[88:91], a[248:251], v[180:183], v[88:91]
 rtr a[244:245], v201, 12544
 v_exp_f32 v250, v250
 m16 v[84:87], a[252:255], v[176:179], v[84:87]
 rtr a[246:247], v201, 14080
 m16 v[92:95], a[252:255], v[180:183], v[92:95]
 ds_read_b128 v[196:199], v205 offset:24576
 s_waitcnt lgkmcnt(4)
 m32 a[0:15], a[224:227], v[192:195], a[0:15]
 rtr a[248:249], v200, 18432
 rtr a[250:251], v200, 19968
 rtr a[252:253], v201, 18432
 v_exp_f32 v251, v251
 v_add_f32 v249, v249, v250
 m32 a[16:31], a[228:231], v[192:195], a[16:31]
 rtr a[254:255], v201, 19968
 rtr a[224:225], v200, 18560
 rtr a[226:227], v200, 20096
 v_add_f32 v249, v249, v251
 cvt v185, v250, v251
 v_mul_f32 v250, s36, v148
 m32 a[32:47], a[232:235], v[192:195], a[32:47]
 rtr a[228:229], v201, 18560
 rtr a[230:231], v201, 20096
 rtr a[232:233], v200, 18688
 v_mul_f32 v251, s36, v149
 v_exp_f32 v250, v250
 m32 a[48:63], a[236:239], v[192:195], a[48:63]
 rtr a[234:235], v200, 20224
 rtr a[236:237], v201, 18688
 rtr a[238:239], v201, 20224
 v_exp_f32 v251, v251
 s_waitcnt lgkmcnt(6)
 m32 a[64:79], a[240:243], v[192:195], a[64:79]
 v_add_f32 v249, v249, v250
 v_add_f32 v249, v249, v251
 cvt v186, v250, v251
 v_mul_f32 v250, s36, v150
 v_mul_f32 v251, s36, v151
 m32 a[80:95], a[244:247], v[192:195], a[80:95]
 v_exp_f32 v250, v250
 v_exp_f32 v251, v251
 v_add_f32 v249, v249, v250
 v_add_f32 v249, v249, v251
 m32 a[0:15], a[248:251], v[196:199], a[0:15]
 cvt v187, v250, v251
 v_mul_f32 v250, s36, v152
 v_mul_f32 v251, s36, v153
 v_exp_f32 v250, v250
 m32 a[16:31], a[252:255], v[196:199], a[16:31]
 v_exp_f32 v251, v251
 s_nop 0
 cvt v188, v250, v251
 s_waitcnt lgkmcnt(0)
 s_barrier
 m32 a[32:47], a[224:227], v[196:199], a[32:47]
 rtr a[240:241], v242, 36864
 rtr a[242:243], v242, 43008
 rtr a[244:245], v243, 36864
 v_add_f32 v169, v250, v251
 v_mul_f32 v250, s36, v154
 v_mul_f32 v251, s36, v155
 m32 a[48:63], a[228:231], v[196:199], a[48:63]
 rtr a[246:247], v243, 43008
 rtr a[248:249], v244, 36864
 rtr a[250:251], v244, 43008
 v_exp_f32 v250, v250
 m32 a[64:79], a[232:235], v[196:199], a[64:79]
 rtr a[252:253], v245, 36864
 rtr a[254:255], v245, 43008
 rtr a[224:225], v242, 36992
 v_exp_f32 v251, v251
 v_add_f32 v169, v169, v250
 v_add_f32 v169, v169, v251
 cvt v189, v250, v251
 v_mul_f32 v250, s36, v156
 v_mul_f32 v251, s36, v157
 v_exp_f32 v250, v250
 v_exp_f32 v251, v251
 v_add_f32 v169, v169, v250
 v_add_f32 v169, v169, v251
 cvt v190, v250, v251
 v_mul_f32 v250, s36, v158
 v_mul_f32 v251, s36, v159
 v_exp_f32 v250, v250
 v_exp_f32 v251, v251
 v_add_f32 v169, v169, v250
 v_add_f32 v169, v169, v251
 cvt v191, v250, v251
 v_add_f32 v250, v249, v169
 v_cmp_nge_f32 s[48:49], s37, v250
 m32 a[80:95], a[236:239], v[196:199], a[80:95]
 rtr a[226:227], v242, 43136
 rtr a[228:229], v243, 36992
 rtr a[230:231], v243, 43136
 s_cmp_lg_u64 s[48:49], 0
 s_cbranch_scc1 RS15_0
RB15_0:
 v_add_f32 v248, v248, v249
 v_add_f32 v168, v168, v169
 s_waitcnt lgkmcnt(6)
 m16 v[0:3], a[240:243], v[184:187], v[0:3]
 rtr a[232:233], v244, 36992
 m16 v[8:11], a[240:243], v[188:191], v[8:11]
 rtr a[234:235], v244, 43136
 rtr a[236:237], v245, 36992
 v_mov_b32 v250, v248
 m16 v[4:7], a[244:247], v[184:187], v[4:7]
 rtr a[238:239], v245, 43136
 v_permlane16_swap_b32 v248, v250
 m16 v[12:15], a[244:247], v[188:191], v[12:15]
 rtr a[240:241], v242, 37120
 rtr a[242:243], v242, 43264
 v_add_f32 v248, v248, v250
 m16 v[16:19], a[248:251], v[184:187], v[16:19]
 rtr a[244:245], v243, 37120
 v_mov_b32 v250, v248
 m16 v[24:27], a[248:251], v[188:191], v[24:27]
 rtr a[246:247], v243, 43264
 rtr a[248:249], v244, 37120
 s_waitcnt lgkmcnt(6)
 m16 v[20:23], a[252:255], v[184:187], v[20:23]
 rtr a[250:251], v244, 43264
 v_permlane32_swap_b32 v248, v250
 m16 v[28:31], a[252:255], v[188:191], v[28:31]
 rtr a[252:253], v245, 37120
 rtr a[254:255], v245, 43264
 v_add_f32 v248, v248, v250
 m16 v[32:35], a[224:227], v[184:187], v[32:35]
 v_rcp_f32 v252, v248
 m16 v[40:43], a[224:227], v[188:191], v[40:43]
 v_mov_b32 v251, v168
 s_nop 1
 v_permlane16_swap_b32 v168, v251
 v_add_f32 v168, v168, v251
 m16 v[36:39], a[228:231], v[184:187], v[36:39]
 v_mov_b32 v251, v168
 s_nop 1
 v_permlane32_swap_b32 v168, v251
 m16 v[44:47], a[228:231], v[188:191], v[44:47]
 v_add_f32 v168, v168, v251
 v_rcp_f32 v249, v168
 m16 v[48:51], a[232:235], v[184:187], v[48:51]
 v_mul_f32 v0, v252, v0
 v_mul_f32 v1, v252, v1
 m16 v[56:59], a[232:235], v[188:191], v[56:59]
 s_waitcnt lgkmcnt(0)
 s_barrier
 m16 v[52:55], a[236:239], v[184:187], v[52:55]
 ds_read_b128 v[192:195], v202 offset:36864
 cvt v0, v0, v1
 m16 v[60:63], a[236:239], v[188:191], v[60:63]
 rtr a[224:225], v200
 rtr a[226:227], v200, 1536
 v_mul_f32 v2, v252, v2
 m16 v[64:67], a[240:243], v[184:187], v[64:67]
 rtr a[228:229], v201
 v_mul_f32 v3, v252, v3
 m16 v[72:75], a[240:243], v[188:191], v[72:75]
 rtr a[230:231], v201, 1536
 rtr a[232:233], v200, 128
 cvt v1, v2, v3
 m16 v[68:71], a[244:247], v[184:187], v[68:71]
 rtr a[234:235], v200, 1664
 v_mul_f32 v4, v252, v4
 m16 v[76:79], a[244:247], v[188:191], v[76:79]
 rtr a[236:237], v201, 128
 rtr a[238:239], v201, 1664
 v_mul_f32 v5, v252, v5
 m16 v[80:83], a[248:251], v[184:187], v[80:83]
 rtr a[240:241], v200, 256
 cvt v2, v4, v5
 m16 v[88:91], a[248:251], v[188:191], v[88:91]
 rtr a[242:243], v200, 1792
 rtr a[244:245], v201, 256
 v_mul_f32 v6, v252, v6
 m16 v[84:87], a[252:255], v[184:187], v[84:87]
 rtr a[246:247], v201, 1792
 v_mul_f32 v7, v252, v7
 m16 v[92:95], a[252:255], v[188:191], v[92:95]
 ds_read_b128 v[196:199], v203 offset:36864
 cvt v3, v6, v7
 s_waitcnt lgkmcnt(5)
 m32 a[0:15], a[224:227], v[192:195], a[0:15]
 rtr a[248:249], v200, 6144
 rtr a[250:251], v200, 7680
 rtr a[252:253], v201, 6144
 v_mul_f32 v8, v249, v8
 v_mul_f32 v9, v249, v9
 cvt v4, v8, v9
 m32 a[16:31], a[228:231], v[192:195], a[16:31]
 rtr a[254:255], v201, 7680
 rtr a[224:225], v200, 6272
 rtr a[226:227], v200, 7808
 v_mul_f32 v10, v249, v10
 v_mul_f32 v11, v249, v11
 cvt v5, v10, v11
 m32 a[32:47], a[232:235], v[192:195], a[32:47]
 rtr a[228:229], v201, 6272
 rtr a[230:231], v201, 7808
 rtr a[232:233], v200, 6400
 v_mul_f32 v12, v249, v12
 v_mul_f32 v13, v249, v13
 cvt v6, v12, v13
 m32 a[48:63], a[236:239], v[192:195], a[48:63]
 rtr a[234:235], v200, 7936
 rtr a[236:237], v201, 6400
 rtr a[238:239], v201, 7936
 v_mul_f32 v14, v249, v14
 v_mul_f32 v15, v249, v15
 s_waitcnt lgkmcnt(6)
 m32 a[64:79], a[240:243], v[192:195], a[64:79]
 cvt v7, v14, v15
 v_mul_f32 v16, v252, v16
 v_mul_f32 v17, v252, v17
 cvt v8, v16, v17
 v_mul_f32 v18, v252, v18
 v_mul_f32 v19, v252, v19
 m32 a[80:95], a[244:247], v[192:195], a[80:95]
 cvt v9, v18, v19
 v_mul_f32 v20, v252, v20
 v_mul_f32 v21, v252, v21
 cvt v10, v20, v21
 v_mul_f32 v22, v252, v22
 v_mul_f32 v23, v252, v23
 m32 a[0:15], a[248:251], v[196:199], a[0:15]
 cvt v11, v22, v23
 v_mul_f32 v24, v249, v24
 v_mul_f32 v25, v249, v25
 s_waitcnt lgkmcnt(0)
 s_barrier
 m32 a[16:31], a[252:255], v[196:199], a[16:31]
 ds_read_b128 v[192:195], v204 offset:36864
 rtr a[240:241], v200, 12288
 rtr a[242:243], v200, 13824
 cvt v12, v24, v25
 v_mul_f32 v26, v249, v26
 v_mul_f32 v27, v249, v27
 m32 a[32:47], a[224:227], v[196:199], a[32:47]
 ds_read_b128 v[180:183], v205 offset:36864
 rtr a[244:245], v200, 18432
 rtr a[246:247], v200, 19968
 cvt v13, v26, v27
 v_mul_f32 v28, v249, v28
 v_mul_f32 v29, v249, v29
 m32 a[48:63], a[228:231], v[196:199], a[48:63]
 rtr a[248:249], v201, 12288
 rtr a[250:251], v201, 13824
 rtr a[252:253], v201, 18432
 cvt v14, v28, v29
 v_mul_f32 v30, v249, v30
 v_mul_f32 v31, v249, v31
 m32 a[64:79], a[232:235], v[196:199], a[64:79]
 rtr a[254:255], v201, 19968
 rtr a[224:225], v200, 12416
 rtr a[226:227], v200, 13952
 cvt v15, v30, v31
 v_mul_f32 v32, v252, v32
 v_mul_f32 v33, v252, v33
 m32 a[80:95], a[236:239], v[196:199], a[80:95]
 rtr a[228:229], v200, 18560
 rtr a[230:231], v200, 20096
 rtr a[232:233], v201, 12416
 cvt v16, v32, v33
 v_mul_f32 v34, v252, v34
 s_waitcnt lgkmcnt(6)
 m32 a[0:15], a[240:243], v[192:195], a[0:15]
 rtr a[234:235], v201, 13952
 rtr a[236:237], v201, 18560
 rtr a[238:239], v201, 20096
 v_mul_f32 v35, v252, v35
 cvt v17, v34, v35
 v_mul_f32 v36, v252, v36
 m32 a[0:15], a[244:247], v[180:183], a[0:15]
 rtr a[240:241], v200, 12544
 rtr a[242:243], v200, 14080
 rtr a[244:245], v200, 18688
 v_mul_f32 v37, v252, v37
 cvt v18, v36, v37
 v_mul_f32 v38, v252, v38
 m32 a[16:31], a[248:251], v[192:195], a[16:31]
 rtr a[246:247], v200, 20224
 rtr a[248:249], v201, 12544
 rtr a[250:251], v201, 14080
 v_mul_f32 v39, v252, v39
 cvt v19, v38, v39
 s_waitcnt lgkmcnt(6)
 m32 a[16:31], a[252:255], v[180:183], a[16:31]
 rtr a[252:253], v201, 18688
 rtr a[254:255], v201, 20224
 v_mul_f32 v40, v249, v40
 v_mul_f32 v41, v249, v41
 cvt v20, v40, v41
 v_mul_f32 v42, v249, v42
 m32 a[32:47], a[224:227], v[192:195], a[32:47]
 v_mul_f32 v43, v249, v43
 cvt v21, v42, v43
 v_mul_f32 v44, v249, v44
 v_mul_f32 v45, v249, v45
 cvt v22, v44, v45
 v_mul_f32 v46, v249, v46
 m32 a[32:47], a[228:231], v[180:183], a[32:47]
 v_mul_f32 v47, v249, v47
 cvt v23, v46, v47
 v_mul_f32 v48, v252, v48
 v_mul_f32 v49, v252, v49
 cvt v24, v48, v49
 v_mul_f32 v50, v252, v50
 m32 a[48:63], a[232:235], v[192:195], a[48:63]
 v_mul_f32 v51, v252, v51
 cvt v25, v50, v51
 v_mul_f32 v52, v252, v52
 v_mul_f32 v53, v252, v53
 cvt v26, v52, v53
 v_mul_f32 v54, v252, v54
 m32 a[48:63], a[236:239], v[180:183], a[48:63]
 v_mul_f32 v55, v252, v55
 cvt v27, v54, v55
 v_mul_f32 v56, v249, v56
 s_waitcnt lgkmcnt(0)
 s_barrier
 m32 a[64:79], a[240:243], v[192:195], a[64:79]
 ds_read_b128 a[224:227], v240
 ds_read_b128 a[228:231], v240 offset:6144
 v_mul_f32 v57, v249, v57
 cvt v28, v56, v57
 v_mul_f32 v58, v249, v58
 v_mul_f32 v59, v249, v59
 m32 a[64:79], a[244:247], v[180:183], a[64:79]
 ds_read_b128 a[232:235], v241
 ds_read_b128 a[236:239], v241 offset:6144
 cvt v29, v58, v59
 v_mul_f32 v60, v249, v60
 v_mul_f32 v61, v249, v61
 cvt v30, v60, v61
 m32 a[80:95], a[248:251], v[192:195], a[80:95]
 ds_read_b128 a[240:243], v240 offset:128
 ds_read_b128 a[244:247], v240 offset:6272
 v_mul_f32 v62, v249, v62
 v_mul_f32 v63, v249, v63
 cvt v31, v62, v63
 v_mul_f32 v64, v252, v64
 m32 a[80:95], a[252:255], v[180:183], a[80:95]
 ds_read_b128 a[248:251], v241 offset:128
 ds_read_b128 a[252:255], v241 offset:6272
 v_mul_f32 v65, v252, v65
 cvt v32, v64, v65
 v_mul_f32 v66, v252, v66
 v_mul_f32 v67, v252, v67
 cvt v33, v66, v67
 v_mul_f32 v68, v252, v68
 v_mul_f32 v69, v252, v69
 cvt v34, v68, v69
 v_mul_f32 v70, v252, v70
 v_mul_f32 v71, v252, v71
 cvt v35, v70, v71
 v_mul_f32 v72, v249, v72
 v_mul_f32 v73, v249, v73
 cvt v36, v72, v73
 v_mul_f32 v74, v249, v74
 v_mul_f32 v75, v249, v75
 cvt v37, v74, v75
 v_mul_f32 v76, v249, v76
 v_mul_f32 v77, v249, v77
 cvt v38, v76, v77
 v_mul_f32 v78, v249, v78
 v_mul_f32 v79, v249, v79
 cvt v39, v78, v79
 v_mul_f32 v80, v252, v80
 v_mul_f32 v81, v252, v81
 cvt v40, v80, v81
 v_mul_f32 v82, v252, v82
 v_mul_f32 v83, v252, v83
 cvt v41, v82, v83
 v_mul_f32 v84, v252, v84
 v_mul_f32 v85, v252, v85
 cvt v42, v84, v85
 v_mul_f32 v86, v252, v86
 v_mul_f32 v87, v252, v87
 cvt v43, v86, v87
 v_mul_f32 v88, v249, v88
 v_mul_f32 v89, v249, v89
 cvt v44, v88, v89
 v_mul_f32 v90, v249, v90
 v_mul_f32 v91, v249, v91
 cvt v45, v90, v91
 v_mul_f32 v92, v249, v92
 v_mul_f32 v93, v249, v93
 cvt v46, v92, v93
 v_mul_f32 v94, v249, v94
 v_mul_f32 v95, v249, v95
 cvt v47, v94, v95
 v_accvgpr_read_b32 v96, a0
 v_accvgpr_read_b32 v253, a1
 cvt v96, v96, v253
 v_accvgpr_read_b32 v97, a2
 v_accvgpr_read_b32 v253, a3
 cvt v97, v97, v253
 v_accvgpr_read_b32 v98, a4
 v_accvgpr_read_b32 v253, a5
 cvt v98, v98, v253
 v_accvgpr_read_b32 v99, a6
 v_accvgpr_read_b32 v253, a7
 cvt v99, v99, v253
 v_accvgpr_read_b32 v100, a8
 v_accvgpr_read_b32 v253, a9
 cvt v100, v100, v253
 v_accvgpr_read_b32 v101, a10
 v_accvgpr_read_b32 v253, a11
 cvt v101, v101, v253
 v_accvgpr_read_b32 v102, a12
 v_accvgpr_read_b32 v253, a13
 cvt v102, v102, v253
 v_accvgpr_read_b32 v103, a14
 v_accvgpr_read_b32 v253, a15
 cvt v103, v103, v253
 v_permlane16_swap_b32 v96, v100
 v_permlane16_swap_b32 v97, v101
 v_permlane16_swap_b32 v98, v102
 v_permlane16_swap_b32 v99, v103
 v_accvgpr_read_b32 v104, a16
 v_accvgpr_read_b32 v253, a17
 cvt v104, v104, v253
 v_accvgpr_read_b32 v105, a18
 v_accvgpr_read_b32 v253, a19
 cvt v105, v105, v253
 v_accvgpr_read_b32 v106, a20
 v_accvgpr_read_b32 v253, a21
 cvt v106, v106, v253
 v_accvgpr_read_b32 v107, a22
 v_accvgpr_read_b32 v253, a23
 cvt v107, v107, v253
 v_accvgpr_read_b32 v108, a24
 v_accvgpr_read_b32 v253, a25
 cvt v108, v108, v253
 v_accvgpr_read_b32 v109, a26
 v_accvgpr_read_b32 v253, a27
 cvt v109, v109, v253
 v_accvgpr_read_b32 v110, a28
 v_accvgpr_read_b32 v253, a29
 cvt v110, v110, v253
 v_accvgpr_read_b32 v111, a30
 v_accvgpr_read_b32 v253, a31
 cvt v111, v111, v253
 v_permlane16_swap_b32 v104, v108
 v_permlane16_swap_b32 v105, v109
 v_permlane16_swap_b32 v106, v110
 v_permlane16_swap_b32 v107, v111
 v_accvgpr_read_b32 v112, a32
 v_accvgpr_read_b32 v253, a33
 cvt v112, v112, v253
 v_accvgpr_read_b32 v113, a34
 v_accvgpr_read_b32 v253, a35
 cvt v113, v113, v253
 v_accvgpr_read_b32 v114, a36
 v_accvgpr_read_b32 v253, a37
 cvt v114, v114, v253
 v_accvgpr_read_b32 v115, a38
 v_accvgpr_read_b32 v253, a39
 cvt v115, v115, v253
 v_accvgpr_read_b32 v116, a40
 v_accvgpr_read_b32 v253, a41
 cvt v116, v116, v253
 v_accvgpr_read_b32 v117, a42
 v_accvgpr_read_b32 v253, a43
 cvt v117, v117, v253
 v_accvgpr_read_b32 v118, a44
 v_accvgpr_read_b32 v253, a45
 cvt v118, v118, v253
 v_accvgpr_read_b32 v119, a46
 v_accvgpr_read_b32 v253, a47
 cvt v119, v119, v253
 v_permlane16_swap_b32 v112, v116
 v_permlane16_swap_b32 v113, v117
 v_permlane16_swap_b32 v114, v118
 v_permlane16_swap_b32 v115, v119
 v_accvgpr_read_b32 v120, a48
 v_accvgpr_read_b32 v253, a49
 cvt v120, v120, v253
 v_accvgpr_read_b32 v121, a50
 v_accvgpr_read_b32 v253, a51
 cvt v121, v121, v253
 v_accvgpr_read_b32 v122, a52
 v_accvgpr_read_b32 v253, a53
 cvt v122, v122, v253
 v_accvgpr_read_b32 v123, a54
 v_accvgpr_read_b32 v253, a55
 cvt v123, v123, v253
 v_accvgpr_read_b32 v124, a56
 v_accvgpr_read_b32 v253, a57
 cvt v124, v124, v253
 v_accvgpr_read_b32 v125, a58
 v_accvgpr_read_b32 v253, a59
 cvt v125, v125, v253
 v_accvgpr_read_b32 v126, a60
 v_accvgpr_read_b32 v253, a61
 cvt v126, v126, v253
 v_accvgpr_read_b32 v127, a62
 v_accvgpr_read_b32 v253, a63
 cvt v127, v127, v253
 v_permlane16_swap_b32 v120, v124
 v_permlane16_swap_b32 v121, v125
 v_permlane16_swap_b32 v122, v126
 v_permlane16_swap_b32 v123, v127
 v_accvgpr_read_b32 v128, a64
 v_accvgpr_read_b32 v253, a65
 cvt v128, v128, v253
 v_accvgpr_read_b32 v129, a66
 v_accvgpr_read_b32 v253, a67
 cvt v129, v129, v253
 v_accvgpr_read_b32 v130, a68
 v_accvgpr_read_b32 v253, a69
 cvt v130, v130, v253
 v_accvgpr_read_b32 v131, a70
 v_accvgpr_read_b32 v253, a71
 cvt v131, v131, v253
 v_accvgpr_read_b32 v132, a72
 v_accvgpr_read_b32 v253, a73
 cvt v132, v132, v253
 v_accvgpr_read_b32 v133, a74
 v_accvgpr_read_b32 v253, a75
 cvt v133, v133, v253
 v_accvgpr_read_b32 v134, a76
 v_accvgpr_read_b32 v253, a77
 cvt v134, v134, v253
 v_accvgpr_read_b32 v135, a78
 v_accvgpr_read_b32 v253, a79
 cvt v135, v135, v253
 v_permlane16_swap_b32 v128, v132
 v_permlane16_swap_b32 v129, v133
 v_permlane16_swap_b32 v130, v134
 v_permlane16_swap_b32 v131, v135
 v_accvgpr_read_b32 v136, a80
 v_accvgpr_read_b32 v253, a81
 cvt v136, v136, v253
 v_accvgpr_read_b32 v137, a82
 v_accvgpr_read_b32 v253, a83
 cvt v137, v137, v253
 v_accvgpr_read_b32 v138, a84
 v_accvgpr_read_b32 v253, a85
 cvt v138, v138, v253
 v_accvgpr_read_b32 v139, a86
 v_accvgpr_read_b32 v253, a87
 cvt v139, v139, v253
 v_accvgpr_read_b32 v140, a88
 v_accvgpr_read_b32 v253, a89
 cvt v140, v140, v253
 v_accvgpr_read_b32 v141, a90
 v_accvgpr_read_b32 v253, a91
 cvt v141, v141, v253
 v_accvgpr_read_b32 v142, a92
 v_accvgpr_read_b32 v253, a93
 cvt v142, v142, v253
 v_accvgpr_read_b32 v143, a94
 v_accvgpr_read_b32 v253, a95
 cvt v143, v143, v253
 v_permlane16_swap_b32 v136, v140
 v_permlane16_swap_b32 v137, v141
 v_permlane16_swap_b32 v138, v142
 v_permlane16_swap_b32 v139, v143
 v_mov_b32 v192, 0
 v_mov_b32 v193, 0
 v_mov_b32 v194, 0
 v_mov_b32 v195, 0
 v_mov_b32 v196, 0
 v_mov_b32 v197, 0
 v_mov_b32 v198, 0
 v_mov_b32 v199, 0
 v_mov_b32 v200, 0
 v_mov_b32 v201, 0
 v_mov_b32 v202, 0
 v_mov_b32 v203, 0
 v_mov_b32 v204, 0
 v_mov_b32 v205, 0
 v_mov_b32 v206, 0
 v_mov_b32 v207, 0
 v_mbcnt_lo_u32_b32 v253, -1, 0
 v_mbcnt_hi_u32_b32 v253, -1, v253
 v_lshlrev_b32 v253, 4, v253
 v_add_u32 v250, s32, v253
 v_lshlrev_b32 v250, 8, v250
 v_mov_b32 v251, 1
 buffer_store_byte v251, v250, s[92:95], s51 offen sc1
LOOP:
 s_waitcnt lgkmcnt(4)
 m16 v[144:147], a[224:227], v[96:99], 0
 m16 v[152:155], a[224:227], v[100:103], 0
 ds_read_b128 a[224:227], v240 offset:256
 v_accvgpr_write_b32 a0, v0
 v_accvgpr_write_b32 a1, v1
 m16 v[148:151], a[228:231], v[96:99], 0
 v_accvgpr_write_b32 a2, v2
 v_accvgpr_write_b32 a3, v3
 m16 v[156:159], a[228:231], v[100:103], 0
 ds_read_b128 a[228:231], v240 offset:6400
 v_accvgpr_write_b32 a4, v4
 v_accvgpr_write_b32 a5, v5
 m16 v[144:147], a[232:235], v[104:107], v[144:147]
 v_accvgpr_write_b32 a6, v6
 v_accvgpr_write_b32 a7, v7
 m16 v[152:155], a[232:235], v[108:111], v[152:155]
 ds_read_b128 a[232:235], v241 offset:256
 cvt v232, v192, v193
 cvt v233, v194, v195
 m16 v[148:151], a[236:239], v[104:107], v[148:151]
 cvt v234, v196, v197
 cvt v235, v198, v199
 m16 v[156:159], a[236:239], v[108:111], v[156:159]
 ds_read_b128 a[236:239], v241 offset:6400
 cvt v236, v200, v201
 s_waitcnt lgkmcnt(2)
 m16 v[144:147], a[240:243], v[112:115], v[144:147]
 cvt v237, v202, v203
 cvt v238, v204, v205
 m16 v[152:155], a[240:243], v[116:119], v[152:155]
 cvt v239, v206, v207
 v_accvgpr_read_b32 v193, a96
 v_lshlrev_b32 v192, 16, v193
 m16 v[148:151], a[244:247], v[112:115], v[148:151]
 v_and_b32 v193, 0xffff0000, v193
 v_accvgpr_read_b32 v195, a97
 m16 v[156:159], a[244:247], v[116:119], v[156:159]
 v_lshlrev_b32 v194, 16, v195
 v_and_b32 v195, 0xffff0000, v195
 v_accvgpr_read_b32 v197, a98
 m16 v[144:147], a[248:251], v[120:123], v[144:147]
 v_lshlrev_b32 v196, 16, v197
 v_and_b32 v197, 0xffff0000, v197
 m16 v[152:155], a[248:251], v[124:127], v[152:155]
 v_accvgpr_read_b32 v199, a99
 v_lshlrev_b32 v198, 16, v199
 v_and_b32 v199, 0xffff0000, v199
 m16 v[148:151], a[252:255], v[120:123], v[148:151]
 v_accvgpr_read_b32 v201, a100
 v_lshlrev_b32 v200, 16, v201
 m16 v[156:159], a[252:255], v[124:127], v[156:159]
 s_waitcnt lgkmcnt(0)
 s_barrier
 m16 v[144:147], a[224:227], v[128:131], v[144:147]
 rtr a[240:241], v172, 24576
 v_and_b32 v201, 0xffff0000, v201
 m16 v[152:155], a[224:227], v[132:135], v[152:155]
 rtr a[242:243], v172, 26624
 rtr a[244:245], v173, 24576
 v_accvgpr_read_b32 v203, a101
 m16 v[148:151], a[228:231], v[128:131], v[148:151]
 rtr a[246:247], v173, 26624
 v_lshlrev_b32 v202, 16, v203
 m16 v[156:159], a[228:231], v[132:135], v[156:159]
 rtr a[248:249], v172, 28672
 rtr a[250:251], v172, 30720
 v_and_b32 v203, 0xffff0000, v203
 m16 v[144:147], a[232:235], v[136:139], v[144:147]
 rtr a[252:253], v173, 28672
 v_accvgpr_read_b32 v205, a102
 m16 v[152:155], a[232:235], v[140:143], v[152:155]
 rtr a[254:255], v173, 30720
 rtr a[224:225], v172, 32768
 v_lshlrev_b32 v204, 16, v205
 m16 v[148:151], a[236:239], v[136:139], v[148:151]
 rtr a[226:227], v172, 34816
 v_and_b32 v205, 0xffff0000, v205
 m16 v[156:159], a[236:239], v[140:143], v[156:159]
 rtr a[228:229], v173, 32768
 rtr a[230:231], v173, 34816
 v_accvgpr_read_b32 v207, a103
 v_lshlrev_b32 v206, 16, v207
 v_and_b32 v207, 0xffff0000, v207
 s_waitcnt lgkmcnt(6)
 m16 v[192:195], a[240:243], v[0:3], v[192:195]
 rtr a[232:233], v172
 v_accvgpr_write_b32 a8, v8
 m16 v[200:203], a[240:243], v[4:7], v[200:203]
 rtr a[234:235], v172, 2048
 rtr a[236:237], v173
 v_accvgpr_write_b32 a9, v9
 m16 v[196:199], a[244:247], v[0:3], v[196:199]
 rtr a[238:239], v173, 2048
 v_accvgpr_write_b32 a10, v10
 m16 v[204:207], a[244:247], v[4:7], v[204:207]
 rtr a[240:241], v172, 4096
 rtr a[242:243], v172, 6144
 v_accvgpr_write_b32 a11, v11
 m16 v[192:195], a[248:251], v[8:11], v[192:195]
 rtr a[244:245], v173, 4096
 v_accvgpr_write_b32 a12, v12
 m16 v[200:203], a[248:251], v[12:15], v[200:203]
 rtr a[246:247], v173, 6144
 rtr a[248:249], v172, 8192
 s_waitcnt lgkmcnt(6)
 m16 v[196:199], a[252:255], v[8:11], v[196:199]
 rtr a[250:251], v172, 10240
 v_max3_f32 v250, v144, v145, v146
 m16 v[204:207], a[252:255], v[12:15], v[204:207]
 rtr a[252:253], v173, 8192
 rtr a[254:255], v173, 10240
 v_max3_f32 v250, v250, v147, v148
 m16 v[192:195], a[224:227], v[16:19], v[192:195]
 v_max3_f32 v250, v250, v149, v150
 v_max_f32 v250, v250, v151
 m16 v[200:203], a[224:227], v[20:23], v[200:203]
 v_mov_b32 v251, v250
 s_nop 1
 v_permlane16_swap_b32 v250, v251
 v_max_f32 v250, v250, v251
 m16 v[196:199], a[228:231], v[16:19], v[196:199]
 v_mov_b32 v251, v250
 s_nop 1
 v_permlane32_swap_b32 v250, v251
 m16 v[204:207], a[228:231], v[20:23], v[204:207]
 v_max_f32 v250, v250, v251
 v_sub_f32 v160, 0, v250
 v_sub_f32 v161, 0, v250
 m16 v[192:195], a[232:235], v[24:27], v[192:195]
 v_sub_f32 v162, 0, v250
 v_sub_f32 v163, 0, v250
 m16 v[200:203], a[232:235], v[28:31], v[200:203]
 v_sub_f32 v144, v144, v250
 v_sub_f32 v145, v145, v250
 s_waitcnt lgkmcnt(0)
 m16 v[196:199], a[236:239], v[24:27], v[196:199]
 v_sub_f32 v146, v146, v250
 v_sub_f32 v147, v147, v250
 m16 v[204:207], a[236:239], v[28:31], v[204:207]
 v_sub_f32 v148, v148, v250
 s_barrier
 m16 v[192:195], a[240:243], v[32:35], v[192:195]
 ds_read_b128 a[224:227], v240 offset:12288
 v_sub_f32 v149, v149, v250
 m16 v[200:203], a[240:243], v[36:39], v[200:203]
 ds_read_b128 a[228:231], v240 offset:18432
 v_sub_f32 v150, v150, v250
 v_sub_f32 v151, v151, v250
 m16 v[196:199], a[244:247], v[32:35], v[196:199]
 ds_read_b128 a[232:235], v241 offset:12288
 v_max3_f32 v250, v152, v153, v154
 m16 v[204:207], a[244:247], v[36:39], v[204:207]
 ds_read_b128 a[236:239], v241 offset:18432
 v_max3_f32 v250, v250, v155, v156
 v_max3_f32 v250, v250, v157, v158
 m16 v[192:195], a[248:251], v[40:43], v[192:195]
 ds_read_b128 a[240:243], v240 offset:12416
 v_max_f32 v250, v250, v159
 m16 v[200:203], a[248:251], v[44:47], v[200:203]
 ds_read_b128 a[244:247], v240 offset:18560
 v_mov_b32 v251, v250
 s_nop 1
 v_permlane16_swap_b32 v250, v251
 v_max_f32 v250, v250, v251
 v_mov_b32 v251, v250
 s_nop 1
 v_permlane32_swap_b32 v250, v251
 v_max_f32 v250, v250, v251
 v_sub_f32 v164, 0, v250
 v_sub_f32 v165, 0, v250
 v_sub_f32 v166, 0, v250
 v_sub_f32 v167, 0, v250
 v_sub_f32 v152, v152, v250
 v_sub_f32 v153, v153, v250
 v_sub_f32 v154, v154, v250
 v_sub_f32 v155, v155, v250
 v_sub_f32 v156, v156, v250
 v_sub_f32 v157, v157, v250
 v_sub_f32 v158, v158, v250
 v_sub_f32 v159, v159, v250
 m16 v[196:199], a[252:255], v[40:43], v[196:199]
 ds_read_b128 a[248:251], v241 offset:12416
 v_mul_f32 v250, s36, v144
 m16 v[204:207], a[252:255], v[44:47], v[204:207]
 ds_read_b128 a[252:255], v241 offset:18560
 v_mul_f32 v251, s36, v145
 v_exp_f32 v250, v250
 v_exp_f32 v251, v251
 s_nop 0
 cvt v176, v250, v251
 v_add_f32 v249, v250, v251
 v_mul_f32 v250, s36, v146
 v_mul_f32 v251, s36, v147
 v_exp_f32 v250, v250
 v_exp_f32 v251, v251
 v_add_f32 v249, v249, v250
 v_add_f32 v249, v249, v251
 cvt v177, v250, v251
 v_mul_f32 v250, s36, v148
 v_mul_f32 v251, s36, v149
 v_exp_f32 v250, v250
 v_exp_f32 v251, v251
 v_add_f32 v249, v249, v250
 v_add_f32 v249, v249, v251
 cvt v178, v250, v251
 v_mul_f32 v250, s36, v150
 v_mul_f32 v251, s36, v151
 v_exp_f32 v250, v250
 v_exp_f32 v251, v251
 v_add_f32 v249, v249, v250
 v_add_f32 v249, v249, v251
 cvt v179, v250, v251
 v_mul_f32 v250, s36, v152
 v_mul_f32 v251, s36, v153
 v_exp_f32 v250, v250
 v_exp_f32 v251, v251
 s_nop 0
 cvt v180, v250, v251
 v_add_f32 v169, v250, v251
 v_mul_f32 v250, s36, v154
 v_mul_f32 v251, s36, v155
 v_exp_f32 v250, v250
 v_exp_f32 v251, v251
 v_add_f32 v169, v169, v250
 v_add_f32 v169, v169, v251
 cvt v181, v250, v251
 v_mul_f32 v250, s36, v156
 v_mul_f32 v251, s36, v157
 v_exp_f32 v250, v250
 v_exp_f32 v251, v251
 v_add_f32 v169, v169, v250
 v_add_f32 v169, v169, v251
 cvt v182, v250, v251
 v_mul_f32 v250, s36, v158
 v_mul_f32 v251, s36, v159
 v_exp_f32 v250, v250
 v_exp_f32 v251, v251
 v_add_f32 v169, v169, v250
 v_add_f32 v169, v169, v251
 cvt v183, v250, v251
 v_mov_b32 v248, v249
 v_mov_b32 v168, v169
 s_waitcnt lgkmcnt(4)
 m16 v[144:147], a[224:227], v[96:99], v[160:163]
 v_accvgpr_write_b32 a13, v13
 v_accvgpr_write_b32 a14, v14
 m16 v[152:155], a[224:227], v[100:103], v[164:167]
 ds_read_b128 a[224:227], v240 offset:12544
 v_accvgpr_write_b32 a15, v15
 v_accvgpr_write_b32 a16, v16
 m16 v[148:151], a[228:231], v[96:99], v[160:163]
 v_accvgpr_write_b32 a17, v17
 v_accvgpr_write_b32 a18, v18
 m16 v[156:159], a[228:231], v[100:103], v[164:167]
 ds_read_b128 a[228:231], v240 offset:18688
 v_accvgpr_write_b32 a19, v19
 v_accvgpr_write_b32 a20, v20
 m16 v[144:147], a[232:235], v[104:107], v[144:147]
 v_accvgpr_write_b32 a21, v21
 v_accvgpr_write_b32 a22, v22
 m16 v[152:155], a[232:235], v[108:111], v[152:155]
 ds_read_b128 a[232:235], v241 offset:12544
 v_accvgpr_write_b32 a23, v23
 v_accvgpr_write_b32 a24, v24
 m16 v[148:151], a[236:239], v[104:107], v[148:151]
 v_accvgpr_write_b32 a25, v25
 v_accvgpr_write_b32 a26, v26
 m16 v[156:159], a[236:239], v[108:111], v[156:159]
 ds_read_b128 a[236:239], v241 offset:18688
 v_accvgpr_write_b32 a27, v27
 s_waitcnt lgkmcnt(2)
 m16 v[144:147], a[240:243], v[112:115], v[144:147]
 v_accvgpr_write_b32 a28, v28
 v_accvgpr_write_b32 a29, v29
 m16 v[152:155], a[240:243], v[116:119], v[152:155]
 v_accvgpr_write_b32 a30, v30
 v_accvgpr_write_b32 a31, v31
 v_accvgpr_write_b32 a32, v32
 m16 v[148:151], a[244:247], v[112:115], v[148:151]
 v_accvgpr_write_b32 a33, v33
 v_accvgpr_write_b32 a34, v34
 m16 v[156:159], a[244:247], v[116:119], v[156:159]
 v_accvgpr_write_b32 a35, v35
 v_accvgpr_write_b32 a36, v36
 v_accvgpr_write_b32 a37, v37
 m16 v[144:147], a[248:251], v[120:123], v[144:147]
 rtr a[240:241], v242
 v_accvgpr_write_b32 a38, v38
 m16 v[152:155], a[248:251], v[124:127], v[152:155]
 rtr a[242:243], v242, 6144
 v_accvgpr_write_b32 a39, v39
 v_accvgpr_write_b32 a40, v40
 m16 v[148:151], a[252:255], v[120:123], v[148:151]
 rtr a[244:245], v243
 v_accvgpr_write_b32 a41, v41
 m16 v[156:159], a[252:255], v[124:127], v[156:159]
 rtr a[246:247], v243, 6144
 v_accvgpr_write_b32 a42, v42
 v_accvgpr_write_b32 a43, v43
 m16 v[144:147], a[224:227], v[128:131], v[144:147]
 rtr a[248:249], v244
 v_accvgpr_write_b32 a44, v44
 m16 v[152:155], a[224:227], v[132:135], v[152:155]
 rtr a[250:251], v244, 6144
 v_accvgpr_write_b32 a45, v45
 v_accvgpr_write_b32 a46, v46
 m16 v[148:151], a[228:231], v[128:131], v[148:151]
 rtr a[252:253], v245
 v_accvgpr_write_b32 a47, v47
 m16 v[156:159], a[228:231], v[132:135], v[156:159]
 rtr a[254:255], v245, 6144
 cvt v192, v192, v193
 s_waitcnt lgkmcnt(4)
 m16 v[144:147], a[232:235], v[136:139], v[144:147]
 rtr a[224:225], v242, 128
 v_accvgpr_write_b32 a96, v192
 m16 v[152:155], a[232:235], v[140:143], v[152:155]
 rtr a[226:227], v242, 6272
 cvt v194, v194, v195
 v_accvgpr_write_b32 a97, v194
 m16 v[148:151], a[236:239], v[136:139], v[148:151]
 rtr a[228:229], v243, 128
 cvt v196, v196, v197
 m16 v[156:159], a[236:239], v[140:143], v[156:159]
 rtr a[230:231], v243, 6272
 v_accvgpr_write_b32 a98, v196
 cvt v198, v198, v199
 m16 v[0:3], a[240:243], v[176:179], 0
 rtr a[232:233], v244, 128
 v_accvgpr_write_b32 a99, v198
 m16 v[8:11], a[240:243], v[180:183], 0
 rtr a[234:235], v244, 6272
 cvt v200, v200, v201
 v_accvgpr_write_b32 a100, v200
 m16 v[4:7], a[244:247], v[176:179], 0
 rtr a[236:237], v245, 128
 cvt v202, v202, v203
 m16 v[12:15], a[244:247], v[180:183], 0
 rtr a[238:239], v245, 6272
 v_accvgpr_write_b32 a101, v202
 s_waitcnt lgkmcnt(4)
 m16 v[16:19], a[248:251], v[176:179], 0
 rtr a[240:241], v242, 256
 cvt v204, v204, v205
 m16 v[24:27], a[248:251], v[180:183], 0
 rtr a[242:243], v242, 6400
 v_accvgpr_write_b32 a102, v204
 cvt v206, v206, v207
 m16 v[20:23], a[252:255], v[176:179], 0
 rtr a[244:245], v243, 256
 v_accvgpr_write_b32 a103, v206
 m16 v[28:31], a[252:255], v[180:183], 0
 rtr a[246:247], v243, 6400
 v_accvgpr_read_b32 v193, a104
 v_lshlrev_b32 v192, 16, v193
 m16 v[32:35], a[224:227], v[176:179], 0
 rtr a[248:249], v244, 256
 v_and_b32 v193, 0xffff0000, v193
 m16 v[40:43], a[224:227], v[180:183], 0
 rtr a[250:251], v244, 6400
 v_accvgpr_read_b32 v195, a105
 v_lshlrev_b32 v194, 16, v195
 m16 v[36:39], a[228:231], v[176:179], 0
 rtr a[252:253], v245, 256
 v_and_b32 v195, 0xffff0000, v195
 m16 v[44:47], a[228:231], v[180:183], 0
 rtr a[254:255], v245, 6400
 v_accvgpr_read_b32 v197, a106
 s_waitcnt lgkmcnt(4)
 m16 v[48:51], a[232:235], v[176:179], 0
 rtr a[224:225], v174, 24576
 v_lshlrev_b32 v196, 16, v197
 m16 v[56:59], a[232:235], v[180:183], 0
 rtr a[226:227], v174, 26624
 rtr a[228:229], v175, 24576
 v_and_b32 v197, 0xffff0000, v197
 m16 v[52:55], a[236:239], v[176:179], 0
 rtr a[230:231], v175, 26624
 v_accvgpr_read_b32 v199, a107
 m16 v[60:63], a[236:239], v[180:183], 0
 rtr a[232:233], v174, 28672
 rtr a[234:235], v174, 30720
 v_lshlrev_b32 v198, 16, v199
 m16 v[64:67], a[240:243], v[176:179], 0
 rtr a[236:237], v175, 28672
 v_and_b32 v199, 0xffff0000, v199
 m16 v[72:75], a[240:243], v[180:183], 0
 rtr a[238:239], v175, 30720
 rtr a[240:241], v174, 32768
 v_accvgpr_read_b32 v201, a108
 m16 v[68:71], a[244:247], v[176:179], 0
 rtr a[242:243], v174, 34816
 v_lshlrev_b32 v200, 16, v201
 m16 v[76:79], a[244:247], v[180:183], 0
 rtr a[244:245], v175, 32768
 rtr a[246:247], v175, 34816
 s_waitcnt lgkmcnt(6)
 m16 v[80:83], a[248:251], v[176:179], 0
 v_and_b32 v201, 0xffff0000, v201
 v_accvgpr_read_b32 v203, a109
 m16 v[88:91], a[248:251], v[180:183], 0
 rtr a[248:249], v174
 rtr a[250:251], v174, 2048
 v_lshlrev_b32 v202, 16, v203
 m16 v[84:87], a[252:255], v[176:179], 0
 v_and_b32 v203, 0xffff0000, v203
 v_accvgpr_read_b32 v205, a110
 m16 v[92:95], a[252:255], v[180:183], 0
 rtr a[252:253], v175
 rtr a[254:255], v175, 2048
 v_lshlrev_b32 v204, 16, v205
 v_and_b32 v205, 0xffff0000, v205
 v_accvgpr_read_b32 v207, a111
 v_lshlrev_b32 v206, 16, v207
 v_and_b32 v207, 0xffff0000, v207
 m16 v[192:195], a[224:227], a[0:3], v[192:195]
 v_mul_f32 v250, s36, v144
 v_mul_f32 v251, s36, v145
 m16 v[200:203], a[224:227], a[4:7], v[200:203]
 rtr a[224:225], v174, 4096
 rtr a[226:227], v174, 6144
 m16 v[196:199], a[228:231], a[0:3], v[196:199]
 v_exp_f32 v250, v250
 m16 v[204:207], a[228:231], a[4:7], v[204:207]
 rtr a[228:229], v175, 4096
 rtr a[230:231], v175, 6144
 m16 v[192:195], a[232:235], a[8:11], v[192:195]
 v_exp_f32 v251, v251
 m16 v[200:203], a[232:235], a[12:15], v[200:203]
 rtr a[232:233], v174, 8192
 rtr a[234:235], v174, 10240
 s_waitcnt lgkmcnt(4)
 m16 v[196:199], a[236:239], a[8:11], v[196:199]
 cvt v184, v250, v251
 v_add_f32 v249, v250, v251
 m16 v[204:207], a[236:239], a[12:15], v[204:207]
 rtr a[236:237], v175, 8192
 rtr a[238:239], v175, 10240
 v_mul_f32 v250, s36, v146
 m16 v[192:195], a[240:243], a[16:19], v[192:195]
 v_mul_f32 v251, s36, v147
 m16 v[200:203], a[240:243], a[20:23], v[200:203]
 v_exp_f32 v250, v250
 m16 v[196:199], a[244:247], a[16:19], v[196:199]
 v_exp_f32 v251, v251
 m16 v[204:207], a[244:247], a[20:23], v[204:207]
 v_add_f32 v249, v249, v250
 v_add_f32 v249, v249, v251
 cvt v185, v250, v251
 m16 v[192:195], a[248:251], a[24:27], v[192:195]
 v_mul_f32 v250, s36, v148
 v_mul_f32 v251, s36, v149
 m16 v[200:203], a[248:251], a[28:31], v[200:203]
 v_exp_f32 v250, v250
 m16 v[196:199], a[252:255], a[24:27], v[196:199]
 v_exp_f32 v251, v251
 m16 v[204:207], a[252:255], a[28:31], v[204:207]
 s_waitcnt lgkmcnt(0)
 s_barrier
 m16 v[192:195], a[224:227], a[32:35], v[192:195]
 ds_read_b128 a[240:243], v240 offset:24576
 v_add_f32 v249, v249, v250
 m16 v[200:203], a[224:227], a[36:39], v[200:203]
 ds_read_b128 a[244:247], v240 offset:30720
 v_add_f32 v249, v249, v251
 cvt v186, v250, v251
 m16 v[196:199], a[228:231], a[32:35], v[196:199]
 ds_read_b128 a[248:251], v241 offset:24576
 v_mul_f32 v250, s36, v150
 m16 v[204:207], a[228:231], a[36:39], v[204:207]
 ds_read_b128 a[252:255], v241 offset:30720
 v_mul_f32 v251, s36, v151
 m16 v[192:195], a[232:235], a[40:43], v[192:195]
 ds_read_b128 a[224:227], v240 offset:24704
 m16 v[200:203], a[232:235], a[44:47], v[200:203]
 ds_read_b128 a[228:231], v240 offset:30848
 v_exp_f32 v250, v250
 v_exp_f32 v251, v251
 v_add_f32 v249, v249, v250
 v_add_f32 v249, v249, v251
 cvt v187, v250, v251
 v_mul_f32 v250, s36, v152
 v_mul_f32 v251, s36, v153
 v_exp_f32 v250, v250
 v_exp_f32 v251, v251
 s_nop 0
 cvt v188, v250, v251
 v_add_f32 v169, v250, v251
 v_mul_f32 v250, s36, v154
 v_mul_f32 v251, s36, v155
 v_exp_f32 v250, v250
 v_exp_f32 v251, v251
 v_add_f32 v169, v169, v250
 v_add_f32 v169, v169, v251
 cvt v189, v250, v251
 v_mul_f32 v250, s36, v156
 v_mul_f32 v251, s36, v157
 v_exp_f32 v250, v250
 v_exp_f32 v251, v251
 v_add_f32 v169, v169, v250
 v_add_f32 v169, v169, v251
 cvt v190, v250, v251
 v_mul_f32 v250, s36, v158
 v_mul_f32 v251, s36, v159
 v_exp_f32 v250, v250
 v_exp_f32 v251, v251
 v_add_f32 v169, v169, v250
 v_add_f32 v169, v169, v251
 cvt v191, v250, v251
 v_add_f32 v250, v249, v169
 v_cmp_nge_f32 s[48:49], s37, v250
 m16 v[196:199], a[236:239], a[40:43], v[196:199]
 ds_read_b128 a[232:235], v241 offset:24704
 m16 v[204:207], a[236:239], a[44:47], v[204:207]
 ds_read_b128 a[236:239], v241 offset:30848
 s_cmp_lg_u64 s[48:49], 0
 s_cbranch_scc1 RS1_1
RB1_1:
 v_add_f32 v248, v248, v249
 v_add_f32 v168, v168, v169
 s_waitcnt lgkmcnt(4)
 m16 v[144:147], a[240:243], v[96:99], v[160:163]
 m16 v[152:155], a[240:243], v[100:103], v[164:167]
 ds_read_b128 a[240:243], v240 offset:24832
 m16 v[148:151], a[244:247], v[96:99], v[160:163]
 m16 v[156:159], a[244:247], v[100:103], v[164:167]
 ds_read_b128 a[244:247], v240 offset:30976
 m16 v[144:147], a[248:251], v[104:107], v[144:147]
 m16 v[152:155], a[248:251], v[108:111], v[152:155]
 ds_read_b128 a[248:251], v241 offset:24832
 cvt v192, v192, v193
 v_accvgpr_write_b32 a104, v192
 m16 v[148:151], a[252:255], v[104:107], v[148:151]
 cvt v194, v194, v195
 v_accvgpr_write_b32 a105, v194
 m16 v[156:159], a[252:255], v[108:111], v[156:159]
 ds_read_b128 a[252:255], v241 offset:30976
 cvt v196, v196, v197
 s_waitcnt lgkmcnt(2)
 m16 v[144:147], a[224:227], v[112:115], v[144:147]
 v_accvgpr_write_b32 a106, v196
 cvt v198, v198, v199
 m16 v[152:155], a[224:227], v[116:119], v[152:155]
 v_accvgpr_write_b32 a107, v198
 cvt v200, v200, v201
 v_accvgpr_write_b32 a108, v200
 m16 v[148:151], a[228:231], v[112:115], v[148:151]
 cvt v202, v202, v203
 v_accvgpr_write_b32 a109, v202
 m16 v[156:159], a[228:231], v[116:119], v[156:159]
 cvt v204, v204, v205
 v_accvgpr_write_b32 a110, v204
 cvt v206, v206, v207
 m16 v[144:147], a[232:235], v[120:123], v[144:147]
 rtr a[224:225], v242, 12288
 v_accvgpr_write_b32 a111, v206
 m16 v[152:155], a[232:235], v[124:127], v[152:155]
 rtr a[226:227], v242, 18432
 v_accvgpr_read_b32 v193, a112
 v_lshlrev_b32 v192, 16, v193
 m16 v[148:151], a[236:239], v[120:123], v[148:151]
 rtr a[228:229], v243, 12288
 v_and_b32 v193, 0xffff0000, v193
 m16 v[156:159], a[236:239], v[124:127], v[156:159]
 rtr a[230:231], v243, 18432
 v_accvgpr_read_b32 v195, a113
 v_lshlrev_b32 v194, 16, v195
 m16 v[144:147], a[240:243], v[128:131], v[144:147]
 rtr a[232:233], v244, 12288
 v_and_b32 v195, 0xffff0000, v195
 m16 v[152:155], a[240:243], v[132:135], v[152:155]
 rtr a[234:235], v244, 18432
 v_accvgpr_read_b32 v197, a114
 v_lshlrev_b32 v196, 16, v197
 m16 v[148:151], a[244:247], v[128:131], v[148:151]
 rtr a[236:237], v245, 12288
 v_and_b32 v197, 0xffff0000, v197
 m16 v[156:159], a[244:247], v[132:135], v[156:159]
 rtr a[238:239], v245, 18432
 v_accvgpr_read_b32 v199, a115
 s_waitcnt lgkmcnt(4)
 m16 v[144:147], a[248:251], v[136:139], v[144:147]
 rtr a[240:241], v242, 12416
 v_lshlrev_b32 v198, 16, v199
 m16 v[152:155], a[248:251], v[140:143], v[152:155]
 rtr a[242:243], v242, 18560
 v_and_b32 v199, 0xffff0000, v199
 v_accvgpr_read_b32 v201, a116
 m16 v[148:151], a[252:255], v[136:139], v[148:151]
 rtr a[244:245], v243, 12416
 v_lshlrev_b32 v200, 16, v201
 m16 v[156:159], a[252:255], v[140:143], v[156:159]
 rtr a[246:247], v243, 18560
 v_and_b32 v201, 0xffff0000, v201
 v_accvgpr_read_b32 v203, a117
 m16 v[0:3], a[224:227], v[184:187], v[0:3]
 rtr a[248:249], v244, 12416
 v_lshlrev_b32 v202, 16, v203
 m16 v[8:11], a[224:227], v[188:191], v[8:11]
 rtr a[250:251], v244, 18560
 v_and_b32 v203, 0xffff0000, v203
 v_accvgpr_read_b32 v205, a118
 m16 v[4:7], a[228:231], v[184:187], v[4:7]
 rtr a[252:253], v245, 12416
 v_lshlrev_b32 v204, 16, v205
 m16 v[12:15], a[228:231], v[188:191], v[12:15]
 rtr a[254:255], v245, 18560
 v_and_b32 v205, 0xffff0000, v205
 s_waitcnt lgkmcnt(4)
 m16 v[16:19], a[232:235], v[184:187], v[16:19]
 rtr a[224:225], v242, 12544
 v_accvgpr_read_b32 v207, a119
 m16 v[24:27], a[232:235], v[188:191], v[24:27]
 rtr a[226:227], v242, 18688
 v_lshlrev_b32 v206, 16, v207
 v_and_b32 v207, 0xffff0000, v207
 m16 v[20:23], a[236:239], v[184:187], v[20:23]
 rtr a[228:229], v243, 12544
 v_mul_f32 v250, s36, v144
 m16 v[28:31], a[236:239], v[188:191], v[28:31]
 rtr a[230:231], v243, 18688
 v_mul_f32 v251, s36, v145
 m16 v[32:35], a[240:243], v[184:187], v[32:35]
 rtr a[232:233], v244, 12544
 m16 v[40:43], a[240:243], v[188:191], v[40:43]
 rtr a[234:235], v244, 18688
 v_exp_f32 v250, v250
 m16 v[36:39], a[244:247], v[184:187], v[36:39]
 rtr a[236:237], v245, 12544
 m16 v[44:47], a[244:247], v[188:191], v[44:47]
 rtr a[238:239], v245, 18688
 s_waitcnt lgkmcnt(4)
 m16 v[48:51], a[248:251], v[184:187], v[48:51]
 rtr a[240:241], v172, 12288
 m16 v[56:59], a[248:251], v[188:191], v[56:59]
 rtr a[242:243], v172, 14336
 rtr a[244:245], v173, 12288
 m16 v[52:55], a[252:255], v[184:187], v[52:55]
 rtr a[246:247], v173, 14336
 m16 v[60:63], a[252:255], v[188:191], v[60:63]
 rtr a[248:249], v172, 16384
 rtr a[250:251], v172, 18432
 m16 v[64:67], a[224:227], v[184:187], v[64:67]
 rtr a[252:253], v173, 16384
 m16 v[72:75], a[224:227], v[188:191], v[72:75]
 rtr a[254:255], v173, 18432
 rtr a[224:225], v172, 20480
 m16 v[68:71], a[228:231], v[184:187], v[68:71]
 rtr a[226:227], v172, 22528
 m16 v[76:79], a[228:231], v[188:191], v[76:79]
 rtr a[228:229], v173, 20480
 rtr a[230:231], v173, 22528
 s_waitcnt lgkmcnt(6)
 m16 v[80:83], a[232:235], v[184:187], v[80:83]
 v_exp_f32 v251, v251
 m16 v[88:91], a[232:235], v[188:191], v[88:91]
 rtr a[232:233], v172, 36864
 rtr a[234:235], v172, 38912
 cvt v176, v250, v251
 m16 v[84:87], a[236:239], v[184:187], v[84:87]
 v_add_f32 v249, v250, v251
 v_mul_f32 v250, s36, v146
 m16 v[92:95], a[236:239], v[188:191], v[92:95]
 rtr a[236:237], v173, 36864
 rtr a[238:239], v173, 38912
 v_mul_f32 v251, s36, v147
 m16 v[192:195], a[240:243], a[0:3], v[192:195]
 v_exp_f32 v250, v250
 m16 v[200:203], a[240:243], a[4:7], v[200:203]
 rtr a[240:241], v172, 40960
 rtr a[242:243], v172, 43008
 m16 v[196:199], a[244:247], a[0:3], v[196:199]
 v_exp_f32 v251, v251
 m16 v[204:207], a[244:247], a[4:7], v[204:207]
 rtr a[244:245], v173, 40960
 rtr a[246:247], v173, 43008
 v_add_f32 v249, v249, v250
 m16 v[192:195], a[248:251], a[8:11], v[192:195]
 v_add_f32 v249, v249, v251
 cvt v177, v250, v251
 m16 v[200:203], a[248:251], a[12:15], v[200:203]
 rtr a[248:249], v172, 45056
 rtr a[250:251], v172, 47104
 s_waitcnt lgkmcnt(4)
 m16 v[196:199], a[252:255], a[8:11], v[196:199]
 v_mul_f32 v250, s36, v148
 v_mul_f32 v251, s36, v149
 m16 v[204:207], a[252:255], a[12:15], v[204:207]
 rtr a[252:253], v173, 45056
 rtr a[254:255], v173, 47104
 m16 v[192:195], a[224:227], a[16:19], v[192:195]
 v_exp_f32 v250, v250
 m16 v[200:203], a[224:227], a[20:23], v[200:203]
 v_exp_f32 v251, v251
 v_add_f32 v249, v249, v250
 m16 v[196:199], a[228:231], a[16:19], v[196:199]
 v_add_f32 v249, v249, v251
 cvt v178, v250, v251
 m16 v[204:207], a[228:231], a[20:23], v[204:207]
 v_mul_f32 v250, s36, v150
 v_mul_f32 v251, s36, v151
 m16 v[192:195], a[232:235], a[24:27], v[192:195]
 v_exp_f32 v250, v250
 m16 v[200:203], a[232:235], a[28:31], v[200:203]
 v_exp_f32 v251, v251
 v_add_f32 v249, v249, v250
 m16 v[196:199], a[236:239], a[24:27], v[196:199]
 v_add_f32 v249, v249, v251
 cvt v179, v250, v251
 m16 v[204:207], a[236:239], a[28:31], v[204:207]
 s_waitcnt lgkmcnt(0)
 s_barrier
 m16 v[192:195], a[240:243], a[32:35], v[192:195]
 ds_read_b128 a[224:227], v240
 v_mul_f32 v250, s36, v152
 m16 v[200:203], a[240:243], a[36:39], v[200:203]
 ds_read_b128 a[228:231], v240 offset:6144
 v_mul_f32 v251, s36, v153
 m16 v[196:199], a[244:247], a[32:35], v[196:199]
 ds_read_b128 a[232:235], v241
 m16 v[204:207], a[244:247], a[36:39], v[204:207]
 ds_read_b128 a[236:239], v241 offset:6144
 v_exp_f32 v250, v250
 m16 v[192:195], a[248:251], a[40:43], v[192:195]
 ds_read_b128 a[240:243], v240 offset:128
 m16 v[200:203], a[248:251], a[44:47], v[200:203]
 ds_read_b128 a[244:247], v240 offset:6272
 v_exp_f32 v251, v251
 s_nop 0
 cvt v180, v250, v251
 v_add_f32 v169, v250, v251
 v_mul_f32 v250, s36, v154
 v_mul_f32 v251, s36, v155
 v_exp_f32 v250, v250
 v_exp_f32 v251, v251
 v_add_f32 v169, v169, v250
 v_add_f32 v169, v169, v251
 cvt v181, v250, v251
 v_mul_f32 v250, s36, v156
 v_mul_f32 v251, s36, v157
 v_exp_f32 v250, v250
 v_exp_f32 v251, v251
 v_add_f32 v169, v169, v250
 v_add_f32 v169, v169, v251
 cvt v182, v250, v251
 v_mul_f32 v250, s36, v158
 v_mul_f32 v251, s36, v159
 v_exp_f32 v250, v250
 v_exp_f32 v251, v251
 v_add_f32 v169, v169, v250
 v_add_f32 v169, v169, v251
 cvt v183, v250, v251
 v_add_f32 v250, v249, v169
 v_cmp_nge_f32 s[48:49], s37, v250
 m16 v[196:199], a[252:255], a[40:43], v[196:199]
 ds_read_b128 a[248:251], v241 offset:128
 m16 v[204:207], a[252:255], a[44:47], v[204:207]
 ds_read_b128 a[252:255], v241 offset:6272
 s_cmp_lg_u64 s[48:49], 0
 s_cbranch_scc1 RS2_1
RB2_1:
 v_add_f32 v248, v248, v249
 v_add_f32 v168, v168, v169
 s_waitcnt lgkmcnt(4)
 m16 v[144:147], a[224:227], v[96:99], v[160:163]
 m16 v[152:155], a[224:227], v[100:103], v[164:167]
 ds_read_b128 a[224:227], v240 offset:256
 m16 v[148:151], a[228:231], v[96:99], v[160:163]
 m16 v[156:159], a[228:231], v[100:103], v[164:167]
 ds_read_b128 a[228:231], v240 offset:6400
 m16 v[144:147], a[232:235], v[104:107], v[144:147]
 m16 v[152:155], a[232:235], v[108:111], v[152:155]
 ds_read_b128 a[232:235], v241 offset:256
 cvt v192, v192, v193
 v_accvgpr_write_b32 a112, v192
 m16 v[148:151], a[236:239], v[104:107], v[148:151]
 cvt v194, v194, v195
 v_accvgpr_write_b32 a113, v194
 m16 v[156:159], a[236:239], v[108:111], v[156:159]
 ds_read_b128 a[236:239], v241 offset:6400
 cvt v196, v196, v197
 s_waitcnt lgkmcnt(2)
 m16 v[144:147], a[240:243], v[112:115], v[144:147]
 v_accvgpr_write_b32 a114, v196
 cvt v198, v198, v199
 m16 v[152:155], a[240:243], v[116:119], v[152:155]
 v_accvgpr_write_b32 a115, v198
 cvt v200, v200, v201
 v_accvgpr_write_b32 a116, v200
 m16 v[148:151], a[244:247], v[112:115], v[148:151]
 cvt v202, v202, v203
 v_accvgpr_write_b32 a117, v202
 m16 v[156:159], a[244:247], v[116:119], v[156:159]
 cvt v204, v204, v205
 v_accvgpr_write_b32 a118, v204
 cvt v206, v206, v207
 m16 v[144:147], a[248:251], v[120:123], v[144:147]
 rtr a[240:241], v242, 24576
 v_accvgpr_write_b32 a119, v206
 m16 v[152:155], a[248:251], v[124:127], v[152:155]
 rtr a[242:243], v242, 30720
 v_accvgpr_read_b32 v193, a120
 v_lshlrev_b32 v192, 16, v193
 m16 v[148:151], a[252:255], v[120:123], v[148:151]
 rtr a[244:245], v243, 24576
 v_and_b32 v193, 0xffff0000, v193
 m16 v[156:159], a[252:255], v[124:127], v[156:159]
 rtr a[246:247], v243, 30720
 v_accvgpr_read_b32 v195, a121
 v_lshlrev_b32 v194, 16, v195
 m16 v[144:147], a[224:227], v[128:131], v[144:147]
 rtr a[248:249], v244, 24576
 v_and_b32 v195, 0xffff0000, v195
 m16 v[152:155], a[224:227], v[132:135], v[152:155]
 rtr a[250:251], v244, 30720
 v_accvgpr_read_b32 v197, a122
 v_lshlrev_b32 v196, 16, v197
 m16 v[148:151], a[228:231], v[128:131], v[148:151]
 rtr a[252:253], v245, 24576
 v_and_b32 v197, 0xffff0000, v197
 m16 v[156:159], a[228:231], v[132:135], v[156:159]
 rtr a[254:255], v245, 30720
 v_accvgpr_read_b32 v199, a123
 s_waitcnt lgkmcnt(4)
 m16 v[144:147], a[232:235], v[136:139], v[144:147]
 rtr a[224:225], v242, 24704
 v_lshlrev_b32 v198, 16, v199
 m16 v[152:155], a[232:235], v[140:143], v[152:155]
 rtr a[226:227], v242, 30848
 v_and_b32 v199, 0xffff0000, v199
 v_accvgpr_read_b32 v201, a124
 m16 v[148:151], a[236:239], v[136:139], v[148:151]
 rtr a[228:229], v243, 24704
 v_lshlrev_b32 v200, 16, v201
 m16 v[156:159], a[236:239], v[140:143], v[156:159]
 rtr a[230:231], v243, 30848
 v_and_b32 v201, 0xffff0000, v201
 v_accvgpr_read_b32 v203, a125
 m16 v[0:3], a[240:243], v[176:179], v[0:3]
 rtr a[232:233], v244, 24704
 v_lshlrev_b32 v202, 16, v203
 m16 v[8:11], a[240:243], v[180:183], v[8:11]
 rtr a[234:235], v244, 30848
 v_and_b32 v203, 0xffff0000, v203
 v_accvgpr_read_b32 v205, a126
 m16 v[4:7], a[244:247], v[176:179], v[4:7]
 rtr a[236:237], v245, 24704
 v_lshlrev_b32 v204, 16, v205
 m16 v[12:15], a[244:247], v[180:183], v[12:15]
 rtr a[238:239], v245, 30848
 v_and_b32 v205, 0xffff0000, v205
 s_waitcnt lgkmcnt(4)
 m16 v[16:19], a[248:251], v[176:179], v[16:19]
 rtr a[240:241], v242, 24832
 v_accvgpr_read_b32 v207, a127
 m16 v[24:27], a[248:251], v[180:183], v[24:27]
 rtr a[242:243], v242, 30976
 v_lshlrev_b32 v206, 16, v207
 v_and_b32 v207, 0xffff0000, v207
 m16 v[20:23], a[252:255], v[176:179], v[20:23]
 rtr a[244:245], v243, 24832
 v_mul_f32 v250, s36, v144
 m16 v[28:31], a[252:255], v[180:183], v[28:31]
 rtr a[246:247], v243, 30976
 v_mul_f32 v251, s36, v145
 m16 v[32:35], a[224:227], v[176:179], v[32:35]
 rtr a[248:249], v244, 24832
 m16 v[40:43], a[224:227], v[180:183], v[40:43]
 rtr a[250:251], v244, 30976
 v_exp_f32 v250, v250
 m16 v[36:39], a[228:231], v[176:179], v[36:39]
 rtr a[252:253], v245, 24832
 m16 v[44:47], a[228:231], v[180:183], v[44:47]
 rtr a[254:255], v245, 30976
 s_waitcnt lgkmcnt(4)
 m16 v[48:51], a[232:235], v[176:179], v[48:51]
 rtr a[224:225], v174, 12288
 m16 v[56:59], a[232:235], v[180:183], v[56:59]
 rtr a[226:227], v174, 14336
 rtr a[228:229], v175, 12288
 m16 v[52:55], a[236:239], v[176:179], v[52:55]
 rtr a[230:231], v175, 14336
 m16 v[60:63], a[236:239], v[180:183], v[60:63]
 rtr a[232:233], v174, 16384
 rtr a[234:235], v174, 18432
 m16 v[64:67], a[240:243], v[176:179], v[64:67]
 rtr a[236:237], v175, 16384
 m16 v[72:75], a[240:243], v[180:183], v[72:75]
 rtr a[238:239], v175, 18432
 rtr a[240:241], v174, 20480
 m16 v[68:71], a[244:247], v[176:179], v[68:71]
 rtr a[242:243], v174, 22528
 m16 v[76:79], a[244:247], v[180:183], v[76:79]
 rtr a[244:245], v175, 20480
 rtr a[246:247], v175, 22528
 s_waitcnt lgkmcnt(6)
 m16 v[80:83], a[248:251], v[176:179], v[80:83]
 v_exp_f32 v251, v251
 m16 v[88:91], a[248:251], v[180:183], v[88:91]
 rtr a[248:249], v174, 36864
 rtr a[250:251], v174, 38912
 cvt v184, v250, v251
 m16 v[84:87], a[252:255], v[176:179], v[84:87]
 v_add_f32 v249, v250, v251
 v_mul_f32 v250, s36, v146
 m16 v[92:95], a[252:255], v[180:183], v[92:95]
 rtr a[252:253], v175, 36864
 rtr a[254:255], v175, 38912
 v_mul_f32 v251, s36, v147
 m16 v[192:195], a[224:227], a[0:3], v[192:195]
 v_exp_f32 v250, v250
 m16 v[200:203], a[224:227], a[4:7], v[200:203]
 rtr a[224:225], v174, 40960
 rtr a[226:227], v174, 43008
 m16 v[196:199], a[228:231], a[0:3], v[196:199]
 v_exp_f32 v251, v251
 m16 v[204:207], a[228:231], a[4:7], v[204:207]
 rtr a[228:229], v175, 40960
 rtr a[230:231], v175, 43008
 v_add_f32 v249, v249, v250
 m16 v[192:195], a[232:235], a[8:11], v[192:195]
 v_add_f32 v249, v249, v251
 cvt v185, v250, v251
 m16 v[200:203], a[232:235], a[12:15], v[200:203]
 rtr a[232:233], v174, 45056
 rtr a[234:235], v174, 47104
 s_waitcnt lgkmcnt(4)
 m16 v[196:199], a[236:239], a[8:11], v[196:199]
 v_mul_f32 v250, s36, v148
 v_mul_f32 v251, s36, v149
 m16 v[204:207], a[236:239], a[12:15], v[204:207]
 rtr a[236:237], v175, 45056
 rtr a[238:239], v175, 47104
 m16 v[192:195], a[240:243], a[16:19], v[192:195]
 v_exp_f32 v250, v250
 m16 v[200:203], a[240:243], a[20:23], v[200:203]
 v_exp_f32 v251, v251
 v_add_f32 v249, v249, v250
 m16 v[196:199], a[244:247], a[16:19], v[196:199]
 v_add_f32 v249, v249, v251
 cvt v186, v250, v251
 m16 v[204:207], a[244:247], a[20:23], v[204:207]
 v_mul_f32 v250, s36, v150
 v_mul_f32 v251, s36, v151
 m16 v[192:195], a[248:251], a[24:27], v[192:195]
 v_exp_f32 v250, v250
 m16 v[200:203], a[248:251], a[28:31], v[200:203]
 v_exp_f32 v251, v251
 v_add_f32 v249, v249, v250
 m16 v[196:199], a[252:255], a[24:27], v[196:199]
 v_add_f32 v249, v249, v251
 cvt v187, v250, v251
 m16 v[204:207], a[252:255], a[28:31], v[204:207]
 s_waitcnt lgkmcnt(0)
 s_barrier
 m16 v[192:195], a[224:227], a[32:35], v[192:195]
 ds_read_b128 a[240:243], v240 offset:12288
 v_mul_f32 v250, s36, v152
 m16 v[200:203], a[224:227], a[36:39], v[200:203]
 ds_read_b128 a[244:247], v240 offset:18432
 v_mul_f32 v251, s36, v153
 m16 v[196:199], a[228:231], a[32:35], v[196:199]
 ds_read_b128 a[248:251], v241 offset:12288
 m16 v[204:207], a[228:231], a[36:39], v[204:207]
 ds_read_b128 a[252:255], v241 offset:18432
 v_exp_f32 v250, v250
 m16 v[192:195], a[232:235], a[40:43], v[192:195]
 ds_read_b128 a[224:227], v240 offset:12416
 m16 v[200:203], a[232:235], a[44:47], v[200:203]
 ds_read_b128 a[228:231], v240 offset:18560
 v_exp_f32 v251, v251
 s_nop 0
 cvt v188, v250, v251
 v_add_f32 v169, v250, v251
 v_mul_f32 v250, s36, v154
 v_mul_f32 v251, s36, v155
 v_exp_f32 v250, v250
 v_exp_f32 v251, v251
 v_add_f32 v169, v169, v250
 v_add_f32 v169, v169, v251
 cvt v189, v250, v251
 v_mul_f32 v250, s36, v156
 v_mul_f32 v251, s36, v157
 v_exp_f32 v250, v250
 v_exp_f32 v251, v251
 v_add_f32 v169, v169, v250
 v_add_f32 v169, v169, v251
 cvt v190, v250, v251
 v_mul_f32 v250, s36, v158
 v_mul_f32 v251, s36, v159
 v_exp_f32 v250, v250
 v_exp_f32 v251, v251
 v_add_f32 v169, v169, v250
 v_add_f32 v169, v169, v251
 cvt v191, v250, v251
 v_add_f32 v250, v249, v169
 v_cmp_nge_f32 s[48:49], s37, v250
 m16 v[196:199], a[236:239], a[40:43], v[196:199]
 ds_read_b128 a[232:235], v241 offset:12416
 m16 v[204:207], a[236:239], a[44:47], v[204:207]
 ds_read_b128 a[236:239], v241 offset:18560
 s_cmp_lg_u64 s[48:49], 0
 s_cbranch_scc1 RS3_1
RB3_1:
 v_add_f32 v248, v248, v249
 v_add_f32 v168, v168, v169
 s_waitcnt lgkmcnt(4)
 m16 v[144:147], a[240:243], v[96:99], v[160:163]
 m16 v[152:155], a[240:243], v[100:103], v[164:167]
 ds_read_b128 a[240:243], v240 offset:12544
 m16 v[148:151], a[244:247], v[96:99], v[160:163]
 m16 v[156:159], a[244:247], v[100:103], v[164:167]
 ds_read_b128 a[244:247], v240 offset:18688
 m16 v[144:147], a[248:251], v[104:107], v[144:147]
 m16 v[152:155], a[248:251], v[108:111], v[152:155]
 ds_read_b128 a[248:251], v241 offset:12544
 cvt v192, v192, v193
 v_accvgpr_write_b32 a120, v192
 m16 v[148:151], a[252:255], v[104:107], v[148:151]
 cvt v194, v194, v195
 v_accvgpr_write_b32 a121, v194
 m16 v[156:159], a[252:255], v[108:111], v[156:159]
 ds_read_b128 a[252:255], v241 offset:18688
 cvt v196, v196, v197
 s_waitcnt lgkmcnt(2)
 m16 v[144:147], a[224:227], v[112:115], v[144:147]
 v_accvgpr_write_b32 a122, v196
 cvt v198, v198, v199
 m16 v[152:155], a[224:227], v[116:119], v[152:155]
 v_accvgpr_write_b32 a123, v198
 cvt v200, v200, v201
 v_accvgpr_write_b32 a124, v200
 m16 v[148:151], a[228:231], v[112:115], v[148:151]
 cvt v202, v202, v203
 v_accvgpr_write_b32 a125, v202
 m16 v[156:159], a[228:231], v[116:119], v[156:159]
 cvt v204, v204, v205
 v_accvgpr_write_b32 a126, v204
 cvt v206, v206, v207
 m16 v[144:147], a[232:235], v[120:123], v[144:147]
 rtr a[224:225], v242
 v_accvgpr_write_b32 a127, v206
 m16 v[152:155], a[232:235], v[124:127], v[152:155]
 rtr a[226:227], v242, 6144
 v_accvgpr_read_b32 v193, a128
 v_lshlrev_b32 v192, 16, v193
 m16 v[148:151], a[236:239], v[120:123], v[148:151]
 rtr a[228:229], v243
 v_and_b32 v193, 0xffff0000, v193
 m16 v[156:159], a[236:239], v[124:127], v[156:159]
 rtr a[230:231], v243, 6144
 v_accvgpr_read_b32 v195, a129
 v_lshlrev_b32 v194, 16, v195
 m16 v[144:147], a[240:243], v[128:131], v[144:147]
 rtr a[232:233], v244
 v_and_b32 v195, 0xffff0000, v195
 m16 v[152:155], a[240:243], v[132:135], v[152:155]
 rtr a[234:235], v244, 6144
 v_accvgpr_read_b32 v197, a130
 v_lshlrev_b32 v196, 16, v197
 m16 v[148:151], a[244:247], v[128:131], v[148:151]
 rtr a[236:237], v245
 v_and_b32 v197, 0xffff0000, v197
 m16 v[156:159], a[244:247], v[132:135], v[156:159]
 rtr a[238:239], v245, 6144
 v_accvgpr_read_b32 v199, a131
 s_waitcnt lgkmcnt(4)
 m16 v[144:147], a[248:251], v[136:139], v[144:147]
 rtr a[240:241], v242, 128
 v_lshlrev_b32 v198, 16, v199
 m16 v[152:155], a[248:251], v[140:143], v[152:155]
 rtr a[242:243], v242, 6272
 v_and_b32 v199, 0xffff0000, v199
 v_accvgpr_read_b32 v201, a132
 m16 v[148:151], a[252:255], v[136:139], v[148:151]
 rtr a[244:245], v243, 128
 v_lshlrev_b32 v200, 16, v201
 m16 v[156:159], a[252:255], v[140:143], v[156:159]
 rtr a[246:247], v243, 6272
 v_and_b32 v201, 0xffff0000, v201
 v_accvgpr_read_b32 v203, a133
 m16 v[0:3], a[224:227], v[184:187], v[0:3]
 rtr a[248:249], v244, 128
 v_lshlrev_b32 v202, 16, v203
 m16 v[8:11], a[224:227], v[188:191], v[8:11]
 rtr a[250:251], v244, 6272
 v_and_b32 v203, 0xffff0000, v203
 v_accvgpr_read_b32 v205, a134
 m16 v[4:7], a[228:231], v[184:187], v[4:7]
 rtr a[252:253], v245, 128
 v_lshlrev_b32 v204, 16, v205
 m16 v[12:15], a[228:231], v[188:191], v[12:15]
 rtr a[254:255], v245, 6272
 v_and_b32 v205, 0xffff0000, v205
 s_waitcnt lgkmcnt(4)
 m16 v[16:19], a[232:235], v[184:187], v[16:19]
 rtr a[224:225], v242, 256
 v_accvgpr_read_b32 v207, a135
 m16 v[24:27], a[232:235], v[188:191], v[24:27]
 rtr a[226:227], v242, 6400
 v_lshlrev_b32 v206, 16, v207
 v_and_b32 v207, 0xffff0000, v207
 m16 v[20:23], a[236:239], v[184:187], v[20:23]
 rtr a[228:229], v243, 256
 v_mul_f32 v250, s36, v144
 m16 v[28:31], a[236:239], v[188:191], v[28:31]
 rtr a[230:231], v243, 6400
 v_mul_f32 v251, s36, v145
 m16 v[32:35], a[240:243], v[184:187], v[32:35]
 rtr a[232:233], v244, 256
 m16 v[40:43], a[240:243], v[188:191], v[40:43]
 rtr a[234:235], v244, 6400
 v_exp_f32 v250, v250
 m16 v[36:39], a[244:247], v[184:187], v[36:39]
 rtr a[236:237], v245, 256
 m16 v[44:47], a[244:247], v[188:191], v[44:47]
 rtr a[238:239], v245, 6400
 s_waitcnt lgkmcnt(4)
 m16 v[48:51], a[248:251], v[184:187], v[48:51]
 rtr a[240:241], v172, 24576
 m16 v[56:59], a[248:251], v[188:191], v[56:59]
 rtr a[242:243], v172, 26624
 rtr a[244:245], v173, 24576
 m16 v[52:55], a[252:255], v[184:187], v[52:55]
 rtr a[246:247], v173, 26624
 m16 v[60:63], a[252:255], v[188:191], v[60:63]
 rtr a[248:249], v172, 28672
 rtr a[250:251], v172, 30720
 m16 v[64:67], a[224:227], v[184:187], v[64:67]
 rtr a[252:253], v173, 28672
 m16 v[72:75], a[224:227], v[188:191], v[72:75]
 rtr a[254:255], v173, 30720
 rtr a[224:225], v172, 32768
 m16 v[68:71], a[228:231], v[184:187], v[68:71]
 rtr a[226:227], v172, 34816
 m16 v[76:79], a[228:231], v[188:191], v[76:79]
 rtr a[228:229], v173, 32768
 rtr a[230:231], v173, 34816
 s_waitcnt lgkmcnt(6)
 m16 v[80:83], a[232:235], v[184:187], v[80:83]
 v_exp_f32 v251, v251
 m16 v[88:91], a[232:235], v[188:191], v[88:91]
 rtr a[232:233], v172
 rtr a[234:235], v172, 2048
 cvt v176, v250, v251
 m16 v[84:87], a[236:239], v[184:187], v[84:87]
 v_add_f32 v249, v250, v251
 v_mul_f32 v250, s36, v146
 m16 v[92:95], a[236:239], v[188:191], v[92:95]
 rtr a[236:237], v173
 rtr a[238:239], v173, 2048
 v_mul_f32 v251, s36, v147
 m16 v[192:195], a[240:243], a[0:3], v[192:195]
 v_exp_f32 v250, v250
 m16 v[200:203], a[240:243], a[4:7], v[200:203]
 rtr a[240:241], v172, 4096
 rtr a[242:243], v172, 6144
 m16 v[196:199], a[244:247], a[0:3], v[196:199]
 v_exp_f32 v251, v251
 m16 v[204:207], a[244:247], a[4:7], v[204:207]
 rtr a[244:245], v173, 4096
 rtr a[246:247], v173, 6144
 v_add_f32 v249, v249, v250
 m16 v[192:195], a[248:251], a[8:11], v[192:195]
 v_add_f32 v249, v249, v251
 cvt v177, v250, v251
 m16 v[200:203], a[248:251], a[12:15], v[200:203]
 rtr a[248:249], v172, 8192
 rtr a[250:251], v172, 10240
 s_waitcnt lgkmcnt(4)
 m16 v[196:199], a[252:255], a[8:11], v[196:199]
 v_mul_f32 v250, s36, v148
 v_mul_f32 v251, s36, v149
 m16 v[204:207], a[252:255], a[12:15], v[204:207]
 rtr a[252:253], v173, 8192
 rtr a[254:255], v173, 10240
 m16 v[192:195], a[224:227], a[16:19], v[192:195]
 v_exp_f32 v250, v250
 m16 v[200:203], a[224:227], a[20:23], v[200:203]
 v_exp_f32 v251, v251
 v_add_f32 v249, v249, v250
 m16 v[196:199], a[228:231], a[16:19], v[196:199]
 v_add_f32 v249, v249, v251
 cvt v178, v250, v251
 m16 v[204:207], a[228:231], a[20:23], v[204:207]
 v_mul_f32 v250, s36, v150
 v_mul_f32 v251, s36, v151
 m16 v[192:195], a[232:235], a[24:27], v[192:195]
 v_exp_f32 v250, v250
 m16 v[200:203], a[232:235], a[28:31], v[200:203]
 v_exp_f32 v251, v251
 v_add_f32 v249, v249, v250
 m16 v[196:199], a[236:239], a[24:27], v[196:199]
 v_add_f32 v249, v249, v251
 cvt v179, v250, v251
 m16 v[204:207], a[236:239], a[28:31], v[204:207]
 s_waitcnt lgkmcnt(0)
 s_barrier
 m16 v[192:195], a[240:243], a[32:35], v[192:195]
 ds_read_b128 a[224:227], v240 offset:24576
 v_mul_f32 v250, s36, v152
 m16 v[200:203], a[240:243], a[36:39], v[200:203]
 ds_read_b128 a[228:231], v240 offset:30720
 v_mul_f32 v251, s36, v153
 m16 v[196:199], a[244:247], a[32:35], v[196:199]
 ds_read_b128 a[232:235], v241 offset:24576
 m16 v[204:207], a[244:247], a[36:39], v[204:207]
 ds_read_b128 a[236:239], v241 offset:30720
 v_exp_f32 v250, v250
 m16 v[192:195], a[248:251], a[40:43], v[192:195]
 ds_read_b128 a[240:243], v240 offset:24704
 m16 v[200:203], a[248:251], a[44:47], v[200:203]
 ds_read_b128 a[244:247], v240 offset:30848
 v_exp_f32 v251, v251
 s_nop 0
 cvt v180, v250, v251
 v_add_f32 v169, v250, v251
 v_mul_f32 v250, s36, v154
 v_mul_f32 v251, s36, v155
 v_exp_f32 v250, v250
 v_exp_f32 v251, v251
 v_add_f32 v169, v169, v250
 v_add_f32 v169, v169, v251
 cvt v181, v250, v251
 v_mul_f32 v250, s36, v156
 v_mul_f32 v251, s36, v157
 v_exp_f32 v250, v250
 v_exp_f32 v251, v251
 v_add_f32 v169, v169, v250
 v_add_f32 v169, v169, v251
 cvt v182, v250, v251
 v_mul_f32 v250, s36, v158
 v_mul_f32 v251, s36, v159
 v_exp_f32 v250, v250
 v_exp_f32 v251, v251
 v_add_f32 v169, v169, v250
 v_add_f32 v169, v169, v251
 cvt v183, v250, v251
 v_add_f32 v250, v249, v169
 v_cmp_nge_f32 s[48:49], s37, v250
 m16 v[196:199], a[252:255], a[40:43], v[196:199]
 ds_read_b128 a[248:251], v241 offset:24704
 m16 v[204:207], a[252:255], a[44:47], v[204:207]
 ds_read_b128 a[252:255], v241 offset:30848
 s_cmp_lg_u64 s[48:49], 0
 s_cbranch_scc1 RS4_1
RB4_1:
 v_add_f32 v248, v248, v249
 v_add_f32 v168, v168, v169
 s_waitcnt lgkmcnt(4)
 m16 v[144:147], a[224:227], v[96:99], v[160:163]
 m16 v[152:155], a[224:227], v[100:103], v[164:167]
 ds_read_b128 a[224:227], v240 offset:24832
 m16 v[148:151], a[228:231], v[96:99], v[160:163]
 m16 v[156:159], a[228:231], v[100:103], v[164:167]
 ds_read_b128 a[228:231], v240 offset:30976
 m16 v[144:147], a[232:235], v[104:107], v[144:147]
 m16 v[152:155], a[232:235], v[108:111], v[152:155]
 ds_read_b128 a[232:235], v241 offset:24832
 cvt v192, v192, v193
 v_accvgpr_write_b32 a128, v192
 m16 v[148:151], a[236:239], v[104:107], v[148:151]
 cvt v194, v194, v195
 v_accvgpr_write_b32 a129, v194
 m16 v[156:159], a[236:239], v[108:111], v[156:159]
 ds_read_b128 a[236:239], v241 offset:30976
 cvt v196, v196, v197
 s_waitcnt lgkmcnt(2)
 m16 v[144:147], a[240:243], v[112:115], v[144:147]
 v_accvgpr_write_b32 a130, v196
 cvt v198, v198, v199
 m16 v[152:155], a[240:243], v[116:119], v[152:155]
 v_accvgpr_write_b32 a131, v198
 cvt v200, v200, v201
 v_accvgpr_write_b32 a132, v200
 m16 v[148:151], a[244:247], v[112:115], v[148:151]
 cvt v202, v202, v203
 v_accvgpr_write_b32 a133, v202
 m16 v[156:159], a[244:247], v[116:119], v[156:159]
 cvt v204, v204, v205
 v_accvgpr_write_b32 a134, v204
 cvt v206, v206, v207
 m16 v[144:147], a[248:251], v[120:123], v[144:147]
 rtr a[240:241], v242, 12288
 v_accvgpr_write_b32 a135, v206
 m16 v[152:155], a[248:251], v[124:127], v[152:155]
 rtr a[242:243], v242, 18432
 v_accvgpr_read_b32 v193, a136
 v_lshlrev_b32 v192, 16, v193
 m16 v[148:151], a[252:255], v[120:123], v[148:151]
 rtr a[244:245], v243, 12288
 v_and_b32 v193, 0xffff0000, v193
 m16 v[156:159], a[252:255], v[124:127], v[156:159]
 rtr a[246:247], v243, 18432
 v_accvgpr_read_b32 v195, a137
 v_lshlrev_b32 v194, 16, v195
 m16 v[144:147], a[224:227], v[128:131], v[144:147]
 rtr a[248:249], v244, 12288
 v_and_b32 v195, 0xffff0000, v195
 m16 v[152:155], a[224:227], v[132:135], v[152:155]
 rtr a[250:251], v244, 18432
 v_accvgpr_read_b32 v197, a138
 v_lshlrev_b32 v196, 16, v197
 m16 v[148:151], a[228:231], v[128:131], v[148:151]
 rtr a[252:253], v245, 12288
 v_and_b32 v197, 0xffff0000, v197
 m16 v[156:159], a[228:231], v[132:135], v[156:159]
 rtr a[254:255], v245, 18432
 v_accvgpr_read_b32 v199, a139
 s_waitcnt lgkmcnt(4)
 m16 v[144:147], a[232:235], v[136:139], v[144:147]
 rtr a[224:225], v242, 12416
 v_lshlrev_b32 v198, 16, v199
 m16 v[152:155], a[232:235], v[140:143], v[152:155]
 rtr a[226:227], v242, 18560
 v_and_b32 v199, 0xffff0000, v199
 v_accvgpr_read_b32 v201, a140
 m16 v[148:151], a[236:239], v[136:139], v[148:151]
 rtr a[228:229], v243, 12416
 v_lshlrev_b32 v200, 16, v201
 m16 v[156:159], a[236:239], v[140:143], v[156:159]
 rtr a[230:231], v243, 18560
 v_and_b32 v201, 0xffff0000, v201
 v_accvgpr_read_b32 v203, a141
 m16 v[0:3], a[240:243], v[176:179], v[0:3]
 rtr a[232:233], v244, 12416
 v_lshlrev_b32 v202, 16, v203
 m16 v[8:11], a[240:243], v[180:183], v[8:11]
 rtr a[234:235], v244, 18560
 v_and_b32 v203, 0xffff0000, v203
 v_accvgpr_read_b32 v205, a142
 m16 v[4:7], a[244:247], v[176:179], v[4:7]
 rtr a[236:237], v245, 12416
 v_lshlrev_b32 v204, 16, v205
 m16 v[12:15], a[244:247], v[180:183], v[12:15]
 rtr a[238:239], v245, 18560
 v_and_b32 v205, 0xffff0000, v205
 s_waitcnt lgkmcnt(4)
 m16 v[16:19], a[248:251], v[176:179], v[16:19]
 rtr a[240:241], v242, 12544
 v_accvgpr_read_b32 v207, a143
 m16 v[24:27], a[248:251], v[180:183], v[24:27]
 rtr a[242:243], v242, 18688
 v_lshlrev_b32 v206, 16, v207
 v_and_b32 v207, 0xffff0000, v207
 m16 v[20:23], a[252:255], v[176:179], v[20:23]
 rtr a[244:245], v243, 12544
 v_mul_f32 v250, s36, v144
 m16 v[28:31], a[252:255], v[180:183], v[28:31]
 rtr a[246:247], v243, 18688
 v_mul_f32 v251, s36, v145
 m16 v[32:35], a[224:227], v[176:179], v[32:35]
 rtr a[248:249], v244, 12544
 m16 v[40:43], a[224:227], v[180:183], v[40:43]
 rtr a[250:251], v244, 18688
 v_exp_f32 v250, v250
 m16 v[36:39], a[228:231], v[176:179], v[36:39]
 rtr a[252:253], v245, 12544
 m16 v[44:47], a[228:231], v[180:183], v[44:47]
 rtr a[254:255], v245, 18688
 s_waitcnt lgkmcnt(4)
 m16 v[48:51], a[232:235], v[176:179], v[48:51]
 rtr a[224:225], v174, 24576
 m16 v[56:59], a[232:235], v[180:183], v[56:59]
 rtr a[226:227], v174, 26624
 rtr a[228:229], v175, 24576
 m16 v[52:55], a[236:239], v[176:179], v[52:55]
 rtr a[230:231], v175, 26624
 m16 v[60:63], a[236:239], v[180:183], v[60:63]
 rtr a[232:233], v174, 28672
 rtr a[234:235], v174, 30720
 m16 v[64:67], a[240:243], v[176:179], v[64:67]
 rtr a[236:237], v175, 28672
 m16 v[72:75], a[240:243], v[180:183], v[72:75]
 rtr a[238:239], v175, 30720
 rtr a[240:241], v174, 32768
 m16 v[68:71], a[244:247], v[176:179], v[68:71]
 rtr a[242:243], v174, 34816
 m16 v[76:79], a[244:247], v[180:183], v[76:79]
 rtr a[244:245], v175, 32768
 rtr a[246:247], v175, 34816
 s_waitcnt lgkmcnt(6)
 m16 v[80:83], a[248:251], v[176:179], v[80:83]
 v_exp_f32 v251, v251
 m16 v[88:91], a[248:251], v[180:183], v[88:91]
 rtr a[248:249], v174
 rtr a[250:251], v174, 2048
 cvt v184, v250, v251
 m16 v[84:87], a[252:255], v[176:179], v[84:87]
 v_add_f32 v249, v250, v251
 v_mul_f32 v250, s36, v146
 m16 v[92:95], a[252:255], v[180:183], v[92:95]
 rtr a[252:253], v175
 rtr a[254:255], v175, 2048
 v_mul_f32 v251, s36, v147
 m16 v[192:195], a[224:227], a[0:3], v[192:195]
 v_exp_f32 v250, v250
 m16 v[200:203], a[224:227], a[4:7], v[200:203]
 rtr a[224:225], v174, 4096
 rtr a[226:227], v174, 6144
 m16 v[196:199], a[228:231], a[0:3], v[196:199]
 v_exp_f32 v251, v251
 m16 v[204:207], a[228:231], a[4:7], v[204:207]
 rtr a[228:229], v175, 4096
 rtr a[230:231], v175, 6144
 v_add_f32 v249, v249, v250
 m16 v[192:195], a[232:235], a[8:11], v[192:195]
 v_add_f32 v249, v249, v251
 cvt v185, v250, v251
 m16 v[200:203], a[232:235], a[12:15], v[200:203]
 rtr a[232:233], v174, 8192
 rtr a[234:235], v174, 10240
 s_waitcnt lgkmcnt(4)
 m16 v[196:199], a[236:239], a[8:11], v[196:199]
 v_mul_f32 v250, s36, v148
 v_mul_f32 v251, s36, v149
 m16 v[204:207], a[236:239], a[12:15], v[204:207]
 rtr a[236:237], v175, 8192
 rtr a[238:239], v175, 10240
 m16 v[192:195], a[240:243], a[16:19], v[192:195]
 v_exp_f32 v250, v250
 m16 v[200:203], a[240:243], a[20:23], v[200:203]
 v_exp_f32 v251, v251
 v_add_f32 v249, v249, v250
 m16 v[196:199], a[244:247], a[16:19], v[196:199]
 v_add_f32 v249, v249, v251
 cvt v186, v250, v251
 m16 v[204:207], a[244:247], a[20:23], v[204:207]
 v_mul_f32 v250, s36, v150
 v_mul_f32 v251, s36, v151
 m16 v[192:195], a[248:251], a[24:27], v[192:195]
 v_exp_f32 v250, v250
 m16 v[200:203], a[248:251], a[28:31], v[200:203]
 v_exp_f32 v251, v251
 v_add_f32 v249, v249, v250
 m16 v[196:199], a[252:255], a[24:27], v[196:199]
 v_add_f32 v249, v249, v251
 cvt v187, v250, v251
 m16 v[204:207], a[252:255], a[28:31], v[204:207]
 s_waitcnt lgkmcnt(0)
 s_barrier
 m16 v[192:195], a[224:227], a[32:35], v[192:195]
 ds_read_b128 a[240:243], v240
 v_mul_f32 v250, s36, v152
 m16 v[200:203], a[224:227], a[36:39], v[200:203]
 ds_read_b128 a[244:247], v240 offset:6144
 v_mul_f32 v251, s36, v153
 m16 v[196:199], a[228:231], a[32:35], v[196:199]
 ds_read_b128 a[248:251], v241
 m16 v[204:207], a[228:231], a[36:39], v[204:207]
 ds_read_b128 a[252:255], v241 offset:6144
 v_exp_f32 v250, v250
 m16 v[192:195], a[232:235], a[40:43], v[192:195]
 ds_read_b128 a[224:227], v240 offset:128
 m16 v[200:203], a[232:235], a[44:47], v[200:203]
 ds_read_b128 a[228:231], v240 offset:6272
 v_exp_f32 v251, v251
 s_nop 0
 cvt v188, v250, v251
 v_add_f32 v169, v250, v251
 v_mul_f32 v250, s36, v154
 v_mul_f32 v251, s36, v155
 v_exp_f32 v250, v250
 v_exp_f32 v251, v251
 v_add_f32 v169, v169, v250
 v_add_f32 v169, v169, v251
 cvt v189, v250, v251
 v_mul_f32 v250, s36, v156
 v_mul_f32 v251, s36, v157
 v_exp_f32 v250, v250
 v_exp_f32 v251, v251
 v_add_f32 v169, v169, v250
 v_add_f32 v169, v169, v251
 cvt v190, v250, v251
 v_mul_f32 v250, s36, v158
 v_mul_f32 v251, s36, v159
 v_exp_f32 v250, v250
 v_exp_f32 v251, v251
 v_add_f32 v169, v169, v250
 v_add_f32 v169, v169, v251
 cvt v191, v250, v251
 v_add_f32 v250, v249, v169
 v_cmp_nge_f32 s[48:49], s37, v250
 m16 v[196:199], a[236:239], a[40:43], v[196:199]
 ds_read_b128 a[232:235], v241 offset:128
 m16 v[204:207], a[236:239], a[44:47], v[204:207]
 ds_read_b128 a[236:239], v241 offset:6272
 s_cmp_lg_u64 s[48:49], 0
 s_cbranch_scc1 RS5_1
RB5_1:
 v_add_f32 v248, v248, v249
 v_add_f32 v168, v168, v169
 s_waitcnt lgkmcnt(4)
 m16 v[144:147], a[240:243], v[96:99], v[160:163]
 m16 v[152:155], a[240:243], v[100:103], v[164:167]
 ds_read_b128 a[240:243], v240 offset:256
 m16 v[148:151], a[244:247], v[96:99], v[160:163]
 m16 v[156:159], a[244:247], v[100:103], v[164:167]
 ds_read_b128 a[244:247], v240 offset:6400
 m16 v[144:147], a[248:251], v[104:107], v[144:147]
 m16 v[152:155], a[248:251], v[108:111], v[152:155]
 ds_read_b128 a[248:251], v241 offset:256
 cvt v192, v192, v193
 v_accvgpr_write_b32 a136, v192
 m16 v[148:151], a[252:255], v[104:107], v[148:151]
 cvt v194, v194, v195
 v_accvgpr_write_b32 a137, v194
 m16 v[156:159], a[252:255], v[108:111], v[156:159]
 ds_read_b128 a[252:255], v241 offset:6400
 cvt v196, v196, v197
 s_waitcnt lgkmcnt(2)
 m16 v[144:147], a[224:227], v[112:115], v[144:147]
 v_accvgpr_write_b32 a138, v196
 cvt v198, v198, v199
 m16 v[152:155], a[224:227], v[116:119], v[152:155]
 v_accvgpr_write_b32 a139, v198
 cvt v200, v200, v201
 v_accvgpr_write_b32 a140, v200
 m16 v[148:151], a[228:231], v[112:115], v[148:151]
 cvt v202, v202, v203
 v_accvgpr_write_b32 a141, v202
 m16 v[156:159], a[228:231], v[116:119], v[156:159]
 cvt v204, v204, v205
 v_accvgpr_write_b32 a142, v204
 cvt v206, v206, v207
 v_accvgpr_write_b32 a143, v206
 m16 v[144:147], a[232:235], v[120:123], v[144:147]
 rtr a[224:225], v172, 12288
 v_accvgpr_read_b32 v193, a144
 m16 v[152:155], a[232:235], v[124:127], v[152:155]
 rtr a[226:227], v172, 14336
 v_lshlrev_b32 v192, 16, v193
 v_and_b32 v193, 0xffff0000, v193
 m16 v[148:151], a[236:239], v[120:123], v[148:151]
 rtr a[228:229], v173, 12288
 v_accvgpr_read_b32 v195, a145
 m16 v[156:159], a[236:239], v[124:127], v[156:159]
 rtr a[230:231], v173, 14336
 v_lshlrev_b32 v194, 16, v195
 v_and_b32 v195, 0xffff0000, v195
 m16 v[144:147], a[240:243], v[128:131], v[144:147]
 rtr a[232:233], v172, 16384
 v_accvgpr_read_b32 v197, a146
 m16 v[152:155], a[240:243], v[132:135], v[152:155]
 rtr a[234:235], v172, 18432
 v_lshlrev_b32 v196, 16, v197
 v_and_b32 v197, 0xffff0000, v197
 m16 v[148:151], a[244:247], v[128:131], v[148:151]
 rtr a[236:237], v173, 16384
 v_accvgpr_read_b32 v199, a147
 m16 v[156:159], a[244:247], v[132:135], v[156:159]
 rtr a[238:239], v173, 18432
 v_lshlrev_b32 v198, 16, v199
 s_waitcnt lgkmcnt(4)
 m16 v[144:147], a[248:251], v[136:139], v[144:147]
 rtr a[240:241], v172, 20480
 v_and_b32 v199, 0xffff0000, v199
 m16 v[152:155], a[248:251], v[140:143], v[152:155]
 rtr a[242:243], v172, 22528
 v_accvgpr_read_b32 v201, a148
 v_lshlrev_b32 v200, 16, v201
 m16 v[148:151], a[252:255], v[136:139], v[148:151]
 rtr a[244:245], v173, 20480
 v_and_b32 v201, 0xffff0000, v201
 m16 v[156:159], a[252:255], v[140:143], v[156:159]
 rtr a[246:247], v173, 22528
 v_accvgpr_read_b32 v203, a149
 v_lshlrev_b32 v202, 16, v203
 v_and_b32 v203, 0xffff0000, v203
 v_accvgpr_read_b32 v205, a150
 v_lshlrev_b32 v204, 16, v205
 v_and_b32 v205, 0xffff0000, v205
 v_accvgpr_read_b32 v207, a151
 v_lshlrev_b32 v206, 16, v207
 v_and_b32 v207, 0xffff0000, v207
 m16 v[192:195], a[224:227], a[0:3], v[192:195]
 rtr a[248:249], v172, 36864
 m16 v[200:203], a[224:227], a[4:7], v[200:203]
 rtr a[250:251], v172, 38912
 m16 v[196:199], a[228:231], a[0:3], v[196:199]
 rtr a[252:253], v173, 36864
 m16 v[204:207], a[228:231], a[4:7], v[204:207]
 rtr a[254:255], v173, 38912
 s_waitcnt lgkmcnt(4)
 m16 v[192:195], a[232:235], a[8:11], v[192:195]
 rtr a[224:225], v172, 40960
 m16 v[200:203], a[232:235], a[12:15], v[200:203]
 rtr a[226:227], v172, 43008
 v_mul_f32 v250, s36, v144
 v_mul_f32 v251, s36, v145
 m16 v[196:199], a[236:239], a[8:11], v[196:199]
 rtr a[228:229], v173, 40960
 m16 v[204:207], a[236:239], a[12:15], v[204:207]
 rtr a[230:231], v173, 43008
 v_exp_f32 v250, v250
 m16 v[192:195], a[240:243], a[16:19], v[192:195]
 rtr a[232:233], v172, 45056
 m16 v[200:203], a[240:243], a[20:23], v[200:203]
 rtr a[234:235], v172, 47104
 v_exp_f32 v251, v251
 m16 v[196:199], a[244:247], a[16:19], v[196:199]
 rtr a[236:237], v173, 45056
 cvt v176, v250, v251
 m16 v[204:207], a[244:247], a[20:23], v[204:207]
 rtr a[238:239], v173, 47104
 v_add_f32 v249, v250, v251
 s_waitcnt lgkmcnt(4)
 m16 v[192:195], a[248:251], a[24:27], v[192:195]
 rtr a[240:241], v242, 24576
 v_mul_f32 v250, s36, v146
 m16 v[200:203], a[248:251], a[28:31], v[200:203]
 rtr a[242:243], v242, 30720
 v_mul_f32 v251, s36, v147
 m16 v[196:199], a[252:255], a[24:27], v[196:199]
 rtr a[244:245], v243, 24576
 m16 v[204:207], a[252:255], a[28:31], v[204:207]
 rtr a[246:247], v243, 30720
 v_exp_f32 v250, v250
 m16 v[192:195], a[224:227], a[32:35], v[192:195]
 rtr a[248:249], v244, 24576
 m16 v[200:203], a[224:227], a[36:39], v[200:203]
 rtr a[250:251], v244, 30720
 v_exp_f32 v251, v251
 m16 v[196:199], a[228:231], a[32:35], v[196:199]
 rtr a[252:253], v245, 24576
 v_add_f32 v249, v249, v250
 m16 v[204:207], a[228:231], a[36:39], v[204:207]
 rtr a[254:255], v245, 30720
 v_add_f32 v249, v249, v251
 s_waitcnt lgkmcnt(4)
 m16 v[192:195], a[232:235], a[40:43], v[192:195]
 rtr a[224:225], v242, 24704
 cvt v177, v250, v251
 m16 v[200:203], a[232:235], a[44:47], v[200:203]
 rtr a[226:227], v242, 30848
 v_mul_f32 v250, s36, v148
 v_mul_f32 v251, s36, v149
 m16 v[196:199], a[236:239], a[40:43], v[196:199]
 rtr a[228:229], v243, 24704
 m16 v[204:207], a[236:239], a[44:47], v[204:207]
 rtr a[230:231], v243, 30848
 v_exp_f32 v250, v250
 m16 v[0:3], a[240:243], v[184:187], v[0:3]
 rtr a[232:233], v244, 24704
 m16 v[8:11], a[240:243], v[188:191], v[8:11]
 rtr a[234:235], v244, 30848
 v_exp_f32 v251, v251
 m16 v[4:7], a[244:247], v[184:187], v[4:7]
 rtr a[236:237], v245, 24704
 v_add_f32 v249, v249, v250
 m16 v[12:15], a[244:247], v[188:191], v[12:15]
 rtr a[238:239], v245, 30848
 v_add_f32 v249, v249, v251
 s_waitcnt lgkmcnt(4)
 m16 v[16:19], a[248:251], v[184:187], v[16:19]
 rtr a[240:241], v242, 24832
 cvt v178, v250, v251
 m16 v[24:27], a[248:251], v[188:191], v[24:27]
 rtr a[242:243], v242, 30976
 cvt v192, v192, v193
 v_accvgpr_write_b32 a144, v192
 m16 v[20:23], a[252:255], v[184:187], v[20:23]
 rtr a[244:245], v243, 24832
 cvt v194, v194, v195
 m16 v[28:31], a[252:255], v[188:191], v[28:31]
 rtr a[246:247], v243, 30976
 v_accvgpr_write_b32 a145, v194
 cvt v196, v196, v197
 m16 v[32:35], a[224:227], v[184:187], v[32:35]
 rtr a[248:249], v244, 24832
 v_accvgpr_write_b32 a146, v196
 m16 v[40:43], a[224:227], v[188:191], v[40:43]
 rtr a[250:251], v244, 30976
 cvt v198, v198, v199
 v_accvgpr_write_b32 a147, v198
 m16 v[36:39], a[228:231], v[184:187], v[36:39]
 rtr a[252:253], v245, 24832
 cvt v200, v200, v201
 m16 v[44:47], a[228:231], v[188:191], v[44:47]
 rtr a[254:255], v245, 30976
 v_accvgpr_write_b32 a148, v200
 cvt v202, v202, v203
 v_accvgpr_write_b32 a149, v202
 cvt v204, v204, v205
 v_accvgpr_write_b32 a150, v204
 cvt v206, v206, v207
 v_accvgpr_write_b32 a151, v206
 s_waitcnt lgkmcnt(4)
 m16 v[48:51], a[232:235], v[184:187], v[48:51]
 rtr a[224:225], v174, 12288
 v_accvgpr_read_b32 v193, a152
 m16 v[56:59], a[232:235], v[188:191], v[56:59]
 rtr a[226:227], v174, 14336
 rtr a[228:229], v175, 12288
 v_lshlrev_b32 v192, 16, v193
 m16 v[52:55], a[236:239], v[184:187], v[52:55]
 rtr a[230:231], v175, 14336
 v_and_b32 v193, 0xffff0000, v193
 m16 v[60:63], a[236:239], v[188:191], v[60:63]
 rtr a[232:233], v174, 16384
 rtr a[234:235], v174, 18432
 v_accvgpr_read_b32 v195, a153
 m16 v[64:67], a[240:243], v[184:187], v[64:67]
 rtr a[236:237], v175, 16384
 v_lshlrev_b32 v194, 16, v195
 m16 v[72:75], a[240:243], v[188:191], v[72:75]
 rtr a[238:239], v175, 18432
 rtr a[240:241], v174, 20480
 v_and_b32 v195, 0xffff0000, v195
 m16 v[68:71], a[244:247], v[184:187], v[68:71]
 rtr a[242:243], v174, 22528
 v_accvgpr_read_b32 v197, a154
 m16 v[76:79], a[244:247], v[188:191], v[76:79]
 rtr a[244:245], v175, 20480
 rtr a[246:247], v175, 22528
 s_waitcnt lgkmcnt(6)
 m16 v[80:83], a[248:251], v[184:187], v[80:83]
 v_lshlrev_b32 v196, 16, v197
 v_and_b32 v197, 0xffff0000, v197
 m16 v[88:91], a[248:251], v[188:191], v[88:91]
 rtr a[248:249], v174, 36864
 rtr a[250:251], v174, 38912
 v_accvgpr_read_b32 v199, a155
 m16 v[84:87], a[252:255], v[184:187], v[84:87]
 v_lshlrev_b32 v198, 16, v199
 v_and_b32 v199, 0xffff0000, v199
 m16 v[92:95], a[252:255], v[188:191], v[92:95]
 rtr a[252:253], v175, 36864
 rtr a[254:255], v175, 38912
 v_accvgpr_read_b32 v201, a156
 v_lshlrev_b32 v200, 16, v201
 v_and_b32 v201, 0xffff0000, v201
 v_accvgpr_read_b32 v203, a157
 v_lshlrev_b32 v202, 16, v203
 v_and_b32 v203, 0xffff0000, v203
 v_accvgpr_read_b32 v205, a158
 v_lshlrev_b32 v204, 16, v205
 v_and_b32 v205, 0xffff0000, v205
 v_accvgpr_read_b32 v207, a159
 v_lshlrev_b32 v206, 16, v207
 v_and_b32 v207, 0xffff0000, v207
 m16 v[192:195], a[224:227], a[0:3], v[192:195]
 v_mul_f32 v250, s36, v150
 v_mul_f32 v251, s36, v151
 m16 v[200:203], a[224:227], a[4:7], v[200:203]
 rtr a[224:225], v174, 40960
 rtr a[226:227], v174, 43008
 m16 v[196:199], a[228:231], a[0:3], v[196:199]
 v_exp_f32 v250, v250
 m16 v[204:207], a[228:231], a[4:7], v[204:207]
 rtr a[228:229], v175, 40960
 rtr a[230:231], v175, 43008
 m16 v[192:195], a[232:235], a[8:11], v[192:195]
 v_exp_f32 v251, v251
 m16 v[200:203], a[232:235], a[12:15], v[200:203]
 rtr a[232:233], v174, 45056
 rtr a[234:235], v174, 47104
 s_waitcnt lgkmcnt(4)
 m16 v[196:199], a[236:239], a[8:11], v[196:199]
 v_add_f32 v249, v249, v250
 v_add_f32 v249, v249, v251
 m16 v[204:207], a[236:239], a[12:15], v[204:207]
 rtr a[236:237], v175, 45056
 rtr a[238:239], v175, 47104
 cvt v179, v250, v251
 m16 v[192:195], a[240:243], a[16:19], v[192:195]
 v_mul_f32 v250, s36, v152
 v_mul_f32 v251, s36, v153
 m16 v[200:203], a[240:243], a[20:23], v[200:203]
 v_exp_f32 v250, v250
 m16 v[196:199], a[244:247], a[16:19], v[196:199]
 v_exp_f32 v251, v251
 m16 v[204:207], a[244:247], a[20:23], v[204:207]
 cvt v180, v250, v251
 v_add_f32 v169, v250, v251
 v_mul_f32 v250, s36, v154
 m16 v[192:195], a[248:251], a[24:27], v[192:195]
 v_mul_f32 v251, s36, v155
 m16 v[200:203], a[248:251], a[28:31], v[200:203]
 v_exp_f32 v250, v250
 m16 v[196:199], a[252:255], a[24:27], v[196:199]
 v_exp_f32 v251, v251
 m16 v[204:207], a[252:255], a[28:31], v[204:207]
 s_waitcnt lgkmcnt(0)
 s_barrier
 m16 v[192:195], a[224:227], a[32:35], v[192:195]
 ds_read_b128 a[240:243], v240 offset:12288
 v_add_f32 v169, v169, v250
 m16 v[200:203], a[224:227], a[36:39], v[200:203]
 ds_read_b128 a[244:247], v240 offset:18432
 v_add_f32 v169, v169, v251
 cvt v181, v250, v251
 m16 v[196:199], a[228:231], a[32:35], v[196:199]
 ds_read_b128 a[248:251], v241 offset:12288
 v_mul_f32 v250, s36, v156
 m16 v[204:207], a[228:231], a[36:39], v[204:207]
 ds_read_b128 a[252:255], v241 offset:18432
 v_mul_f32 v251, s36, v157
 m16 v[192:195], a[232:235], a[40:43], v[192:195]
 ds_read_b128 a[224:227], v240 offset:12416
 m16 v[200:203], a[232:235], a[44:47], v[200:203]
 ds_read_b128 a[228:231], v240 offset:18560
 v_exp_f32 v250, v250
 v_exp_f32 v251, v251
 v_add_f32 v169, v169, v250
 v_add_f32 v169, v169, v251
 cvt v182, v250, v251
 v_mul_f32 v250, s36, v158
 v_mul_f32 v251, s36, v159
 v_exp_f32 v250, v250
 v_exp_f32 v251, v251
 v_add_f32 v169, v169, v250
 v_add_f32 v169, v169, v251
 cvt v183, v250, v251
 v_add_f32 v250, v249, v169
 v_cmp_nge_f32 s[48:49], s37, v250
 m16 v[196:199], a[236:239], a[40:43], v[196:199]
 ds_read_b128 a[232:235], v241 offset:12416
 m16 v[204:207], a[236:239], a[44:47], v[204:207]
 ds_read_b128 a[236:239], v241 offset:18560
 s_cmp_lg_u64 s[48:49], 0
 s_cbranch_scc1 RS6_1
RB6_1:
 v_add_f32 v248, v248, v249
 v_add_f32 v168, v168, v169
 s_waitcnt lgkmcnt(4)
 m16 v[144:147], a[240:243], v[96:99], v[160:163]
 m16 v[152:155], a[240:243], v[100:103], v[164:167]
 ds_read_b128 a[240:243], v240 offset:12544
 m16 v[148:151], a[244:247], v[96:99], v[160:163]
 m16 v[156:159], a[244:247], v[100:103], v[164:167]
 ds_read_b128 a[244:247], v240 offset:18688
 m16 v[144:147], a[248:251], v[104:107], v[144:147]
 m16 v[152:155], a[248:251], v[108:111], v[152:155]
 ds_read_b128 a[248:251], v241 offset:12544
 cvt v192, v192, v193
 v_accvgpr_write_b32 a152, v192
 m16 v[148:151], a[252:255], v[104:107], v[148:151]
 cvt v194, v194, v195
 v_accvgpr_write_b32 a153, v194
 m16 v[156:159], a[252:255], v[108:111], v[156:159]
 ds_read_b128 a[252:255], v241 offset:18688
 cvt v196, v196, v197
 s_waitcnt lgkmcnt(2)
 m16 v[144:147], a[224:227], v[112:115], v[144:147]
 v_accvgpr_write_b32 a154, v196
 cvt v198, v198, v199
 m16 v[152:155], a[224:227], v[116:119], v[152:155]
 v_accvgpr_write_b32 a155, v198
 cvt v200, v200, v201
 v_accvgpr_write_b32 a156, v200
 m16 v[148:151], a[228:231], v[112:115], v[148:151]
 cvt v202, v202, v203
 v_accvgpr_write_b32 a157, v202
 m16 v[156:159], a[228:231], v[116:119], v[156:159]
 cvt v204, v204, v205
 v_accvgpr_write_b32 a158, v204
 cvt v206, v206, v207
 v_accvgpr_write_b32 a159, v206
 m16 v[144:147], a[232:235], v[120:123], v[144:147]
 rtr a[224:225], v172, 24576
 v_accvgpr_read_b32 v193, a160
 m16 v[152:155], a[232:235], v[124:127], v[152:155]
 rtr a[226:227], v172, 26624
 v_lshlrev_b32 v192, 16, v193
 v_and_b32 v193, 0xffff0000, v193
 m16 v[148:151], a[236:239], v[120:123], v[148:151]
 rtr a[228:229], v173, 24576
 v_accvgpr_read_b32 v195, a161
 m16 v[156:159], a[236:239], v[124:127], v[156:159]
 rtr a[230:231], v173, 26624
 v_lshlrev_b32 v194, 16, v195
 v_and_b32 v195, 0xffff0000, v195
 m16 v[144:147], a[240:243], v[128:131], v[144:147]
 rtr a[232:233], v172, 28672
 v_accvgpr_read_b32 v197, a162
 m16 v[152:155], a[240:243], v[132:135], v[152:155]
 rtr a[234:235], v172, 30720
 v_lshlrev_b32 v196, 16, v197
 v_and_b32 v197, 0xffff0000, v197
 m16 v[148:151], a[244:247], v[128:131], v[148:151]
 rtr a[236:237], v173, 28672
 v_accvgpr_read_b32 v199, a163
 m16 v[156:159], a[244:247], v[132:135], v[156:159]
 rtr a[238:239], v173, 30720
 v_lshlrev_b32 v198, 16, v199
 s_waitcnt lgkmcnt(4)
 m16 v[144:147], a[248:251], v[136:139], v[144:147]
 rtr a[240:241], v172, 32768
 v_and_b32 v199, 0xffff0000, v199
 m16 v[152:155], a[248:251], v[140:143], v[152:155]
 rtr a[242:243], v172, 34816
 v_accvgpr_read_b32 v201, a164
 v_lshlrev_b32 v200, 16, v201
 m16 v[148:151], a[252:255], v[136:139], v[148:151]
 rtr a[244:245], v173, 32768
 v_and_b32 v201, 0xffff0000, v201
 m16 v[156:159], a[252:255], v[140:143], v[156:159]
 rtr a[246:247], v173, 34816
 v_accvgpr_read_b32 v203, a165
 v_lshlrev_b32 v202, 16, v203
 v_and_b32 v203, 0xffff0000, v203
 v_accvgpr_read_b32 v205, a166
 v_lshlrev_b32 v204, 16, v205
 v_and_b32 v205, 0xffff0000, v205
 v_accvgpr_read_b32 v207, a167
 v_lshlrev_b32 v206, 16, v207
 v_and_b32 v207, 0xffff0000, v207
 m16 v[192:195], a[224:227], a[0:3], v[192:195]
 rtr a[248:249], v172
 m16 v[200:203], a[224:227], a[4:7], v[200:203]
 rtr a[250:251], v172, 2048
 m16 v[196:199], a[228:231], a[0:3], v[196:199]
 rtr a[252:253], v173
 m16 v[204:207], a[228:231], a[4:7], v[204:207]
 rtr a[254:255], v173, 2048
 s_waitcnt lgkmcnt(4)
 m16 v[192:195], a[232:235], a[8:11], v[192:195]
 rtr a[224:225], v172, 4096
 m16 v[200:203], a[232:235], a[12:15], v[200:203]
 rtr a[226:227], v172, 6144
 v_mul_f32 v250, s36, v144
 v_mul_f32 v251, s36, v145
 m16 v[196:199], a[236:239], a[8:11], v[196:199]
 rtr a[228:229], v173, 4096
 m16 v[204:207], a[236:239], a[12:15], v[204:207]
 rtr a[230:231], v173, 6144
 v_exp_f32 v250, v250
 m16 v[192:195], a[240:243], a[16:19], v[192:195]
 rtr a[232:233], v172, 8192
 m16 v[200:203], a[240:243], a[20:23], v[200:203]
 rtr a[234:235], v172, 10240
 v_exp_f32 v251, v251
 m16 v[196:199], a[244:247], a[16:19], v[196:199]
 rtr a[236:237], v173, 8192
 cvt v184, v250, v251
 m16 v[204:207], a[244:247], a[20:23], v[204:207]
 rtr a[238:239], v173, 10240
 v_add_f32 v249, v250, v251
 s_waitcnt lgkmcnt(4)
 m16 v[192:195], a[248:251], a[24:27], v[192:195]
 rtr a[240:241], v242
 v_mul_f32 v250, s36, v146
 m16 v[200:203], a[248:251], a[28:31], v[200:203]
 rtr a[242:243], v242, 6144
 v_mul_f32 v251, s36, v147
 m16 v[196:199], a[252:255], a[24:27], v[196:199]
 rtr a[244:245], v243
 m16 v[204:207], a[252:255], a[28:31], v[204:207]
 rtr a[246:247], v243, 6144
 v_exp_f32 v250, v250
 m16 v[192:195], a[224:227], a[32:35], v[192:195]
 rtr a[248:249], v244
 m16 v[200:203], a[224:227], a[36:39], v[200:203]
 rtr a[250:251], v244, 6144
 v_exp_f32 v251, v251
 m16 v[196:199], a[228:231], a[32:35], v[196:199]
 rtr a[252:253], v245
 v_add_f32 v249, v249, v250
 m16 v[204:207], a[228:231], a[36:39], v[204:207]
 rtr a[254:255], v245, 6144
 v_add_f32 v249, v249, v251
 s_waitcnt lgkmcnt(4)
 m16 v[192:195], a[232:235], a[40:43], v[192:195]
 rtr a[224:225], v242, 128
 cvt v185, v250, v251
 m16 v[200:203], a[232:235], a[44:47], v[200:203]
 rtr a[226:227], v242, 6272
 v_mul_f32 v250, s36, v148
 v_mul_f32 v251, s36, v149
 m16 v[196:199], a[236:239], a[40:43], v[196:199]
 rtr a[228:229], v243, 128
 m16 v[204:207], a[236:239], a[44:47], v[204:207]
 rtr a[230:231], v243, 6272
 v_exp_f32 v250, v250
 m16 v[0:3], a[240:243], v[176:179], v[0:3]
 rtr a[232:233], v244, 128
 m16 v[8:11], a[240:243], v[180:183], v[8:11]
 rtr a[234:235], v244, 6272
 v_exp_f32 v251, v251
 m16 v[4:7], a[244:247], v[176:179], v[4:7]
 rtr a[236:237], v245, 128
 v_add_f32 v249, v249, v250
 m16 v[12:15], a[244:247], v[180:183], v[12:15]
 rtr a[238:239], v245, 6272
 v_add_f32 v249, v249, v251
 s_waitcnt lgkmcnt(4)
 m16 v[16:19], a[248:251], v[176:179], v[16:19]
 rtr a[240:241], v242, 256
 cvt v186, v250, v251
 m16 v[24:27], a[248:251], v[180:183], v[24:27]
 rtr a[242:243], v242, 6400
 cvt v192, v192, v193
 v_accvgpr_write_b32 a160, v192
 m16 v[20:23], a[252:255], v[176:179], v[20:23]
 rtr a[244:245], v243, 256
 cvt v194, v194, v195
 m16 v[28:31], a[252:255], v[180:183], v[28:31]
 rtr a[246:247], v243, 6400
 v_accvgpr_write_b32 a161, v194
 cvt v196, v196, v197
 m16 v[32:35], a[224:227], v[176:179], v[32:35]
 rtr a[248:249], v244, 256
 v_accvgpr_write_b32 a162, v196
 m16 v[40:43], a[224:227], v[180:183], v[40:43]
 rtr a[250:251], v244, 6400
 cvt v198, v198, v199
 v_accvgpr_write_b32 a163, v198
 m16 v[36:39], a[228:231], v[176:179], v[36:39]
 rtr a[252:253], v245, 256
 cvt v200, v200, v201
 m16 v[44:47], a[228:231], v[180:183], v[44:47]
 rtr a[254:255], v245, 6400
 v_accvgpr_write_b32 a164, v200
 cvt v202, v202, v203
 v_accvgpr_write_b32 a165, v202
 cvt v204, v204, v205
 v_accvgpr_write_b32 a166, v204
 cvt v206, v206, v207
 v_accvgpr_write_b32 a167, v206
 s_waitcnt lgkmcnt(4)
 m16 v[48:51], a[232:235], v[176:179], v[48:51]
 rtr a[224:225], v174, 24576
 v_accvgpr_read_b32 v193, a168
 m16 v[56:59], a[232:235], v[180:183], v[56:59]
 rtr a[226:227], v174, 26624
 rtr a[228:229], v175, 24576
 v_lshlrev_b32 v192, 16, v193
 m16 v[52:55], a[236:239], v[176:179], v[52:55]
 rtr a[230:231], v175, 26624
 v_and_b32 v193, 0xffff0000, v193
 m16 v[60:63], a[236:239], v[180:183], v[60:63]
 rtr a[232:233], v174, 28672
 rtr a[234:235], v174, 30720
 v_accvgpr_read_b32 v195, a169
 m16 v[64:67], a[240:243], v[176:179], v[64:67]
 rtr a[236:237], v175, 28672
 v_lshlrev_b32 v194, 16, v195
 m16 v[72:75], a[240:243], v[180:183], v[72:75]
 rtr a[238:239], v175, 30720
 rtr a[240:241], v174, 32768
 v_and_b32 v195, 0xffff0000, v195
 m16 v[68:71], a[244:247], v[176:179], v[68:71]
 rtr a[242:243], v174, 34816
 v_accvgpr_read_b32 v197, a170
 m16 v[76:79], a[244:247], v[180:183], v[76:79]
 rtr a[244:245], v175, 32768
 rtr a[246:247], v175, 34816
 s_waitcnt lgkmcnt(6)
 m16 v[80:83], a[248:251], v[176:179], v[80:83]
 v_lshlrev_b32 v196, 16, v197
 v_and_b32 v197, 0xffff0000, v197
 m16 v[88:91], a[248:251], v[180:183], v[88:91]
 rtr a[248:249], v174
 rtr a[250:251], v174, 2048
 v_accvgpr_read_b32 v199, a171
 m16 v[84:87], a[252:255], v[176:179], v[84:87]
 v_lshlrev_b32 v198, 16, v199
 v_and_b32 v199, 0xffff0000, v199
 m16 v[92:95], a[252:255], v[180:183], v[92:95]
 rtr a[252:253], v175
 rtr a[254:255], v175, 2048
 v_accvgpr_read_b32 v201, a172
 v_lshlrev_b32 v200, 16, v201
 v_and_b32 v201, 0xffff0000, v201
 v_accvgpr_read_b32 v203, a173
 v_lshlrev_b32 v202, 16, v203
 v_and_b32 v203, 0xffff0000, v203
 v_accvgpr_read_b32 v205, a174
 v_lshlrev_b32 v204, 16, v205
 v_and_b32 v205, 0xffff0000, v205
 v_accvgpr_read_b32 v207, a175
 v_lshlrev_b32 v206, 16, v207
 v_and_b32 v207, 0xffff0000, v207
 m16 v[192:195], a[224:227], a[0:3], v[192:195]
 v_mul_f32 v250, s36, v150
 v_mul_f32 v251, s36, v151
 m16 v[200:203], a[224:227], a[4:7], v[200:203]
 rtr a[224:225], v174, 4096
 rtr a[226:227], v174, 6144
 m16 v[196:199], a[228:231], a[0:3], v[196:199]
 v_exp_f32 v250, v250
 m16 v[204:207], a[228:231], a[4:7], v[204:207]
 rtr a[228:229], v175, 4096
 rtr a[230:231], v175, 6144
 m16 v[192:195], a[232:235], a[8:11], v[192:195]
 v_exp_f32 v251, v251
 m16 v[200:203], a[232:235], a[12:15], v[200:203]
 rtr a[232:233], v174, 8192
 rtr a[234:235], v174, 10240
 s_waitcnt lgkmcnt(4)
 m16 v[196:199], a[236:239], a[8:11], v[196:199]
 v_add_f32 v249, v249, v250
 v_add_f32 v249, v249, v251
 m16 v[204:207], a[236:239], a[12:15], v[204:207]
 rtr a[236:237], v175, 8192
 rtr a[238:239], v175, 10240
 cvt v187, v250, v251
 m16 v[192:195], a[240:243], a[16:19], v[192:195]
 v_mul_f32 v250, s36, v152
 v_mul_f32 v251, s36, v153
 m16 v[200:203], a[240:243], a[20:23], v[200:203]
 v_exp_f32 v250, v250
 m16 v[196:199], a[244:247], a[16:19], v[196:199]
 v_exp_f32 v251, v251
 m16 v[204:207], a[244:247], a[20:23], v[204:207]
 cvt v188, v250, v251
 v_add_f32 v169, v250, v251
 v_mul_f32 v250, s36, v154
 m16 v[192:195], a[248:251], a[24:27], v[192:195]
 v_mul_f32 v251, s36, v155
 m16 v[200:203], a[248:251], a[28:31], v[200:203]
 v_exp_f32 v250, v250
 m16 v[196:199], a[252:255], a[24:27], v[196:199]
 v_exp_f32 v251, v251
 m16 v[204:207], a[252:255], a[28:31], v[204:207]
 s_waitcnt lgkmcnt(0)
 s_barrier
 m16 v[192:195], a[224:227], a[32:35], v[192:195]
 ds_read_b128 a[240:243], v240 offset:24576
 v_add_f32 v169, v169, v250
 m16 v[200:203], a[224:227], a[36:39], v[200:203]
 ds_read_b128 a[244:247], v240 offset:30720
 v_add_f32 v169, v169, v251
 cvt v189, v250, v251
 m16 v[196:199], a[228:231], a[32:35], v[196:199]
 ds_read_b128 a[248:251], v241 offset:24576
 v_mul_f32 v250, s36, v156
 m16 v[204:207], a[228:231], a[36:39], v[204:207]
 ds_read_b128 a[252:255], v241 offset:30720
 v_mul_f32 v251, s36, v157
 m16 v[192:195], a[232:235], a[40:43], v[192:195]
 ds_read_b128 a[224:227], v240 offset:24704
 m16 v[200:203], a[232:235], a[44:47], v[200:203]
 ds_read_b128 a[228:231], v240 offset:30848
 v_exp_f32 v250, v250
 v_exp_f32 v251, v251
 v_add_f32 v169, v169, v250
 v_add_f32 v169, v169, v251
 cvt v190, v250, v251
 v_mul_f32 v250, s36, v158
 v_mul_f32 v251, s36, v159
 v_exp_f32 v250, v250
 v_exp_f32 v251, v251
 v_add_f32 v169, v169, v250
 v_add_f32 v169, v169, v251
 cvt v191, v250, v251
 v_add_f32 v250, v249, v169
 v_cmp_nge_f32 s[48:49], s37, v250
 m16 v[196:199], a[236:239], a[40:43], v[196:199]
 ds_read_b128 a[232:235], v241 offset:24704
 m16 v[204:207], a[236:239], a[44:47], v[204:207]
 ds_read_b128 a[236:239], v241 offset:30848
 s_cmp_lg_u64 s[48:49], 0
 s_cbranch_scc1 RS7_1
RB7_1:
 v_add_f32 v248, v248, v249
 v_add_f32 v168, v168, v169
 s_waitcnt lgkmcnt(4)
 m16 v[144:147], a[240:243], v[96:99], v[160:163]
 m16 v[152:155], a[240:243], v[100:103], v[164:167]
 ds_read_b128 a[240:243], v240 offset:24832
 m16 v[148:151], a[244:247], v[96:99], v[160:163]
 m16 v[156:159], a[244:247], v[100:103], v[164:167]
 ds_read_b128 a[244:247], v240 offset:30976
 m16 v[144:147], a[248:251], v[104:107], v[144:147]
 m16 v[152:155], a[248:251], v[108:111], v[152:155]
 ds_read_b128 a[248:251], v241 offset:24832
 cvt v192, v192, v193
 v_accvgpr_write_b32 a168, v192
 m16 v[148:151], a[252:255], v[104:107], v[148:151]
 cvt v194, v194, v195
 v_accvgpr_write_b32 a169, v194
 m16 v[156:159], a[252:255], v[108:111], v[156:159]
 ds_read_b128 a[252:255], v241 offset:30976
 s_cmp_eq_u32 s38, 0
 s_cbranch_scc1 MB0
MR0:
 s_waitcnt lgkmcnt(2)
 m16 v[144:147], a[224:227], v[112:115], v[144:147]
 cvt v196, v196, v197
 v_accvgpr_write_b32 a170, v196
 m16 v[152:155], a[224:227], v[116:119], v[152:155]
 cvt v198, v198, v199
 v_accvgpr_write_b32 a171, v198
 cvt v200, v200, v201
 m16 v[148:151], a[228:231], v[112:115], v[148:151]
 v_accvgpr_write_b32 a172, v200
 cvt v202, v202, v203
 m16 v[156:159], a[228:231], v[116:119], v[156:159]
 v_accvgpr_write_b32 a173, v202
 cvt v204, v204, v205
 v_accvgpr_write_b32 a174, v204
 m16 v[144:147], a[232:235], v[120:123], v[144:147]
 cvt v206, v206, v207
 v_accvgpr_write_b32 a175, v206
 m16 v[152:155], a[232:235], v[124:127], v[152:155]
 v_accvgpr_read_b32 v193, a176
 v_lshlrev_b32 v192, 16, v193
 v_and_b32 v193, 0xffff0000, v193
 m16 v[148:151], a[236:239], v[120:123], v[148:151]
 v_accvgpr_read_b32 v195, a177
 v_lshlrev_b32 v194, 16, v195
 m16 v[156:159], a[236:239], v[124:127], v[156:159]
 s_waitcnt lgkmcnt(0)
 s_barrier
 m16 v[144:147], a[240:243], v[128:131], v[144:147]
 rtr a[224:225], v242, 12288
 v_and_b32 v195, 0xffff0000, v195
 m16 v[152:155], a[240:243], v[132:135], v[152:155]
 rtr a[226:227], v242, 18432
 rtr a[228:229], v243, 12288
 v_accvgpr_read_b32 v197, a178
 m16 v[148:151], a[244:247], v[128:131], v[148:151]
 rtr a[230:231], v243, 18432
 v_lshlrev_b32 v196, 16, v197
 m16 v[156:159], a[244:247], v[132:135], v[156:159]
 rtr a[232:233], v244, 12288
 rtr a[234:235], v244, 18432
 v_and_b32 v197, 0xffff0000, v197
 m16 v[144:147], a[248:251], v[136:139], v[144:147]
 rtr a[236:237], v245, 12288
 v_accvgpr_read_b32 v199, a179
 m16 v[152:155], a[248:251], v[140:143], v[152:155]
 rtr a[238:239], v245, 18432
 v_lshlrev_b32 v198, 16, v199
 v_and_b32 v199, 0xffff0000, v199
 m16 v[148:151], a[252:255], v[136:139], v[148:151]
 rtr a[240:241], v242, 12416
 v_accvgpr_read_b32 v201, a180
 m16 v[156:159], a[252:255], v[140:143], v[156:159]
 rtr a[242:243], v242, 18560
 v_lshlrev_b32 v200, 16, v201
 s_waitcnt lgkmcnt(4)
 m16 v[0:3], a[224:227], v[184:187], v[0:3]
 rtr a[244:245], v243, 12416
 v_and_b32 v201, 0xffff0000, v201
 m16 v[8:11], a[224:227], v[188:191], v[8:11]
 rtr a[246:247], v243, 18560
 v_accvgpr_read_b32 v203, a181
 v_lshlrev_b32 v202, 16, v203
 m16 v[4:7], a[228:231], v[184:187], v[4:7]
 rtr a[248:249], v244, 12416
 v_and_b32 v203, 0xffff0000, v203
 m16 v[12:15], a[228:231], v[188:191], v[12:15]
 rtr a[250:251], v244, 18560
 v_accvgpr_read_b32 v205, a182
 v_lshlrev_b32 v204, 16, v205
 m16 v[16:19], a[232:235], v[184:187], v[16:19]
 rtr a[252:253], v245, 12416
 v_and_b32 v205, 0xffff0000, v205
 m16 v[24:27], a[232:235], v[188:191], v[24:27]
 rtr a[254:255], v245, 18560
 v_accvgpr_read_b32 v207, a183
 s_waitcnt lgkmcnt(4)
 m16 v[20:23], a[236:239], v[184:187], v[20:23]
 rtr a[224:225], v242, 12544
 v_lshlrev_b32 v206, 16, v207
 m16 v[28:31], a[236:239], v[188:191], v[28:31]
 rtr a[226:227], v242, 18688
 v_and_b32 v207, 0xffff0000, v207
 v_mul_f32 v250, s36, v144
 m16 v[32:35], a[240:243], v[184:187], v[32:35]
 rtr a[228:229], v243, 12544
 v_mul_f32 v251, s36, v145
 m16 v[40:43], a[240:243], v[188:191], v[40:43]
 rtr a[230:231], v243, 18688
 v_exp_f32 v250, v250
 m16 v[36:39], a[244:247], v[184:187], v[36:39]
 rtr a[232:233], v244, 12544
 m16 v[44:47], a[244:247], v[188:191], v[44:47]
 rtr a[234:235], v244, 18688
 s_waitcnt lgkmcnt(4)
 m16 v[48:51], a[248:251], v[184:187], v[48:51]
 rtr a[236:237], v245, 12544
 m16 v[56:59], a[248:251], v[188:191], v[56:59]
 rtr a[238:239], v245, 18688
 rtr a[240:241], v172, 12288
 m16 v[52:55], a[252:255], v[184:187], v[52:55]
 rtr a[242:243], v172, 14336
 m16 v[60:63], a[252:255], v[188:191], v[60:63]
 rtr a[244:245], v173, 12288
 rtr a[246:247], v173, 14336
 m16 v[64:67], a[224:227], v[184:187], v[64:67]
 rtr a[248:249], v172, 16384
 m16 v[72:75], a[224:227], v[188:191], v[72:75]
 rtr a[250:251], v172, 18432
 rtr a[252:253], v173, 16384
 s_waitcnt lgkmcnt(6)
 m16 v[68:71], a[228:231], v[184:187], v[68:71]
 rtr a[254:255], v173, 18432
 m16 v[76:79], a[228:231], v[188:191], v[76:79]
 rtr a[224:225], v172, 20480
 rtr a[226:227], v172, 22528
 m16 v[80:83], a[232:235], v[184:187], v[80:83]
 rtr a[228:229], v173, 20480
 m16 v[88:91], a[232:235], v[188:191], v[88:91]
 rtr a[230:231], v173, 22528
 rtr a[232:233], v172, 36864
 m16 v[84:87], a[236:239], v[184:187], v[84:87]
 rtr a[234:235], v172, 38912
 m16 v[92:95], a[236:239], v[188:191], v[92:95]
 rtr a[236:237], v173, 36864
 rtr a[238:239], v173, 38912
 s_waitcnt lgkmcnt(6)
 m16 v[192:195], a[240:243], a[0:3], v[192:195]
 v_exp_f32 v251, v251
 m16 v[200:203], a[240:243], a[4:7], v[200:203]
 rtr a[240:241], v172, 40960
 rtr a[242:243], v172, 43008
 cvt v176, v250, v251
 m16 v[196:199], a[244:247], a[0:3], v[196:199]
 v_add_f32 v249, v250, v251
 v_mul_f32 v250, s36, v146
 m16 v[204:207], a[244:247], a[4:7], v[204:207]
 rtr a[244:245], v173, 40960
 rtr a[246:247], v173, 43008
 v_mul_f32 v251, s36, v147
 m16 v[192:195], a[248:251], a[8:11], v[192:195]
 v_exp_f32 v250, v250
 m16 v[200:203], a[248:251], a[12:15], v[200:203]
 rtr a[248:249], v172, 45056
 rtr a[250:251], v172, 47104
 m16 v[196:199], a[252:255], a[8:11], v[196:199]
 v_exp_f32 v251, v251
 m16 v[204:207], a[252:255], a[12:15], v[204:207]
 rtr a[252:253], v173, 45056
 rtr a[254:255], v173, 47104
 v_add_f32 v249, v249, v250
 m16 v[192:195], a[224:227], a[16:19], v[192:195]
 v_add_f32 v249, v249, v251
 cvt v177, v250, v251
 m16 v[200:203], a[224:227], a[20:23], v[200:203]
 v_mul_f32 v250, s36, v148
 v_mul_f32 v251, s36, v149
 s_waitcnt lgkmcnt(2)
 m16 v[196:199], a[228:231], a[16:19], v[196:199]
 v_exp_f32 v250, v250
 m16 v[204:207], a[228:231], a[20:23], v[204:207]
 v_exp_f32 v251, v251
 v_add_f32 v249, v249, v250
 m16 v[192:195], a[232:235], a[24:27], v[192:195]
 v_add_f32 v249, v249, v251
 cvt v178, v250, v251
 m16 v[200:203], a[232:235], a[28:31], v[200:203]
 v_mul_f32 v250, s36, v150
 v_mul_f32 v251, s36, v151
 m16 v[196:199], a[236:239], a[24:27], v[196:199]
 v_exp_f32 v250, v250
 m16 v[204:207], a[236:239], a[28:31], v[204:207]
 s_waitcnt lgkmcnt(0)
 s_barrier
 m16 v[192:195], a[240:243], a[32:35], v[192:195]
 ds_read_b128 a[224:227], v240
 m16 v[200:203], a[240:243], a[36:39], v[200:203]
 ds_read_b128 a[228:231], v240 offset:6144
 v_exp_f32 v251, v251
 m16 v[196:199], a[244:247], a[32:35], v[196:199]
 ds_read_b128 a[232:235], v241
 v_add_f32 v249, v249, v250
 m16 v[204:207], a[244:247], a[36:39], v[204:207]
 ds_read_b128 a[236:239], v241 offset:6144
 v_add_f32 v249, v249, v251
 cvt v179, v250, v251
 m16 v[192:195], a[248:251], a[40:43], v[192:195]
 ds_read_b128 a[240:243], v240 offset:128
 v_mul_f32 v250, s36, v152
 m16 v[200:203], a[248:251], a[44:47], v[200:203]
 ds_read_b128 a[244:247], v240 offset:6272
 v_mul_f32 v251, s36, v153
 v_exp_f32 v250, v250
 v_exp_f32 v251, v251
 s_nop 0
 cvt v180, v250, v251
 v_add_f32 v169, v250, v251
 v_mul_f32 v250, s36, v154
 v_mul_f32 v251, s36, v155
 v_exp_f32 v250, v250
 v_exp_f32 v251, v251
 v_add_f32 v169, v169, v250
 v_add_f32 v169, v169, v251
 cvt v181, v250, v251
 v_mul_f32 v250, s36, v156
 v_mul_f32 v251, s36, v157
 v_exp_f32 v250, v250
 v_exp_f32 v251, v251
 v_add_f32 v169, v169, v250
 v_add_f32 v169, v169, v251
 cvt v182, v250, v251
 v_mul_f32 v250, s36, v158
 v_mul_f32 v251, s36, v159
 v_exp_f32 v250, v250
 v_exp_f32 v251, v251
 v_add_f32 v169, v169, v250
 v_add_f32 v169, v169, v251
 cvt v183, v250, v251
 v_add_f32 v250, v249, v169
 v_cmp_nge_f32 s[48:49], s37, v250
 m16 v[196:199], a[252:255], a[40:43], v[196:199]
 ds_read_b128 a[248:251], v241 offset:128
 m16 v[204:207], a[252:255], a[44:47], v[204:207]
 ds_read_b128 a[252:255], v241 offset:6272
 s_cmp_lg_u64 s[48:49], 0
 s_cbranch_scc1 RS8_1
RB8_1:
 v_add_f32 v248, v248, v249
 v_add_f32 v168, v168, v169
 s_waitcnt lgkmcnt(4)
 m16 v[144:147], a[224:227], v[96:99], v[160:163]
 m16 v[152:155], a[224:227], v[100:103], v[164:167]
 ds_read_b128 a[224:227], v240 offset:256
 m16 v[148:151], a[228:231], v[96:99], v[160:163]
 m16 v[156:159], a[228:231], v[100:103], v[164:167]
 ds_read_b128 a[228:231], v240 offset:6400
 m16 v[144:147], a[232:235], v[104:107], v[144:147]
 m16 v[152:155], a[232:235], v[108:111], v[152:155]
 ds_read_b128 a[232:235], v241 offset:256
 cvt v192, v192, v193
 v_accvgpr_write_b32 a176, v192
 m16 v[148:151], a[236:239], v[104:107], v[148:151]
 cvt v194, v194, v195
 v_accvgpr_write_b32 a177, v194
 m16 v[156:159], a[236:239], v[108:111], v[156:159]
 ds_read_b128 a[236:239], v241 offset:6400
 cvt v196, v196, v197
 s_waitcnt lgkmcnt(2)
 m16 v[144:147], a[240:243], v[112:115], v[144:147]
 v_accvgpr_write_b32 a178, v196
 cvt v198, v198, v199
 m16 v[152:155], a[240:243], v[116:119], v[152:155]
 v_accvgpr_write_b32 a179, v198
 cvt v200, v200, v201
 v_accvgpr_write_b32 a180, v200
 m16 v[148:151], a[244:247], v[112:115], v[148:151]
 cvt v202, v202, v203
 v_accvgpr_write_b32 a181, v202
 m16 v[156:159], a[244:247], v[116:119], v[156:159]
 cvt v204, v204, v205
 v_accvgpr_write_b32 a182, v204
 cvt v206, v206, v207
 m16 v[144:147], a[248:251], v[120:123], v[144:147]
 rtr a[240:241], v242, 24576
 v_accvgpr_write_b32 a183, v206
 m16 v[152:155], a[248:251], v[124:127], v[152:155]
 rtr a[242:243], v242, 30720
 v_accvgpr_read_b32 v193, a184
 v_lshlrev_b32 v192, 16, v193
 m16 v[148:151], a[252:255], v[120:123], v[148:151]
 rtr a[244:245], v243, 24576
 v_and_b32 v193, 0xffff0000, v193
 m16 v[156:159], a[252:255], v[124:127], v[156:159]
 rtr a[246:247], v243, 30720
 v_accvgpr_read_b32 v195, a185
 v_lshlrev_b32 v194, 16, v195
 m16 v[144:147], a[224:227], v[128:131], v[144:147]
 rtr a[248:249], v244, 24576
 v_and_b32 v195, 0xffff0000, v195
 m16 v[152:155], a[224:227], v[132:135], v[152:155]
 rtr a[250:251], v244, 30720
 v_accvgpr_read_b32 v197, a186
 v_lshlrev_b32 v196, 16, v197
 m16 v[148:151], a[228:231], v[128:131], v[148:151]
 rtr a[252:253], v245, 24576
 v_and_b32 v197, 0xffff0000, v197
 m16 v[156:159], a[228:231], v[132:135], v[156:159]
 rtr a[254:255], v245, 30720
 v_accvgpr_read_b32 v199, a187
 s_waitcnt lgkmcnt(4)
 m16 v[144:147], a[232:235], v[136:139], v[144:147]
 rtr a[224:225], v242, 24704
 v_lshlrev_b32 v198, 16, v199
 m16 v[152:155], a[232:235], v[140:143], v[152:155]
 rtr a[226:227], v242, 30848
 v_and_b32 v199, 0xffff0000, v199
 v_accvgpr_read_b32 v201, a188
 m16 v[148:151], a[236:239], v[136:139], v[148:151]
 rtr a[228:229], v243, 24704
 v_lshlrev_b32 v200, 16, v201
 m16 v[156:159], a[236:239], v[140:143], v[156:159]
 rtr a[230:231], v243, 30848
 v_and_b32 v201, 0xffff0000, v201
 v_accvgpr_read_b32 v203, a189
 m16 v[0:3], a[240:243], v[176:179], v[0:3]
 rtr a[232:233], v244, 24704
 v_lshlrev_b32 v202, 16, v203
 m16 v[8:11], a[240:243], v[180:183], v[8:11]
 rtr a[234:235], v244, 30848
 v_and_b32 v203, 0xffff0000, v203
 v_accvgpr_read_b32 v205, a190
 m16 v[4:7], a[244:247], v[176:179], v[4:7]
 rtr a[236:237], v245, 24704
 v_lshlrev_b32 v204, 16, v205
 m16 v[12:15], a[244:247], v[180:183], v[12:15]
 rtr a[238:239], v245, 30848
 v_and_b32 v205, 0xffff0000, v205
 s_waitcnt lgkmcnt(4)
 m16 v[16:19], a[248:251], v[176:179], v[16:19]
 rtr a[240:241], v242, 24832
 v_accvgpr_read_b32 v207, a191
 m16 v[24:27], a[248:251], v[180:183], v[24:27]
 rtr a[242:243], v242, 30976
 v_lshlrev_b32 v206, 16, v207
 v_and_b32 v207, 0xffff0000, v207
 m16 v[20:23], a[252:255], v[176:179], v[20:23]
 rtr a[244:245], v243, 24832
 v_mul_f32 v250, s36, v144
 m16 v[28:31], a[252:255], v[180:183], v[28:31]
 rtr a[246:247], v243, 30976
 v_mul_f32 v251, s36, v145
 m16 v[32:35], a[224:227], v[176:179], v[32:35]
 rtr a[248:249], v244, 24832
 m16 v[40:43], a[224:227], v[180:183], v[40:43]
 rtr a[250:251], v244, 30976
 v_exp_f32 v250, v250
 m16 v[36:39], a[228:231], v[176:179], v[36:39]
 rtr a[252:253], v245, 24832
 m16 v[44:47], a[228:231], v[180:183], v[44:47]
 rtr a[254:255], v245, 30976
 s_waitcnt lgkmcnt(4)
 m16 v[48:51], a[232:235], v[176:179], v[48:51]
 rtr a[224:225], v174, 12288
 m16 v[56:59], a[232:235], v[180:183], v[56:59]
 rtr a[226:227], v174, 14336
 rtr a[228:229], v175, 12288
 m16 v[52:55], a[236:239], v[176:179], v[52:55]
 rtr a[230:231], v175, 14336
 m16 v[60:63], a[236:239], v[180:183], v[60:63]
 rtr a[232:233], v174, 16384
 rtr a[234:235], v174, 18432
 m16 v[64:67], a[240:243], v[176:179], v[64:67]
 rtr a[236:237], v175, 16384
 m16 v[72:75], a[240:243], v[180:183], v[72:75]
 rtr a[238:239], v175, 18432
 rtr a[240:241], v174, 20480
 m16 v[68:71], a[244:247], v[176:179], v[68:71]
 rtr a[242:243], v174, 22528
 m16 v[76:79], a[244:247], v[180:183], v[76:79]
 rtr a[244:245], v175, 20480
 rtr a[246:247], v175, 22528
 s_waitcnt lgkmcnt(6)
 m16 v[80:83], a[248:251], v[176:179], v[80:83]
 v_exp_f32 v251, v251
 m16 v[88:91], a[248:251], v[180:183], v[88:91]
 rtr a[248:249], v174, 36864
 rtr a[250:251], v174, 38912
 cvt v184, v250, v251
 m16 v[84:87], a[252:255], v[176:179], v[84:87]
 v_add_f32 v249, v250, v251
 v_mul_f32 v250, s36, v146
 m16 v[92:95], a[252:255], v[180:183], v[92:95]
 rtr a[252:253], v175, 36864
 rtr a[254:255], v175, 38912
 v_mul_f32 v251, s36, v147
 m16 v[192:195], a[224:227], a[0:3], v[192:195]
 v_exp_f32 v250, v250
 m16 v[200:203], a[224:227], a[4:7], v[200:203]
 rtr a[224:225], v174, 40960
 rtr a[226:227], v174, 43008
 m16 v[196:199], a[228:231], a[0:3], v[196:199]
 v_exp_f32 v251, v251
 m16 v[204:207], a[228:231], a[4:7], v[204:207]
 rtr a[228:229], v175, 40960
 rtr a[230:231], v175, 43008
 v_add_f32 v249, v249, v250
 m16 v[192:195], a[232:235], a[8:11], v[192:195]
 v_add_f32 v249, v249, v251
 cvt v185, v250, v251
 m16 v[200:203], a[232:235], a[12:15], v[200:203]
 rtr a[232:233], v174, 45056
 rtr a[234:235], v174, 47104
 s_waitcnt lgkmcnt(4)
 m16 v[196:199], a[236:239], a[8:11], v[196:199]
 v_mul_f32 v250, s36, v148
 v_mul_f32 v251, s36, v149
 m16 v[204:207], a[236:239], a[12:15], v[204:207]
 rtr a[236:237], v175, 45056
 rtr a[238:239], v175, 47104
 m16 v[192:195], a[240:243], a[16:19], v[192:195]
 v_exp_f32 v250, v250
 m16 v[200:203], a[240:243], a[20:23], v[200:203]
 v_exp_f32 v251, v251
 v_add_f32 v249, v249, v250
 m16 v[196:199], a[244:247], a[16:19], v[196:199]
 v_add_f32 v249, v249, v251
 cvt v186, v250, v251
 m16 v[204:207], a[244:247], a[20:23], v[204:207]
 v_mul_f32 v250, s36, v150
 v_mul_f32 v251, s36, v151
 m16 v[192:195], a[248:251], a[24:27], v[192:195]
 v_exp_f32 v250, v250
 m16 v[200:203], a[248:251], a[28:31], v[200:203]
 v_exp_f32 v251, v251
 v_add_f32 v249, v249, v250
 m16 v[196:199], a[252:255], a[24:27], v[196:199]
 v_add_f32 v249, v249, v251
 cvt v187, v250, v251
 m16 v[204:207], a[252:255], a[28:31], v[204:207]
 s_waitcnt lgkmcnt(0)
 s_barrier
 m16 v[192:195], a[224:227], a[32:35], v[192:195]
 ds_read_b128 a[240:243], v240 offset:12288
 v_mul_f32 v250, s36, v152
 m16 v[200:203], a[224:227], a[36:39], v[200:203]
 ds_read_b128 a[244:247], v240 offset:18432
 v_mul_f32 v251, s36, v153
 m16 v[196:199], a[228:231], a[32:35], v[196:199]
 ds_read_b128 a[248:251], v241 offset:12288
 m16 v[204:207], a[228:231], a[36:39], v[204:207]
 ds_read_b128 a[252:255], v241 offset:18432
 v_exp_f32 v250, v250
 m16 v[192:195], a[232:235], a[40:43], v[192:195]
 ds_read_b128 a[224:227], v240 offset:12416
 m16 v[200:203], a[232:235], a[44:47], v[200:203]
 ds_read_b128 a[228:231], v240 offset:18560
 v_exp_f32 v251, v251
 s_nop 0
 cvt v188, v250, v251
 v_add_f32 v169, v250, v251
 v_mul_f32 v250, s36, v154
 v_mul_f32 v251, s36, v155
 v_exp_f32 v250, v250
 v_exp_f32 v251, v251
 v_add_f32 v169, v169, v250
 v_add_f32 v169, v169, v251
 cvt v189, v250, v251
 v_mul_f32 v250, s36, v156
 v_mul_f32 v251, s36, v157
 v_exp_f32 v250, v250
 v_exp_f32 v251, v251
 v_add_f32 v169, v169, v250
 v_add_f32 v169, v169, v251
 cvt v190, v250, v251
 v_mul_f32 v250, s36, v158
 v_mul_f32 v251, s36, v159
 v_exp_f32 v250, v250
 v_exp_f32 v251, v251
 v_add_f32 v169, v169, v250
 v_add_f32 v169, v169, v251
 cvt v191, v250, v251
 v_add_f32 v250, v249, v169
 v_cmp_nge_f32 s[48:49], s37, v250
 m16 v[196:199], a[236:239], a[40:43], v[196:199]
 ds_read_b128 a[232:235], v241 offset:12416
 m16 v[204:207], a[236:239], a[44:47], v[204:207]
 ds_read_b128 a[236:239], v241 offset:18560
 s_cmp_lg_u64 s[48:49], 0
 s_cbranch_scc1 RS9_1
RB9_1:
 v_add_f32 v248, v248, v249
 v_add_f32 v168, v168, v169
 s_waitcnt lgkmcnt(4)
 m16 v[144:147], a[240:243], v[96:99], v[160:163]
 m16 v[152:155], a[240:243], v[100:103], v[164:167]
 ds_read_b128 a[240:243], v240 offset:12544
 m16 v[148:151], a[244:247], v[96:99], v[160:163]
 m16 v[156:159], a[244:247], v[100:103], v[164:167]
 ds_read_b128 a[244:247], v240 offset:18688
 m16 v[144:147], a[248:251], v[104:107], v[144:147]
 m16 v[152:155], a[248:251], v[108:111], v[152:155]
 ds_read_b128 a[248:251], v241 offset:12544
 cvt v192, v192, v193
 v_accvgpr_write_b32 a184, v192
 m16 v[148:151], a[252:255], v[104:107], v[148:151]
 cvt v194, v194, v195
 v_accvgpr_write_b32 a185, v194
 m16 v[156:159], a[252:255], v[108:111], v[156:159]
 ds_read_b128 a[252:255], v241 offset:18688
 cvt v196, v196, v197
 s_waitcnt lgkmcnt(2)
 m16 v[144:147], a[224:227], v[112:115], v[144:147]
 v_accvgpr_write_b32 a186, v196
 cvt v198, v198, v199
 m16 v[152:155], a[224:227], v[116:119], v[152:155]
 v_accvgpr_write_b32 a187, v198
 cvt v200, v200, v201
 v_accvgpr_write_b32 a188, v200
 m16 v[148:151], a[228:231], v[112:115], v[148:151]
 cvt v202, v202, v203
 v_accvgpr_write_b32 a189, v202
 m16 v[156:159], a[228:231], v[116:119], v[156:159]
 cvt v204, v204, v205
 v_accvgpr_write_b32 a190, v204
 cvt v206, v206, v207
 m16 v[144:147], a[232:235], v[120:123], v[144:147]
 rtr a[224:225], v242
 v_accvgpr_write_b32 a191, v206
 m16 v[152:155], a[232:235], v[124:127], v[152:155]
 rtr a[226:227], v242, 6144
 v_accvgpr_read_b32 v193, a192
 v_lshlrev_b32 v192, 16, v193
 m16 v[148:151], a[236:239], v[120:123], v[148:151]
 rtr a[228:229], v243
 v_and_b32 v193, 0xffff0000, v193
 m16 v[156:159], a[236:239], v[124:127], v[156:159]
 rtr a[230:231], v243, 6144
 v_accvgpr_read_b32 v195, a193
 v_lshlrev_b32 v194, 16, v195
 m16 v[144:147], a[240:243], v[128:131], v[144:147]
 rtr a[232:233], v244
 v_and_b32 v195, 0xffff0000, v195
 m16 v[152:155], a[240:243], v[132:135], v[152:155]
 rtr a[234:235], v244, 6144
 v_accvgpr_read_b32 v197, a194
 v_lshlrev_b32 v196, 16, v197
 m16 v[148:151], a[244:247], v[128:131], v[148:151]
 rtr a[236:237], v245
 v_and_b32 v197, 0xffff0000, v197
 m16 v[156:159], a[244:247], v[132:135], v[156:159]
 rtr a[238:239], v245, 6144
 v_accvgpr_read_b32 v199, a195
 s_waitcnt lgkmcnt(4)
 m16 v[144:147], a[248:251], v[136:139], v[144:147]
 rtr a[240:241], v242, 128
 v_lshlrev_b32 v198, 16, v199
 m16 v[152:155], a[248:251], v[140:143], v[152:155]
 rtr a[242:243], v242, 6272
 v_and_b32 v199, 0xffff0000, v199
 v_accvgpr_read_b32 v201, a196
 m16 v[148:151], a[252:255], v[136:139], v[148:151]
 rtr a[244:245], v243, 128
 v_lshlrev_b32 v200, 16, v201
 m16 v[156:159], a[252:255], v[140:143], v[156:159]
 rtr a[246:247], v243, 6272
 v_and_b32 v201, 0xffff0000, v201
 v_accvgpr_read_b32 v203, a197
 m16 v[0:3], a[224:227], v[184:187], v[0:3]
 rtr a[248:249], v244, 128
 v_lshlrev_b32 v202, 16, v203
 m16 v[8:11], a[224:227], v[188:191], v[8:11]
 rtr a[250:251], v244, 6272
 v_and_b32 v203, 0xffff0000, v203
 v_accvgpr_read_b32 v205, a198
 m16 v[4:7], a[228:231], v[184:187], v[4:7]
 rtr a[252:253], v245, 128
 v_lshlrev_b32 v204, 16, v205
 m16 v[12:15], a[228:231], v[188:191], v[12:15]
 rtr a[254:255], v245, 6272
 v_and_b32 v205, 0xffff0000, v205
 s_waitcnt lgkmcnt(4)
 m16 v[16:19], a[232:235], v[184:187], v[16:19]
 rtr a[224:225], v242, 256
 v_accvgpr_read_b32 v207, a199
 m16 v[24:27], a[232:235], v[188:191], v[24:27]
 rtr a[226:227], v242, 6400
 v_lshlrev_b32 v206, 16, v207
 v_and_b32 v207, 0xffff0000, v207
 m16 v[20:23], a[236:239], v[184:187], v[20:23]
 rtr a[228:229], v243, 256
 v_mul_f32 v250, s36, v144
 m16 v[28:31], a[236:239], v[188:191], v[28:31]
 rtr a[230:231], v243, 6400
 v_mul_f32 v251, s36, v145
 m16 v[32:35], a[240:243], v[184:187], v[32:35]
 rtr a[232:233], v244, 256
 m16 v[40:43], a[240:243], v[188:191], v[40:43]
 rtr a[234:235], v244, 6400
 v_exp_f32 v250, v250
 m16 v[36:39], a[244:247], v[184:187], v[36:39]
 rtr a[236:237], v245, 256
 m16 v[44:47], a[244:247], v[188:191], v[44:47]
 rtr a[238:239], v245, 6400
 s_waitcnt lgkmcnt(4)
 m16 v[48:51], a[248:251], v[184:187], v[48:51]
 rtr a[240:241], v172, 24576
 m16 v[56:59], a[248:251], v[188:191], v[56:59]
 rtr a[242:243], v172, 26624
 rtr a[244:245], v173, 24576
 m16 v[52:55], a[252:255], v[184:187], v[52:55]
 rtr a[246:247], v173, 26624
 m16 v[60:63], a[252:255], v[188:191], v[60:63]
 rtr a[248:249], v172, 28672
 rtr a[250:251], v172, 30720
 m16 v[64:67], a[224:227], v[184:187], v[64:67]
 rtr a[252:253], v173, 28672
 m16 v[72:75], a[224:227], v[188:191], v[72:75]
 rtr a[254:255], v173, 30720
 rtr a[224:225], v172, 32768
 m16 v[68:71], a[228:231], v[184:187], v[68:71]
 rtr a[226:227], v172, 34816
 m16 v[76:79], a[228:231], v[188:191], v[76:79]
 rtr a[228:229], v173, 32768
 rtr a[230:231], v173, 34816
 s_waitcnt lgkmcnt(6)
 m16 v[80:83], a[232:235], v[184:187], v[80:83]
 v_exp_f32 v251, v251
 m16 v[88:91], a[232:235], v[188:191], v[88:91]
 rtr a[232:233], v172
 rtr a[234:235], v172, 2048
 cvt v176, v250, v251
 m16 v[84:87], a[236:239], v[184:187], v[84:87]
 v_add_f32 v249, v250, v251
 v_mul_f32 v250, s36, v146
 m16 v[92:95], a[236:239], v[188:191], v[92:95]
 rtr a[236:237], v173
 rtr a[238:239], v173, 2048
 v_mul_f32 v251, s36, v147
 m16 v[192:195], a[240:243], a[0:3], v[192:195]
 v_exp_f32 v250, v250
 m16 v[200:203], a[240:243], a[4:7], v[200:203]
 rtr a[240:241], v172, 4096
 rtr a[242:243], v172, 6144
 m16 v[196:199], a[244:247], a[0:3], v[196:199]
 v_exp_f32 v251, v251
 m16 v[204:207], a[244:247], a[4:7], v[204:207]
 rtr a[244:245], v173, 4096
 rtr a[246:247], v173, 6144
 v_add_f32 v249, v249, v250
 m16 v[192:195], a[248:251], a[8:11], v[192:195]
 v_add_f32 v249, v249, v251
 cvt v177, v250, v251
 m16 v[200:203], a[248:251], a[12:15], v[200:203]
 rtr a[248:249], v172, 8192
 rtr a[250:251], v172, 10240
 s_waitcnt lgkmcnt(4)
 m16 v[196:199], a[252:255], a[8:11], v[196:199]
 v_mul_f32 v250, s36, v148
 v_mul_f32 v251, s36, v149
 m16 v[204:207], a[252:255], a[12:15], v[204:207]
 rtr a[252:253], v173, 8192
 rtr a[254:255], v173, 10240
 m16 v[192:195], a[224:227], a[16:19], v[192:195]
 v_exp_f32 v250, v250
 m16 v[200:203], a[224:227], a[20:23], v[200:203]
 v_exp_f32 v251, v251
 v_add_f32 v249, v249, v250
 m16 v[196:199], a[228:231], a[16:19], v[196:199]
 v_add_f32 v249, v249, v251
 cvt v178, v250, v251
 m16 v[204:207], a[228:231], a[20:23], v[204:207]
 v_mul_f32 v250, s36, v150
 v_mul_f32 v251, s36, v151
 m16 v[192:195], a[232:235], a[24:27], v[192:195]
 v_exp_f32 v250, v250
 m16 v[200:203], a[232:235], a[28:31], v[200:203]
 v_exp_f32 v251, v251
 v_add_f32 v249, v249, v250
 m16 v[196:199], a[236:239], a[24:27], v[196:199]
 v_add_f32 v249, v249, v251
 cvt v179, v250, v251
 m16 v[204:207], a[236:239], a[28:31], v[204:207]
 s_waitcnt lgkmcnt(0)
 s_barrier
 m16 v[192:195], a[240:243], a[32:35], v[192:195]
 ds_read_b128 a[224:227], v240 offset:24576
 v_mul_f32 v250, s36, v152
 m16 v[200:203], a[240:243], a[36:39], v[200:203]
 ds_read_b128 a[228:231], v240 offset:30720
 v_mul_f32 v251, s36, v153
 m16 v[196:199], a[244:247], a[32:35], v[196:199]
 ds_read_b128 a[232:235], v241 offset:24576
 m16 v[204:207], a[244:247], a[36:39], v[204:207]
 ds_read_b128 a[236:239], v241 offset:30720
 v_exp_f32 v250, v250
 m16 v[192:195], a[248:251], a[40:43], v[192:195]
 ds_read_b128 a[240:243], v240 offset:24704
 m16 v[200:203], a[248:251], a[44:47], v[200:203]
 ds_read_b128 a[244:247], v240 offset:30848
 v_exp_f32 v251, v251
 s_nop 0
 cvt v180, v250, v251
 v_add_f32 v169, v250, v251
 v_mul_f32 v250, s36, v154
 v_mul_f32 v251, s36, v155
 v_exp_f32 v250, v250
 v_exp_f32 v251, v251
 v_add_f32 v169, v169, v250
 v_add_f32 v169, v169, v251
 cvt v181, v250, v251
 v_mul_f32 v250, s36, v156
 v_mul_f32 v251, s36, v157
 v_exp_f32 v250, v250
 v_exp_f32 v251, v251
 v_add_f32 v169, v169, v250
 v_add_f32 v169, v169, v251
 cvt v182, v250, v251
 v_mul_f32 v250, s36, v158
 v_mul_f32 v251, s36, v159
 v_exp_f32 v250, v250
 v_exp_f32 v251, v251
 v_add_f32 v169, v169, v250
 v_add_f32 v169, v169, v251
 cvt v183, v250, v251
 v_add_f32 v250, v249, v169
 v_cmp_nge_f32 s[48:49], s37, v250
 m16 v[196:199], a[252:255], a[40:43], v[196:199]
 ds_read_b128 a[248:251], v241 offset:24704
 m16 v[204:207], a[252:255], a[44:47], v[204:207]
 ds_read_b128 a[252:255], v241 offset:30848
 s_cmp_lg_u64 s[48:49], 0
 s_cbranch_scc1 RS10_1
RB10_1:
 v_add_f32 v248, v248, v249
 v_add_f32 v168, v168, v169
 s_waitcnt lgkmcnt(4)
 m16 v[144:147], a[224:227], v[96:99], v[160:163]
 m16 v[152:155], a[224:227], v[100:103], v[164:167]
 ds_read_b128 a[224:227], v240 offset:24832
 m16 v[148:151], a[228:231], v[96:99], v[160:163]
 m16 v[156:159], a[228:231], v[100:103], v[164:167]
 ds_read_b128 a[228:231], v240 offset:30976
 m16 v[144:147], a[232:235], v[104:107], v[144:147]
 m16 v[152:155], a[232:235], v[108:111], v[152:155]
 ds_read_b128 a[232:235], v241 offset:24832
 cvt v192, v192, v193
 v_accvgpr_write_b32 a192, v192
 m16 v[148:151], a[236:239], v[104:107], v[148:151]
 cvt v194, v194, v195
 v_accvgpr_write_b32 a193, v194
 m16 v[156:159], a[236:239], v[108:111], v[156:159]
 ds_read_b128 a[236:239], v241 offset:30976
 cvt v196, v196, v197
 s_waitcnt lgkmcnt(2)
 m16 v[144:147], a[240:243], v[112:115], v[144:147]
 v_accvgpr_write_b32 a194, v196
 cvt v198, v198, v199
 m16 v[152:155], a[240:243], v[116:119], v[152:155]
 v_accvgpr_write_b32 a195, v198
 cvt v200, v200, v201
 v_accvgpr_write_b32 a196, v200
 m16 v[148:151], a[244:247], v[112:115], v[148:151]
 cvt v202, v202, v203
 v_accvgpr_write_b32 a197, v202
 m16 v[156:159], a[244:247], v[116:119], v[156:159]
 cvt v204, v204, v205
 v_accvgpr_write_b32 a198, v204
 cvt v206, v206, v207
 m16 v[144:147], a[248:251], v[120:123], v[144:147]
 rtr a[240:241], v242, 12288
 v_accvgpr_write_b32 a199, v206
 m16 v[152:155], a[248:251], v[124:127], v[152:155]
 rtr a[242:243], v242, 18432
 v_accvgpr_read_b32 v193, a200
 v_lshlrev_b32 v192, 16, v193
 m16 v[148:151], a[252:255], v[120:123], v[148:151]
 rtr a[244:245], v243, 12288
 v_and_b32 v193, 0xffff0000, v193
 m16 v[156:159], a[252:255], v[124:127], v[156:159]
 rtr a[246:247], v243, 18432
 v_accvgpr_read_b32 v195, a201
 v_lshlrev_b32 v194, 16, v195
 m16 v[144:147], a[224:227], v[128:131], v[144:147]
 rtr a[248:249], v244, 12288
 v_and_b32 v195, 0xffff0000, v195
 m16 v[152:155], a[224:227], v[132:135], v[152:155]
 rtr a[250:251], v244, 18432
 v_accvgpr_read_b32 v197, a202
 v_lshlrev_b32 v196, 16, v197
 m16 v[148:151], a[228:231], v[128:131], v[148:151]
 rtr a[252:253], v245, 12288
 v_and_b32 v197, 0xffff0000, v197
 m16 v[156:159], a[228:231], v[132:135], v[156:159]
 rtr a[254:255], v245, 18432
 v_accvgpr_read_b32 v199, a203
 s_waitcnt lgkmcnt(4)
 m16 v[144:147], a[232:235], v[136:139], v[144:147]
 rtr a[224:225], v242, 12416
 v_lshlrev_b32 v198, 16, v199
 m16 v[152:155], a[232:235], v[140:143], v[152:155]
 rtr a[226:227], v242, 18560
 v_and_b32 v199, 0xffff0000, v199
 v_accvgpr_read_b32 v201, a204
 m16 v[148:151], a[236:239], v[136:139], v[148:151]
 rtr a[228:229], v243, 12416
 v_lshlrev_b32 v200, 16, v201
 m16 v[156:159], a[236:239], v[140:143], v[156:159]
 rtr a[230:231], v243, 18560
 v_and_b32 v201, 0xffff0000, v201
 v_accvgpr_read_b32 v203, a205
 m16 v[0:3], a[240:243], v[176:179], v[0:3]
 rtr a[232:233], v244, 12416
 v_lshlrev_b32 v202, 16, v203
 m16 v[8:11], a[240:243], v[180:183], v[8:11]
 rtr a[234:235], v244, 18560
 v_and_b32 v203, 0xffff0000, v203
 v_accvgpr_read_b32 v205, a206
 m16 v[4:7], a[244:247], v[176:179], v[4:7]
 rtr a[236:237], v245, 12416
 v_lshlrev_b32 v204, 16, v205
 m16 v[12:15], a[244:247], v[180:183], v[12:15]
 rtr a[238:239], v245, 18560
 v_and_b32 v205, 0xffff0000, v205
 s_waitcnt lgkmcnt(4)
 m16 v[16:19], a[248:251], v[176:179], v[16:19]
 rtr a[240:241], v242, 12544
 v_accvgpr_read_b32 v207, a207
 m16 v[24:27], a[248:251], v[180:183], v[24:27]
 rtr a[242:243], v242, 18688
 v_lshlrev_b32 v206, 16, v207
 v_and_b32 v207, 0xffff0000, v207
 m16 v[20:23], a[252:255], v[176:179], v[20:23]
 rtr a[244:245], v243, 12544
 v_mul_f32 v250, s36, v144
 m16 v[28:31], a[252:255], v[180:183], v[28:31]
 rtr a[246:247], v243, 18688
 v_mul_f32 v251, s36, v145
 m16 v[32:35], a[224:227], v[176:179], v[32:35]
 rtr a[248:249], v244, 12544
 m16 v[40:43], a[224:227], v[180:183], v[40:43]
 rtr a[250:251], v244, 18688
 v_exp_f32 v250, v250
 m16 v[36:39], a[228:231], v[176:179], v[36:39]
 rtr a[252:253], v245, 12544
 m16 v[44:47], a[228:231], v[180:183], v[44:47]
 rtr a[254:255], v245, 18688
 s_waitcnt lgkmcnt(4)
 m16 v[48:51], a[232:235], v[176:179], v[48:51]
 rtr a[224:225], v174, 24576
 m16 v[56:59], a[232:235], v[180:183], v[56:59]
 rtr a[226:227], v174, 26624
 rtr a[228:229], v175, 24576
 m16 v[52:55], a[236:239], v[176:179], v[52:55]
 rtr a[230:231], v175, 26624
 m16 v[60:63], a[236:239], v[180:183], v[60:63]
 rtr a[232:233], v174, 28672
 rtr a[234:235], v174, 30720
 m16 v[64:67], a[240:243], v[176:179], v[64:67]
 rtr a[236:237], v175, 28672
 m16 v[72:75], a[240:243], v[180:183], v[72:75]
 rtr a[238:239], v175, 30720
 rtr a[240:241], v174, 32768
 m16 v[68:71], a[244:247], v[176:179], v[68:71]
 rtr a[242:243], v174, 34816
 m16 v[76:79], a[244:247], v[180:183], v[76:79]
 rtr a[244:245], v175, 32768
 rtr a[246:247], v175, 34816
 s_waitcnt lgkmcnt(6)
 m16 v[80:83], a[248:251], v[176:179], v[80:83]
 v_exp_f32 v251, v251
 m16 v[88:91], a[248:251], v[180:183], v[88:91]
 rtr a[248:249], v174
 rtr a[250:251], v174, 2048
 cvt v184, v250, v251
 m16 v[84:87], a[252:255], v[176:179], v[84:87]
 v_add_f32 v249, v250, v251
 v_mul_f32 v250, s36, v146
 m16 v[92:95], a[252:255], v[180:183], v[92:95]
 rtr a[252:253], v175
 rtr a[254:255], v175, 2048
 v_mul_f32 v251, s36, v147
 m16 v[192:195], a[224:227], a[0:3], v[192:195]
 v_exp_f32 v250, v250
 m16 v[200:203], a[224:227], a[4:7], v[200:203]
 rtr a[224:225], v174, 4096
 rtr a[226:227], v174, 6144
 m16 v[196:199], a[228:231], a[0:3], v[196:199]
 v_exp_f32 v251, v251
 m16 v[204:207], a[228:231], a[4:7], v[204:207]
 rtr a[228:229], v175, 4096
 rtr a[230:231], v175, 6144
 v_add_f32 v249, v249, v250
 m16 v[192:195], a[232:235], a[8:11], v[192:195]
 v_add_f32 v249, v249, v251
 cvt v185, v250, v251
 m16 v[200:203], a[232:235], a[12:15], v[200:203]
 rtr a[232:233], v174, 8192
 rtr a[234:235], v174, 10240
 s_waitcnt lgkmcnt(4)
 m16 v[196:199], a[236:239], a[8:11], v[196:199]
 v_mul_f32 v250, s36, v148
 v_mul_f32 v251, s36, v149
 m16 v[204:207], a[236:239], a[12:15], v[204:207]
 rtr a[236:237], v175, 8192
 rtr a[238:239], v175, 10240
 m16 v[192:195], a[240:243], a[16:19], v[192:195]
 v_exp_f32 v250, v250
 m16 v[200:203], a[240:243], a[20:23], v[200:203]
 v_exp_f32 v251, v251
 v_add_f32 v249, v249, v250
 m16 v[196:199], a[244:247], a[16:19], v[196:199]
 v_add_f32 v249, v249, v251
 cvt v186, v250, v251
 m16 v[204:207], a[244:247], a[20:23], v[204:207]
 v_mul_f32 v250, s36, v150
 v_mul_f32 v251, s36, v151
 m16 v[192:195], a[248:251], a[24:27], v[192:195]
 v_exp_f32 v250, v250
 m16 v[200:203], a[248:251], a[28:31], v[200:203]
 v_exp_f32 v251, v251
 v_add_f32 v249, v249, v250
 m16 v[196:199], a[252:255], a[24:27], v[196:199]
 v_add_f32 v249, v249, v251
 cvt v187, v250, v251
 m16 v[204:207], a[252:255], a[28:31], v[204:207]
 s_waitcnt lgkmcnt(0)
 s_barrier
 m16 v[192:195], a[224:227], a[32:35], v[192:195]
 ds_read_b128 a[240:243], v240
 v_mul_f32 v250, s36, v152
 m16 v[200:203], a[224:227], a[36:39], v[200:203]
 ds_read_b128 a[244:247], v240 offset:6144
 v_mul_f32 v251, s36, v153
 m16 v[196:199], a[228:231], a[32:35], v[196:199]
 ds_read_b128 a[248:251], v241
 m16 v[204:207], a[228:231], a[36:39], v[204:207]
 ds_read_b128 a[252:255], v241 offset:6144
 v_exp_f32 v250, v250
 m16 v[192:195], a[232:235], a[40:43], v[192:195]
 ds_read_b128 a[224:227], v240 offset:128
 m16 v[200:203], a[232:235], a[44:47], v[200:203]
 ds_read_b128 a[228:231], v240 offset:6272
 v_exp_f32 v251, v251
 s_nop 0
 cvt v188, v250, v251
 v_add_f32 v169, v250, v251
 v_mul_f32 v250, s36, v154
 v_mul_f32 v251, s36, v155
 v_exp_f32 v250, v250
 v_exp_f32 v251, v251
 v_add_f32 v169, v169, v250
 v_add_f32 v169, v169, v251
 cvt v189, v250, v251
 v_mul_f32 v250, s36, v156
 v_mul_f32 v251, s36, v157
 v_exp_f32 v250, v250
 v_exp_f32 v251, v251
 v_add_f32 v169, v169, v250
 v_add_f32 v169, v169, v251
 cvt v190, v250, v251
 v_mul_f32 v250, s36, v158
 v_mul_f32 v251, s36, v159
 v_exp_f32 v250, v250
 v_exp_f32 v251, v251
 v_add_f32 v169, v169, v250
 v_add_f32 v169, v169, v251
 cvt v191, v250, v251
 v_add_f32 v250, v249, v169
 v_cmp_nge_f32 s[48:49], s37, v250
 m16 v[196:199], a[236:239], a[40:43], v[196:199]
 ds_read_b128 a[232:235], v241 offset:128
 m16 v[204:207], a[236:239], a[44:47], v[204:207]
 ds_read_b128 a[236:239], v241 offset:6272
 s_cmp_lg_u64 s[48:49], 0
 s_cbranch_scc1 RS11_1
RB11_1:
 v_add_f32 v248, v248, v249
 v_add_f32 v168, v168, v169
 s_waitcnt lgkmcnt(4)
 m16 v[144:147], a[240:243], v[96:99], v[160:163]
 m16 v[152:155], a[240:243], v[100:103], v[164:167]
 ds_read_b128 a[240:243], v240 offset:256
 m16 v[148:151], a[244:247], v[96:99], v[160:163]
 m16 v[156:159], a[244:247], v[100:103], v[164:167]
 ds_read_b128 a[244:247], v240 offset:6400
 m16 v[144:147], a[248:251], v[104:107], v[144:147]
 m16 v[152:155], a[248:251], v[108:111], v[152:155]
 ds_read_b128 a[248:251], v241 offset:256
 cvt v192, v192, v193
 v_accvgpr_write_b32 a200, v192
 m16 v[148:151], a[252:255], v[104:107], v[148:151]
 cvt v194, v194, v195
 v_accvgpr_write_b32 a201, v194
 m16 v[156:159], a[252:255], v[108:111], v[156:159]
 ds_read_b128 a[252:255], v241 offset:6400
 cvt v196, v196, v197
 s_waitcnt lgkmcnt(2)
 m16 v[144:147], a[224:227], v[112:115], v[144:147]
 v_accvgpr_write_b32 a202, v196
 cvt v198, v198, v199
 m16 v[152:155], a[224:227], v[116:119], v[152:155]
 v_accvgpr_write_b32 a203, v198
 cvt v200, v200, v201
 v_accvgpr_write_b32 a204, v200
 m16 v[148:151], a[228:231], v[112:115], v[148:151]
 cvt v202, v202, v203
 v_accvgpr_write_b32 a205, v202
 m16 v[156:159], a[228:231], v[116:119], v[156:159]
 cvt v204, v204, v205
 v_accvgpr_write_b32 a206, v204
 cvt v206, v206, v207
 m16 v[144:147], a[232:235], v[120:123], v[144:147]
 rtr a[224:225], v242, 24576
 v_accvgpr_write_b32 a207, v206
 m16 v[152:155], a[232:235], v[124:127], v[152:155]
 rtr a[226:227], v242, 30720
 v_accvgpr_read_b32 v193, a208
 v_lshlrev_b32 v192, 16, v193
 m16 v[148:151], a[236:239], v[120:123], v[148:151]
 rtr a[228:229], v243, 24576
 v_and_b32 v193, 0xffff0000, v193
 m16 v[156:159], a[236:239], v[124:127], v[156:159]
 rtr a[230:231], v243, 30720
 v_accvgpr_read_b32 v195, a209
 v_lshlrev_b32 v194, 16, v195
 m16 v[144:147], a[240:243], v[128:131], v[144:147]
 rtr a[232:233], v244, 24576
 v_and_b32 v195, 0xffff0000, v195
 m16 v[152:155], a[240:243], v[132:135], v[152:155]
 rtr a[234:235], v244, 30720
 v_accvgpr_read_b32 v197, a210
 v_lshlrev_b32 v196, 16, v197
 m16 v[148:151], a[244:247], v[128:131], v[148:151]
 rtr a[236:237], v245, 24576
 v_and_b32 v197, 0xffff0000, v197
 m16 v[156:159], a[244:247], v[132:135], v[156:159]
 rtr a[238:239], v245, 30720
 v_accvgpr_read_b32 v199, a211
 s_waitcnt lgkmcnt(4)
 m16 v[144:147], a[248:251], v[136:139], v[144:147]
 rtr a[240:241], v242, 24704
 v_lshlrev_b32 v198, 16, v199
 m16 v[152:155], a[248:251], v[140:143], v[152:155]
 rtr a[242:243], v242, 30848
 v_and_b32 v199, 0xffff0000, v199
 v_accvgpr_read_b32 v201, a212
 m16 v[148:151], a[252:255], v[136:139], v[148:151]
 rtr a[244:245], v243, 24704
 v_lshlrev_b32 v200, 16, v201
 m16 v[156:159], a[252:255], v[140:143], v[156:159]
 rtr a[246:247], v243, 30848
 v_and_b32 v201, 0xffff0000, v201
 v_accvgpr_read_b32 v203, a213
 m16 v[0:3], a[224:227], v[184:187], v[0:3]
 rtr a[248:249], v244, 24704
 v_lshlrev_b32 v202, 16, v203
 m16 v[8:11], a[224:227], v[188:191], v[8:11]
 rtr a[250:251], v244, 30848
 v_and_b32 v203, 0xffff0000, v203
 v_accvgpr_read_b32 v205, a214
 m16 v[4:7], a[228:231], v[184:187], v[4:7]
 rtr a[252:253], v245, 24704
 v_lshlrev_b32 v204, 16, v205
 m16 v[12:15], a[228:231], v[188:191], v[12:15]
 rtr a[254:255], v245, 30848
 v_and_b32 v205, 0xffff0000, v205
 s_waitcnt lgkmcnt(4)
 m16 v[16:19], a[232:235], v[184:187], v[16:19]
 rtr a[224:225], v242, 24832
 v_accvgpr_read_b32 v207, a215
 m16 v[24:27], a[232:235], v[188:191], v[24:27]
 rtr a[226:227], v242, 30976
 v_lshlrev_b32 v206, 16, v207
 v_and_b32 v207, 0xffff0000, v207
 m16 v[20:23], a[236:239], v[184:187], v[20:23]
 rtr a[228:229], v243, 24832
 v_mul_f32 v250, s36, v144
 m16 v[28:31], a[236:239], v[188:191], v[28:31]
 rtr a[230:231], v243, 30976
 v_mul_f32 v251, s36, v145
 m16 v[32:35], a[240:243], v[184:187], v[32:35]
 rtr a[232:233], v244, 24832
 m16 v[40:43], a[240:243], v[188:191], v[40:43]
 rtr a[234:235], v244, 30976
 v_exp_f32 v250, v250
 m16 v[36:39], a[244:247], v[184:187], v[36:39]
 rtr a[236:237], v245, 24832
 m16 v[44:47], a[244:247], v[188:191], v[44:47]
 rtr a[238:239], v245, 30976
 s_waitcnt lgkmcnt(4)
 m16 v[48:51], a[248:251], v[184:187], v[48:51]
 rtr a[240:241], v172, 12288
 m16 v[56:59], a[248:251], v[188:191], v[56:59]
 rtr a[242:243], v172, 14336
 rtr a[244:245], v173, 12288
 m16 v[52:55], a[252:255], v[184:187], v[52:55]
 rtr a[246:247], v173, 14336
 m16 v[60:63], a[252:255], v[188:191], v[60:63]
 rtr a[248:249], v172, 16384
 rtr a[250:251], v172, 18432
 m16 v[64:67], a[224:227], v[184:187], v[64:67]
 rtr a[252:253], v173, 16384
 m16 v[72:75], a[224:227], v[188:191], v[72:75]
 rtr a[254:255], v173, 18432
 rtr a[224:225], v172, 20480
 m16 v[68:71], a[228:231], v[184:187], v[68:71]
 rtr a[226:227], v172, 22528
 m16 v[76:79], a[228:231], v[188:191], v[76:79]
 rtr a[228:229], v173, 20480
 rtr a[230:231], v173, 22528
 s_waitcnt lgkmcnt(6)
 m16 v[80:83], a[232:235], v[184:187], v[80:83]
 v_exp_f32 v251, v251
 m16 v[88:91], a[232:235], v[188:191], v[88:91]
 rtr a[232:233], v172, 36864
 rtr a[234:235], v172, 38912
 cvt v176, v250, v251
 m16 v[84:87], a[236:239], v[184:187], v[84:87]
 v_add_f32 v249, v250, v251
 v_mul_f32 v250, s36, v146
 m16 v[92:95], a[236:239], v[188:191], v[92:95]
 rtr a[236:237], v173, 36864
 rtr a[238:239], v173, 38912
 v_mul_f32 v251, s36, v147
 m16 v[192:195], a[240:243], a[0:3], v[192:195]
 v_exp_f32 v250, v250
 m16 v[200:203], a[240:243], a[4:7], v[200:203]
 rtr a[240:241], v172, 40960
 rtr a[242:243], v172, 43008
 m16 v[196:199], a[244:247], a[0:3], v[196:199]
 v_exp_f32 v251, v251
 m16 v[204:207], a[244:247], a[4:7], v[204:207]
 rtr a[244:245], v173, 40960
 rtr a[246:247], v173, 43008
 v_add_f32 v249, v249, v250
 m16 v[192:195], a[248:251], a[8:11], v[192:195]
 v_add_f32 v249, v249, v251
 cvt v177, v250, v251
 m16 v[200:203], a[248:251], a[12:15], v[200:203]
 rtr a[248:249], v172, 45056
 rtr a[250:251], v172, 47104
 s_waitcnt lgkmcnt(4)
 m16 v[196:199], a[252:255], a[8:11], v[196:199]
 v_mul_f32 v250, s36, v148
 v_mul_f32 v251, s36, v149
 m16 v[204:207], a[252:255], a[12:15], v[204:207]
 rtr a[252:253], v173, 45056
 rtr a[254:255], v173, 47104
 m16 v[192:195], a[224:227], a[16:19], v[192:195]
 v_exp_f32 v250, v250
 m16 v[200:203], a[224:227], a[20:23], v[200:203]
 v_exp_f32 v251, v251
 v_add_f32 v249, v249, v250
 m16 v[196:199], a[228:231], a[16:19], v[196:199]
 v_add_f32 v249, v249, v251
 cvt v178, v250, v251
 m16 v[204:207], a[228:231], a[20:23], v[204:207]
 v_mul_f32 v250, s36, v150
 v_mul_f32 v251, s36, v151
 m16 v[192:195], a[232:235], a[24:27], v[192:195]
 v_exp_f32 v250, v250
 m16 v[200:203], a[232:235], a[28:31], v[200:203]
 v_exp_f32 v251, v251
 v_add_f32 v249, v249, v250
 m16 v[196:199], a[236:239], a[24:27], v[196:199]
 v_add_f32 v249, v249, v251
 cvt v179, v250, v251
 m16 v[204:207], a[236:239], a[28:31], v[204:207]
 s_waitcnt lgkmcnt(0)
 s_barrier
 m16 v[192:195], a[240:243], a[32:35], v[192:195]
 ds_read_b128 a[224:227], v240 offset:12288
 v_mul_f32 v250, s36, v152
 m16 v[200:203], a[240:243], a[36:39], v[200:203]
 ds_read_b128 a[228:231], v240 offset:18432
 v_mul_f32 v251, s36, v153
 m16 v[196:199], a[244:247], a[32:35], v[196:199]
 ds_read_b128 a[232:235], v241 offset:12288
 m16 v[204:207], a[244:247], a[36:39], v[204:207]
 ds_read_b128 a[236:239], v241 offset:18432
 v_exp_f32 v250, v250
 m16 v[192:195], a[248:251], a[40:43], v[192:195]
 ds_read_b128 a[240:243], v240 offset:12416
 m16 v[200:203], a[248:251], a[44:47], v[200:203]
 ds_read_b128 a[244:247], v240 offset:18560
 v_exp_f32 v251, v251
 s_nop 0
 cvt v180, v250, v251
 v_add_f32 v169, v250, v251
 v_mul_f32 v250, s36, v154
 v_mul_f32 v251, s36, v155
 v_exp_f32 v250, v250
 v_exp_f32 v251, v251
 v_add_f32 v169, v169, v250
 v_add_f32 v169, v169, v251
 cvt v181, v250, v251
 v_mul_f32 v250, s36, v156
 v_mul_f32 v251, s36, v157
 v_exp_f32 v250, v250
 v_exp_f32 v251, v251
 v_add_f32 v169, v169, v250
 v_add_f32 v169, v169, v251
 cvt v182, v250, v251
 v_mul_f32 v250, s36, v158
 v_mul_f32 v251, s36, v159
 v_exp_f32 v250, v250
 v_exp_f32 v251, v251
 v_add_f32 v169, v169, v250
 v_add_f32 v169, v169, v251
 cvt v183, v250, v251
 v_add_f32 v250, v249, v169
 v_cmp_nge_f32 s[48:49], s37, v250
 m16 v[196:199], a[252:255], a[40:43], v[196:199]
 ds_read_b128 a[248:251], v241 offset:12416
 m16 v[204:207], a[252:255], a[44:47], v[204:207]
 ds_read_b128 a[252:255], v241 offset:18560
 s_cmp_lg_u64 s[48:49], 0
 s_cbranch_scc1 RS12_1
RB12_1:
 v_add_f32 v248, v248, v249
 v_add_f32 v168, v168, v169
 s_waitcnt lgkmcnt(4)
 m16 v[144:147], a[224:227], v[96:99], v[160:163]
 m16 v[152:155], a[224:227], v[100:103], v[164:167]
 ds_read_b128 a[224:227], v240 offset:12544
 m16 v[148:151], a[228:231], v[96:99], v[160:163]
 m16 v[156:159], a[228:231], v[100:103], v[164:167]
 ds_read_b128 a[228:231], v240 offset:18688
 m16 v[144:147], a[232:235], v[104:107], v[144:147]
 m16 v[152:155], a[232:235], v[108:111], v[152:155]
 ds_read_b128 a[232:235], v241 offset:12544
 cvt v192, v192, v193
 v_accvgpr_write_b32 a208, v192
 m16 v[148:151], a[236:239], v[104:107], v[148:151]
 cvt v194, v194, v195
 v_accvgpr_write_b32 a209, v194
 m16 v[156:159], a[236:239], v[108:111], v[156:159]
 ds_read_b128 a[236:239], v241 offset:18688
 cvt v196, v196, v197
 s_waitcnt lgkmcnt(2)
 m16 v[144:147], a[240:243], v[112:115], v[144:147]
 v_accvgpr_write_b32 a210, v196
 cvt v198, v198, v199
 m16 v[152:155], a[240:243], v[116:119], v[152:155]
 v_accvgpr_write_b32 a211, v198
 cvt v200, v200, v201
 v_accvgpr_write_b32 a212, v200
 m16 v[148:151], a[244:247], v[112:115], v[148:151]
 cvt v202, v202, v203
 v_accvgpr_write_b32 a213, v202
 m16 v[156:159], a[244:247], v[116:119], v[156:159]
 cvt v204, v204, v205
 v_accvgpr_write_b32 a214, v204
 cvt v206, v206, v207
 m16 v[144:147], a[248:251], v[120:123], v[144:147]
 rtr a[240:241], v242
 v_accvgpr_write_b32 a215, v206
 m16 v[152:155], a[248:251], v[124:127], v[152:155]
 rtr a[242:243], v242, 6144
 v_accvgpr_read_b32 v193, a216
 v_lshlrev_b32 v192, 16, v193
 m16 v[148:151], a[252:255], v[120:123], v[148:151]
 rtr a[244:245], v243
 v_and_b32 v193, 0xffff0000, v193
 m16 v[156:159], a[252:255], v[124:127], v[156:159]
 rtr a[246:247], v243, 6144
 v_accvgpr_read_b32 v195, a217
 v_lshlrev_b32 v194, 16, v195
 m16 v[144:147], a[224:227], v[128:131], v[144:147]
 rtr a[248:249], v244
 v_and_b32 v195, 0xffff0000, v195
 m16 v[152:155], a[224:227], v[132:135], v[152:155]
 rtr a[250:251], v244, 6144
 v_accvgpr_read_b32 v197, a218
 v_lshlrev_b32 v196, 16, v197
 m16 v[148:151], a[228:231], v[128:131], v[148:151]
 rtr a[252:253], v245
 v_and_b32 v197, 0xffff0000, v197
 m16 v[156:159], a[228:231], v[132:135], v[156:159]
 rtr a[254:255], v245, 6144
 v_accvgpr_read_b32 v199, a219
 s_waitcnt lgkmcnt(4)
 m16 v[144:147], a[232:235], v[136:139], v[144:147]
 rtr a[224:225], v242, 128
 v_lshlrev_b32 v198, 16, v199
 m16 v[152:155], a[232:235], v[140:143], v[152:155]
 rtr a[226:227], v242, 6272
 v_and_b32 v199, 0xffff0000, v199
 v_accvgpr_read_b32 v201, a220
 m16 v[148:151], a[236:239], v[136:139], v[148:151]
 rtr a[228:229], v243, 128
 v_lshlrev_b32 v200, 16, v201
 m16 v[156:159], a[236:239], v[140:143], v[156:159]
 rtr a[230:231], v243, 6272
 v_and_b32 v201, 0xffff0000, v201
 v_accvgpr_read_b32 v203, a221
 m16 v[0:3], a[240:243], v[176:179], v[0:3]
 rtr a[232:233], v244, 128
 v_lshlrev_b32 v202, 16, v203
 m16 v[8:11], a[240:243], v[180:183], v[8:11]
 rtr a[234:235], v244, 6272
 v_and_b32 v203, 0xffff0000, v203
 v_accvgpr_read_b32 v205, a222
 m16 v[4:7], a[244:247], v[176:179], v[4:7]
 rtr a[236:237], v245, 128
 v_lshlrev_b32 v204, 16, v205
 m16 v[12:15], a[244:247], v[180:183], v[12:15]
 rtr a[238:239], v245, 6272
 v_and_b32 v205, 0xffff0000, v205
 s_waitcnt lgkmcnt(4)
 m16 v[16:19], a[248:251], v[176:179], v[16:19]
 rtr a[240:241], v242, 256
 v_accvgpr_read_b32 v207, a223
 m16 v[24:27], a[248:251], v[180:183], v[24:27]
 rtr a[242:243], v242, 6400
 v_lshlrev_b32 v206, 16, v207
 v_and_b32 v207, 0xffff0000, v207
 m16 v[20:23], a[252:255], v[176:179], v[20:23]
 rtr a[244:245], v243, 256
 v_mul_f32 v250, s36, v144
 m16 v[28:31], a[252:255], v[180:183], v[28:31]
 rtr a[246:247], v243, 6400
 v_mul_f32 v251, s36, v145
 m16 v[32:35], a[224:227], v[176:179], v[32:35]
 rtr a[248:249], v244, 256
 m16 v[40:43], a[224:227], v[180:183], v[40:43]
 rtr a[250:251], v244, 6400
 v_exp_f32 v250, v250
 m16 v[36:39], a[228:231], v[176:179], v[36:39]
 rtr a[252:253], v245, 256
 m16 v[44:47], a[228:231], v[180:183], v[44:47]
 rtr a[254:255], v245, 6400
 s_waitcnt lgkmcnt(4)
 m16 v[48:51], a[232:235], v[176:179], v[48:51]
 rtr a[224:225], v174, 12288
 m16 v[56:59], a[232:235], v[180:183], v[56:59]
 rtr a[226:227], v174, 14336
 rtr a[228:229], v175, 12288
 m16 v[52:55], a[236:239], v[176:179], v[52:55]
 rtr a[230:231], v175, 14336
 m16 v[60:63], a[236:239], v[180:183], v[60:63]
 rtr a[232:233], v174, 16384
 rtr a[234:235], v174, 18432
 m16 v[64:67], a[240:243], v[176:179], v[64:67]
 rtr a[236:237], v175, 16384
 m16 v[72:75], a[240:243], v[180:183], v[72:75]
 rtr a[238:239], v175, 18432
 rtr a[240:241], v174, 20480
 m16 v[68:71], a[244:247], v[176:179], v[68:71]
 rtr a[242:243], v174, 22528
 m16 v[76:79], a[244:247], v[180:183], v[76:79]
 rtr a[244:245], v175, 20480
 rtr a[246:247], v175, 22528
 s_waitcnt lgkmcnt(6)
 m16 v[80:83], a[248:251], v[176:179], v[80:83]
 v_exp_f32 v251, v251
 m16 v[88:91], a[248:251], v[180:183], v[88:91]
 rtr a[248:249], v174, 36864
 rtr a[250:251], v174, 38912
 cvt v184, v250, v251
 m16 v[84:87], a[252:255], v[176:179], v[84:87]
 v_add_f32 v249, v250, v251
 v_mul_f32 v250, s36, v146
 m16 v[92:95], a[252:255], v[180:183], v[92:95]
 rtr a[252:253], v175, 36864
 rtr a[254:255], v175, 38912
 v_mul_f32 v251, s36, v147
 m16 v[192:195], a[224:227], a[0:3], v[192:195]
 v_exp_f32 v250, v250
 m16 v[200:203], a[224:227], a[4:7], v[200:203]
 rtr a[224:225], v174, 40960
 rtr a[226:227], v174, 43008
 m16 v[196:199], a[228:231], a[0:3], v[196:199]
 v_exp_f32 v251, v251
 m16 v[204:207], a[228:231], a[4:7], v[204:207]
 rtr a[228:229], v175, 40960
 rtr a[230:231], v175, 43008
 v_add_f32 v249, v249, v250
 m16 v[192:195], a[232:235], a[8:11], v[192:195]
 v_add_f32 v249, v249, v251
 cvt v185, v250, v251
 m16 v[200:203], a[232:235], a[12:15], v[200:203]
 rtr a[232:233], v174, 45056
 rtr a[234:235], v174, 47104
 s_waitcnt lgkmcnt(4)
 m16 v[196:199], a[236:239], a[8:11], v[196:199]
 v_mul_f32 v250, s36, v148
 v_mul_f32 v251, s36, v149
 m16 v[204:207], a[236:239], a[12:15], v[204:207]
 rtr a[236:237], v175, 45056
 rtr a[238:239], v175, 47104
 m16 v[192:195], a[240:243], a[16:19], v[192:195]
 v_exp_f32 v250, v250
 m16 v[200:203], a[240:243], a[20:23], v[200:203]
 v_exp_f32 v251, v251
 v_add_f32 v249, v249, v250
 m16 v[196:199], a[244:247], a[16:19], v[196:199]
 v_add_f32 v249, v249, v251
 cvt v186, v250, v251
 m16 v[204:207], a[244:247], a[20:23], v[204:207]
 v_mul_f32 v250, s36, v150
 v_mul_f32 v251, s36, v151
 m16 v[192:195], a[248:251], a[24:27], v[192:195]
 v_exp_f32 v250, v250
 m16 v[200:203], a[248:251], a[28:31], v[200:203]
 v_exp_f32 v251, v251
 v_add_f32 v249, v249, v250
 m16 v[196:199], a[252:255], a[24:27], v[196:199]
 v_add_f32 v249, v249, v251
 cvt v187, v250, v251
 m16 v[204:207], a[252:255], a[28:31], v[204:207]
 s_waitcnt lgkmcnt(0)
 s_barrier
 m16 v[192:195], a[224:227], a[32:35], v[192:195]
 ds_read_b128 a[240:243], v240 offset:24576
 v_mul_f32 v250, s36, v152
 m16 v[200:203], a[224:227], a[36:39], v[200:203]
 ds_read_b128 a[244:247], v240 offset:30720
 v_mul_f32 v251, s36, v153
 m16 v[196:199], a[228:231], a[32:35], v[196:199]
 ds_read_b128 a[248:251], v241 offset:24576
 m16 v[204:207], a[228:231], a[36:39], v[204:207]
 ds_read_b128 a[252:255], v241 offset:30720
 v_exp_f32 v250, v250
 m16 v[192:195], a[232:235], a[40:43], v[192:195]
 ds_read_b128 a[224:227], v240 offset:24704
 m16 v[200:203], a[232:235], a[44:47], v[200:203]
 ds_read_b128 a[228:231], v240 offset:30848
 v_exp_f32 v251, v251
 s_nop 0
 cvt v188, v250, v251
 v_add_f32 v169, v250, v251
 v_mul_f32 v250, s36, v154
 v_mul_f32 v251, s36, v155
 v_exp_f32 v250, v250
 v_exp_f32 v251, v251
 v_add_f32 v169, v169, v250
 v_add_f32 v169, v169, v251
 cvt v189, v250, v251
 v_mul_f32 v250, s36, v156
 v_mul_f32 v251, s36, v157
 v_exp_f32 v250, v250
 v_exp_f32 v251, v251
 v_add_f32 v169, v169, v250
 v_add_f32 v169, v169, v251
 cvt v190, v250, v251
 v_mul_f32 v250, s36, v158
 v_mul_f32 v251, s36, v159
 v_exp_f32 v250, v250
 v_exp_f32 v251, v251
 v_add_f32 v169, v169, v250
 v_add_f32 v169, v169, v251
 cvt v191, v250, v251
 v_add_f32 v250, v249, v169
 v_cmp_nge_f32 s[48:49], s37, v250
 m16 v[196:199], a[236:239], a[40:43], v[196:199]
 ds_read_b128 a[232:235], v241 offset:24704
 m16 v[204:207], a[236:239], a[44:47], v[204:207]
 ds_read_b128 a[236:239], v241 offset:30848
 s_cmp_lg_u64 s[48:49], 0
 s_cbranch_scc1 RS13_1
RB13_1:
 v_add_f32 v248, v248, v249
 v_add_f32 v168, v168, v169
 s_waitcnt lgkmcnt(4)
 m16 v[144:147], a[240:243], v[96:99], v[160:163]
 m16 v[152:155], a[240:243], v[100:103], v[164:167]
 ds_read_b128 a[240:243], v240 offset:24832
 m16 v[148:151], a[244:247], v[96:99], v[160:163]
 m16 v[156:159], a[244:247], v[100:103], v[164:167]
 ds_read_b128 a[244:247], v240 offset:30976
 m16 v[144:147], a[248:251], v[104:107], v[144:147]
 m16 v[152:155], a[248:251], v[108:111], v[152:155]
 ds_read_b128 a[248:251], v241 offset:24832
 cvt v192, v192, v193
 v_accvgpr_write_b32 a216, v192
 m16 v[148:151], a[252:255], v[104:107], v[148:151]
 cvt v194, v194, v195
 v_accvgpr_write_b32 a217, v194
 m16 v[156:159], a[252:255], v[108:111], v[156:159]
 ds_read_b128 a[252:255], v241 offset:30976
 cvt v196, v196, v197
 s_waitcnt lgkmcnt(2)
 m16 v[144:147], a[224:227], v[112:115], v[144:147]
 v_accvgpr_write_b32 a218, v196
 cvt v198, v198, v199
 m16 v[152:155], a[224:227], v[116:119], v[152:155]
 v_accvgpr_write_b32 a219, v198
 cvt v200, v200, v201
 v_accvgpr_write_b32 a220, v200
 m16 v[148:151], a[228:231], v[112:115], v[148:151]
 cvt v202, v202, v203
 v_accvgpr_write_b32 a221, v202
 m16 v[156:159], a[228:231], v[116:119], v[156:159]
 cvt v204, v204, v205
 v_accvgpr_write_b32 a222, v204
 cvt v206, v206, v207
 m16 v[144:147], a[232:235], v[120:123], v[144:147]
 rtr a[224:225], v242, 12288
 v_accvgpr_write_b32 a223, v206
 m16 v[152:155], a[232:235], v[124:127], v[152:155]
 rtr a[226:227], v242, 18432
 v_lshlrev_b32 v192, 16, v208
 v_and_b32 v193, 0xffff0000, v208
 m16 v[148:151], a[236:239], v[120:123], v[148:151]
 rtr a[228:229], v243, 12288
 v_lshlrev_b32 v194, 16, v209
 m16 v[156:159], a[236:239], v[124:127], v[156:159]
 rtr a[230:231], v243, 18432
 v_and_b32 v195, 0xffff0000, v209
 v_lshlrev_b32 v196, 16, v210
 m16 v[144:147], a[240:243], v[128:131], v[144:147]
 rtr a[232:233], v244, 12288
 v_and_b32 v197, 0xffff0000, v210
 m16 v[152:155], a[240:243], v[132:135], v[152:155]
 rtr a[234:235], v244, 18432
 v_lshlrev_b32 v198, 16, v211
 v_and_b32 v199, 0xffff0000, v211
 m16 v[148:151], a[244:247], v[128:131], v[148:151]
 rtr a[236:237], v245, 12288
 v_lshlrev_b32 v200, 16, v212
 m16 v[156:159], a[244:247], v[132:135], v[156:159]
 rtr a[238:239], v245, 18432
 v_and_b32 v201, 0xffff0000, v212
 s_waitcnt lgkmcnt(4)
 m16 v[144:147], a[248:251], v[136:139], v[144:147]
 rtr a[240:241], v242, 12416
 v_lshlrev_b32 v202, 16, v213
 m16 v[152:155], a[248:251], v[140:143], v[152:155]
 rtr a[242:243], v242, 18560
 v_and_b32 v203, 0xffff0000, v213
 v_lshlrev_b32 v204, 16, v214
 m16 v[148:151], a[252:255], v[136:139], v[148:151]
 rtr a[244:245], v243, 12416
 v_and_b32 v205, 0xffff0000, v214
 m16 v[156:159], a[252:255], v[140:143], v[156:159]
 rtr a[246:247], v243, 18560
 v_lshlrev_b32 v206, 16, v215
 v_and_b32 v207, 0xffff0000, v215
 m16 v[0:3], a[224:227], v[184:187], v[0:3]
 rtr a[248:249], v244, 12416
 m16 v[8:11], a[224:227], v[188:191], v[8:11]
 rtr a[250:251], v244, 18560
 m16 v[4:7], a[228:231], v[184:187], v[4:7]
 rtr a[252:253], v245, 12416
 m16 v[12:15], a[228:231], v[188:191], v[12:15]
 rtr a[254:255], v245, 18560
 s_waitcnt lgkmcnt(4)
 m16 v[16:19], a[232:235], v[184:187], v[16:19]
 rtr a[224:225], v242, 12544
 m16 v[24:27], a[232:235], v[188:191], v[24:27]
 rtr a[226:227], v242, 18688
 v_mul_f32 v250, s36, v144
 v_mul_f32 v251, s36, v145
 m16 v[20:23], a[236:239], v[184:187], v[20:23]
 rtr a[228:229], v243, 12544
 m16 v[28:31], a[236:239], v[188:191], v[28:31]
 rtr a[230:231], v243, 18688
 v_exp_f32 v250, v250
 m16 v[32:35], a[240:243], v[184:187], v[32:35]
 rtr a[232:233], v244, 12544
 m16 v[40:43], a[240:243], v[188:191], v[40:43]
 rtr a[234:235], v244, 18688
 v_exp_f32 v251, v251
 m16 v[36:39], a[244:247], v[184:187], v[36:39]
 rtr a[236:237], v245, 12544
 cvt v176, v250, v251
 m16 v[44:47], a[244:247], v[188:191], v[44:47]
 rtr a[238:239], v245, 18688
 v_add_f32 v249, v250, v251
 s_waitcnt lgkmcnt(4)
 m16 v[48:51], a[248:251], v[184:187], v[48:51]
 rtr a[240:241], v172, 24576
 v_mul_f32 v250, s36, v146
 m16 v[56:59], a[248:251], v[188:191], v[56:59]
 rtr a[242:243], v172, 26624
 rtr a[244:245], v173, 24576
 v_mul_f32 v251, s36, v147
 m16 v[52:55], a[252:255], v[184:187], v[52:55]
 rtr a[246:247], v173, 26624
 m16 v[60:63], a[252:255], v[188:191], v[60:63]
 rtr a[248:249], v172, 28672
 rtr a[250:251], v172, 30720
 m16 v[64:67], a[224:227], v[184:187], v[64:67]
 rtr a[252:253], v173, 28672
 m16 v[72:75], a[224:227], v[188:191], v[72:75]
 rtr a[254:255], v173, 30720
 rtr a[224:225], v172, 32768
 m16 v[68:71], a[228:231], v[184:187], v[68:71]
 rtr a[226:227], v172, 34816
 m16 v[76:79], a[228:231], v[188:191], v[76:79]
 rtr a[228:229], v173, 32768
 rtr a[230:231], v173, 34816
 s_waitcnt lgkmcnt(6)
 m16 v[80:83], a[232:235], v[184:187], v[80:83]
 v_exp_f32 v250, v250
 m16 v[88:91], a[232:235], v[188:191], v[88:91]
 rtr a[232:233], v172
 rtr a[234:235], v172, 2048
 m16 v[84:87], a[236:239], v[184:187], v[84:87]
 v_exp_f32 v251, v251
 m16 v[92:95], a[236:239], v[188:191], v[92:95]
 rtr a[236:237], v173
 rtr a[238:239], v173, 2048
 v_add_f32 v249, v249, v250
 m16 v[192:195], a[240:243], a[0:3], v[192:195]
 v_add_f32 v249, v249, v251
 cvt v177, v250, v251
 m16 v[200:203], a[240:243], a[4:7], v[200:203]
 rtr a[240:241], v172, 4096
 rtr a[242:243], v172, 6144
 v_mul_f32 v250, s36, v148
 m16 v[196:199], a[244:247], a[0:3], v[196:199]
 v_mul_f32 v251, s36, v149
 m16 v[204:207], a[244:247], a[4:7], v[204:207]
 rtr a[244:245], v173, 4096
 rtr a[246:247], v173, 6144
 m16 v[192:195], a[248:251], a[8:11], v[192:195]
 v_exp_f32 v250, v250
 m16 v[200:203], a[248:251], a[12:15], v[200:203]
 rtr a[248:249], v172, 8192
 rtr a[250:251], v172, 10240
 s_waitcnt lgkmcnt(4)
 m16 v[196:199], a[252:255], a[8:11], v[196:199]
 v_exp_f32 v251, v251
 m16 v[204:207], a[252:255], a[12:15], v[204:207]
 rtr a[252:253], v173, 8192
 rtr a[254:255], v173, 10240
 v_add_f32 v249, v249, v250
 m16 v[192:195], a[224:227], a[16:19], v[192:195]
 v_add_f32 v249, v249, v251
 cvt v178, v250, v251
 m16 v[200:203], a[224:227], a[20:23], v[200:203]
 v_mul_f32 v250, s36, v150
 v_mul_f32 v251, s36, v151
 m16 v[196:199], a[228:231], a[16:19], v[196:199]
 v_exp_f32 v250, v250
 m16 v[204:207], a[228:231], a[20:23], v[204:207]
 v_exp_f32 v251, v251
 v_add_f32 v249, v249, v250
 m16 v[192:195], a[232:235], a[24:27], v[192:195]
 v_add_f32 v249, v249, v251
 cvt v179, v250, v251
 m16 v[200:203], a[232:235], a[28:31], v[200:203]
 v_mul_f32 v250, s36, v152
 v_mul_f32 v251, s36, v153
 m16 v[196:199], a[236:239], a[24:27], v[196:199]
 v_exp_f32 v250, v250
 m16 v[204:207], a[236:239], a[28:31], v[204:207]
 s_waitcnt lgkmcnt(0)
 s_barrier
 m16 v[192:195], a[240:243], a[32:35], v[192:195]
 ds_read_b128 a[224:227], v240
 m16 v[200:203], a[240:243], a[36:39], v[200:203]
 ds_read_b128 a[228:231], v240 offset:6144
 v_exp_f32 v251, v251
 m16 v[196:199], a[244:247], a[32:35], v[196:199]
 ds_read_b128 a[232:235], v241
 cvt v180, v250, v251
 m16 v[204:207], a[244:247], a[36:39], v[204:207]
 ds_read_b128 a[236:239], v241 offset:6144
 v_add_f32 v169, v250, v251
 v_mul_f32 v250, s36, v154
 m16 v[192:195], a[248:251], a[40:43], v[192:195]
 ds_read_b128 a[240:243], v240 offset:128
 v_mul_f32 v251, s36, v155
 m16 v[200:203], a[248:251], a[44:47], v[200:203]
 ds_read_b128 a[244:247], v240 offset:6272
 v_exp_f32 v250, v250
 v_exp_f32 v251, v251
 v_add_f32 v169, v169, v250
 v_add_f32 v169, v169, v251
 cvt v181, v250, v251
 v_mul_f32 v250, s36, v156
 v_mul_f32 v251, s36, v157
 v_exp_f32 v250, v250
 v_exp_f32 v251, v251
 v_add_f32 v169, v169, v250
 v_add_f32 v169, v169, v251
 cvt v182, v250, v251
 v_mul_f32 v250, s36, v158
 v_mul_f32 v251, s36, v159
 v_exp_f32 v250, v250
 v_exp_f32 v251, v251
 v_add_f32 v169, v169, v250
 v_add_f32 v169, v169, v251
 cvt v183, v250, v251
 v_add_f32 v250, v249, v169
 v_cmp_nge_f32 s[48:49], s37, v250
 m16 v[196:199], a[252:255], a[40:43], v[196:199]
 ds_read_b128 a[248:251], v241 offset:128
 m16 v[204:207], a[252:255], a[44:47], v[204:207]
 ds_read_b128 a[252:255], v241 offset:6272
 s_cmp_lg_u64 s[48:49], 0
 s_cbranch_scc1 RS14_1
RB14_1:
 v_add_f32 v248, v248, v249
 v_add_f32 v168, v168, v169
 s_waitcnt lgkmcnt(4)
 m16 v[144:147], a[224:227], v[96:99], v[160:163]
 m16 v[152:155], a[224:227], v[100:103], v[164:167]
 ds_read_b128 a[224:227], v240 offset:256
 m16 v[148:151], a[228:231], v[96:99], v[160:163]
 m16 v[156:159], a[228:231], v[100:103], v[164:167]
 ds_read_b128 a[228:231], v240 offset:6400
 m16 v[144:147], a[232:235], v[104:107], v[144:147]
 m16 v[152:155], a[232:235], v[108:111], v[152:155]
 ds_read_b128 a[232:235], v241 offset:256
 cvt v208, v192, v193
 cvt v209, v194, v195
 m16 v[148:151], a[236:239], v[104:107], v[148:151]
 cvt v210, v196, v197
 cvt v211, v198, v199
 m16 v[156:159], a[236:239], v[108:111], v[156:159]
 ds_read_b128 a[236:239], v241 offset:6400
 cvt v212, v200, v201
 s_waitcnt lgkmcnt(2)
 m16 v[144:147], a[240:243], v[112:115], v[144:147]
 cvt v213, v202, v203
 cvt v214, v204, v205
 m16 v[152:155], a[240:243], v[116:119], v[152:155]
 cvt v215, v206, v207
 v_lshlrev_b32 v192, 16, v216
 v_and_b32 v193, 0xffff0000, v216
 m16 v[148:151], a[244:247], v[112:115], v[148:151]
 v_lshlrev_b32 v194, 16, v217
 v_and_b32 v195, 0xffff0000, v217
 m16 v[156:159], a[244:247], v[116:119], v[156:159]
 v_lshlrev_b32 v196, 16, v218
 v_and_b32 v197, 0xffff0000, v218
 v_lshlrev_b32 v198, 16, v219
 m16 v[144:147], a[248:251], v[120:123], v[144:147]
 v_and_b32 v199, 0xffff0000, v219
 v_lshlrev_b32 v200, 16, v220
 m16 v[152:155], a[248:251], v[124:127], v[152:155]
 v_and_b32 v201, 0xffff0000, v220
 v_lshlrev_b32 v202, 16, v221
 v_and_b32 v203, 0xffff0000, v221
 m16 v[148:151], a[252:255], v[120:123], v[148:151]
 v_lshlrev_b32 v204, 16, v222
 v_and_b32 v205, 0xffff0000, v222
 m16 v[156:159], a[252:255], v[124:127], v[156:159]
 s_waitcnt lgkmcnt(0)
 s_barrier
 m16 v[144:147], a[224:227], v[128:131], v[144:147]
 rtr a[240:241], v242, 24576
 v_lshlrev_b32 v206, 16, v223
 m16 v[152:155], a[224:227], v[132:135], v[152:155]
 rtr a[242:243], v242, 30720
 rtr a[244:245], v243, 24576
 v_and_b32 v207, 0xffff0000, v223
 m16 v[148:151], a[228:231], v[128:131], v[148:151]
 rtr a[246:247], v243, 30720
 m16 v[156:159], a[228:231], v[132:135], v[156:159]
 rtr a[248:249], v244, 24576
 rtr a[250:251], v244, 30720
 m16 v[144:147], a[232:235], v[136:139], v[144:147]
 rtr a[252:253], v245, 24576
 m16 v[152:155], a[232:235], v[140:143], v[152:155]
 rtr a[254:255], v245, 30720
 m16 v[148:151], a[236:239], v[136:139], v[148:151]
 rtr a[224:225], v242, 24704
 m16 v[156:159], a[236:239], v[140:143], v[156:159]
 rtr a[226:227], v242, 30848
 s_waitcnt lgkmcnt(4)
 m16 v[0:3], a[240:243], v[176:179], v[0:3]
 rtr a[228:229], v243, 24704
 m16 v[8:11], a[240:243], v[180:183], v[8:11]
 rtr a[230:231], v243, 30848
 m16 v[4:7], a[244:247], v[176:179], v[4:7]
 rtr a[232:233], v244, 24704
 m16 v[12:15], a[244:247], v[180:183], v[12:15]
 rtr a[234:235], v244, 30848
 m16 v[16:19], a[248:251], v[176:179], v[16:19]
 rtr a[236:237], v245, 24704
 m16 v[24:27], a[248:251], v[180:183], v[24:27]
 rtr a[238:239], v245, 30848
 v_mul_f32 v250, s36, v144
 s_waitcnt lgkmcnt(4)
 m16 v[20:23], a[252:255], v[176:179], v[20:23]
 rtr a[240:241], v242, 24832
 v_mul_f32 v251, s36, v145
 m16 v[28:31], a[252:255], v[180:183], v[28:31]
 rtr a[242:243], v242, 30976
 v_exp_f32 v250, v250
 m16 v[32:35], a[224:227], v[176:179], v[32:35]
 rtr a[244:245], v243, 24832
 m16 v[40:43], a[224:227], v[180:183], v[40:43]
 rtr a[246:247], v243, 30976
 v_exp_f32 v251, v251
 m16 v[36:39], a[228:231], v[176:179], v[36:39]
 rtr a[248:249], v244, 24832
 cvt v184, v250, v251
 m16 v[44:47], a[228:231], v[180:183], v[44:47]
 rtr a[250:251], v244, 30976
 v_add_f32 v249, v250, v251
 s_waitcnt lgkmcnt(4)
 m16 v[48:51], a[232:235], v[176:179], v[48:51]
 rtr a[252:253], v245, 24832
 v_mul_f32 v250, s36, v146
 m16 v[56:59], a[232:235], v[180:183], v[56:59]
 rtr a[254:255], v245, 30976
 rtr a[224:225], v174, 24576
 v_mul_f32 v251, s36, v147
 m16 v[52:55], a[236:239], v[176:179], v[52:55]
 rtr a[226:227], v174, 26624
 m16 v[60:63], a[236:239], v[180:183], v[60:63]
 rtr a[228:229], v175, 24576
 rtr a[230:231], v175, 26624
 m16 v[64:67], a[240:243], v[176:179], v[64:67]
 rtr a[232:233], v174, 28672
 m16 v[72:75], a[240:243], v[180:183], v[72:75]
 rtr a[234:235], v174, 30720
 rtr a[236:237], v175, 28672
 s_waitcnt lgkmcnt(6)
 m16 v[68:71], a[244:247], v[176:179], v[68:71]
 rtr a[238:239], v175, 30720
 m16 v[76:79], a[244:247], v[180:183], v[76:79]
 rtr a[240:241], v174, 32768
 rtr a[242:243], v174, 34816
 m16 v[80:83], a[248:251], v[176:179], v[80:83]
 rtr a[244:245], v175, 32768
 m16 v[88:91], a[248:251], v[180:183], v[88:91]
 rtr a[246:247], v175, 34816
 rtr a[248:249], v174
 m16 v[84:87], a[252:255], v[176:179], v[84:87]
 rtr a[250:251], v174, 2048
 m16 v[92:95], a[252:255], v[180:183], v[92:95]
 rtr a[252:253], v175
 rtr a[254:255], v175, 2048
 s_waitcnt lgkmcnt(6)
 m16 v[192:195], a[224:227], a[0:3], v[192:195]
 v_exp_f32 v250, v250
 m16 v[200:203], a[224:227], a[4:7], v[200:203]
 rtr a[224:225], v174, 4096
 rtr a[226:227], v174, 6144
 m16 v[196:199], a[228:231], a[0:3], v[196:199]
 v_exp_f32 v251, v251
 m16 v[204:207], a[228:231], a[4:7], v[204:207]
 rtr a[228:229], v175, 4096
 rtr a[230:231], v175, 6144
 v_add_f32 v249, v249, v250
 m16 v[192:195], a[232:235], a[8:11], v[192:195]
 v_add_f32 v249, v249, v251
 cvt v185, v250, v251
 m16 v[200:203], a[232:235], a[12:15], v[200:203]
 rtr a[232:233], v174, 8192
 rtr a[234:235], v174, 10240
 v_mul_f32 v250, s36, v148
 m16 v[196:199], a[236:239], a[8:11], v[196:199]
 v_mul_f32 v251, s36, v149
 m16 v[204:207], a[236:239], a[12:15], v[204:207]
 rtr a[236:237], v175, 8192
 rtr a[238:239], v175, 10240
 m16 v[192:195], a[240:243], a[16:19], v[192:195]
 v_exp_f32 v250, v250
 m16 v[200:203], a[240:243], a[20:23], v[200:203]
 v_exp_f32 v251, v251
 s_waitcnt lgkmcnt(2)
 m16 v[196:199], a[244:247], a[16:19], v[196:199]
 v_add_f32 v249, v249, v250
 v_add_f32 v249, v249, v251
 m16 v[204:207], a[244:247], a[20:23], v[204:207]
 cvt v186, v250, v251
 v_mul_f32 v250, s36, v150
 v_mul_f32 v251, s36, v151
 m16 v[192:195], a[248:251], a[24:27], v[192:195]
 v_exp_f32 v250, v250
 m16 v[200:203], a[248:251], a[28:31], v[200:203]
 v_exp_f32 v251, v251
 v_add_f32 v249, v249, v250
 m16 v[196:199], a[252:255], a[24:27], v[196:199]
 v_add_f32 v249, v249, v251
 cvt v187, v250, v251
 m16 v[204:207], a[252:255], a[28:31], v[204:207]
 s_waitcnt lgkmcnt(0)
 s_barrier
 m16 v[192:195], a[224:227], a[32:35], v[192:195]
 rtr a[240:241], v242
 v_mul_f32 v250, s36, v152
 m16 v[200:203], a[224:227], a[36:39], v[200:203]
 rtr a[242:243], v242, 6144
 rtr a[244:245], v243
 v_mul_f32 v251, s36, v153
 m16 v[196:199], a[228:231], a[32:35], v[196:199]
 rtr a[246:247], v243, 6144
 m16 v[204:207], a[228:231], a[36:39], v[204:207]
 rtr a[248:249], v244
 rtr a[250:251], v244, 6144
 m16 v[192:195], a[232:235], a[40:43], v[192:195]
 rtr a[252:253], v245
 m16 v[200:203], a[232:235], a[44:47], v[200:203]
 rtr a[254:255], v245, 6144
 rtr a[224:225], v242, 128
 v_exp_f32 v250, v250
 v_exp_f32 v251, v251
 s_nop 0
 cvt v188, v250, v251
 v_add_f32 v169, v250, v251
 v_mul_f32 v250, s36, v154
 v_mul_f32 v251, s36, v155
 v_exp_f32 v250, v250
 v_exp_f32 v251, v251
 v_add_f32 v169, v169, v250
 v_add_f32 v169, v169, v251
 cvt v189, v250, v251
 v_mul_f32 v250, s36, v156
 v_mul_f32 v251, s36, v157
 v_exp_f32 v250, v250
 v_exp_f32 v251, v251
 v_add_f32 v169, v169, v250
 v_add_f32 v169, v169, v251
 cvt v190, v250, v251
 v_mul_f32 v250, s36, v158
 v_mul_f32 v251, s36, v159
 v_exp_f32 v250, v250
 v_exp_f32 v251, v251
 v_add_f32 v169, v169, v250
 v_add_f32 v169, v169, v251
 cvt v191, v250, v251
 v_add_f32 v250, v249, v169
 v_cmp_nge_f32 s[48:49], s37, v250
 m16 v[196:199], a[236:239], a[40:43], v[196:199]
 rtr a[226:227], v242, 6272
 m16 v[204:207], a[236:239], a[44:47], v[204:207]
 rtr a[228:229], v243, 128
 rtr a[230:231], v243, 6272
 s_cmp_lg_u64 s[48:49], 0
 s_cbranch_scc1 RS15_1
RB15_1:
 v_add_f32 v248, v248, v249
 v_add_f32 v168, v168, v169
 s_waitcnt lgkmcnt(6)
 m16 v[0:3], a[240:243], v[184:187], v[0:3]
 rtr a[232:233], v244, 128
 m16 v[8:11], a[240:243], v[188:191], v[8:11]
 rtr a[234:235], v244, 6272
 rtr a[236:237], v245, 128
 s_cmp_eq_u32 s38, 1
 s_cbranch_scc1 MB1
MR1:
 m16 v[4:7], a[244:247], v[184:187], v[4:7]
 rtr a[238:239], v245, 6272
 v_mov_b32 v250, v248
 m16 v[12:15], a[244:247], v[188:191], v[12:15]
 rtr a[240:241], v242, 256
 rtr a[242:243], v242, 6400
 v_permlane16_swap_b32 v248, v250
 m16 v[16:19], a[248:251], v[184:187], v[16:19]
 rtr a[244:245], v243, 256
 v_add_f32 v248, v248, v250
 m16 v[24:27], a[248:251], v[188:191], v[24:27]
 rtr a[246:247], v243, 6400
 rtr a[248:249], v244, 256
 s_waitcnt lgkmcnt(6)
 m16 v[20:23], a[252:255], v[184:187], v[20:23]
 rtr a[250:251], v244, 6400
 v_mov_b32 v250, v248
 m16 v[28:31], a[252:255], v[188:191], v[28:31]
 rtr a[252:253], v245, 256
 rtr a[254:255], v245, 6400
 v_permlane32_swap_b32 v248, v250
 m16 v[32:35], a[224:227], v[184:187], v[32:35]
 v_add_f32 v248, v248, v250
 v_lshlrev_b32 v144, 16, v224
 m16 v[40:43], a[224:227], v[188:191], v[40:43]
 v_rcp_f32 v252, v248
 v_mov_b32 v251, v168
 m16 v[36:39], a[228:231], v[184:187], v[36:39]
 s_nop 0
 v_permlane16_swap_b32 v168, v251
 v_add_f32 v168, v168, v251
 m16 v[44:47], a[228:231], v[188:191], v[44:47]
 v_mov_b32 v251, v168
 s_nop 1
 v_permlane32_swap_b32 v168, v251
 v_add_f32 v168, v168, v251
 v_rcp_f32 v249, v168
 m16 v[48:51], a[232:235], v[184:187], v[48:51]
 v_and_b32 v145, 0xffff0000, v224
 v_lshlrev_b32 v146, 16, v225
 m16 v[56:59], a[232:235], v[188:191], v[56:59]
 v_and_b32 v147, 0xffff0000, v225
 v_lshlrev_b32 v148, 16, v226
 s_waitcnt lgkmcnt(0)
 m16 v[52:55], a[236:239], v[184:187], v[52:55]
 v_and_b32 v149, 0xffff0000, v226
 v_lshlrev_b32 v150, 16, v227
 m16 v[60:63], a[236:239], v[188:191], v[60:63]
 v_and_b32 v151, 0xffff0000, v227
 s_barrier
 m16 v[64:67], a[240:243], v[184:187], v[64:67]
 rtr a[224:225], v172, 12288
 v_lshlrev_b32 v152, 16, v228
 m16 v[72:75], a[240:243], v[188:191], v[72:75]
 rtr a[226:227], v172, 14336
 rtr a[228:229], v173, 12288
 v_and_b32 v153, 0xffff0000, v228
 m16 v[68:71], a[244:247], v[184:187], v[68:71]
 rtr a[230:231], v173, 14336
 v_lshlrev_b32 v154, 16, v229
 m16 v[76:79], a[244:247], v[188:191], v[76:79]
 rtr a[232:233], v172, 16384
 rtr a[234:235], v172, 18432
 v_and_b32 v155, 0xffff0000, v229
 m16 v[80:83], a[248:251], v[184:187], v[80:83]
 rtr a[236:237], v173, 16384
 v_lshlrev_b32 v156, 16, v230
 m16 v[88:91], a[248:251], v[188:191], v[88:91]
 rtr a[238:239], v173, 18432
 rtr a[240:241], v172, 20480
 v_and_b32 v157, 0xffff0000, v230
 m16 v[84:87], a[252:255], v[184:187], v[84:87]
 rtr a[242:243], v172, 22528
 v_lshlrev_b32 v158, 16, v231
 m16 v[92:95], a[252:255], v[188:191], v[92:95]
 rtr a[244:245], v173, 20480
 rtr a[246:247], v173, 22528
 v_and_b32 v159, 0xffff0000, v231
 s_waitcnt lgkmcnt(6)
 m16 v[144:147], a[224:227], a[0:3], v[144:147]
 rtr a[248:249], v172, 36864
 cvt v216, v192, v193
 m16 v[152:155], a[224:227], a[4:7], v[152:155]
 rtr a[250:251], v172, 38912
 rtr a[252:253], v173, 36864
 cvt v217, v194, v195
 m16 v[148:151], a[228:231], a[0:3], v[148:151]
 rtr a[254:255], v173, 38912
 cvt v218, v196, v197
 m16 v[156:159], a[228:231], a[4:7], v[156:159]
 rtr a[224:225], v172, 40960
 rtr a[226:227], v172, 43008
 cvt v219, v198, v199
 m16 v[144:147], a[232:235], a[8:11], v[144:147]
 rtr a[228:229], v173, 40960
 cvt v220, v200, v201
 m16 v[152:155], a[232:235], a[12:15], v[152:155]
 rtr a[230:231], v173, 43008
 rtr a[232:233], v172, 45056
 s_waitcnt lgkmcnt(6)
 m16 v[148:151], a[236:239], a[8:11], v[148:151]
 rtr a[234:235], v172, 47104
 cvt v221, v202, v203
 m16 v[156:159], a[236:239], a[12:15], v[156:159]
 rtr a[236:237], v173, 45056
 rtr a[238:239], v173, 47104
 cvt v222, v204, v205
 m16 v[144:147], a[240:243], a[16:19], v[144:147]
 cvt v223, v206, v207
 v_lshlrev_b32 v192, 16, v232
 m16 v[152:155], a[240:243], a[20:23], v[152:155]
 v_and_b32 v193, 0xffff0000, v232
 v_lshlrev_b32 v194, 16, v233
 v_and_b32 v195, 0xffff0000, v233
 m16 v[148:151], a[244:247], a[16:19], v[148:151]
 v_lshlrev_b32 v196, 16, v234
 v_and_b32 v197, 0xffff0000, v234
 m16 v[156:159], a[244:247], a[20:23], v[156:159]
 v_lshlrev_b32 v198, 16, v235
 v_and_b32 v199, 0xffff0000, v235
 v_lshlrev_b32 v200, 16, v236
 m16 v[144:147], a[248:251], a[24:27], v[144:147]
 v_and_b32 v201, 0xffff0000, v236
 v_lshlrev_b32 v202, 16, v237
 m16 v[152:155], a[248:251], a[28:31], v[152:155]
 v_and_b32 v203, 0xffff0000, v237
 v_lshlrev_b32 v204, 16, v238
 s_waitcnt lgkmcnt(0)
 m16 v[148:151], a[252:255], a[24:27], v[148:151]
 v_and_b32 v205, 0xffff0000, v238
 v_lshlrev_b32 v206, 16, v239
 m16 v[156:159], a[252:255], a[28:31], v[156:159]
 v_and_b32 v207, 0xffff0000, v239
 s_barrier
 m16 v[144:147], a[224:227], a[32:35], v[144:147]
 rtr a[240:241], v174, 12288
 v_mul_f32 v0, v252, v0
 m16 v[152:155], a[224:227], a[36:39], v[152:155]
 rtr a[242:243], v174, 14336
 rtr a[244:245], v175, 12288
 v_mul_f32 v1, v252, v1
 m16 v[148:151], a[228:231], a[32:35], v[148:151]
 rtr a[246:247], v175, 14336
 cvt v0, v0, v1
 m16 v[156:159], a[228:231], a[36:39], v[156:159]
 rtr a[248:249], v174, 16384
 rtr a[250:251], v174, 18432
 v_mul_f32 v2, v252, v2
 m16 v[144:147], a[232:235], a[40:43], v[144:147]
 rtr a[252:253], v175, 16384
 v_mul_f32 v3, v252, v3
 m16 v[152:155], a[232:235], a[44:47], v[152:155]
 rtr a[254:255], v175, 18432
 rtr a[224:225], v174, 20480
 cvt v1, v2, v3
 m16 v[148:151], a[236:239], a[40:43], v[148:151]
 rtr a[226:227], v174, 22528
 v_mul_f32 v4, v252, v4
 m16 v[156:159], a[236:239], a[44:47], v[156:159]
 rtr a[228:229], v175, 20480
 rtr a[230:231], v175, 22528
 s_waitcnt lgkmcnt(6)
 m16 v[192:195], a[240:243], a[0:3], v[192:195]
 rtr a[232:233], v174, 36864
 v_mul_f32 v5, v252, v5
 m16 v[200:203], a[240:243], a[4:7], v[200:203]
 rtr a[234:235], v174, 38912
 rtr a[236:237], v175, 36864
 cvt v2, v4, v5
 m16 v[196:199], a[244:247], a[0:3], v[196:199]
 rtr a[238:239], v175, 38912
 v_mul_f32 v6, v252, v6
 m16 v[204:207], a[244:247], a[4:7], v[204:207]
 rtr a[240:241], v174, 40960
 rtr a[242:243], v174, 43008
 v_mul_f32 v7, v252, v7
 m16 v[192:195], a[248:251], a[8:11], v[192:195]
 rtr a[244:245], v175, 40960
 cvt v3, v6, v7
 m16 v[200:203], a[248:251], a[12:15], v[200:203]
 rtr a[246:247], v175, 43008
 rtr a[248:249], v174, 45056
 s_waitcnt lgkmcnt(6)
 m16 v[196:199], a[252:255], a[8:11], v[196:199]
 rtr a[250:251], v174, 47104
 v_mul_f32 v8, v249, v8
 m16 v[204:207], a[252:255], a[12:15], v[204:207]
 rtr a[252:253], v175, 45056
 rtr a[254:255], v175, 47104
 v_mul_f32 v9, v249, v9
 m16 v[192:195], a[224:227], a[16:19], v[192:195]
 cvt v4, v8, v9
 v_mul_f32 v10, v249, v10
 m16 v[200:203], a[224:227], a[20:23], v[200:203]
 v_mul_f32 v11, v249, v11
 cvt v5, v10, v11
 v_mul_f32 v12, v249, v12
 m16 v[196:199], a[228:231], a[16:19], v[196:199]
 v_mul_f32 v13, v249, v13
 cvt v6, v12, v13
 m16 v[204:207], a[228:231], a[20:23], v[204:207]
 v_mul_f32 v14, v249, v14
 v_mul_f32 v15, v249, v15
 cvt v7, v14, v15
 m16 v[192:195], a[232:235], a[24:27], v[192:195]
 v_mul_f32 v16, v252, v16
 v_mul_f32 v17, v252, v17
 m16 v[200:203], a[232:235], a[28:31], v[200:203]
 cvt v8, v16, v17
 v_mul_f32 v18, v252, v18
 s_waitcnt lgkmcnt(0)
 m16 v[196:199], a[236:239], a[24:27], v[196:199]
 v_mul_f32 v19, v252, v19
 cvt v9, v18, v19
 m16 v[204:207], a[236:239], a[28:31], v[204:207]
 v_mul_f32 v20, v252, v20
 s_barrier
 m16 v[192:195], a[240:243], a[32:35], v[192:195]
 ds_read_b128 a[224:227], v240
 v_mul_f32 v21, v252, v21
 m16 v[200:203], a[240:243], a[36:39], v[200:203]
 ds_read_b128 a[228:231], v240 offset:6144
 cvt v10, v20, v21
 v_mul_f32 v22, v252, v22
 m16 v[196:199], a[244:247], a[32:35], v[196:199]
 ds_read_b128 a[232:235], v241
 v_mul_f32 v23, v252, v23
 m16 v[204:207], a[244:247], a[36:39], v[204:207]
 ds_read_b128 a[236:239], v241 offset:6144
 cvt v11, v22, v23
 v_mul_f32 v24, v249, v24
 m16 v[192:195], a[248:251], a[40:43], v[192:195]
 ds_read_b128 a[240:243], v240 offset:128
 v_mul_f32 v25, v249, v25
 m16 v[200:203], a[248:251], a[44:47], v[200:203]
 ds_read_b128 a[244:247], v240 offset:6272
 cvt v12, v24, v25
 v_mul_f32 v26, v249, v26
 m16 v[196:199], a[252:255], a[40:43], v[196:199]
 ds_read_b128 a[248:251], v241 offset:128
 v_mul_f32 v27, v249, v27
 m16 v[204:207], a[252:255], a[44:47], v[204:207]
 ds_read_b128 a[252:255], v241 offset:6272
 cvt v13, v26, v27
 v_mul_f32 v28, v249, v28
 v_mul_f32 v29, v249, v29
 cvt v14, v28, v29
 v_mul_f32 v30, v249, v30
 v_mul_f32 v31, v249, v31
 cvt v15, v30, v31
 v_mul_f32 v32, v252, v32
 v_mul_f32 v33, v252, v33
 cvt v16, v32, v33
 v_mul_f32 v34, v252, v34
 v_mul_f32 v35, v252, v35
 cvt v17, v34, v35
 v_mul_f32 v36, v252, v36
 v_mul_f32 v37, v252, v37
 cvt v18, v36, v37
 v_mul_f32 v38, v252, v38
 v_mul_f32 v39, v252, v39
 cvt v19, v38, v39
 v_mul_f32 v40, v249, v40
 v_mul_f32 v41, v249, v41
 cvt v20, v40, v41
 v_mul_f32 v42, v249, v42
 v_mul_f32 v43, v249, v43
 cvt v21, v42, v43
 v_mul_f32 v44, v249, v44
 v_mul_f32 v45, v249, v45
 cvt v22, v44, v45
 v_mul_f32 v46, v249, v46
 v_mul_f32 v47, v249, v47
 cvt v23, v46, v47
 v_mul_f32 v48, v252, v48
 v_mul_f32 v49, v252, v49
 cvt v24, v48, v49
 v_mul_f32 v50, v252, v50
 v_mul_f32 v51, v252, v51
 cvt v25, v50, v51
 v_mul_f32 v52, v252, v52
 v_mul_f32 v53, v252, v53
 cvt v26, v52, v53
 v_mul_f32 v54, v252, v54
 v_mul_f32 v55, v252, v55
 cvt v27, v54, v55
 v_mul_f32 v56, v249, v56
 v_mul_f32 v57, v249, v57
 cvt v28, v56, v57
 v_mul_f32 v58, v249, v58
 v_mul_f32 v59, v249, v59
 cvt v29, v58, v59
 v_mul_f32 v60, v249, v60
 v_mul_f32 v61, v249, v61
 cvt v30, v60, v61
 v_mul_f32 v62, v249, v62
 v_mul_f32 v63, v249, v63
 cvt v31, v62, v63
 v_mul_f32 v64, v252, v64
 v_mul_f32 v65, v252, v65
 cvt v32, v64, v65
 v_mul_f32 v66, v252, v66
 v_mul_f32 v67, v252, v67
 cvt v33, v66, v67
 v_mul_f32 v68, v252, v68
 v_mul_f32 v69, v252, v69
 cvt v34, v68, v69
 v_mul_f32 v70, v252, v70
 v_mul_f32 v71, v252, v71
 cvt v35, v70, v71
 v_mul_f32 v72, v249, v72
 v_mul_f32 v73, v249, v73
 cvt v36, v72, v73
 v_mul_f32 v74, v249, v74
 v_mul_f32 v75, v249, v75
 cvt v37, v74, v75
 v_mul_f32 v76, v249, v76
 v_mul_f32 v77, v249, v77
 cvt v38, v76, v77
 v_mul_f32 v78, v249, v78
 v_mul_f32 v79, v249, v79
 cvt v39, v78, v79
 v_mul_f32 v80, v252, v80
 v_mul_f32 v81, v252, v81
 cvt v40, v80, v81
 v_mul_f32 v82, v252, v82
 v_mul_f32 v83, v252, v83
 cvt v41, v82, v83
 v_mul_f32 v84, v252, v84
 v_mul_f32 v85, v252, v85
 cvt v42, v84, v85
 v_mul_f32 v86, v252, v86
 v_mul_f32 v87, v252, v87
 cvt v43, v86, v87
 v_mul_f32 v88, v249, v88
 v_mul_f32 v89, v249, v89
 cvt v44, v88, v89
 v_mul_f32 v90, v249, v90
 v_mul_f32 v91, v249, v91
 cvt v45, v90, v91
 v_mul_f32 v92, v249, v92
 v_mul_f32 v93, v249, v93
 cvt v46, v92, v93
 v_mul_f32 v94, v249, v94
 v_mul_f32 v95, v249, v95
 cvt v47, v94, v95
 v_accvgpr_read_b32 v96, a48
 v_accvgpr_read_b32 v97, a49
 v_accvgpr_read_b32 v98, a50
 v_accvgpr_read_b32 v99, a51
 v_accvgpr_read_b32 v100, a52
 v_accvgpr_read_b32 v101, a53
 v_accvgpr_read_b32 v102, a54
 v_accvgpr_read_b32 v103, a55
 v_accvgpr_read_b32 v104, a56
 v_accvgpr_read_b32 v105, a57
 v_accvgpr_read_b32 v106, a58
 v_accvgpr_read_b32 v107, a59
 v_accvgpr_read_b32 v108, a60
 v_accvgpr_read_b32 v109, a61
 v_accvgpr_read_b32 v110, a62
 v_accvgpr_read_b32 v111, a63
 v_accvgpr_read_b32 v112, a64
 v_accvgpr_read_b32 v113, a65
 v_accvgpr_read_b32 v114, a66
 v_accvgpr_read_b32 v115, a67
 v_accvgpr_read_b32 v116, a68
 v_accvgpr_read_b32 v117, a69
 v_accvgpr_read_b32 v118, a70
 v_accvgpr_read_b32 v119, a71
 v_accvgpr_read_b32 v120, a72
 v_accvgpr_read_b32 v121, a73
 v_accvgpr_read_b32 v122, a74
 v_accvgpr_read_b32 v123, a75
 v_accvgpr_read_b32 v124, a76
 v_accvgpr_read_b32 v125, a77
 v_accvgpr_read_b32 v126, a78
 v_accvgpr_read_b32 v127, a79
 v_accvgpr_read_b32 v128, a80
 v_accvgpr_read_b32 v129, a81
 v_accvgpr_read_b32 v130, a82
 v_accvgpr_read_b32 v131, a83
 v_accvgpr_read_b32 v132, a84
 v_accvgpr_read_b32 v133, a85
 v_accvgpr_read_b32 v134, a86
 v_accvgpr_read_b32 v135, a87
 v_accvgpr_read_b32 v136, a88
 v_accvgpr_read_b32 v137, a89
 v_accvgpr_read_b32 v138, a90
 v_accvgpr_read_b32 v139, a91
 v_accvgpr_read_b32 v140, a92
 v_accvgpr_read_b32 v141, a93
 v_accvgpr_read_b32 v142, a94
 v_accvgpr_read_b32 v143, a95
 cvt v224, v144, v145
 cvt v225, v146, v147
 cvt v226, v148, v149
 cvt v227, v150, v151
 cvt v228, v152, v153
 cvt v229, v154, v155
 cvt v230, v156, v157
 cvt v231, v158, v159
 s_add_u32 s38, s38, 1
 s_cmp_lt_u32 s38, 3
 s_cbranch_scc1 LOOP
ZONE:
 v_add_u32 v176, 0x1e000, v172
 v_add_u32 v177, 0x1e000, v173
 v_add_u32 v178, 0x1e000, v174
 v_add_u32 v179, 0x1e000, v175
 s_waitcnt lgkmcnt(0)
 rtr a[224:225], v176
 rtr a[226:227], v176, 2048
 rtr a[228:229], v177
 rtr a[230:231], v177, 2048
 rtr a[232:233], v178
 rtr a[234:235], v178, 2048
 rtr a[236:237], v179
 rtr a[238:239], v179, 2048
 rtr a[240:241], v176, 4096
 rtr a[242:243], v176, 6144
 rtr a[244:245], v177, 4096
 rtr a[246:247], v177, 6144
 v_lshlrev_b32 v96, 22, v253
 v_accvgpr_read_b32 v145, a96
 v_lshlrev_b32 v144, 16, v145
 v_and_b32 v145, 0xffff0000, v145
 v_accvgpr_read_b32 v147, a97
 v_lshlrev_b32 v146, 16, v147
 v_and_b32 v147, 0xffff0000, v147
 v_accvgpr_read_b32 v149, a98
 v_lshlrev_b32 v148, 16, v149
 v_and_b32 v149, 0xffff0000, v149
 v_accvgpr_read_b32 v151, a99
 v_lshlrev_b32 v150, 16, v151
 v_and_b32 v151, 0xffff0000, v151
 v_accvgpr_read_b32 v153, a100
 v_lshlrev_b32 v152, 16, v153
 v_and_b32 v153, 0xffff0000, v153
 v_accvgpr_read_b32 v155, a101
 v_lshlrev_b32 v154, 16, v155
 v_and_b32 v155, 0xffff0000, v155
 v_accvgpr_read_b32 v157, a102
 v_lshlrev_b32 v156, 16, v157
 v_and_b32 v157, 0xffff0000, v157
 v_accvgpr_read_b32 v159, a103
 v_lshlrev_b32 v158, 16, v159
 v_and_b32 v159, 0xffff0000, v159
 s_waitcnt lgkmcnt(10)
 m16 v[144:147], a[224:227], v[0:3], v[144:147]
 rtr a[248:249], v178, 4096
 m16 v[152:155], a[224:227], v[4:7], v[152:155]
 rtr a[250:251], v178, 6144
 rtr a[252:253], v179, 4096
 s_waitcnt lgkmcnt(11)
 m16 v[148:151], a[228:231], v[0:3], v[148:151]
 rtr a[254:255], v179, 6144
 v_accvgpr_read_b32 v113, a104
 m16 v[156:159], a[228:231], v[4:7], v[156:159]
 rtr a[224:225], v176, 8192
 rtr a[226:227], v176, 10240
 v_lshlrev_b32 v112, 16, v113
 v_and_b32 v113, 0xffff0000, v113
 v_accvgpr_read_b32 v115, a105
 v_lshlrev_b32 v114, 16, v115
 v_and_b32 v115, 0xffff0000, v115
 v_accvgpr_read_b32 v117, a106
 v_lshlrev_b32 v116, 16, v117
 v_and_b32 v117, 0xffff0000, v117
 v_accvgpr_read_b32 v119, a107
 v_lshlrev_b32 v118, 16, v119
 v_and_b32 v119, 0xffff0000, v119
 v_accvgpr_read_b32 v121, a108
 v_lshlrev_b32 v120, 16, v121
 v_and_b32 v121, 0xffff0000, v121
 v_accvgpr_read_b32 v123, a109
 v_lshlrev_b32 v122, 16, v123
 v_and_b32 v123, 0xffff0000, v123
 v_accvgpr_read_b32 v125, a110
 v_lshlrev_b32 v124, 16, v125
 v_and_b32 v125, 0xffff0000, v125
 v_accvgpr_read_b32 v127, a111
 v_lshlrev_b32 v126, 16, v127
 v_and_b32 v127, 0xffff0000, v127
 s_waitcnt lgkmcnt(6)
 m16 v[112:115], a[232:235], v[0:3], v[112:115]
 rtr a[228:229], v177, 8192
 v_accvgpr_read_b32 v49, a112
 m16 v[120:123], a[232:235], v[4:7], v[120:123]
 rtr a[230:231], v177, 10240
 rtr a[232:233], v178, 8192
 v_lshlrev_b32 v48, 16, v49
 m16 v[116:119], a[236:239], v[0:3], v[116:119]
 rtr a[234:235], v178, 10240
 v_and_b32 v49, 0xffff0000, v49
 m16 v[124:127], a[236:239], v[4:7], v[124:127]
 rtr a[236:237], v179, 8192
 rtr a[238:239], v179, 10240
 v_accvgpr_read_b32 v51, a113
 m16 v[144:147], a[240:243], v[8:11], v[144:147]
 v_lshlrev_b32 v50, 16, v51
 v_and_b32 v51, 0xffff0000, v51
 m16 v[152:155], a[240:243], v[12:15], v[152:155]
 v_accvgpr_read_b32 v53, a114
 v_lshlrev_b32 v52, 16, v53
 v_and_b32 v53, 0xffff0000, v53
 m16 v[148:151], a[244:247], v[8:11], v[148:151]
 v_accvgpr_read_b32 v55, a115
 v_lshlrev_b32 v54, 16, v55
 m16 v[156:159], a[244:247], v[12:15], v[156:159]
 v_and_b32 v55, 0xffff0000, v55
 v_accvgpr_read_b32 v57, a116
 s_waitcnt lgkmcnt(0)
 m16 v[112:115], a[248:251], v[8:11], v[112:115]
 v_add_u32 v177, 0x21000, v173
 v_lshlrev_b32 v56, 16, v57
 m16 v[120:123], a[248:251], v[12:15], v[120:123]
 v_add_u32 v179, 0x21000, v175
 v_and_b32 v57, 0xffff0000, v57
 v_accvgpr_read_b32 v59, a117
 m16 v[116:119], a[252:255], v[8:11], v[116:119]
 v_add_u32 v176, 0x21000, v172
 v_lshlrev_b32 v58, 16, v59
 m16 v[124:127], a[252:255], v[12:15], v[124:127]
 v_add_u32 v178, 0x21000, v174
 s_barrier
 m16 v[144:147], a[224:227], v[16:19], v[144:147]
 rtr a[240:241], v176
 v_and_b32 v59, 0xffff0000, v59
 m16 v[152:155], a[224:227], v[20:23], v[152:155]
 rtr a[242:243], v176, 2048
 rtr a[244:245], v177
 v_accvgpr_read_b32 v61, a118
 m16 v[148:151], a[228:231], v[16:19], v[148:151]
 rtr a[246:247], v177, 2048
 v_lshlrev_b32 v60, 16, v61
 m16 v[156:159], a[228:231], v[20:23], v[156:159]
 rtr a[248:249], v178
 rtr a[250:251], v178, 2048
 v_and_b32 v61, 0xffff0000, v61
 m16 v[112:115], a[232:235], v[16:19], v[112:115]
 rtr a[252:253], v179
 v_accvgpr_read_b32 v63, a119
 m16 v[120:123], a[232:235], v[20:23], v[120:123]
 rtr a[254:255], v179, 2048
 rtr a[224:225], v176, 4096
 v_lshlrev_b32 v62, 16, v63
 m16 v[116:119], a[236:239], v[16:19], v[116:119]
 rtr a[226:227], v176, 6144
 v_and_b32 v63, 0xffff0000, v63
 m16 v[124:127], a[236:239], v[20:23], v[124:127]
 rtr a[228:229], v177, 4096
 rtr a[230:231], v177, 6144
 s_waitcnt lgkmcnt(6)
 m16 v[144:147], a[240:243], v[24:27], v[144:147]
 rtr a[232:233], v178, 4096
 v_accvgpr_read_b32 v65, a120
 m16 v[152:155], a[240:243], v[28:31], v[152:155]
 rtr a[234:235], v178, 6144
 rtr a[236:237], v179, 4096
 v_lshlrev_b32 v64, 16, v65
 m16 v[148:151], a[244:247], v[24:27], v[148:151]
 rtr a[238:239], v179, 6144
 v_and_b32 v65, 0xffff0000, v65
 m16 v[156:159], a[244:247], v[28:31], v[156:159]
 rtr a[240:241], v176, 8192
 rtr a[242:243], v176, 10240
 v_accvgpr_read_b32 v67, a121
 m16 v[112:115], a[248:251], v[24:27], v[112:115]
 rtr a[244:245], v177, 8192
 v_lshlrev_b32 v66, 16, v67
 m16 v[120:123], a[248:251], v[28:31], v[120:123]
 rtr a[246:247], v177, 10240
 rtr a[248:249], v178, 8192
 s_waitcnt lgkmcnt(6)
 m16 v[116:119], a[252:255], v[24:27], v[116:119]
 rtr a[250:251], v178, 10240
 v_and_b32 v67, 0xffff0000, v67
 m16 v[124:127], a[252:255], v[28:31], v[124:127]
 rtr a[252:253], v179, 8192
 rtr a[254:255], v179, 10240
 v_accvgpr_read_b32 v69, a122
 m16 v[144:147], a[224:227], v[32:35], v[144:147]
 v_lshlrev_b32 v68, 16, v69
 v_and_b32 v69, 0xffff0000, v69
 m16 v[152:155], a[224:227], v[36:39], v[152:155]
 v_accvgpr_read_b32 v71, a123
 v_lshlrev_b32 v70, 16, v71
 v_and_b32 v71, 0xffff0000, v71
 m16 v[148:151], a[228:231], v[32:35], v[148:151]
 v_accvgpr_read_b32 v73, a124
 v_lshlrev_b32 v72, 16, v73
 m16 v[156:159], a[228:231], v[36:39], v[156:159]
 v_and_b32 v73, 0xffff0000, v73
 v_accvgpr_read_b32 v75, a125
 v_lshlrev_b32 v74, 16, v75
 m16 v[112:115], a[232:235], v[32:35], v[112:115]
 v_add_u32 v177, 0x24000, v173
 v_and_b32 v75, 0xffff0000, v75
 m16 v[120:123], a[232:235], v[36:39], v[120:123]
 v_add_u32 v179, 0x24000, v175
 v_accvgpr_read_b32 v77, a126
 s_waitcnt lgkmcnt(0)
 m16 v[116:119], a[236:239], v[32:35], v[116:119]
 v_add_u32 v176, 0x24000, v172
 v_lshlrev_b32 v76, 16, v77
 m16 v[124:127], a[236:239], v[36:39], v[124:127]
 v_add_u32 v178, 0x24000, v174
 s_barrier
 m16 v[144:147], a[240:243], v[40:43], v[144:147]
 rtr a[224:225], v176
 v_and_b32 v77, 0xffff0000, v77
 m16 v[152:155], a[240:243], v[44:47], v[152:155]
 rtr a[226:227], v176, 2048
 rtr a[228:229], v177
 v_accvgpr_read_b32 v79, a127
 m16 v[148:151], a[244:247], v[40:43], v[148:151]
 rtr a[230:231], v177, 2048
 v_lshlrev_b32 v78, 16, v79
 m16 v[156:159], a[244:247], v[44:47], v[156:159]
 rtr a[232:233], v178
 rtr a[234:235], v178, 2048
 v_and_b32 v79, 0xffff0000, v79
 m16 v[112:115], a[248:251], v[40:43], v[112:115]
 rtr a[236:237], v179
 cvt v232, v192, v193
 m16 v[120:123], a[248:251], v[44:47], v[120:123]
 rtr a[238:239], v179, 2048
 rtr a[240:241], v176, 4096
 cvt v233, v194, v195
 m16 v[116:119], a[252:255], v[40:43], v[116:119]
 rtr a[242:243], v176, 6144
 cvt v234, v196, v197
 m16 v[124:127], a[252:255], v[44:47], v[124:127]
 rtr a[244:245], v177, 4096
 rtr a[246:247], v177, 6144
 s_waitcnt lgkmcnt(6)
 m16 v[48:51], a[224:227], v[0:3], v[48:51]
 rtr a[248:249], v178, 4096
 cvt v235, v198, v199
 m16 v[56:59], a[224:227], v[4:7], v[56:59]
 rtr a[250:251], v178, 6144
 rtr a[252:253], v179, 4096
 cvt v236, v200, v201
 m16 v[52:55], a[228:231], v[0:3], v[52:55]
 rtr a[254:255], v179, 6144
 cvt v237, v202, v203
 m16 v[60:63], a[228:231], v[4:7], v[60:63]
 rtr a[224:225], v176, 8192
 rtr a[226:227], v176, 10240
 cvt v238, v204, v205
 m16 v[64:67], a[232:235], v[0:3], v[64:67]
 rtr a[228:229], v177, 8192
 cvt v239, v206, v207
 m16 v[72:75], a[232:235], v[4:7], v[72:75]
 rtr a[230:231], v177, 10240
 rtr a[232:233], v178, 8192
 s_waitcnt lgkmcnt(6)
 m16 v[68:71], a[236:239], v[0:3], v[68:71]
 rtr a[234:235], v178, 10240
 cvt v144, v144, v145
 m16 v[76:79], a[236:239], v[4:7], v[76:79]
 rtr a[236:237], v179, 8192
 rtr a[238:239], v179, 10240
 cvt v145, v146, v147
 m16 v[48:51], a[240:243], v[8:11], v[48:51]
 cvt v146, v148, v149
 cvt v147, v150, v151
 m16 v[56:59], a[240:243], v[12:15], v[56:59]
 buffer_store_dwordx4 v[144:147], v253, s[28:31], s41 offen sc1
 cvt v152, v152, v153
 m16 v[52:55], a[244:247], v[8:11], v[52:55]
 cvt v153, v154, v155
 cvt v154, v156, v157
 m16 v[60:63], a[244:247], v[12:15], v[60:63]
 cvt v155, v158, v159
 buffer_store_dwordx4 v[152:155], v253, s[28:31], s41 offen offset:1024 sc1
 m16 v[64:67], a[248:251], v[8:11], v[64:67]
 v_add_u32 v177, 0xf000, v173
 cvt v112, v112, v113
 m16 v[72:75], a[248:251], v[12:15], v[72:75]
 v_add_u32 v179, 0xf000, v175
 cvt v113, v114, v115
 s_waitcnt lgkmcnt(0)
 m16 v[68:71], a[252:255], v[8:11], v[68:71]
 v_add_u32 v176, 0xf000, v172
 cvt v114, v116, v117
 m16 v[76:79], a[252:255], v[12:15], v[76:79]
 v_add_u32 v178, 0xf000, v174
 s_barrier
 m16 v[48:51], a[224:227], v[16:19], v[48:51]
 rtr a[240:241], v176
 cvt v115, v118, v119
 m16 v[56:59], a[224:227], v[20:23], v[56:59]
 rtr a[242:243], v176, 2048
 rtr a[244:245], v177
 v_accvgpr_read_b32 v145, a128
 m16 v[52:55], a[228:231], v[16:19], v[52:55]
 rtr a[246:247], v177, 2048
 v_lshlrev_b32 v144, 16, v145
 m16 v[60:63], a[228:231], v[20:23], v[60:63]
 rtr a[248:249], v178
 rtr a[250:251], v178, 2048
 v_and_b32 v145, 0xffff0000, v145
 m16 v[64:67], a[232:235], v[16:19], v[64:67]
 rtr a[252:253], v179
 v_accvgpr_read_b32 v147, a129
 m16 v[72:75], a[232:235], v[20:23], v[72:75]
 rtr a[254:255], v179, 2048
 rtr a[224:225], v176, 4096
 v_lshlrev_b32 v146, 16, v147
 m16 v[68:71], a[236:239], v[16:19], v[68:71]
 rtr a[226:227], v176, 6144
 v_and_b32 v147, 0xffff0000, v147
 m16 v[76:79], a[236:239], v[20:23], v[76:79]
 rtr a[228:229], v177, 4096
 rtr a[230:231], v177, 6144
 s_waitcnt lgkmcnt(6)
 m16 v[48:51], a[240:243], v[24:27], v[48:51]
 rtr a[232:233], v178, 4096
 v_accvgpr_read_b32 v149, a130
 m16 v[56:59], a[240:243], v[28:31], v[56:59]
 rtr a[234:235], v178, 6144
 rtr a[236:237], v179, 4096
 v_lshlrev_b32 v148, 16, v149
 m16 v[52:55], a[244:247], v[24:27], v[52:55]
 rtr a[238:239], v179, 6144
 v_and_b32 v149, 0xffff0000, v149
 m16 v[60:63], a[244:247], v[28:31], v[60:63]
 rtr a[240:241], v176, 8192
 rtr a[242:243], v176, 10240
 v_accvgpr_read_b32 v151, a131
 m16 v[64:67], a[248:251], v[24:27], v[64:67]
 rtr a[244:245], v177, 8192
 v_lshlrev_b32 v150, 16, v151
 m16 v[72:75], a[248:251], v[28:31], v[72:75]
 rtr a[246:247], v177, 10240
 rtr a[248:249], v178, 8192
 s_waitcnt lgkmcnt(6)
 m16 v[68:71], a[252:255], v[24:27], v[68:71]
 rtr a[250:251], v178, 10240
 v_and_b32 v151, 0xffff0000, v151
 m16 v[76:79], a[252:255], v[28:31], v[76:79]
 rtr a[252:253], v179, 8192
 rtr a[254:255], v179, 10240
 v_accvgpr_read_b32 v153, a132
 m16 v[48:51], a[224:227], v[32:35], v[48:51]
 buffer_store_dwordx4 v[112:115], v253, s[28:31], s41 offen offset:2048 sc1
 m16 v[56:59], a[224:227], v[36:39], v[56:59]
 cvt v120, v120, v121
 cvt v121, v122, v123
 cvt v122, v124, v125
 m16 v[52:55], a[228:231], v[32:35], v[52:55]
 cvt v123, v126, v127
 v_lshlrev_b32 v152, 16, v153
 m16 v[60:63], a[228:231], v[36:39], v[60:63]
 buffer_store_dwordx4 v[120:123], v253, s[28:31], s41 offen offset:3072 sc1
 s_add_u32 s41, s41, 4096
 m16 v[64:67], a[232:235], v[32:35], v[64:67]
 v_add_u32 v177, 0x12000, v173
 v_and_b32 v153, 0xffff0000, v153
 m16 v[72:75], a[232:235], v[36:39], v[72:75]
 v_add_u32 v179, 0x12000, v175
 v_accvgpr_read_b32 v155, a133
 s_waitcnt lgkmcnt(0)
 m16 v[68:71], a[236:239], v[32:35], v[68:71]
 v_add_u32 v176, 0x12000, v172
 v_lshlrev_b32 v154, 16, v155
 m16 v[76:79], a[236:239], v[36:39], v[76:79]
 v_add_u32 v178, 0x12000, v174
 s_barrier
 m16 v[48:51], a[240:243], v[40:43], v[48:51]
 rtr a[224:225], v176
 v_and_b32 v155, 0xffff0000, v155
 m16 v[56:59], a[240:243], v[44:47], v[56:59]
 rtr a[226:227], v176, 2048
 rtr a[228:229], v177
 v_accvgpr_read_b32 v157, a134
 m16 v[52:55], a[244:247], v[40:43], v[52:55]
 rtr a[230:231], v177, 2048
 v_lshlrev_b32 v156, 16, v157
 m16 v[60:63], a[244:247], v[44:47], v[60:63]
 rtr a[232:233], v178
 rtr a[234:235], v178, 2048
 v_and_b32 v157, 0xffff0000, v157
 m16 v[64:67], a[248:251], v[40:43], v[64:67]
 rtr a[236:237], v179
 v_accvgpr_read_b32 v159, a135
 m16 v[72:75], a[248:251], v[44:47], v[72:75]
 rtr a[238:239], v179, 2048
 rtr a[240:241], v176, 4096
 v_lshlrev_b32 v158, 16, v159
 m16 v[68:71], a[252:255], v[40:43], v[68:71]
 rtr a[242:243], v176, 6144
 v_and_b32 v159, 0xffff0000, v159
 m16 v[76:79], a[252:255], v[44:47], v[76:79]
 rtr a[244:245], v177, 4096
 rtr a[246:247], v177, 6144
 s_waitcnt lgkmcnt(6)
 m16 v[144:147], a[224:227], v[0:3], v[144:147]
 rtr a[248:249], v178, 4096
 v_accvgpr_read_b32 v113, a136
 m16 v[152:155], a[224:227], v[4:7], v[152:155]
 rtr a[250:251], v178, 6144
 rtr a[252:253], v179, 4096
 v_lshlrev_b32 v112, 16, v113
 m16 v[148:151], a[228:231], v[0:3], v[148:151]
 rtr a[254:255], v179, 6144
 v_and_b32 v113, 0xffff0000, v113
 m16 v[156:159], a[228:231], v[4:7], v[156:159]
 rtr a[224:225], v176, 8192
 rtr a[226:227], v176, 10240
 v_accvgpr_read_b32 v115, a137
 v_lshlrev_b32 v114, 16, v115
 v_and_b32 v115, 0xffff0000, v115
 v_accvgpr_read_b32 v117, a138
 v_lshlrev_b32 v116, 16, v117
 v_and_b32 v117, 0xffff0000, v117
 v_accvgpr_read_b32 v119, a139
 v_lshlrev_b32 v118, 16, v119
 v_and_b32 v119, 0xffff0000, v119
 v_accvgpr_read_b32 v121, a140
 v_lshlrev_b32 v120, 16, v121
 v_and_b32 v121, 0xffff0000, v121
 v_accvgpr_read_b32 v123, a141
 v_lshlrev_b32 v122, 16, v123
 v_and_b32 v123, 0xffff0000, v123
 v_accvgpr_read_b32 v125, a142
 v_lshlrev_b32 v124, 16, v125
 v_and_b32 v125, 0xffff0000, v125
 v_accvgpr_read_b32 v127, a143
 v_lshlrev_b32 v126, 16, v127
 v_and_b32 v127, 0xffff0000, v127
 m16 v[112:115], a[232:235], v[0:3], v[112:115]
 rtr a[228:229], v177, 8192
 cvt v48, v48, v49
 m16 v[120:123], a[232:235], v[4:7], v[120:123]
 rtr a[230:231], v177, 10240
 rtr a[232:233], v178, 8192
 s_waitcnt lgkmcnt(6)
 m16 v[116:119], a[236:239], v[0:3], v[116:119]
 rtr a[234:235], v178, 10240
 cvt v49, v50, v51
 m16 v[124:127], a[236:239], v[4:7], v[124:127]
 rtr a[236:237], v179, 8192
 rtr a[238:239], v179, 10240
 cvt v50, v52, v53
 m16 v[144:147], a[240:243], v[8:11], v[144:147]
 cvt v51, v54, v55
 m16 v[152:155], a[240:243], v[12:15], v[152:155]
 buffer_store_dwordx4 v[48:51], v253, s[28:31], s41 offen sc1
 cvt v56, v56, v57
 m16 v[148:151], a[244:247], v[8:11], v[148:151]
 cvt v57, v58, v59
 cvt v58, v60, v61
 m16 v[156:159], a[244:247], v[12:15], v[156:159]
 cvt v59, v62, v63
 buffer_store_dwordx4 v[56:59], v253, s[28:31], s41 offen offset:1024 sc1
 m16 v[112:115], a[248:251], v[8:11], v[112:115]
 v_add_u32 v177, 0x18000, v173
 cvt v64, v64, v65
 m16 v[120:123], a[248:251], v[12:15], v[120:123]
 v_add_u32 v179, 0x18000, v175
 cvt v65, v66, v67
 s_waitcnt lgkmcnt(0)
 m16 v[116:119], a[252:255], v[8:11], v[116:119]
 v_add_u32 v176, 0x18000, v172
 cvt v66, v68, v69
 m16 v[124:127], a[252:255], v[12:15], v[124:127]
 v_add_u32 v178, 0x18000, v174
 s_barrier
 m16 v[144:147], a[224:227], v[16:19], v[144:147]
 rtr a[240:241], v176
 cvt v67, v70, v71
 m16 v[152:155], a[224:227], v[20:23], v[152:155]
 rtr a[242:243], v176, 2048
 rtr a[244:245], v177
 v_accvgpr_read_b32 v49, a144
 m16 v[148:151], a[228:231], v[16:19], v[148:151]
 rtr a[246:247], v177, 2048
 v_lshlrev_b32 v48, 16, v49
 m16 v[156:159], a[228:231], v[20:23], v[156:159]
 rtr a[248:249], v178
 rtr a[250:251], v178, 2048
 v_and_b32 v49, 0xffff0000, v49
 m16 v[112:115], a[232:235], v[16:19], v[112:115]
 rtr a[252:253], v179
 v_accvgpr_read_b32 v51, a145
 m16 v[120:123], a[232:235], v[20:23], v[120:123]
 rtr a[254:255], v179, 2048
 rtr a[224:225], v176, 4096
 v_lshlrev_b32 v50, 16, v51
 m16 v[116:119], a[236:239], v[16:19], v[116:119]
 rtr a[226:227], v176, 6144
 v_and_b32 v51, 0xffff0000, v51
 m16 v[124:127], a[236:239], v[20:23], v[124:127]
 rtr a[228:229], v177, 4096
 rtr a[230:231], v177, 6144
 s_waitcnt lgkmcnt(6)
 m16 v[144:147], a[240:243], v[24:27], v[144:147]
 rtr a[232:233], v178, 4096
 v_accvgpr_read_b32 v53, a146
 m16 v[152:155], a[240:243], v[28:31], v[152:155]
 rtr a[234:235], v178, 6144
 rtr a[236:237], v179, 4096
 v_lshlrev_b32 v52, 16, v53
 m16 v[148:151], a[244:247], v[24:27], v[148:151]
 rtr a[238:239], v179, 6144
 v_and_b32 v53, 0xffff0000, v53
 m16 v[156:159], a[244:247], v[28:31], v[156:159]
 rtr a[240:241], v176, 8192
 rtr a[242:243], v176, 10240
 v_accvgpr_read_b32 v55, a147
 m16 v[112:115], a[248:251], v[24:27], v[112:115]
 rtr a[244:245], v177, 8192
 v_lshlrev_b32 v54, 16, v55
 m16 v[120:123], a[248:251], v[28:31], v[120:123]
 rtr a[246:247], v177, 10240
 rtr a[248:249], v178, 8192
 s_waitcnt lgkmcnt(6)
 m16 v[116:119], a[252:255], v[24:27], v[116:119]
 rtr a[250:251], v178, 10240
 v_and_b32 v55, 0xffff0000, v55
 m16 v[124:127], a[252:255], v[28:31], v[124:127]
 rtr a[252:253], v179, 8192
 rtr a[254:255], v179, 10240
 v_accvgpr_read_b32 v57, a148
 m16 v[144:147], a[224:227], v[32:35], v[144:147]
 buffer_store_dwordx4 v[64:67], v253, s[28:31], s41 offen offset:2048 sc1
 m16 v[152:155], a[224:227], v[36:39], v[152:155]
 cvt v72, v72, v73
 cvt v73, v74, v75
 cvt v74, v76, v77
 m16 v[148:151], a[228:231], v[32:35], v[148:151]
 cvt v75, v78, v79
 v_lshlrev_b32 v56, 16, v57
 m16 v[156:159], a[228:231], v[36:39], v[156:159]
 buffer_store_dwordx4 v[72:75], v253, s[28:31], s41 offen offset:3072 sc1
 s_add_u32 s41, s41, 4096
 m16 v[112:115], a[232:235], v[32:35], v[112:115]
 v_and_b32 v57, 0xffff0000, v57
 v_accvgpr_read_b32 v59, a149
 m16 v[120:123], a[232:235], v[36:39], v[120:123]
 v_lshlrev_b32 v58, 16, v59
 v_and_b32 v59, 0xffff0000, v59
 s_waitcnt lgkmcnt(0)
 m16 v[116:119], a[236:239], v[32:35], v[116:119]
 v_accvgpr_read_b32 v61, a150
 v_lshlrev_b32 v60, 16, v61
 m16 v[124:127], a[236:239], v[36:39], v[124:127]
 v_and_b32 v61, 0xffff0000, v61
 s_barrier
 m16 v[144:147], a[240:243], v[40:43], v[144:147]
 rtr a[224:225], v172, 49152
 v_accvgpr_read_b32 v63, a151
 m16 v[152:155], a[240:243], v[44:47], v[152:155]
 rtr a[226:227], v172, 51200
 rtr a[228:229], v173, 49152
 v_lshlrev_b32 v62, 16, v63
 m16 v[148:151], a[244:247], v[40:43], v[148:151]
 rtr a[230:231], v173, 51200
 v_and_b32 v63, 0xffff0000, v63
 m16 v[156:159], a[244:247], v[44:47], v[156:159]
 rtr a[232:233], v174, 49152
 rtr a[234:235], v174, 51200
 v_accvgpr_read_b32 v65, a152
 m16 v[112:115], a[248:251], v[40:43], v[112:115]
 rtr a[236:237], v175, 49152
 v_lshlrev_b32 v64, 16, v65
 m16 v[120:123], a[248:251], v[44:47], v[120:123]
 rtr a[238:239], v175, 51200
 rtr a[240:241], v172, 53248
 v_and_b32 v65, 0xffff0000, v65
 m16 v[116:119], a[252:255], v[40:43], v[116:119]
 rtr a[242:243], v172, 55296
 v_accvgpr_read_b32 v67, a153
 m16 v[124:127], a[252:255], v[44:47], v[124:127]
 rtr a[244:245], v173, 53248
 rtr a[246:247], v173, 55296
 s_waitcnt lgkmcnt(6)
 m16 v[48:51], a[224:227], v[0:3], v[48:51]
 rtr a[248:249], v174, 53248
 v_lshlrev_b32 v66, 16, v67
 m16 v[56:59], a[224:227], v[4:7], v[56:59]
 rtr a[250:251], v174, 55296
 rtr a[252:253], v175, 53248
 v_and_b32 v67, 0xffff0000, v67
 m16 v[52:55], a[228:231], v[0:3], v[52:55]
 rtr a[254:255], v175, 55296
 v_accvgpr_read_b32 v69, a154
 m16 v[60:63], a[228:231], v[4:7], v[60:63]
 rtr a[224:225], v172, 57344
 rtr a[226:227], v172, 59392
 v_lshlrev_b32 v68, 16, v69
 v_and_b32 v69, 0xffff0000, v69
 v_accvgpr_read_b32 v71, a155
 v_lshlrev_b32 v70, 16, v71
 v_and_b32 v71, 0xffff0000, v71
 v_accvgpr_read_b32 v73, a156
 v_lshlrev_b32 v72, 16, v73
 v_and_b32 v73, 0xffff0000, v73
 v_accvgpr_read_b32 v75, a157
 v_lshlrev_b32 v74, 16, v75
 v_and_b32 v75, 0xffff0000, v75
 v_accvgpr_read_b32 v77, a158
 v_lshlrev_b32 v76, 16, v77
 v_and_b32 v77, 0xffff0000, v77
 v_accvgpr_read_b32 v79, a159
 v_lshlrev_b32 v78, 16, v79
 v_and_b32 v79, 0xffff0000, v79
 m16 v[64:67], a[232:235], v[0:3], v[64:67]
 rtr a[228:229], v173, 57344
 cvt v144, v144, v145
 m16 v[72:75], a[232:235], v[4:7], v[72:75]
 rtr a[230:231], v173, 59392
 rtr a[232:233], v174, 57344
 s_waitcnt lgkmcnt(6)
 m16 v[68:71], a[236:239], v[0:3], v[68:71]
 rtr a[234:235], v174, 59392
 cvt v145, v146, v147
 m16 v[76:79], a[236:239], v[4:7], v[76:79]
 rtr a[236:237], v175, 57344
 rtr a[238:239], v175, 59392
 cvt v146, v148, v149
 m16 v[48:51], a[240:243], v[8:11], v[48:51]
 cvt v147, v150, v151
 m16 v[56:59], a[240:243], v[12:15], v[56:59]
 buffer_store_dwordx4 v[144:147], v253, s[28:31], s41 offen sc1
 cvt v152, v152, v153
 m16 v[52:55], a[244:247], v[8:11], v[52:55]
 cvt v153, v154, v155
 cvt v154, v156, v157
 m16 v[60:63], a[244:247], v[12:15], v[60:63]
 s_waitcnt vmcnt(1)
 v_mov_b32 v97, 1
 cvt v155, v158, v159
 m16 v[64:67], a[248:251], v[8:11], v[64:67]
 v_add_u32 v177, 0x1b000, v173
 m16 v[72:75], a[248:251], v[12:15], v[72:75]
 v_add_u32 v179, 0x1b000, v175
 s_waitcnt lgkmcnt(0)
 m16 v[68:71], a[252:255], v[8:11], v[68:71]
 v_add_u32 v176, 0x1b000, v172
 m16 v[76:79], a[252:255], v[12:15], v[76:79]
 v_add_u32 v178, 0x1b000, v174
 s_barrier
 buffer_store_dword v97, v96, s[28:31], s39 offen sc1
 m16 v[48:51], a[224:227], v[16:19], v[48:51]
 rtr a[240:241], v176
 m16 v[56:59], a[224:227], v[20:23], v[56:59]
 rtr a[242:243], v176, 2048
 rtr a[244:245], v177
 m16 v[52:55], a[228:231], v[16:19], v[52:55]
 rtr a[246:247], v177, 2048
 m16 v[60:63], a[228:231], v[20:23], v[60:63]
 rtr a[248:249], v178
 rtr a[250:251], v178, 2048
 m16 v[64:67], a[232:235], v[16:19], v[64:67]
 rtr a[252:253], v179
 m16 v[72:75], a[232:235], v[20:23], v[72:75]
 rtr a[254:255], v179, 2048
 rtr a[224:225], v176, 4096
 m16 v[68:71], a[236:239], v[16:19], v[68:71]
 rtr a[226:227], v176, 6144
 m16 v[76:79], a[236:239], v[20:23], v[76:79]
 rtr a[228:229], v177, 4096
 rtr a[230:231], v177, 6144
 s_waitcnt lgkmcnt(6)
 m16 v[48:51], a[240:243], v[24:27], v[48:51]
 rtr a[232:233], v178, 4096
 m16 v[56:59], a[240:243], v[28:31], v[56:59]
 rtr a[234:235], v178, 6144
 rtr a[236:237], v179, 4096
 m16 v[52:55], a[244:247], v[24:27], v[52:55]
 rtr a[238:239], v179, 6144
 m16 v[60:63], a[244:247], v[28:31], v[60:63]
 rtr a[240:241], v176, 8192
 rtr a[242:243], v176, 10240
 m16 v[64:67], a[248:251], v[24:27], v[64:67]
 rtr a[244:245], v177, 8192
 m16 v[72:75], a[248:251], v[28:31], v[72:75]
 rtr a[246:247], v177, 10240
 rtr a[248:249], v178, 8192
 s_waitcnt lgkmcnt(6)
 m16 v[68:71], a[252:255], v[24:27], v[68:71]
 rtr a[250:251], v178, 10240
 m16 v[76:79], a[252:255], v[28:31], v[76:79]
 rtr a[252:253], v179, 8192
 rtr a[254:255], v179, 10240
 m16 v[48:51], a[224:227], v[32:35], v[48:51]
 buffer_store_dwordx4 v[152:155], v253, s[28:31], s41 offen offset:1024 sc1
 m16 v[56:59], a[224:227], v[36:39], v[56:59]
 cvt v112, v112, v113
 cvt v113, v114, v115
 cvt v114, v116, v117
 m16 v[52:55], a[228:231], v[32:35], v[52:55]
 cvt v115, v118, v119
 v_accvgpr_read_b32 v145, a160
 m16 v[60:63], a[228:231], v[36:39], v[60:63]
 buffer_store_dwordx4 v[112:115], v253, s[28:31], s41 offen offset:2048 sc1
 cvt v120, v120, v121
 m16 v[64:67], a[232:235], v[32:35], v[64:67]
 cvt v121, v122, v123
 cvt v122, v124, v125
 m16 v[72:75], a[232:235], v[36:39], v[72:75]
 cvt v123, v126, v127
 v_lshlrev_b32 v144, 16, v145
 s_waitcnt lgkmcnt(0)
 m16 v[68:71], a[236:239], v[32:35], v[68:71]
 buffer_store_dwordx4 v[120:123], v253, s[28:31], s41 offen offset:3072 sc1
 m16 v[76:79], a[236:239], v[36:39], v[76:79]
 s_add_u32 s41, s41, 4096
 s_barrier
 m16 v[48:51], a[240:243], v[40:43], v[48:51]
 rtr a[224:225], v172, 24576
 v_and_b32 v145, 0xffff0000, v145
 m16 v[56:59], a[240:243], v[44:47], v[56:59]
 rtr a[226:227], v172, 26624
 rtr a[228:229], v173, 24576
 v_accvgpr_read_b32 v147, a161
 m16 v[52:55], a[244:247], v[40:43], v[52:55]
 rtr a[230:231], v173, 26624
 v_lshlrev_b32 v146, 16, v147
 m16 v[60:63], a[244:247], v[44:47], v[60:63]
 rtr a[232:233], v174, 24576
 rtr a[234:235], v174, 26624
 v_and_b32 v147, 0xffff0000, v147
 m16 v[64:67], a[248:251], v[40:43], v[64:67]
 rtr a[236:237], v175, 24576
 v_accvgpr_read_b32 v149, a162
 m16 v[72:75], a[248:251], v[44:47], v[72:75]
 rtr a[238:239], v175, 26624
 rtr a[240:241], v172, 28672
 v_lshlrev_b32 v148, 16, v149
 m16 v[68:71], a[252:255], v[40:43], v[68:71]
 rtr a[242:243], v172, 30720
 v_and_b32 v149, 0xffff0000, v149
 m16 v[76:79], a[252:255], v[44:47], v[76:79]
 rtr a[244:245], v173, 28672
 rtr a[246:247], v173, 30720
 v_accvgpr_read_b32 v151, a163
 v_lshlrev_b32 v150, 16, v151
 v_and_b32 v151, 0xffff0000, v151
 v_accvgpr_read_b32 v153, a164
 v_lshlrev_b32 v152, 16, v153
 v_and_b32 v153, 0xffff0000, v153
 v_accvgpr_read_b32 v155, a165
 v_lshlrev_b32 v154, 16, v155
 v_and_b32 v155, 0xffff0000, v155
 v_accvgpr_read_b32 v157, a166
 v_lshlrev_b32 v156, 16, v157
 v_and_b32 v157, 0xffff0000, v157
 v_accvgpr_read_b32 v159, a167
 v_lshlrev_b32 v158, 16, v159
 v_and_b32 v159, 0xffff0000, v159
 s_waitcnt lgkmcnt(6)
 m16 v[144:147], a[224:227], v[0:3], v[144:147]
 rtr a[248:249], v174, 28672
 v_accvgpr_read_b32 v113, a168
 m16 v[152:155], a[224:227], v[4:7], v[152:155]
 rtr a[250:251], v174, 30720
 rtr a[252:253], v175, 28672
 v_lshlrev_b32 v112, 16, v113
 m16 v[148:151], a[228:231], v[0:3], v[148:151]
 rtr a[254:255], v175, 30720
 v_and_b32 v113, 0xffff0000, v113
 m16 v[156:159], a[228:231], v[4:7], v[156:159]
 rtr a[224:225], v172, 32768
 rtr a[226:227], v172, 34816
 v_accvgpr_read_b32 v115, a169
 v_lshlrev_b32 v114, 16, v115
 v_and_b32 v115, 0xffff0000, v115
 v_accvgpr_read_b32 v117, a170
 v_lshlrev_b32 v116, 16, v117
 v_and_b32 v117, 0xffff0000, v117
 v_accvgpr_read_b32 v119, a171
 v_lshlrev_b32 v118, 16, v119
 v_and_b32 v119, 0xffff0000, v119
 v_accvgpr_read_b32 v121, a172
 v_lshlrev_b32 v120, 16, v121
 v_and_b32 v121, 0xffff0000, v121
 v_accvgpr_read_b32 v123, a173
 v_lshlrev_b32 v122, 16, v123
 v_and_b32 v123, 0xffff0000, v123
 v_accvgpr_read_b32 v125, a174
 v_lshlrev_b32 v124, 16, v125
 v_and_b32 v125, 0xffff0000, v125
 v_accvgpr_read_b32 v127, a175
 v_lshlrev_b32 v126, 16, v127
 v_and_b32 v127, 0xffff0000, v127
 m16 v[112:115], a[232:235], v[0:3], v[112:115]
 rtr a[228:229], v173, 32768
 cvt v48, v48, v49
 m16 v[120:123], a[232:235], v[4:7], v[120:123]
 rtr a[230:231], v173, 34816
 rtr a[232:233], v174, 32768
 s_waitcnt lgkmcnt(6)
 m16 v[116:119], a[236:239], v[0:3], v[116:119]
 rtr a[234:235], v174, 34816
 cvt v49, v50, v51
 m16 v[124:127], a[236:239], v[4:7], v[124:127]
 rtr a[236:237], v175, 32768
 rtr a[238:239], v175, 34816
 cvt v50, v52, v53
 m16 v[144:147], a[240:243], v[8:11], v[144:147]
 cvt v51, v54, v55
 m16 v[152:155], a[240:243], v[12:15], v[152:155]
 buffer_store_dwordx4 v[48:51], v253, s[28:31], s41 offen sc1
 cvt v56, v56, v57
 m16 v[148:151], a[244:247], v[8:11], v[148:151]
 cvt v57, v58, v59
 cvt v58, v60, v61
 m16 v[156:159], a[244:247], v[12:15], v[156:159]
 cvt v59, v62, v63
 buffer_store_dwordx4 v[56:59], v253, s[28:31], s41 offen offset:1024 sc1
 m16 v[112:115], a[248:251], v[8:11], v[112:115]
 cvt v64, v64, v65
 cvt v65, v66, v67
 m16 v[120:123], a[248:251], v[12:15], v[120:123]
 cvt v66, v68, v69
 cvt v67, v70, v71
 s_waitcnt lgkmcnt(0)
 m16 v[116:119], a[252:255], v[8:11], v[116:119]
 buffer_store_dwordx4 v[64:67], v253, s[28:31], s41 offen offset:2048 sc1
 m16 v[124:127], a[252:255], v[12:15], v[124:127]
 cvt v72, v72, v73
 s_barrier
 m16 v[144:147], a[224:227], v[16:19], v[144:147]
 rtr a[240:241], v172
 cvt v73, v74, v75
 m16 v[152:155], a[224:227], v[20:23], v[152:155]
 rtr a[242:243], v172, 2048
 rtr a[244:245], v173
 cvt v74, v76, v77
 m16 v[148:151], a[228:231], v[16:19], v[148:151]
 rtr a[246:247], v173, 2048
 cvt v75, v78, v79
 m16 v[156:159], a[228:231], v[20:23], v[156:159]
 rtr a[248:249], v174
 rtr a[250:251], v174, 2048
 v_accvgpr_read_b32 v49, a176
 m16 v[112:115], a[232:235], v[16:19], v[112:115]
 rtr a[252:253], v175
 v_lshlrev_b32 v48, 16, v49
 m16 v[120:123], a[232:235], v[20:23], v[120:123]
 rtr a[254:255], v175, 2048
 rtr a[224:225], v172, 4096
 v_and_b32 v49, 0xffff0000, v49
 m16 v[116:119], a[236:239], v[16:19], v[116:119]
 rtr a[226:227], v172, 6144
 v_accvgpr_read_b32 v51, a177
 m16 v[124:127], a[236:239], v[20:23], v[124:127]
 rtr a[228:229], v173, 4096
 rtr a[230:231], v173, 6144
 s_waitcnt lgkmcnt(6)
 m16 v[144:147], a[240:243], v[24:27], v[144:147]
 rtr a[232:233], v174, 4096
 v_lshlrev_b32 v50, 16, v51
 m16 v[152:155], a[240:243], v[28:31], v[152:155]
 rtr a[234:235], v174, 6144
 rtr a[236:237], v175, 4096
 v_and_b32 v51, 0xffff0000, v51
 m16 v[148:151], a[244:247], v[24:27], v[148:151]
 rtr a[238:239], v175, 6144
 v_accvgpr_read_b32 v53, a178
 m16 v[156:159], a[244:247], v[28:31], v[156:159]
 rtr a[240:241], v172, 8192
 rtr a[242:243], v172, 10240
 v_lshlrev_b32 v52, 16, v53
 m16 v[112:115], a[248:251], v[24:27], v[112:115]
 rtr a[244:245], v173, 8192
 v_and_b32 v53, 0xffff0000, v53
 m16 v[120:123], a[248:251], v[28:31], v[120:123]
 rtr a[246:247], v173, 10240
 rtr a[248:249], v174, 8192
 s_waitcnt lgkmcnt(6)
 m16 v[116:119], a[252:255], v[24:27], v[116:119]
 rtr a[250:251], v174, 10240
 v_accvgpr_read_b32 v55, a179
 m16 v[124:127], a[252:255], v[28:31], v[124:127]
 rtr a[252:253], v175, 8192
 rtr a[254:255], v175, 10240
 v_lshlrev_b32 v54, 16, v55
 m16 v[144:147], a[224:227], v[32:35], v[144:147]
 buffer_store_dwordx4 v[72:75], v253, s[28:31], s41 offen offset:3072 sc1
 m16 v[152:155], a[224:227], v[36:39], v[152:155]
 s_add_u32 s41, s41, 4096
 v_and_b32 v55, 0xffff0000, v55
 v_accvgpr_read_b32 v57, a180
 m16 v[148:151], a[228:231], v[32:35], v[148:151]
 v_lshlrev_b32 v56, 16, v57
 v_and_b32 v57, 0xffff0000, v57
 m16 v[156:159], a[228:231], v[36:39], v[156:159]
 v_accvgpr_read_b32 v59, a181
 v_lshlrev_b32 v58, 16, v59
 v_and_b32 v59, 0xffff0000, v59
 m16 v[112:115], a[232:235], v[32:35], v[112:115]
 v_add_u32 v177, 0x15000, v173
 v_accvgpr_read_b32 v61, a182
 m16 v[120:123], a[232:235], v[36:39], v[120:123]
 v_add_u32 v179, 0x15000, v175
 v_lshlrev_b32 v60, 16, v61
 s_waitcnt lgkmcnt(0)
 m16 v[116:119], a[236:239], v[32:35], v[116:119]
 v_add_u32 v176, 0x15000, v172
 v_and_b32 v61, 0xffff0000, v61
 m16 v[124:127], a[236:239], v[36:39], v[124:127]
 v_add_u32 v178, 0x15000, v174
 s_barrier
 m16 v[144:147], a[240:243], v[40:43], v[144:147]
 rtr a[224:225], v176
 v_accvgpr_read_b32 v63, a183
 m16 v[152:155], a[240:243], v[44:47], v[152:155]
 rtr a[226:227], v176, 2048
 rtr a[228:229], v177
 v_lshlrev_b32 v62, 16, v63
 m16 v[148:151], a[244:247], v[40:43], v[148:151]
 rtr a[230:231], v177, 2048
 v_and_b32 v63, 0xffff0000, v63
 m16 v[156:159], a[244:247], v[44:47], v[156:159]
 rtr a[232:233], v178
 rtr a[234:235], v178, 2048
 v_accvgpr_read_b32 v65, a184
 m16 v[112:115], a[248:251], v[40:43], v[112:115]
 rtr a[236:237], v179
 v_lshlrev_b32 v64, 16, v65
 m16 v[120:123], a[248:251], v[44:47], v[120:123]
 rtr a[238:239], v179, 2048
 rtr a[240:241], v176, 4096
 v_and_b32 v65, 0xffff0000, v65
 m16 v[116:119], a[252:255], v[40:43], v[116:119]
 rtr a[242:243], v176, 6144
 v_accvgpr_read_b32 v67, a185
 m16 v[124:127], a[252:255], v[44:47], v[124:127]
 rtr a[244:245], v177, 4096
 rtr a[246:247], v177, 6144
 s_waitcnt lgkmcnt(6)
 m16 v[48:51], a[224:227], v[0:3], v[48:51]
 rtr a[248:249], v178, 4096
 v_lshlrev_b32 v66, 16, v67
 m16 v[56:59], a[224:227], v[4:7], v[56:59]
 rtr a[250:251], v178, 6144
 rtr a[252:253], v179, 4096
 v_and_b32 v67, 0xffff0000, v67
 m16 v[52:55], a[228:231], v[0:3], v[52:55]
 rtr a[254:255], v179, 6144
 v_accvgpr_read_b32 v69, a186
 m16 v[60:63], a[228:231], v[4:7], v[60:63]
 rtr a[224:225], v176, 8192
 rtr a[226:227], v176, 10240
 v_lshlrev_b32 v68, 16, v69
 v_and_b32 v69, 0xffff0000, v69
 v_accvgpr_read_b32 v71, a187
 v_lshlrev_b32 v70, 16, v71
 v_and_b32 v71, 0xffff0000, v71
 v_accvgpr_read_b32 v73, a188
 v_lshlrev_b32 v72, 16, v73
 v_and_b32 v73, 0xffff0000, v73
 v_accvgpr_read_b32 v75, a189
 v_lshlrev_b32 v74, 16, v75
 v_and_b32 v75, 0xffff0000, v75
 v_accvgpr_read_b32 v77, a190
 v_lshlrev_b32 v76, 16, v77
 v_and_b32 v77, 0xffff0000, v77
 v_accvgpr_read_b32 v79, a191
 v_lshlrev_b32 v78, 16, v79
 v_and_b32 v79, 0xffff0000, v79
 m16 v[64:67], a[232:235], v[0:3], v[64:67]
 rtr a[228:229], v177, 8192
 cvt v144, v144, v145
 m16 v[72:75], a[232:235], v[4:7], v[72:75]
 rtr a[230:231], v177, 10240
 rtr a[232:233], v178, 8192
 s_waitcnt lgkmcnt(6)
 m16 v[68:71], a[236:239], v[0:3], v[68:71]
 rtr a[234:235], v178, 10240
 cvt v145, v146, v147
 m16 v[76:79], a[236:239], v[4:7], v[76:79]
 rtr a[236:237], v179, 8192
 rtr a[238:239], v179, 10240
 cvt v146, v148, v149
 m16 v[48:51], a[240:243], v[8:11], v[48:51]
 cvt v147, v150, v151
 m16 v[56:59], a[240:243], v[12:15], v[56:59]
 buffer_store_dwordx4 v[144:147], v253, s[28:31], s41 offen sc1
 cvt v152, v152, v153
 m16 v[52:55], a[244:247], v[8:11], v[52:55]
 cvt v153, v154, v155
 cvt v154, v156, v157
 m16 v[60:63], a[244:247], v[12:15], v[60:63]
 s_waitcnt vmcnt(1)
 v_mov_b32 v97, 2
 cvt v155, v158, v159
 m16 v[64:67], a[248:251], v[8:11], v[64:67]
 rtr a[240:241], v172, 12288
 m16 v[72:75], a[248:251], v[12:15], v[72:75]
 rtr a[242:243], v172, 14336
 rtr a[244:245], v173, 12288
 s_waitcnt lgkmcnt(3)
 m16 v[68:71], a[252:255], v[8:11], v[68:71]
 rtr a[246:247], v173, 14336
 m16 v[76:79], a[252:255], v[12:15], v[76:79]
 rtr a[248:249], v174, 12288
 rtr a[250:251], v174, 14336
 buffer_store_dword v97, v96, s[28:31], s39 offen sc1
 m16 v[48:51], a[224:227], v[16:19], v[48:51]
 rtr a[252:253], v175, 12288
 m16 v[56:59], a[224:227], v[20:23], v[56:59]
 rtr a[254:255], v175, 14336
 rtr a[224:225], v172, 16384
 m16 v[52:55], a[228:231], v[16:19], v[52:55]
 rtr a[226:227], v172, 18432
 m16 v[60:63], a[228:231], v[20:23], v[60:63]
 rtr a[228:229], v173, 16384
 rtr a[230:231], v173, 18432
 m16 v[64:67], a[232:235], v[16:19], v[64:67]
 buffer_store_dwordx4 v[152:155], v253, s[28:31], s41 offen offset:1024 sc1
 m16 v[72:75], a[232:235], v[20:23], v[72:75]
 rtr a[232:233], v174, 16384
 rtr a[234:235], v174, 18432
 cvt v112, v112, v113
 m16 v[68:71], a[236:239], v[16:19], v[68:71]
 cvt v113, v114, v115
 cvt v114, v116, v117
 m16 v[76:79], a[236:239], v[20:23], v[76:79]
 rtr a[236:237], v175, 16384
 rtr a[238:239], v175, 18432
 s_waitcnt lgkmcnt(4)
 m16 v[48:51], a[240:243], v[24:27], v[48:51]
 cvt v115, v118, v119
 v_accvgpr_read_b32 v145, a192
 m16 v[56:59], a[240:243], v[28:31], v[56:59]
 rtr a[240:241], v172, 20480
 rtr a[242:243], v172, 22528
 v_lshlrev_b32 v144, 16, v145
 m16 v[52:55], a[244:247], v[24:27], v[52:55]
 buffer_store_dwordx4 v[112:115], v253, s[28:31], s41 offen offset:2048 sc1
 m16 v[60:63], a[244:247], v[28:31], v[60:63]
 rtr a[244:245], v173, 20480
 rtr a[246:247], v173, 22528
 cvt v120, v120, v121
 m16 v[64:67], a[248:251], v[24:27], v[64:67]
 cvt v121, v122, v123
 cvt v122, v124, v125
 m16 v[72:75], a[248:251], v[28:31], v[72:75]
 rtr a[248:249], v174, 20480
 rtr a[250:251], v174, 22528
 cvt v123, v126, v127
 m16 v[68:71], a[252:255], v[24:27], v[68:71]
 buffer_store_dwordx4 v[120:123], v253, s[28:31], s41 offen offset:3072 sc1
 m16 v[76:79], a[252:255], v[28:31], v[76:79]
 rtr a[252:253], v175, 20480
 rtr a[254:255], v175, 22528
 s_add_u32 s41, s41, 4096
 m16 v[48:51], a[224:227], v[32:35], v[48:51]
 v_and_b32 v145, 0xffff0000, v145
 v_accvgpr_read_b32 v147, a193
 m16 v[56:59], a[224:227], v[36:39], v[56:59]
 v_lshlrev_b32 v146, 16, v147
 v_and_b32 v147, 0xffff0000, v147
 v_accvgpr_read_b32 v149, a194
 m16 v[52:55], a[228:231], v[32:35], v[52:55]
 v_lshlrev_b32 v148, 16, v149
 v_and_b32 v149, 0xffff0000, v149
 m16 v[60:63], a[228:231], v[36:39], v[60:63]
 v_accvgpr_read_b32 v151, a195
 v_lshlrev_b32 v150, 16, v151
 s_waitcnt lgkmcnt(0)
 m16 v[64:67], a[232:235], v[32:35], v[64:67]
 rtr a[224:225], v172, 36864
 v_and_b32 v151, 0xffff0000, v151
 m16 v[72:75], a[232:235], v[36:39], v[72:75]
 rtr a[226:227], v172, 38912
 rtr a[228:229], v173, 36864
 v_accvgpr_read_b32 v153, a196
 m16 v[68:71], a[236:239], v[32:35], v[68:71]
 rtr a[230:231], v173, 38912
 v_lshlrev_b32 v152, 16, v153
 m16 v[76:79], a[236:239], v[36:39], v[76:79]
 rtr a[232:233], v174, 36864
 rtr a[234:235], v174, 38912
 v_and_b32 v153, 0xffff0000, v153
 m16 v[48:51], a[240:243], v[40:43], v[48:51]
 rtr a[236:237], v175, 36864
 v_accvgpr_read_b32 v155, a197
 m16 v[56:59], a[240:243], v[44:47], v[56:59]
 rtr a[238:239], v175, 38912
 rtr a[240:241], v172, 40960
 v_lshlrev_b32 v154, 16, v155
 m16 v[52:55], a[244:247], v[40:43], v[52:55]
 rtr a[242:243], v172, 43008
 v_and_b32 v155, 0xffff0000, v155
 m16 v[60:63], a[244:247], v[44:47], v[60:63]
 rtr a[244:245], v173, 40960
 rtr a[246:247], v173, 43008
 v_accvgpr_read_b32 v157, a198
 m16 v[64:67], a[248:251], v[40:43], v[64:67]
 v_lshlrev_b32 v156, 16, v157
 v_and_b32 v157, 0xffff0000, v157
 m16 v[72:75], a[248:251], v[44:47], v[72:75]
 rtr a[248:249], v174, 40960
 rtr a[250:251], v174, 43008
 v_accvgpr_read_b32 v159, a199
 m16 v[68:71], a[252:255], v[40:43], v[68:71]
 v_lshlrev_b32 v158, 16, v159
 v_and_b32 v159, 0xffff0000, v159
 m16 v[76:79], a[252:255], v[44:47], v[76:79]
 rtr a[252:253], v175, 40960
 rtr a[254:255], v175, 43008
 s_waitcnt lgkmcnt(4)
 m16 v[144:147], a[224:227], v[0:3], v[144:147]
 v_accvgpr_read_b32 v113, a200
 v_lshlrev_b32 v112, 16, v113
 m16 v[152:155], a[224:227], v[4:7], v[152:155]
 rtr a[224:225], v172, 45056
 rtr a[226:227], v172, 47104
 v_and_b32 v113, 0xffff0000, v113
 m16 v[148:151], a[228:231], v[0:3], v[148:151]
 v_accvgpr_read_b32 v115, a201
 v_lshlrev_b32 v114, 16, v115
 m16 v[156:159], a[228:231], v[4:7], v[156:159]
 rtr a[228:229], v173, 45056
 rtr a[230:231], v173, 47104
 v_and_b32 v115, 0xffff0000, v115
 v_accvgpr_read_b32 v117, a202
 v_lshlrev_b32 v116, 16, v117
 v_and_b32 v117, 0xffff0000, v117
 v_accvgpr_read_b32 v119, a203
 v_lshlrev_b32 v118, 16, v119
 v_and_b32 v119, 0xffff0000, v119
 v_accvgpr_read_b32 v121, a204
 v_lshlrev_b32 v120, 16, v121
 v_and_b32 v121, 0xffff0000, v121
 v_accvgpr_read_b32 v123, a205
 v_lshlrev_b32 v122, 16, v123
 v_and_b32 v123, 0xffff0000, v123
 v_accvgpr_read_b32 v125, a206
 v_lshlrev_b32 v124, 16, v125
 v_and_b32 v125, 0xffff0000, v125
 v_accvgpr_read_b32 v127, a207
 v_lshlrev_b32 v126, 16, v127
 v_and_b32 v127, 0xffff0000, v127
 m16 v[112:115], a[232:235], v[0:3], v[112:115]
 cvt v48, v48, v49
 cvt v49, v50, v51
 m16 v[120:123], a[232:235], v[4:7], v[120:123]
 rtr a[232:233], v174, 45056
 rtr a[234:235], v174, 47104
 cvt v50, v52, v53
 m16 v[116:119], a[236:239], v[0:3], v[116:119]
 cvt v51, v54, v55
 m16 v[124:127], a[236:239], v[4:7], v[124:127]
 rtr a[236:237], v175, 45056
 rtr a[238:239], v175, 47104
 m16 v[144:147], a[240:243], v[8:11], v[144:147]
 buffer_store_dwordx4 v[48:51], v253, s[28:31], s41 offen sc1
 m16 v[152:155], a[240:243], v[12:15], v[152:155]
 cvt v56, v56, v57
 cvt v57, v58, v59
 cvt v58, v60, v61
 m16 v[148:151], a[244:247], v[8:11], v[148:151]
 cvt v59, v62, v63
 m16 v[156:159], a[244:247], v[12:15], v[156:159]
 buffer_store_dwordx4 v[56:59], v253, s[28:31], s41 offen offset:1024 sc1
 s_waitcnt lgkmcnt(0)
 m16 v[112:115], a[248:251], v[8:11], v[112:115]
 v_add_u32 v177, 0x1e000, v173
 cvt v64, v64, v65
 m16 v[120:123], a[248:251], v[12:15], v[120:123]
 v_add_u32 v179, 0x1e000, v175
 cvt v65, v66, v67
 cvt v66, v68, v69
 m16 v[116:119], a[252:255], v[8:11], v[116:119]
 v_add_u32 v176, 0x1e000, v172
 cvt v67, v70, v71
 m16 v[124:127], a[252:255], v[12:15], v[124:127]
 v_add_u32 v178, 0x1e000, v174
 buffer_store_dwordx4 v[64:67], v253, s[28:31], s41 offen offset:2048 sc1
 m16 v[144:147], a[224:227], v[16:19], v[144:147]
 rtr a[240:241], v176
 cvt v72, v72, v73
 m16 v[152:155], a[224:227], v[20:23], v[152:155]
 rtr a[242:243], v176, 2048
 rtr a[244:245], v177
 cvt v73, v74, v75
 m16 v[148:151], a[228:231], v[16:19], v[148:151]
 rtr a[246:247], v177, 2048
 cvt v74, v76, v77
 m16 v[156:159], a[228:231], v[20:23], v[156:159]
 rtr a[248:249], v178
 rtr a[250:251], v178, 2048
 cvt v75, v78, v79
 m16 v[112:115], a[232:235], v[16:19], v[112:115]
 rtr a[252:253], v179
 v_accvgpr_read_b32 v49, a208
 m16 v[120:123], a[232:235], v[20:23], v[120:123]
 rtr a[254:255], v179, 2048
 rtr a[224:225], v176, 4096
 v_lshlrev_b32 v48, 16, v49
 m16 v[116:119], a[236:239], v[16:19], v[116:119]
 rtr a[226:227], v176, 6144
 v_and_b32 v49, 0xffff0000, v49
 m16 v[124:127], a[236:239], v[20:23], v[124:127]
 rtr a[228:229], v177, 4096
 rtr a[230:231], v177, 6144
 s_waitcnt lgkmcnt(6)
 m16 v[144:147], a[240:243], v[24:27], v[144:147]
 rtr a[232:233], v178, 4096
 v_accvgpr_read_b32 v51, a209
 m16 v[152:155], a[240:243], v[28:31], v[152:155]
 rtr a[234:235], v178, 6144
 rtr a[236:237], v179, 4096
 v_lshlrev_b32 v50, 16, v51
 m16 v[148:151], a[244:247], v[24:27], v[148:151]
 rtr a[238:239], v179, 6144
 v_and_b32 v51, 0xffff0000, v51
 m16 v[156:159], a[244:247], v[28:31], v[156:159]
 rtr a[240:241], v176, 8192
 rtr a[242:243], v176, 10240
 v_accvgpr_read_b32 v53, a210
 m16 v[112:115], a[248:251], v[24:27], v[112:115]
 rtr a[244:245], v177, 8192
 v_lshlrev_b32 v52, 16, v53
 m16 v[120:123], a[248:251], v[28:31], v[120:123]
 rtr a[246:247], v177, 10240
 rtr a[248:249], v178, 8192
 s_waitcnt lgkmcnt(6)
 m16 v[116:119], a[252:255], v[24:27], v[116:119]
 rtr a[250:251], v178, 10240
 v_and_b32 v53, 0xffff0000, v53
 m16 v[124:127], a[252:255], v[28:31], v[124:127]
 rtr a[252:253], v179, 8192
 rtr a[254:255], v179, 10240
 v_accvgpr_read_b32 v55, a211
 m16 v[144:147], a[224:227], v[32:35], v[144:147]
 buffer_store_dwordx4 v[72:75], v253, s[28:31], s41 offen offset:3072 sc1
 m16 v[152:155], a[224:227], v[36:39], v[152:155]
 s_add_u32 s41, s41, 4096
 v_lshlrev_b32 v54, 16, v55
 v_and_b32 v55, 0xffff0000, v55
 m16 v[148:151], a[228:231], v[32:35], v[148:151]
 v_accvgpr_read_b32 v57, a212
 v_lshlrev_b32 v56, 16, v57
 m16 v[156:159], a[228:231], v[36:39], v[156:159]
 v_and_b32 v57, 0xffff0000, v57
 v_accvgpr_read_b32 v59, a213
 v_lshlrev_b32 v58, 16, v59
 m16 v[112:115], a[232:235], v[32:35], v[112:115]
 v_add_u32 v177, 0x21000, v173
 v_and_b32 v59, 0xffff0000, v59
 m16 v[120:123], a[232:235], v[36:39], v[120:123]
 v_add_u32 v179, 0x21000, v175
 v_accvgpr_read_b32 v61, a214
 s_waitcnt lgkmcnt(0)
 m16 v[116:119], a[236:239], v[32:35], v[116:119]
 v_add_u32 v176, 0x21000, v172
 v_lshlrev_b32 v60, 16, v61
 m16 v[124:127], a[236:239], v[36:39], v[124:127]
 v_add_u32 v178, 0x21000, v174
 v_and_b32 v61, 0xffff0000, v61
 v_accvgpr_read_b32 v63, a215
 m16 v[144:147], a[240:243], v[40:43], v[144:147]
 rtr a[224:225], v176
 v_lshlrev_b32 v62, 16, v63
 m16 v[152:155], a[240:243], v[44:47], v[152:155]
 rtr a[226:227], v176, 2048
 rtr a[228:229], v177
 v_and_b32 v63, 0xffff0000, v63
 m16 v[148:151], a[244:247], v[40:43], v[148:151]
 rtr a[230:231], v177, 2048
 v_accvgpr_read_b32 v65, a216
 m16 v[156:159], a[244:247], v[44:47], v[156:159]
 rtr a[232:233], v178
 rtr a[234:235], v178, 2048
 v_lshlrev_b32 v64, 16, v65
 m16 v[112:115], a[248:251], v[40:43], v[112:115]
 rtr a[236:237], v179
 v_and_b32 v65, 0xffff0000, v65
 m16 v[120:123], a[248:251], v[44:47], v[120:123]
 rtr a[238:239], v179, 2048
 rtr a[240:241], v176, 4096
 v_accvgpr_read_b32 v67, a217
 m16 v[116:119], a[252:255], v[40:43], v[116:119]
 rtr a[242:243], v176, 6144
 v_lshlrev_b32 v66, 16, v67
 m16 v[124:127], a[252:255], v[44:47], v[124:127]
 rtr a[244:245], v177, 4096
 rtr a[246:247], v177, 6144
 s_waitcnt lgkmcnt(6)
 m16 v[48:51], a[224:227], v[0:3], v[48:51]
 rtr a[248:249], v178, 4096
 v_and_b32 v67, 0xffff0000, v67
 m16 v[56:59], a[224:227], v[4:7], v[56:59]
 rtr a[250:251], v178, 6144
 rtr a[252:253], v179, 4096
 v_accvgpr_read_b32 v69, a218
 m16 v[52:55], a[228:231], v[0:3], v[52:55]
 rtr a[254:255], v179, 6144
 v_lshlrev_b32 v68, 16, v69
 m16 v[60:63], a[228:231], v[4:7], v[60:63]
 rtr a[224:225], v176, 8192
 rtr a[226:227], v176, 10240
 v_and_b32 v69, 0xffff0000, v69
 v_accvgpr_read_b32 v71, a219
 v_lshlrev_b32 v70, 16, v71
 v_and_b32 v71, 0xffff0000, v71
 v_accvgpr_read_b32 v73, a220
 v_lshlrev_b32 v72, 16, v73
 v_and_b32 v73, 0xffff0000, v73
 v_accvgpr_read_b32 v75, a221
 v_lshlrev_b32 v74, 16, v75
 v_and_b32 v75, 0xffff0000, v75
 v_accvgpr_read_b32 v77, a222
 v_lshlrev_b32 v76, 16, v77
 v_and_b32 v77, 0xffff0000, v77
 v_accvgpr_read_b32 v79, a223
 v_lshlrev_b32 v78, 16, v79
 v_and_b32 v79, 0xffff0000, v79
 m16 v[64:67], a[232:235], v[0:3], v[64:67]
 rtr a[228:229], v177, 8192
 cvt v144, v144, v145
 m16 v[72:75], a[232:235], v[4:7], v[72:75]
 rtr a[230:231], v177, 10240
 rtr a[232:233], v178, 8192
 s_waitcnt lgkmcnt(6)
 m16 v[68:71], a[236:239], v[0:3], v[68:71]
 rtr a[234:235], v178, 10240
 cvt v145, v146, v147
 m16 v[76:79], a[236:239], v[4:7], v[76:79]
 rtr a[236:237], v179, 8192
 rtr a[238:239], v179, 10240
 cvt v146, v148, v149
 m16 v[48:51], a[240:243], v[8:11], v[48:51]
 cvt v147, v150, v151
 m16 v[56:59], a[240:243], v[12:15], v[56:59]
 buffer_store_dwordx4 v[144:147], v253, s[28:31], s41 offen sc1
 cvt v152, v152, v153
 m16 v[52:55], a[244:247], v[8:11], v[52:55]
 cvt v153, v154, v155
 cvt v154, v156, v157
 m16 v[60:63], a[244:247], v[12:15], v[60:63]
 s_waitcnt vmcnt(1)
 v_mov_b32 v97, 3
 cvt v155, v158, v159
 m16 v[64:67], a[248:251], v[8:11], v[64:67]
 v_add_u32 v177, 0x24000, v173
 m16 v[72:75], a[248:251], v[12:15], v[72:75]
 v_add_u32 v179, 0x24000, v175
 s_waitcnt lgkmcnt(0)
 m16 v[68:71], a[252:255], v[8:11], v[68:71]
 v_add_u32 v176, 0x24000, v172
 m16 v[76:79], a[252:255], v[12:15], v[76:79]
 v_add_u32 v178, 0x24000, v174
 buffer_store_dword v97, v96, s[28:31], s39 offen sc1
 m16 v[48:51], a[224:227], v[16:19], v[48:51]
 rtr a[240:241], v176
 m16 v[56:59], a[224:227], v[20:23], v[56:59]
 rtr a[242:243], v176, 2048
 rtr a[244:245], v177
 m16 v[52:55], a[228:231], v[16:19], v[52:55]
 rtr a[246:247], v177, 2048
 m16 v[60:63], a[228:231], v[20:23], v[60:63]
 rtr a[248:249], v178
 rtr a[250:251], v178, 2048
 m16 v[64:67], a[232:235], v[16:19], v[64:67]
 rtr a[252:253], v179
 m16 v[72:75], a[232:235], v[20:23], v[72:75]
 rtr a[254:255], v179, 2048
 rtr a[224:225], v176, 4096
 m16 v[68:71], a[236:239], v[16:19], v[68:71]
 rtr a[226:227], v176, 6144
 m16 v[76:79], a[236:239], v[20:23], v[76:79]
 rtr a[228:229], v177, 4096
 rtr a[230:231], v177, 6144
 s_waitcnt lgkmcnt(6)
 m16 v[48:51], a[240:243], v[24:27], v[48:51]
 rtr a[232:233], v178, 4096
 m16 v[56:59], a[240:243], v[28:31], v[56:59]
 rtr a[234:235], v178, 6144
 rtr a[236:237], v179, 4096
 m16 v[52:55], a[244:247], v[24:27], v[52:55]
 rtr a[238:239], v179, 6144
 m16 v[60:63], a[244:247], v[28:31], v[60:63]
 rtr a[240:241], v176, 8192
 rtr a[242:243], v176, 10240
 m16 v[64:67], a[248:251], v[24:27], v[64:67]
 rtr a[244:245], v177, 8192
 m16 v[72:75], a[248:251], v[28:31], v[72:75]
 rtr a[246:247], v177, 10240
 rtr a[248:249], v178, 8192
 s_waitcnt lgkmcnt(6)
 m16 v[68:71], a[252:255], v[24:27], v[68:71]
 rtr a[250:251], v178, 10240
 m16 v[76:79], a[252:255], v[28:31], v[76:79]
 rtr a[252:253], v179, 8192
 rtr a[254:255], v179, 10240
 m16 v[48:51], a[224:227], v[32:35], v[48:51]
 buffer_store_dwordx4 v[152:155], v253, s[28:31], s41 offen offset:1024 sc1
 m16 v[56:59], a[224:227], v[36:39], v[56:59]
 cvt v112, v112, v113
 cvt v113, v114, v115
 cvt v114, v116, v117
 m16 v[52:55], a[228:231], v[32:35], v[52:55]
 cvt v115, v118, v119
 v_lshlrev_b32 v144, 16, v208
 m16 v[60:63], a[228:231], v[36:39], v[60:63]
 buffer_store_dwordx4 v[112:115], v253, s[28:31], s41 offen offset:2048 sc1
 cvt v120, v120, v121
 m16 v[64:67], a[232:235], v[32:35], v[64:67]
 v_add_u32 v177, 0xf000, v173
 cvt v121, v122, v123
 m16 v[72:75], a[232:235], v[36:39], v[72:75]
 v_add_u32 v179, 0xf000, v175
 cvt v122, v124, v125
 s_waitcnt lgkmcnt(0)
 m16 v[68:71], a[236:239], v[32:35], v[68:71]
 v_add_u32 v176, 0xf000, v172
 cvt v123, v126, v127
 m16 v[76:79], a[236:239], v[36:39], v[76:79]
 v_add_u32 v178, 0xf000, v174
 buffer_store_dwordx4 v[120:123], v253, s[28:31], s41 offen offset:3072 sc1
 s_add_u32 s41, s41, 4096
 m16 v[48:51], a[240:243], v[40:43], v[48:51]
 rtr a[224:225], v176
 v_and_b32 v145, 0xffff0000, v208
 m16 v[56:59], a[240:243], v[44:47], v[56:59]
 rtr a[226:227], v176, 2048
 rtr a[228:229], v177
 v_lshlrev_b32 v146, 16, v209
 m16 v[52:55], a[244:247], v[40:43], v[52:55]
 rtr a[230:231], v177, 2048
 v_and_b32 v147, 0xffff0000, v209
 m16 v[60:63], a[244:247], v[44:47], v[60:63]
 rtr a[232:233], v178
 rtr a[234:235], v178, 2048
 v_lshlrev_b32 v148, 16, v210
 m16 v[64:67], a[248:251], v[40:43], v[64:67]
 rtr a[236:237], v179
 v_and_b32 v149, 0xffff0000, v210
 m16 v[72:75], a[248:251], v[44:47], v[72:75]
 rtr a[238:239], v179, 2048
 rtr a[240:241], v176, 4096
 v_lshlrev_b32 v150, 16, v211
 m16 v[68:71], a[252:255], v[40:43], v[68:71]
 rtr a[242:243], v176, 6144
 v_and_b32 v151, 0xffff0000, v211
 m16 v[76:79], a[252:255], v[44:47], v[76:79]
 rtr a[244:245], v177, 4096
 rtr a[246:247], v177, 6144
 v_lshlrev_b32 v152, 16, v212
 v_and_b32 v153, 0xffff0000, v212
 v_lshlrev_b32 v154, 16, v213
 v_and_b32 v155, 0xffff0000, v213
 v_lshlrev_b32 v156, 16, v214
 v_and_b32 v157, 0xffff0000, v214
 v_lshlrev_b32 v158, 16, v215
 v_and_b32 v159, 0xffff0000, v215
 s_waitcnt lgkmcnt(6)
 m16 v[144:147], a[224:227], v[0:3], v[144:147]
 rtr a[248:249], v178, 4096
 v_lshlrev_b32 v112, 16, v216
 m16 v[152:155], a[224:227], v[4:7], v[152:155]
 rtr a[250:251], v178, 6144
 rtr a[252:253], v179, 4096
 v_and_b32 v113, 0xffff0000, v216
 m16 v[148:151], a[228:231], v[0:3], v[148:151]
 rtr a[254:255], v179, 6144
 v_lshlrev_b32 v114, 16, v217
 m16 v[156:159], a[228:231], v[4:7], v[156:159]
 rtr a[224:225], v176, 8192
 rtr a[226:227], v176, 10240
 v_and_b32 v115, 0xffff0000, v217
 v_lshlrev_b32 v116, 16, v218
 v_and_b32 v117, 0xffff0000, v218
 v_lshlrev_b32 v118, 16, v219
 v_and_b32 v119, 0xffff0000, v219
 v_lshlrev_b32 v120, 16, v220
 v_and_b32 v121, 0xffff0000, v220
 v_lshlrev_b32 v122, 16, v221
 v_and_b32 v123, 0xffff0000, v221
 v_lshlrev_b32 v124, 16, v222
 v_and_b32 v125, 0xffff0000, v222
 v_lshlrev_b32 v126, 16, v223
 v_and_b32 v127, 0xffff0000, v223
 m16 v[112:115], a[232:235], v[0:3], v[112:115]
 rtr a[228:229], v177, 8192
 cvt v48, v48, v49
 m16 v[120:123], a[232:235], v[4:7], v[120:123]
 rtr a[230:231], v177, 10240
 rtr a[232:233], v178, 8192
 s_waitcnt lgkmcnt(6)
 m16 v[116:119], a[236:239], v[0:3], v[116:119]
 rtr a[234:235], v178, 10240
 cvt v49, v50, v51
 m16 v[124:127], a[236:239], v[4:7], v[124:127]
 rtr a[236:237], v179, 8192
 rtr a[238:239], v179, 10240
 cvt v50, v52, v53
 m16 v[144:147], a[240:243], v[8:11], v[144:147]
 cvt v51, v54, v55
 m16 v[152:155], a[240:243], v[12:15], v[152:155]
 buffer_store_dwordx4 v[48:51], v253, s[28:31], s41 offen sc1
 cvt v56, v56, v57
 m16 v[148:151], a[244:247], v[8:11], v[148:151]
 cvt v57, v58, v59
 cvt v58, v60, v61
 m16 v[156:159], a[244:247], v[12:15], v[156:159]
 cvt v59, v62, v63
 buffer_store_dwordx4 v[56:59], v253, s[28:31], s41 offen offset:1024 sc1
 m16 v[112:115], a[248:251], v[8:11], v[112:115]
 v_add_u32 v177, 0x12000, v173
 cvt v64, v64, v65
 m16 v[120:123], a[248:251], v[12:15], v[120:123]
 v_add_u32 v179, 0x12000, v175
 cvt v65, v66, v67
 s_waitcnt lgkmcnt(0)
 m16 v[116:119], a[252:255], v[8:11], v[116:119]
 v_add_u32 v176, 0x12000, v172
 cvt v66, v68, v69
 m16 v[124:127], a[252:255], v[12:15], v[124:127]
 v_add_u32 v178, 0x12000, v174
 cvt v67, v70, v71
 v_lshlrev_b32 v48, 16, v224
 m16 v[144:147], a[224:227], v[16:19], v[144:147]
 rtr a[240:241], v176
 v_and_b32 v49, 0xffff0000, v224
 m16 v[152:155], a[224:227], v[20:23], v[152:155]
 rtr a[242:243], v176, 2048
 rtr a[244:245], v177
 v_lshlrev_b32 v50, 16, v225
 m16 v[148:151], a[228:231], v[16:19], v[148:151]
 rtr a[246:247], v177, 2048
 v_and_b32 v51, 0xffff0000, v225
 m16 v[156:159], a[228:231], v[20:23], v[156:159]
 rtr a[248:249], v178
 rtr a[250:251], v178, 2048
 v_lshlrev_b32 v52, 16, v226
 m16 v[112:115], a[232:235], v[16:19], v[112:115]
 rtr a[252:253], v179
 v_and_b32 v53, 0xffff0000, v226
 m16 v[120:123], a[232:235], v[20:23], v[120:123]
 rtr a[254:255], v179, 2048
 rtr a[224:225], v176, 4096
 v_lshlrev_b32 v54, 16, v227
 m16 v[116:119], a[236:239], v[16:19], v[116:119]
 rtr a[226:227], v176, 6144
 v_and_b32 v55, 0xffff0000, v227
 m16 v[124:127], a[236:239], v[20:23], v[124:127]
 rtr a[228:229], v177, 4096
 rtr a[230:231], v177, 6144
 s_waitcnt lgkmcnt(6)
 m16 v[144:147], a[240:243], v[24:27], v[144:147]
 rtr a[232:233], v178, 4096
 v_lshlrev_b32 v56, 16, v228
 m16 v[152:155], a[240:243], v[28:31], v[152:155]
 rtr a[234:235], v178, 6144
 rtr a[236:237], v179, 4096
 v_and_b32 v57, 0xffff0000, v228
 m16 v[148:151], a[244:247], v[24:27], v[148:151]
 rtr a[238:239], v179, 6144
 v_lshlrev_b32 v58, 16, v229
 m16 v[156:159], a[244:247], v[28:31], v[156:159]
 rtr a[240:241], v176, 8192
 rtr a[242:243], v176, 10240
 v_and_b32 v59, 0xffff0000, v229
 m16 v[112:115], a[248:251], v[24:27], v[112:115]
 rtr a[244:245], v177, 8192
 v_lshlrev_b32 v60, 16, v230
 m16 v[120:123], a[248:251], v[28:31], v[120:123]
 rtr a[246:247], v177, 10240
 rtr a[248:249], v178, 8192
 s_waitcnt lgkmcnt(6)
 m16 v[116:119], a[252:255], v[24:27], v[116:119]
 rtr a[250:251], v178, 10240
 v_and_b32 v61, 0xffff0000, v230
 m16 v[124:127], a[252:255], v[28:31], v[124:127]
 rtr a[252:253], v179, 8192
 rtr a[254:255], v179, 10240
 v_lshlrev_b32 v62, 16, v231
 m16 v[144:147], a[224:227], v[32:35], v[144:147]
 buffer_store_dwordx4 v[64:67], v253, s[28:31], s41 offen offset:2048 sc1
 m16 v[152:155], a[224:227], v[36:39], v[152:155]
 cvt v72, v72, v73
 cvt v73, v74, v75
 cvt v74, v76, v77
 m16 v[148:151], a[228:231], v[32:35], v[148:151]
 cvt v75, v78, v79
 v_and_b32 v63, 0xffff0000, v231
 m16 v[156:159], a[228:231], v[36:39], v[156:159]
 buffer_store_dwordx4 v[72:75], v253, s[28:31], s41 offen offset:3072 sc1
 s_add_u32 s41, s41, 4096
 m16 v[112:115], a[232:235], v[32:35], v[112:115]
 v_add_u32 v177, 0x18000, v173
 v_lshlrev_b32 v64, 16, v232
 m16 v[120:123], a[232:235], v[36:39], v[120:123]
 v_add_u32 v179, 0x18000, v175
 v_and_b32 v65, 0xffff0000, v232
 s_waitcnt lgkmcnt(0)
 m16 v[116:119], a[236:239], v[32:35], v[116:119]
 v_add_u32 v176, 0x18000, v172
 v_lshlrev_b32 v66, 16, v233
 m16 v[124:127], a[236:239], v[36:39], v[124:127]
 v_add_u32 v178, 0x18000, v174
 v_and_b32 v67, 0xffff0000, v233
 v_lshlrev_b32 v68, 16, v234
 m16 v[144:147], a[240:243], v[40:43], v[144:147]
 rtr a[224:225], v176
 v_and_b32 v69, 0xffff0000, v234
 m16 v[152:155], a[240:243], v[44:47], v[152:155]
 rtr a[226:227], v176, 2048
 rtr a[228:229], v177
 v_lshlrev_b32 v70, 16, v235
 m16 v[148:151], a[244:247], v[40:43], v[148:151]
 rtr a[230:231], v177, 2048
 v_and_b32 v71, 0xffff0000, v235
 m16 v[156:159], a[244:247], v[44:47], v[156:159]
 rtr a[232:233], v178
 rtr a[234:235], v178, 2048
 v_lshlrev_b32 v72, 16, v236
 m16 v[112:115], a[248:251], v[40:43], v[112:115]
 rtr a[236:237], v179
 v_and_b32 v73, 0xffff0000, v236
 m16 v[120:123], a[248:251], v[44:47], v[120:123]
 rtr a[238:239], v179, 2048
 rtr a[240:241], v176, 4096
 v_lshlrev_b32 v74, 16, v237
 m16 v[116:119], a[252:255], v[40:43], v[116:119]
 rtr a[242:243], v176, 6144
 v_and_b32 v75, 0xffff0000, v237
 m16 v[124:127], a[252:255], v[44:47], v[124:127]
 rtr a[244:245], v177, 4096
 rtr a[246:247], v177, 6144
 s_waitcnt lgkmcnt(6)
 m16 v[48:51], a[224:227], v[0:3], v[48:51]
 rtr a[248:249], v178, 4096
 v_lshlrev_b32 v76, 16, v238
 m16 v[56:59], a[224:227], v[4:7], v[56:59]
 rtr a[250:251], v178, 6144
 rtr a[252:253], v179, 4096
 v_and_b32 v77, 0xffff0000, v238
 m16 v[52:55], a[228:231], v[0:3], v[52:55]
 rtr a[254:255], v179, 6144
 v_lshlrev_b32 v78, 16, v239
 m16 v[60:63], a[228:231], v[4:7], v[60:63]
 rtr a[224:225], v176, 8192
 rtr a[226:227], v176, 10240
 v_and_b32 v79, 0xffff0000, v239
 m16 v[64:67], a[232:235], v[0:3], v[64:67]
 rtr a[228:229], v177, 8192
 cvt v144, v144, v145
 m16 v[72:75], a[232:235], v[4:7], v[72:75]
 rtr a[230:231], v177, 10240
 rtr a[232:233], v178, 8192
 s_waitcnt lgkmcnt(6)
 m16 v[68:71], a[236:239], v[0:3], v[68:71]
 rtr a[234:235], v178, 10240
 cvt v145, v146, v147
 m16 v[76:79], a[236:239], v[4:7], v[76:79]
 rtr a[236:237], v179, 8192
 rtr a[238:239], v179, 10240
 cvt v146, v148, v149
 m16 v[48:51], a[240:243], v[8:11], v[48:51]
 cvt v147, v150, v151
 m16 v[56:59], a[240:243], v[12:15], v[56:59]
 buffer_store_dwordx4 v[144:147], v253, s[28:31], s41 offen sc1
 cvt v152, v152, v153
 m16 v[52:55], a[244:247], v[8:11], v[52:55]
 cvt v153, v154, v155
 cvt v154, v156, v157
 m16 v[60:63], a[244:247], v[12:15], v[60:63]
 s_waitcnt vmcnt(1)
 v_mov_b32 v97, 4
 cvt v155, v158, v159
 m16 v[64:67], a[248:251], v[8:11], v[64:67]
 rtr a[240:241], v172, 49152
 m16 v[72:75], a[248:251], v[12:15], v[72:75]
 rtr a[242:243], v172, 51200
 rtr a[244:245], v173, 49152
 s_waitcnt lgkmcnt(3)
 m16 v[68:71], a[252:255], v[8:11], v[68:71]
 rtr a[246:247], v173, 51200
 m16 v[76:79], a[252:255], v[12:15], v[76:79]
 rtr a[248:249], v174, 49152
 rtr a[250:251], v174, 51200
 buffer_store_dword v97, v96, s[28:31], s39 offen sc1
 m16 v[48:51], a[224:227], v[16:19], v[48:51]
 rtr a[252:253], v175, 49152
 m16 v[56:59], a[224:227], v[20:23], v[56:59]
 rtr a[254:255], v175, 51200
 rtr a[224:225], v172, 53248
 m16 v[52:55], a[228:231], v[16:19], v[52:55]
 rtr a[226:227], v172, 55296
 m16 v[60:63], a[228:231], v[20:23], v[60:63]
 rtr a[228:229], v173, 53248
 rtr a[230:231], v173, 55296
 m16 v[64:67], a[232:235], v[16:19], v[64:67]
 buffer_store_dwordx4 v[152:155], v253, s[28:31], s41 offen offset:1024 sc1
 m16 v[72:75], a[232:235], v[20:23], v[72:75]
 rtr a[232:233], v174, 53248
 rtr a[234:235], v174, 55296
 cvt v112, v112, v113
 m16 v[68:71], a[236:239], v[16:19], v[68:71]
 cvt v113, v114, v115
 cvt v114, v116, v117
 m16 v[76:79], a[236:239], v[20:23], v[76:79]
 rtr a[236:237], v175, 53248
 rtr a[238:239], v175, 55296
 s_waitcnt lgkmcnt(4)
 m16 v[48:51], a[240:243], v[24:27], v[48:51]
 cvt v115, v118, v119
 m16 v[56:59], a[240:243], v[28:31], v[56:59]
 rtr a[240:241], v172, 57344
 rtr a[242:243], v172, 59392
 m16 v[52:55], a[244:247], v[24:27], v[52:55]
 buffer_store_dwordx4 v[112:115], v253, s[28:31], s41 offen offset:2048 sc1
 m16 v[60:63], a[244:247], v[28:31], v[60:63]
 rtr a[244:245], v173, 57344
 rtr a[246:247], v173, 59392
 cvt v120, v120, v121
 m16 v[64:67], a[248:251], v[24:27], v[64:67]
 cvt v121, v122, v123
 cvt v122, v124, v125
 m16 v[72:75], a[248:251], v[28:31], v[72:75]
 rtr a[248:249], v174, 57344
 rtr a[250:251], v174, 59392
 cvt v123, v126, v127
 m16 v[68:71], a[252:255], v[24:27], v[68:71]
 buffer_store_dwordx4 v[120:123], v253, s[28:31], s41 offen offset:3072 sc1
 m16 v[76:79], a[252:255], v[28:31], v[76:79]
 rtr a[252:253], v175, 57344
 rtr a[254:255], v175, 59392
 s_add_u32 s41, s41, 4096
 m16 v[48:51], a[224:227], v[32:35], v[48:51]
 m16 v[56:59], a[224:227], v[36:39], v[56:59]
 m16 v[52:55], a[228:231], v[32:35], v[52:55]
 m16 v[60:63], a[228:231], v[36:39], v[60:63]
 s_waitcnt lgkmcnt(0)
 m16 v[64:67], a[232:235], v[32:35], v[64:67]
 m16 v[72:75], a[232:235], v[36:39], v[72:75]
 m16 v[68:71], a[236:239], v[32:35], v[68:71]
 m16 v[76:79], a[236:239], v[36:39], v[76:79]
 m16 v[48:51], a[240:243], v[40:43], v[48:51]
 m16 v[56:59], a[240:243], v[44:47], v[56:59]
 m16 v[52:55], a[244:247], v[40:43], v[52:55]
 m16 v[60:63], a[244:247], v[44:47], v[60:63]
 m16 v[64:67], a[248:251], v[40:43], v[64:67]
 m16 v[72:75], a[248:251], v[44:47], v[72:75]
 m16 v[68:71], a[252:255], v[40:43], v[68:71]
 m16 v[76:79], a[252:255], v[44:47], v[76:79]
 s_nop 4
 cvt v48, v48, v49
 cvt v49, v50, v51
 cvt v50, v52, v53
 cvt v51, v54, v55
 buffer_store_dwordx4 v[48:51], v253, s[28:31], s41 offen sc1
 cvt v56, v56, v57
 cvt v57, v58, v59
 cvt v58, v60, v61
 cvt v59, v62, v63
 buffer_store_dwordx4 v[56:59], v253, s[28:31], s41 offen offset:1024 sc1
 cvt v64, v64, v65
 cvt v65, v66, v67
 cvt v66, v68, v69
 cvt v67, v70, v71
 buffer_store_dwordx4 v[64:67], v253, s[28:31], s41 offen offset:2048 sc1
 cvt v72, v72, v73
 cvt v73, v74, v75
 cvt v74, v76, v77
 cvt v75, v78, v79
 buffer_store_dwordx4 v[72:75], v253, s[28:31], s41 offen offset:3072 sc1
 s_add_u32 s41, s41, 4096
 v_lshrrev_b32 v4, 4, v253
 s_mul_i32 s43, s40, 983040
 s_lshl_b32 s46, s34, 10
 s_add_u32 s43, s43, s46
 s_mul_i32 s50, s33, 245760
 s_mul_i32 s46, s35, 1280
 s_add_u32 s50, s50, s46
 s_lshr_b32 s46, s34, 1
 s_lshl_b32 s46, s46, 6
 s_add_u32 s50, s50, s46
 s_and_b32 s46, s34, 1
 s_mul_i32 s46, s46, 40960
 s_add_u32 s50, s50, s46
 s_lshl_b32 s47, s40, 10
 s_add_u32 s47, s47, 33554432
 s_mov_b32 s42, 262144
 v_and_b32 v5, 15, v4
 v_mul_u32_u24 v5, 2560, v5
 v_bfe_u32 v7, v4, 4, 1
 v_lshl_add_u32 v5, v7, 5, v5
 v_lshrrev_b32 v7, 5, v4
 v_lshl_add_u32 v5, v7, 4, v5
 v_and_b32 v6, 7, v4
 v_lshlrev_b32 v6, 7, v6
 s_lshl_b32 s46, s32, 2
 s_add_u32 s47, s47, s46
 s_mul_i32 s46, s32, 40960
 s_add_u32 s43, s43, s46
 s_mul_i32 s46, s32, 81920
 s_add_u32 s50, s50, s46
 buffer_load_dword v8, v6, s[28:31], s47 offen sc1
 s_waitcnt vmcnt(1)
 v_mov_b32 v97, 5
 buffer_store_dword v97, v96, s[28:31], s39 offen sc1
 s_waitcnt vmcnt(1)
PB:
 v_cmp_gt_u32 vcc, 4, v8
 s_cbranch_vccz PBy
 s_sleep 4
 buffer_load_dword v8, v6, s[28:31], s47 offen sc1
 s_sub_u32 s42, s42, 1
 s_waitcnt vmcnt(0)
 s_cbranch_scc0 PB
 s_endpgm
PBy:
 s_add_u32 s46, s43, 16384
 buffer_load_dwordx4 v[112:115], v253, s[28:31], s46 offen sc1
 s_add_u32 s46, s46, 122880
 buffer_load_dwordx4 v[116:119], v253, s[28:31], s46 offen sc1
 s_add_u32 s46, s46, 122880
 buffer_load_dwordx4 v[120:123], v253, s[28:31], s46 offen sc1
 s_add_u32 s46, s46, 122880
 buffer_load_dwordx4 v[124:127], v253, s[28:31], s46 offen sc1
 s_add_u32 s46, s46, 122880
 buffer_load_dwordx4 v[128:131], v253, s[28:31], s46 offen sc1
 s_add_u32 s46, s46, 122880
 buffer_load_dwordx4 v[132:135], v253, s[28:31], s46 offen sc1
 s_add_u32 s46, s46, 122880
 buffer_load_dwordx4 v[136:139], v253, s[28:31], s46 offen sc1
 s_add_u32 s46, s46, 122880
 buffer_load_dwordx4 v[140:143], v253, s[28:31], s46 offen sc1
 s_add_u32 s46, s43, 24576
 buffer_load_dwordx4 v[144:147], v253, s[28:31], s46 offen sc1
 s_add_u32 s46, s46, 122880
 buffer_load_dwordx4 v[148:151], v253, s[28:31], s46 offen sc1
 s_add_u32 s46, s46, 122880
 buffer_load_dwordx4 v[152:155], v253, s[28:31], s46 offen sc1
 s_add_u32 s46, s46, 122880
 buffer_load_dwordx4 v[156:159], v253, s[28:31], s46 offen sc1
 s_add_u32 s46, s46, 122880
 buffer_load_dwordx4 v[160:163], v253, s[28:31], s46 offen sc1
 s_add_u32 s46, s46, 122880
 buffer_load_dwordx4 v[164:167], v253, s[28:31], s46 offen sc1
 s_add_u32 s46, s46, 122880
 buffer_load_dwordx4 v[168:171], v253, s[28:31], s46 offen sc1
 s_add_u32 s46, s46, 122880
 buffer_load_dwordx4 v[172:175], v253, s[28:31], s46 offen sc1
 buffer_load_dword v8, v6, s[28:31], s47 offen sc1
 s_movk_i32 s6, 0
 s_add_u32 s46, s50, 512
 s_waitcnt vmcnt(9)
 s_call_b64 s[44:45], RSUM
 s_movk_i32 s6, 32
 s_add_u32 s46, s50, 768
 s_waitcnt vmcnt(2)
 s_call_b64 s[44:45], RSUM
 s_waitcnt vmcnt(2)
PA:
 v_cmp_gt_u32 vcc, 5, v8
 s_cbranch_vccz PAy
 s_sleep 4
 buffer_load_dword v8, v6, s[28:31], s47 offen sc1
 s_sub_u32 s42, s42, 1
 s_waitcnt vmcnt(0)
 s_cbranch_scc0 PA
 s_endpgm
PAy:
 s_add_u32 s46, s43, 32768
 buffer_load_dwordx4 v[112:115], v253, s[28:31], s46 offen sc1
 s_add_u32 s46, s46, 122880
 buffer_load_dwordx4 v[116:119], v253, s[28:31], s46 offen sc1
 s_add_u32 s46, s46, 122880
 buffer_load_dwordx4 v[120:123], v253, s[28:31], s46 offen sc1
 s_add_u32 s46, s46, 122880
 buffer_load_dwordx4 v[124:127], v253, s[28:31], s46 offen sc1
 s_add_u32 s46, s46, 122880
 buffer_load_dwordx4 v[128:131], v253, s[28:31], s46 offen sc1
 s_add_u32 s46, s46, 122880
 buffer_load_dwordx4 v[132:135], v253, s[28:31], s46 offen sc1
 s_add_u32 s46, s46, 122880
 buffer_load_dwordx4 v[136:139], v253, s[28:31], s46 offen sc1
 s_add_u32 s46, s46, 122880
 buffer_load_dwordx4 v[140:143], v253, s[28:31], s46 offen sc1
 s_movk_i32 s6, 0
 s_add_u32 s46, s50, 1024
 s_waitcnt vmcnt(0)
 s_call_b64 s[44:45], RSUM
PDONE:
 s_endpgm
CODEEND:
RS1_0:
 s_call_b64 s[44:45], RARE1
 s_branch RB1_0
RS2_0:
 s_call_b64 s[44:45], RARE0
 s_branch RB2_0
RS3_0:
 s_call_b64 s[44:45], RARE1
 s_branch RB3_0
RS4_0:
 s_call_b64 s[44:45], RARE0
 s_branch RB4_0
RS5_0:
 s_call_b64 s[44:45], RARE1
 s_branch RB5_0
RS6_0:
 s_call_b64 s[44:45], RARE0
 s_branch RB6_0
RS7_0:
 s_call_b64 s[44:45], RARE1
 s_branch RB7_0
RS8_0:
 s_call_b64 s[44:45], RARE0
 s_branch RB8_0
RS9_0:
 s_call_b64 s[44:45], RARE1
 s_branch RB9_0
RS10_0:
 s_call_b64 s[44:45], RARE0
 s_branch RB10_0
RS11_0:
 s_call_b64 s[44:45], RARE1
 s_branch RB11_0
RS12_0:
 s_call_b64 s[44:45], RARE0
 s_branch RB12_0
RS13_0:
 s_call_b64 s[44:45], RARE1
 s_branch RB13_0
RS14_0:
 s_call_b64 s[44:45], RARE0
 s_branch RB14_0
RS15_0:
 s_call_b64 s[44:45], RARE1
 s_branch RB15_0
RS1_1:
 s_call_b64 s[44:45], RARE1
 s_branch RB1_1
RS2_1:
 s_call_b64 s[44:45], RARE0
 s_branch RB2_1
RS3_1:
 s_call_b64 s[44:45], RARE1
 s_branch RB3_1
RS4_1:
 s_call_b64 s[44:45], RARE0
 s_branch RB4_1
RS5_1:
 s_call_b64 s[44:45], RARE1
 s_branch RB5_1
RS6_1:
 s_call_b64 s[44:45], RARE0
 s_branch RB6_1
RS7_1:
 s_call_b64 s[44:45], RARE1
 s_branch RB7_1
RS8_1:
 s_call_b64 s[44:45], RARE0
 s_branch RB8_1
RS9_1:
 s_call_b64 s[44:45], RARE1
 s_branch RB9_1
RS10_1:
 s_call_b64 s[44:45], RARE0
 s_branch RB10_1
RS11_1:
 s_call_b64 s[44:45], RARE1
 s_branch RB11_1
RS12_1:
 s_call_b64 s[44:45], RARE0
 s_branch RB12_1
RS13_1:
 s_call_b64 s[44:45], RARE1
 s_branch RB13_1
RS14_1:
 s_call_b64 s[44:45], RARE0
 s_branch RB14_1
RS15_1:
 s_call_b64 s[44:45], RARE1
 s_branch RB15_1
MB0:
 v_add_u32 v252, s87, v253
 ds_read_b128 a[48:51], v252
 ds_read_b128 a[52:55], v252 offset:1024
 ds_read_b128 a[56:59], v252 offset:2048
 ds_read_b128 a[60:63], v252 offset:3072
 ds_read_b128 a[64:67], v252 offset:4096
 ds_read_b128 a[68:71], v252 offset:5120
 ds_read_b128 a[72:75], v252 offset:6144
 ds_read_b128 a[76:79], v252 offset:7168
 ds_read_b128 a[80:83], v252 offset:8192
 ds_read_b128 a[84:87], v252 offset:9216
 ds_read_b128 a[88:91], v252 offset:10240
 ds_read_b128 a[92:95], v252 offset:11264
 s_waitcnt lgkmcnt(0)
 s_branch MR0
MB1:
 v_add_u32 v96, s87, v253
 ds_read_b128 a[48:51], v96
 ds_read_b128 a[52:55], v96 offset:1024
 ds_read_b128 a[56:59], v96 offset:2048
 ds_read_b128 a[60:63], v96 offset:3072
 ds_read_b128 a[64:67], v96 offset:4096
 ds_read_b128 a[68:71], v96 offset:5120
 ds_read_b128 a[72:75], v96 offset:6144
 ds_read_b128 a[76:79], v96 offset:7168
 ds_read_b128 a[80:83], v96 offset:8192
 ds_read_b128 a[84:87], v96 offset:9216
 ds_read_b128 a[88:91], v96 offset:10240
 ds_read_b128 a[92:95], v96 offset:11264
 s_waitcnt lgkmcnt(0)
 s_branch MR1
RARE0:
 s_nop 15
 s_nop 3
 v_max3_f32 v250, v144, v145, v146
 v_max3_f32 v250, v250, v147, v148
 v_max3_f32 v250, v250, v149, v150
 v_max_f32 v250, v250, v151
 v_mov_b32 v251, v250
 s_nop 1
 v_permlane16_swap_b32 v250, v251
 v_max_f32 v250, v250, v251
 v_mov_b32 v251, v250
 s_nop 1
 v_permlane32_swap_b32 v250, v251
 v_max_f32 v250, v250, v251
 v_max_f32 v250, 0, v250
 v_sub_f32 v251, 0, v250
 v_mul_f32 v251, s36, v251
 v_exp_f32 v251, v251
 v_sub_f32 v160, v160, v250
 v_sub_f32 v161, v161, v250
 v_sub_f32 v162, v162, v250
 v_sub_f32 v163, v163, v250
 v_sub_f32 v144, v144, v250
 v_sub_f32 v145, v145, v250
 v_sub_f32 v146, v146, v250
 v_sub_f32 v147, v147, v250
 v_sub_f32 v148, v148, v250
 v_sub_f32 v149, v149, v250
 v_sub_f32 v150, v150, v250
 v_sub_f32 v151, v151, v250
 v_mul_f32 v0, v0, v251
 v_mul_f32 v1, v1, v251
 v_mul_f32 v2, v2, v251
 v_mul_f32 v3, v3, v251
 v_mul_f32 v4, v4, v251
 v_mul_f32 v5, v5, v251
 v_mul_f32 v6, v6, v251
 v_mul_f32 v7, v7, v251
 v_mul_f32 v16, v16, v251
 v_mul_f32 v17, v17, v251
 v_mul_f32 v18, v18, v251
 v_mul_f32 v19, v19, v251
 v_mul_f32 v20, v20, v251
 v_mul_f32 v21, v21, v251
 v_mul_f32 v22, v22, v251
 v_mul_f32 v23, v23, v251
 v_mul_f32 v32, v32, v251
 v_mul_f32 v33, v33, v251
 v_mul_f32 v34, v34, v251
 v_mul_f32 v35, v35, v251
 v_mul_f32 v36, v36, v251
 v_mul_f32 v37, v37, v251
 v_mul_f32 v38, v38, v251
 v_mul_f32 v39, v39, v251
 v_mul_f32 v48, v48, v251
 v_mul_f32 v49, v49, v251
 v_mul_f32 v50, v50, v251
 v_mul_f32 v51, v51, v251
 v_mul_f32 v52, v52, v251
 v_mul_f32 v53, v53, v251
 v_mul_f32 v54, v54, v251
 v_mul_f32 v55, v55, v251
 v_mul_f32 v64, v64, v251
 v_mul_f32 v65, v65, v251
 v_mul_f32 v66, v66, v251
 v_mul_f32 v67, v67, v251
 v_mul_f32 v68, v68, v251
 v_mul_f32 v69, v69, v251
 v_mul_f32 v70, v70, v251
 v_mul_f32 v71, v71, v251
 v_mul_f32 v80, v80, v251
 v_mul_f32 v81, v81, v251
 v_mul_f32 v82, v82, v251
 v_mul_f32 v83, v83, v251
 v_mul_f32 v84, v84, v251
 v_mul_f32 v85, v85, v251
 v_mul_f32 v86, v86, v251
 v_mul_f32 v87, v87, v251
 v_mul_f32 v248, v248, v251
 v_max3_f32 v250, v152, v153, v154
 v_max3_f32 v250, v250, v155, v156
 v_max3_f32 v250, v250, v157, v158
 v_max_f32 v250, v250, v159
 v_mov_b32 v251, v250
 s_nop 1
 v_permlane16_swap_b32 v250, v251
 v_max_f32 v250, v250, v251
 v_mov_b32 v251, v250
 s_nop 1
 v_permlane32_swap_b32 v250, v251
 v_max_f32 v250, v250, v251
 v_max_f32 v250, 0, v250
 v_sub_f32 v251, 0, v250
 v_mul_f32 v251, s36, v251
 v_exp_f32 v251, v251
 v_sub_f32 v164, v164, v250
 v_sub_f32 v165, v165, v250
 v_sub_f32 v166, v166, v250
 v_sub_f32 v167, v167, v250
 v_sub_f32 v152, v152, v250
 v_sub_f32 v153, v153, v250
 v_sub_f32 v154, v154, v250
 v_sub_f32 v155, v155, v250
 v_sub_f32 v156, v156, v250
 v_sub_f32 v157, v157, v250
 v_sub_f32 v158, v158, v250
 v_sub_f32 v159, v159, v250
 v_mul_f32 v8, v8, v251
 v_mul_f32 v9, v9, v251
 v_mul_f32 v10, v10, v251
 v_mul_f32 v11, v11, v251
 v_mul_f32 v12, v12, v251
 v_mul_f32 v13, v13, v251
 v_mul_f32 v14, v14, v251
 v_mul_f32 v15, v15, v251
 v_mul_f32 v24, v24, v251
 v_mul_f32 v25, v25, v251
 v_mul_f32 v26, v26, v251
 v_mul_f32 v27, v27, v251
 v_mul_f32 v28, v28, v251
 v_mul_f32 v29, v29, v251
 v_mul_f32 v30, v30, v251
 v_mul_f32 v31, v31, v251
 v_mul_f32 v40, v40, v251
 v_mul_f32 v41, v41, v251
 v_mul_f32 v42, v42, v251
 v_mul_f32 v43, v43, v251
 v_mul_f32 v44, v44, v251
 v_mul_f32 v45, v45, v251
 v_mul_f32 v46, v46, v251
 v_mul_f32 v47, v47, v251
 v_mul_f32 v56, v56, v251
 v_mul_f32 v57, v57, v251
 v_mul_f32 v58, v58, v251
 v_mul_f32 v59, v59, v251
 v_mul_f32 v60, v60, v251
 v_mul_f32 v61, v61, v251
 v_mul_f32 v62, v62, v251
 v_mul_f32 v63, v63, v251
 v_mul_f32 v72, v72, v251
 v_mul_f32 v73, v73, v251
 v_mul_f32 v74, v74, v251
 v_mul_f32 v75, v75, v251
 v_mul_f32 v76, v76, v251
 v_mul_f32 v77, v77, v251
 v_mul_f32 v78, v78, v251
 v_mul_f32 v79, v79, v251
 v_mul_f32 v88, v88, v251
 v_mul_f32 v89, v89, v251
 v_mul_f32 v90, v90, v251
 v_mul_f32 v91, v91, v251
 v_mul_f32 v92, v92, v251
 v_mul_f32 v93, v93, v251
 v_mul_f32 v94, v94, v251
 v_mul_f32 v95, v95, v251
 v_mul_f32 v168, v168, v251
 v_mul_f32 v250, s36, v144
 v_mul_f32 v251, s36, v145
 v_exp_f32 v250, v250
 v_exp_f32 v251, v251
 s_nop 0
 cvt v176, v250, v251
 v_add_f32 v249, v250, v251
 v_mul_f32 v250, s36, v146
 v_mul_f32 v251, s36, v147
 v_exp_f32 v250, v250
 v_exp_f32 v251, v251
 v_add_f32 v249, v249, v250
 v_add_f32 v249, v249, v251
 cvt v177, v250, v251
 v_mul_f32 v250, s36, v148
 v_mul_f32 v251, s36, v149
 v_exp_f32 v250, v250
 v_exp_f32 v251, v251
 v_add_f32 v249, v249, v250
 v_add_f32 v249, v249, v251
 cvt v178, v250, v251
 v_mul_f32 v250, s36, v150
 v_mul_f32 v251, s36, v151
 v_exp_f32 v250, v250
 v_exp_f32 v251, v251
 v_add_f32 v249, v249, v250
 v_add_f32 v249, v249, v251
 cvt v179, v250, v251
 v_mul_f32 v250, s36, v152
 v_mul_f32 v251, s36, v153
 v_exp_f32 v250, v250
 v_exp_f32 v251, v251
 s_nop 0
 cvt v180, v250, v251
 v_add_f32 v169, v250, v251
 v_mul_f32 v250, s36, v154
 v_mul_f32 v251, s36, v155
 v_exp_f32 v250, v250
 v_exp_f32 v251, v251
 v_add_f32 v169, v169, v250
 v_add_f32 v169, v169, v251
 cvt v181, v250, v251
 v_mul_f32 v250, s36, v156
 v_mul_f32 v251, s36, v157
 v_exp_f32 v250, v250
 v_exp_f32 v251, v251
 v_add_f32 v169, v169, v250
 v_add_f32 v169, v169, v251
 cvt v182, v250, v251
 v_mul_f32 v250, s36, v158
 v_mul_f32 v251, s36, v159
 v_exp_f32 v250, v250
 v_exp_f32 v251, v251
 v_add_f32 v169, v169, v250
 v_add_f32 v169, v169, v251
 cvt v183, v250, v251
 s_nop 3
 s_setpc_b64 s[44:45]
RARE1:
 s_nop 15
 s_nop 3
 v_max3_f32 v250, v144, v145, v146
 v_max3_f32 v250, v250, v147, v148
 v_max3_f32 v250, v250, v149, v150
 v_max_f32 v250, v250, v151
 v_mov_b32 v251, v250
 s_nop 1
 v_permlane16_swap_b32 v250, v251
 v_max_f32 v250, v250, v251
 v_mov_b32 v251, v250
 s_nop 1
 v_permlane32_swap_b32 v250, v251
 v_max_f32 v250, v250, v251
 v_max_f32 v250, 0, v250
 v_sub_f32 v251, 0, v250
 v_mul_f32 v251, s36, v251
 v_exp_f32 v251, v251
 v_sub_f32 v160, v160, v250
 v_sub_f32 v161, v161, v250
 v_sub_f32 v162, v162, v250
 v_sub_f32 v163, v163, v250
 v_sub_f32 v144, v144, v250
 v_sub_f32 v145, v145, v250
 v_sub_f32 v146, v146, v250
 v_sub_f32 v147, v147, v250
 v_sub_f32 v148, v148, v250
 v_sub_f32 v149, v149, v250
 v_sub_f32 v150, v150, v250
 v_sub_f32 v151, v151, v250
 v_mul_f32 v0, v0, v251
 v_mul_f32 v1, v1, v251
 v_mul_f32 v2, v2, v251
 v_mul_f32 v3, v3, v251
 v_mul_f32 v4, v4, v251
 v_mul_f32 v5, v5, v251
 v_mul_f32 v6, v6, v251
 v_mul_f32 v7, v7, v251
 v_mul_f32 v16, v16, v251
 v_mul_f32 v17, v17, v251
 v_mul_f32 v18, v18, v251
 v_mul_f32 v19, v19, v251
 v_mul_f32 v20, v20, v251
 v_mul_f32 v21, v21, v251
 v_mul_f32 v22, v22, v251
 v_mul_f32 v23, v23, v251
 v_mul_f32 v32, v32, v251
 v_mul_f32 v33, v33, v251
 v_mul_f32 v34, v34, v251
 v_mul_f32 v35, v35, v251
 v_mul_f32 v36, v36, v251
 v_mul_f32 v37, v37, v251
 v_mul_f32 v38, v38, v251
 v_mul_f32 v39, v39, v251
 v_mul_f32 v48, v48, v251
 v_mul_f32 v49, v49, v251
 v_mul_f32 v50, v50, v251
 v_mul_f32 v51, v51, v251
 v_mul_f32 v52, v52, v251
 v_mul_f32 v53, v53, v251
 v_mul_f32 v54, v54, v251
 v_mul_f32 v55, v55, v251
 v_mul_f32 v64, v64, v251
 v_mul_f32 v65, v65, v251
 v_mul_f32 v66, v66, v251
 v_mul_f32 v67, v67, v251
 v_mul_f32 v68, v68, v251
 v_mul_f32 v69, v69, v251
 v_mul_f32 v70, v70, v251
 v_mul_f32 v71, v71, v251
 v_mul_f32 v80, v80, v251
 v_mul_f32 v81, v81, v251
 v_mul_f32 v82, v82, v251
 v_mul_f32 v83, v83, v251
 v_mul_f32 v84, v84, v251
 v_mul_f32 v85, v85, v251
 v_mul_f32 v86, v86, v251
 v_mul_f32 v87, v87, v251
 v_mul_f32 v248, v248, v251
 v_max3_f32 v250, v152, v153, v154
 v_max3_f32 v250, v250, v155, v156
 v_max3_f32 v250, v250, v157, v158
 v_max_f32 v250, v250, v159
 v_mov_b32 v251, v250
 s_nop 1
 v_permlane16_swap_b32 v250, v251
 v_max_f32 v250, v250, v251
 v_mov_b32 v251, v250
 s_nop 1
 v_permlane32_swap_b32 v250, v251
 v_max_f32 v250, v250, v251
 v_max_f32 v250, 0, v250
 v_sub_f32 v251, 0, v250
 v_mul_f32 v251, s36, v251
 v_exp_f32 v251, v251
 v_sub_f32 v164, v164, v250
 v_sub_f32 v165, v165, v250
 v_sub_f32 v166, v166, v250
 v_sub_f32 v167, v167, v250
 v_sub_f32 v152, v152, v250
 v_sub_f32 v153, v153, v250
 v_sub_f32 v154, v154, v250
 v_sub_f32 v155, v155, v250
 v_sub_f32 v156, v156, v250
 v_sub_f32 v157, v157, v250
 v_sub_f32 v158, v158, v250
 v_sub_f32 v159, v159, v250
 v_mul_f32 v8, v8, v251
 v_mul_f32 v9, v9, v251
 v_mul_f32 v10, v10, v251
 v_mul_f32 v11, v11, v251
 v_mul_f32 v12, v12, v251
 v_mul_f32 v13, v13, v251
 v_mul_f32 v14, v14, v251
 v_mul_f32 v15, v15, v251
 v_mul_f32 v24, v24, v251
 v_mul_f32 v25, v25, v251
 v_mul_f32 v26, v26, v251
 v_mul_f32 v27, v27, v251
 v_mul_f32 v28, v28, v251
 v_mul_f32 v29, v29, v251
 v_mul_f32 v30, v30, v251
 v_mul_f32 v31, v31, v251
 v_mul_f32 v40, v40, v251
 v_mul_f32 v41, v41, v251
 v_mul_f32 v42, v42, v251
 v_mul_f32 v43, v43, v251
 v_mul_f32 v44, v44, v251
 v_mul_f32 v45, v45, v251
 v_mul_f32 v46, v46, v251
 v_mul_f32 v47, v47, v251
 v_mul_f32 v56, v56, v251
 v_mul_f32 v57, v57, v251
 v_mul_f32 v58, v58, v251
 v_mul_f32 v59, v59, v251
 v_mul_f32 v60, v60, v251
 v_mul_f32 v61, v61, v251
 v_mul_f32 v62, v62, v251
 v_mul_f32 v63, v63, v251
 v_mul_f32 v72, v72, v251
 v_mul_f32 v73, v73, v251
 v_mul_f32 v74, v74, v251
 v_mul_f32 v75, v75, v251
 v_mul_f32 v76, v76, v251
 v_mul_f32 v77, v77, v251
 v_mul_f32 v78, v78, v251
 v_mul_f32 v79, v79, v251
 v_mul_f32 v88, v88, v251
 v_mul_f32 v89, v89, v251
 v_mul_f32 v90, v90, v251
 v_mul_f32 v91, v91, v251
 v_mul_f32 v92, v92, v251
 v_mul_f32 v93, v93, v251
 v_mul_f32 v94, v94, v251
 v_mul_f32 v95, v95, v251
 v_mul_f32 v168, v168, v251
 v_mul_f32 v250, s36, v144
 v_mul_f32 v251, s36, v145
 v_exp_f32 v250, v250
 v_exp_f32 v251, v251
 s_nop 0
 cvt v184, v250, v251
 v_add_f32 v249, v250, v251
 v_mul_f32 v250, s36, v146
 v_mul_f32 v251, s36, v147
 v_exp_f32 v250, v250
 v_exp_f32 v251, v251
 v_add_f32 v249, v249, v250
 v_add_f32 v249, v249, v251
 cvt v185, v250, v251
 v_mul_f32 v250, s36, v148
 v_mul_f32 v251, s36, v149
 v_exp_f32 v250, v250
 v_exp_f32 v251, v251
 v_add_f32 v249, v249, v250
 v_add_f32 v249, v249, v251
 cvt v186, v250, v251
 v_mul_f32 v250, s36, v150
 v_mul_f32 v251, s36, v151
 v_exp_f32 v250, v250
 v_exp_f32 v251, v251
 v_add_f32 v249, v249, v250
 v_add_f32 v249, v249, v251
 cvt v187, v250, v251
 v_mul_f32 v250, s36, v152
 v_mul_f32 v251, s36, v153
 v_exp_f32 v250, v250
 v_exp_f32 v251, v251
 s_nop 0
 cvt v188, v250, v251
 v_add_f32 v169, v250, v251
 v_mul_f32 v250, s36, v154
 v_mul_f32 v251, s36, v155
 v_exp_f32 v250, v250
 v_exp_f32 v251, v251
 v_add_f32 v169, v169, v250
 v_add_f32 v169, v169, v251
 cvt v189, v250, v251
 v_mul_f32 v250, s36, v156
 v_mul_f32 v251, s36, v157
 v_exp_f32 v250, v250
 v_exp_f32 v251, v251
 v_add_f32 v169, v169, v250
 v_add_f32 v169, v169, v251
 cvt v190, v250, v251
 v_mul_f32 v250, s36, v158
 v_mul_f32 v251, s36, v159
 v_exp_f32 v250, v250
 v_exp_f32 v251, v251
 v_add_f32 v169, v169, v250
 v_add_f32 v169, v169, v251
 cvt v191, v250, v251
 s_nop 3
 s_setpc_b64 s[44:45]
.section .rodata,"a"
.p2align 6
.amdhsa_kernel concat_heads__gqa_block_cached__gqa_block_cached__near_ridge_kernel
  .amdhsa_next_free_vgpr 512
  .amdhsa_next_free_sgpr 96
  .amdhsa_accum_offset 256
  .amdhsa_group_segment_fixed_size 0
  .amdhsa_kernarg_size 104
  .amdhsa_user_sgpr_count 2
  .amdhsa_user_sgpr_kernarg_segment_ptr 1
  .amdhsa_system_sgpr_workgroup_id_x 1
  .amdhsa_float_denorm_mode_32 3
.end_amdhsa_kernel
```
